```python
import torch

def _softmax(x, axis=-1):
    return torch.softmax(x, dim=axis)
def _gelu(x):
    return torch.nn.functional.gelu(x, approximate="tanh")
def _silu(x):
    return torch.nn.functional.silu(x)
def _sigmoid(x):
    return torch.sigmoid(x)
def _layernorm(x, axis=-1, eps=1e-5):
    m = x.mean(dim=axis, keepdim=True)
    v = x.var(dim=axis, keepdim=True, unbiased=False)
    return (x - m) / torch.sqrt(v + eps)
def _scatter_add(tgt, idx, src, axis=0):
    return tgt.clone().index_add_(axis, idx, src)
def _segment_sum(src, seg, n):
    out = torch.zeros((n,) + src.shape[1:], dtype=src.dtype)
    return out.index_add_(0, seg, src)
def _pad(x, pw):
    flat = tuple(v for pair in reversed(pw) for v in pair)
    return torch.nn.functional.pad(x, flat)

kernel_name = 'standalone__deep_cross_fibinet__recsys'

def setup_inputs():

    _w = (lambda a: (lambda t: t.to(torch.bfloat16) if t.is_floating_point() else t)(torch.as_tensor(a)))
    B, F, D = 4096, 26, 64
    V = min(100000, 100000)
    Fr = max(F // 2, 1)
    H = min(F * D, 256)
    return {
        "idx": _w((lambda lo, hi, *s: torch.randint(lo, hi, s))(0, V, B, F).to(torch.int64)),
        "table": _w((lambda *s: torch.randn(*s, dtype=torch.bfloat16) * 1.6)(V, D)),
        "se_w1": _w((lambda *s: torch.randn(*s, dtype=torch.bfloat16) * 1.6)(F, Fr)),
        "se_w2": _w((lambda *s: torch.randn(*s, dtype=torch.bfloat16) * 1.6)(Fr, F)),
        "w_bi": _w((lambda *s: torch.randn(*s, dtype=torch.bfloat16) * 0.05)(D, D) * (D ** -0.5)),
        "w_cross": _w((lambda *s: torch.randn(*s, dtype=torch.bfloat16) * 0.05)(2 * F * F * D) * 0.01),
        "w_deep1": _w((lambda *s: torch.randn(*s, dtype=torch.bfloat16) * 0.8)(F * D, H) * ((F * D) ** -0.5)),
        "w_deep2": _w((lambda *s: torch.randn(*s, dtype=torch.bfloat16) * 0.05)(H) * 0.01),
    }

def reference(idx, table, se_w1, se_w2, w_bi, w_cross, w_deep1, w_deep2):
    emb = table[idx]
    B = emb.shape[0]
    z = emb.mean(axis=-1)
    a = _sigmoid(_gelu(z @ se_w1) @ se_w2)
    v = a[:, :, None] * emb
    eW = torch.einsum('bfd,de->bfe', emb, w_bi)
    vW = torch.einsum('bfd,de->bfe', v, w_bi)
    p = torch.einsum('bie,bje->bije', eW, emb).reshape(B, -1)
    q = torch.einsum('bie,bje->bije', vW, v).reshape(B, -1)
    cross_feat = torch.concatenate([p, q], axis=-1)
    logit_cross = cross_feat @ w_cross
    h = _gelu(emb.reshape(B, -1) @ w_deep1)
    logit_deep = h @ w_deep2
    return logit_cross + logit_deep
```

```asm
; @launch grid=(256,1,1) block=(512,1,1) lds=163840
.amdgcn_target "amdgcn-amd-amdhsa--gfx950"
.text
.globl standalone__deep_cross_fibinet__recsys_kernel
.p2align 8
.type standalone__deep_cross_fibinet__recsys_kernel,@function
standalone__deep_cross_fibinet__recsys_kernel:
    s_cmp_ge_u32 s2, 256
    s_cbranch_scc1 L_end
    v_lshrrev_b32 v242, 6, v0
    s_load_dwordx4 s[4:7], s[0:1], 0
    s_load_dwordx4 s[12:15], s[0:1], 40
    v_readfirstlane_b32 s86, v242
    s_load_dwordx4 s[20:23], s[0:1], 64
    s_load_dwordx2 s[24:25], s[0:1], 80
    s_getpc_b64 s[92:93]
    s_bfe_u32 s88, s2, 0x20003
    s_lshl_b32 s91, s86, 2
    s_lshr_b32 s91, 0x77773244, s91
    s_and_b32 s91, s91, 15
    s_lshl_b32 s91, s91, 3
    s_load_dwordx2 s[44:45], s[0:1], s91
    s_mul_i32 s91, s88, 5120
    v_lshl_add_u32 v240, v0, 7, s91
    v_min_u32 v240, 20376, v240
    v_mov_b32 v241, s93
    v_add_co_u32 v240, vcc, s92, v240
    v_and_b32 v1, 63, v0
    s_lshl_b32 s89, s86, 10
    v_addc_co_u32 v241, vcc, 0, v241, vcc
    v_cmp_gt_u32 vcc, 40, v0
    v_lshlrev_b32 v246, 4, v1
    s_and_saveexec_b64 s[92:93], vcc
    s_cbranch_execz L_cpf
    global_load_dword v243, v[240:241], off
L_cpf:
    s_mov_b64 exec, -1
    s_lshr_b32 s91, s2, 5
    s_lshl_b32 s91, s91, 3
    s_and_b32 s92, s2, 7
    s_add_u32 s87, s91, s92
    s_lshl_b32 s91, s87, 3
    s_add_u32 s91, s91, s86
    s_mul_i32 s90, s91, 832
    s_mov_b32 s30, 425984
    s_mov_b32 s31, 0x00020000
    s_add_u32 m0, s89, 147456
    s_lshl_b32 s91, s88, 3
    s_lshr_b32 s91, 2496875776, s91
    s_bfe_u32 s27, s91, 0x10007
    s_bitcmp1_b32 s91, 6
    s_cselect_b32 s96, -1, 1
    s_cselect_b32 s3, 100, 4
    s_cselect_b32 s92, 52, 0
    s_and_b32 s91, s91, 31
    s_add_u32 s97, s91, s92
    s_lshl_b32 s60, s91, 2
    s_add_u32 s61, s60, s3
    s_sub_u32 s93, s61, 104
    v_and_b32 v245, 7, v1
    s_min_u32 s61, s61, s93
    v_lshrrev_b32 v247, 2, v1
    s_add_u32 s62, s61, s3
    s_sub_u32 s93, s62, 104
    v_and_b32 v247, 4, v247
    s_min_u32 s62, s62, s93
    v_xor_b32 v247, v247, v245
    s_add_u32 s63, s62, s3
    s_sub_u32 s93, s63, 104
    v_lshrrev_b32 v248, 3, v0
    s_min_u32 s63, s63, s93
    v_lshlrev_b32 v248, 9, v248
    s_add_u32 s64, s63, s3
    v_lshl_add_u32 v247, v247, 4, v248
    s_sub_u32 s93, s64, 104
    s_min_u32 s64, s64, s93
    v_mov_b32 v248, s88
    s_add_u32 s65, s64, s3
    v_lshl_add_u32 v10, v248, 7, v247
    s_sub_u32 s93, s65, 104
    s_min_u32 s65, s65, s93
    v_bfe_u32 v247, v0, 4, 3
    s_add_u32 s66, s65, s3
    v_xor_b32 v247, v247, v245
    s_sub_u32 s93, s66, 104
    s_min_u32 s66, s66, s93
    v_lshlrev_b32 v11, 4, v247
    s_add_u32 s67, s66, s3
    v_min_u32 v249, 25, v1
    s_sub_u32 s93, s67, 104
    v_mad_u32_u24 v249, v242, 26, v249
    s_min_u32 s67, s67, s93
    s_mov_b32 s34, 12800000
    v_lshlrev_b32 v249, 9, v249
    s_mov_b32 s35, 0x00020000
    v_lshl_add_u32 v249, v248, 7, v249
    s_mov_b32 s38, 173056
    s_mov_b32 s39, 0x00020000
    v_min_u32 v250, 5, v1
    s_mov_b32 s42, 851968
    v_mad_u32_u24 v250, v242, 6, v250
    s_mov_b32 s43, 0x00020000
    v_lshlrev_b32 v250, 7, v250
    s_waitcnt lgkmcnt(0)
    s_mov_b32 s28, s4
    s_and_b32 s29, s5, 0xffff
    buffer_load_dwordx4 v246, s[28:31], s90 offen lds
    s_mov_b32 s36, s12
    s_and_b32 s37, s13, 0xffff
    s_mov_b32 s40, s14
    s_and_b32 s41, s15, 0xffff
    s_cmp_eq_u32 s27, 1
    s_cbranch_scc1 L_proB
    s_and_b32 s45, s45, 0xffff
    s_mov_b32 s47, 0x00020000
    s_lshl_b32 s91, s88, 7
    s_movk_i32 s46, 676
    s_cmp_ge_u32 s86, 4
    s_cselect_b32 s46, 512, s46
    s_cselect_b32 s91, s91, 0
    s_lshl_b32 s92, s86, 12
    s_lshl_b32 s93, s88, 5
    s_add_u32 s92, s92, s93
    v_and_b32 v248, 16, v246
    v_lshrrev_b32 v247, 1, v1
    s_cmp_lt_u32 s86, 2
    s_cselect_b32 s46, 8192, s46
    s_cselect_b32 s91, s92, s91
    s_cselect_b32 s92, 7, 5
    s_add_u32 m0, s89, 131072
    v_lshl_add_u32 v247, v247, s92, v248
    buffer_load_dwordx4 v247, s[44:47], s91 offen lds
    s_add_u32 m0, s89, 65536
    s_lshl_b32 s91, s60, 13
    buffer_load_dwordx4 v10, s[40:43], s91 offen lds
    s_add_u32 m0, s89, 73728
    s_lshl_b32 s91, s61, 13
    buffer_load_dwordx4 v10, s[40:43], s91 offen lds
    s_lshr_b32 s91, s2, 3
    s_mul_i32 s91, s91, 5504
    buffer_load_dword v243, v250, s[36:39], s91 offen
    s_lshr_b32 s91, s2, 5
    s_mul_i32 s91, s91, 106496
    buffer_load_dword v243, v249, s[40:43], s91 offen
    s_mov_b32 s32, s6
    s_and_b32 s33, s7, 0xffff
    v_lshrrev_b32 v244, 3, v1
    s_add_u32 s91, s89, 147456
    v_mul_u32_u24 v12, 104, v244
    v_add_u32 v12, s91, v12
    v_add_u32 v44, s60, v12
    v_add_u32 v45, s61, v12
    v_add_u32 v46, s62, v12
    v_add_u32 v47, s63, v12
    v_add_u32 v48, s64, v12
    v_add_u32 v49, s65, v12
    v_add_u32 v50, s66, v12
    v_add_u32 v51, s67, v12
    s_waitcnt vmcnt(5)
    ds_read_b32 v44, v44
    ds_read_b32 v45, v45
    ds_read_b32 v46, v46
    ds_read_b32 v47, v47
    ds_read_b32 v48, v48
    ds_read_b32 v49, v49
    ds_read_b32 v50, v50
    ds_read_b32 v51, v51
    s_add_u32 m0, s89, 0
    s_waitcnt lgkmcnt(7)
    v_lshl_add_u32 v44, v44, 7, v11
    buffer_load_dwordx4 v44, s[32:35], 0 offen lds
    s_add_u32 m0, s89, 8192
    s_waitcnt lgkmcnt(6)
    v_lshl_add_u32 v45, v45, 7, v11
    buffer_load_dwordx4 v45, s[32:35], 0 offen lds
    s_add_u32 m0, s89, 16384
    s_waitcnt lgkmcnt(5)
    v_lshl_add_u32 v46, v46, 7, v11
    buffer_load_dwordx4 v46, s[32:35], 0 offen lds
    s_add_u32 m0, s89, 24576
    s_waitcnt lgkmcnt(4)
    v_lshl_add_u32 v47, v47, 7, v11
    buffer_load_dwordx4 v47, s[32:35], 0 offen lds
    s_add_u32 m0, s89, 32768
    s_waitcnt lgkmcnt(3)
    v_lshl_add_u32 v48, v48, 7, v11
    buffer_load_dwordx4 v48, s[32:35], 0 offen lds
    s_add_u32 m0, s89, 40960
    s_waitcnt lgkmcnt(2)
    v_lshl_add_u32 v49, v49, 7, v11
    buffer_load_dwordx4 v49, s[32:35], 0 offen lds
    s_add_u32 m0, s89, 49152
    s_waitcnt lgkmcnt(1)
    v_lshl_add_u32 v50, v50, 7, v11
    buffer_load_dwordx4 v50, s[32:35], 0 offen lds
    s_add_u32 m0, s89, 57344
    s_waitcnt lgkmcnt(0)
    v_lshl_add_u32 v51, v51, 7, v11
    buffer_load_dwordx4 v51, s[32:35], 0 offen lds
    s_mov_b32 s48, s20
    s_and_b32 s49, s21, 0xffff
    s_mov_b32 s50, 8192
    s_mov_b32 s51, 0x00020000
    s_mov_b32 s52, s22
    s_and_b32 s53, s23, 0xffff
    s_mov_b32 s54, 256
    s_mov_b32 s55, 0x00020000
    s_mov_b32 s56, s24
    s_and_b32 s57, s25, 0xffff
    s_mov_b32 s58, 268435456
    s_mov_b32 s59, 0x00020000
    s_lshl_b32 s91, s88, 3
    s_add_u32 s91, s91, s86
    s_cmp_lg_u32 s91, 23
    s_cbranch_scc1 L_z1
    v_mov_b32 v76, 0
    v_mov_b32 v77, 0
    v_mov_b32 v78, 0
    v_mov_b32 v79, 0
    s_lshl_b32 s91, s87, 10
    buffer_store_dwordx4 v[76:79], v246, s[56:59], s91 offen sc0 sc1
L_z1:
    v_and_b32 v247, 5, v0
    v_cmp_eq_u32 s[92:93], 0, v247
    v_mov_b32 v247, 0x3c80
    v_lshlrev_b32 v248, 2, v0
    v_cndmask_b32 v247, 0, v247, s[92:93]
    v_add_u32 v248, 139264, v248
    ds_write_b32 v248, v247
    s_waitcnt vmcnt(8)
    s_mul_i32 s28, s86, s96
    s_add_u32 s28, s28, s97
    v_lshrrev_b32 v240, 4, v1
    s_sub_u32 s93, s28, 26
    s_min_u32 s28, s28, s93
    s_sub_u32 s93, s28, 26
    s_min_u32 s28, s28, s93
    v_bfe_u32 v241, v1, 1, 2
    s_mul_i32 s28, s28, 3328
    v_lshl_add_u32 v241, v240, 2, v241
    s_cmp_eq_u32 s96, 1
    s_cselect_b32 s92, 8, 18
    s_mul_i32 s92, s92, 3328
    v_bfe_u32 v242, v1, 3, 1
    v_lshl_add_u32 v242, v241, 1, v242
    s_add_u32 s29, s28, s92
    s_sub_u32 s93, s29, 86528
    s_min_u32 s29, s29, s93
    s_add_u32 s30, s29, s92
    s_sub_u32 s93, s30, 86528
    s_min_u32 s30, s30, s93
    v_mul_i32_i24 v243, s96, v242
    v_add_u32 v243, s97, v243
    v_subrev_u32 v244, 26, v243
    v_min_u32 v243, v243, v244
    v_subrev_u32 v244, 26, v243
    v_min_u32 v243, v243, v244
    s_and_b32 s92, s86, 1
    s_add_u32 s92, s92, 24
    s_mul_i32 s31, s92, s96
    s_add_u32 s31, s31, s97
    v_xor_b32 v240, v240, v1
    s_sub_u32 s93, s31, 26
    s_min_u32 s31, s31, s93
    s_sub_u32 s93, s31, 26
    s_min_u32 s31, s31, s93
    v_and_b32 v240, 1, v240
    s_and_b32 s92, s86, 2
    s_mul_i32 s92, s92, 13
    s_add_u32 s31, s31, s92
    s_lshl_b32 s92, s88, 5
    v_lshl_add_u32 v240, v240, 4, s92
    s_mul_i32 s31, s31, 3328
    v_lshl_add_u32 v240, v243, 7, v240
    v_add_u32 v241, 3, v241
    v_lshrrev_b32 v241, 4, v241
    v_lshl_add_u32 v13, v241, 30, v240
    s_add_u32 s68, s67, s3
    s_sub_u32 s93, s68, 104
    s_min_u32 s68, s68, s93
    s_add_u32 s69, s68, s3
    s_sub_u32 s93, s69, 104
    s_min_u32 s69, s69, s93
    s_add_u32 s70, s69, s3
    s_sub_u32 s93, s70, 104
    s_min_u32 s70, s70, s93
    s_add_u32 s71, s70, s3
    s_sub_u32 s93, s71, 104
    s_min_u32 s71, s71, s93
    s_add_u32 s72, s71, s3
    s_sub_u32 s93, s72, 104
    s_min_u32 s72, s72, s93
    s_add_u32 s73, s72, s3
    s_sub_u32 s93, s73, 104
    s_min_u32 s73, s73, s93
    s_add_u32 s74, s73, s3
    s_sub_u32 s93, s74, 104
    s_min_u32 s74, s74, s93
    s_add_u32 s75, s74, s3
    s_sub_u32 s93, s75, 104
    s_min_u32 s75, s75, s93
    s_add_u32 s76, s75, s3
    s_sub_u32 s93, s76, 104
    s_min_u32 s76, s76, s93
    s_add_u32 s77, s76, s3
    s_sub_u32 s93, s77, 104
    s_min_u32 s77, s77, s93
    s_add_u32 s78, s77, s3
    s_sub_u32 s93, s78, 104
    s_min_u32 s78, s78, s93
    s_add_u32 s79, s78, s3
    s_sub_u32 s93, s79, 104
    s_min_u32 s79, s79, s93
    s_add_u32 s80, s79, s3
    s_sub_u32 s93, s80, 104
    s_min_u32 s80, s80, s93
    s_add_u32 s81, s80, s3
    s_sub_u32 s93, s81, 104
    s_min_u32 s81, s81, s93
    s_add_u32 s82, s81, s3
    s_sub_u32 s93, s82, 104
    s_min_u32 s82, s82, s93
    s_add_u32 s83, s82, s3
    s_sub_u32 s93, s83, 104
    s_min_u32 s83, s83, s93
    s_add_u32 s84, s83, s3
    s_sub_u32 s93, s84, 104
    s_min_u32 s84, s84, s93
    s_add_u32 s85, s84, s3
    s_sub_u32 s93, s85, 104
    s_min_u32 s85, s85, s93
    s_mov_b32 s94, 0x05040100
    s_mov_b32 s95, 0x07060302
    s_lshr_b32 s91, s86, 1
    s_lshr_b32 s92, s86, 2
    s_add_u32 s90, s91, s92
    s_and_b32 s90, s90, 1
    v_and_b32 v100, 31, v1
    v_lshrrev_b32 v101, 5, v1
    v_bfe_u32 v102, v1, 1, 3
    s_and_b32 s91, s86, 1
    s_lshl_b32 s91, s91, 5
    v_add_u32 v103, s91, v100
    s_lshl_b32 s92, s92, 13
    v_lshl_add_u32 v104, v103, 7, s92
    v_xor_b32 v105, v101, v102
    v_lshl_add_u32 v2, v105, 4, v104
    v_xor_b32 v3, 32, v2
    v_xor_b32 v4, 64, v2
    v_xor_b32 v5, 96, v2
    v_bfe_u32 v104, v1, 2, 2
    v_lshl_add_u32 v105, v101, 3, v104
    s_add_u32 s92, s92, 65536
    v_lshl_add_u32 v105, v105, 7, s92
    v_bfe_u32 v106, v1, 4, 1
    s_lshr_b32 s91, s86, 2
    v_xor_b32 v106, s91, v106
    v_bfe_u32 v107, v1, 1, 1
    v_lshl_add_u32 v106, v106, 1, v107
    s_and_b32 s91, s86, 2
    s_lshl_b32 s91, s91, 1
    v_or_b32 v106, s91, v106
    v_lshrrev_b32 v107, 1, v1
    v_and_b32 v107, 4, v107
    v_xor_b32 v106, v106, v107
    v_lshl_add_u32 v105, v106, 4, v105
    v_and_b32 v107, 1, v1
    v_lshl_add_u32 v6, v107, 3, v105
    s_lshl_b32 s91, s88, 1
    s_lshr_b32 s92, s86, 2
    s_add_u32 s91, s91, s92
    v_xor_b32 v104, s91, v102
    v_lshlrev_b32 v105, 13, v101
    v_lshl_add_u32 v105, v103, 7, v105
    v_lshl_add_u32 v105, v104, 4, v105
    s_and_b32 s91, s86, 2
    s_lshl_b32 s91, s91, 2
    v_add_u32 v7, s91, v105
    v_bfe_u32 v104, v1, 3, 1
    v_xor_b32 v104, s92, v104
    v_lshl_add_u32 v105, v1, 5, s91
    v_lshl_add_u32 v26, v104, 4, v105
    s_lshl_b32 s91, s90, 13
    s_lshl_b32 s92, s92, 7
    s_add_u32 s91, s91, s92
    s_and_b32 s92, s86, 1
    s_lshl_b32 s92, s92, 8
    s_add_u32 s91, s91, s92
    s_add_u32 s91, s91, 131072
    v_lshl_add_u32 v104, v101, 11, s91
    v_lshl_add_u32 v8, v100, 2, v104
    s_lshr_b32 s91, s86, 1
    s_lshl_b32 s91, s91, 11
    s_add_u32 s91, s91, s92
    s_add_u32 s91, s91, 131072
    v_lshl_add_u32 v9, v1, 2, s91
    s_lshl_b32 s91, s90, 1
    s_lshr_b32 s92, s86, 2
    s_add_u32 s91, s91, s92
    s_lshl_b32 s91, s91, 10
    s_add_u32 s91, s91, 155648
    v_lshl_add_u32 v14, v103, 4, s91
    v_mov_b32 v142, 0xbdd2d3e8
    v_mov_b32 v143, 0xc0135761
    v_mov_b32 v151, 0
    v_mov_b32 v159, 0
    v_mov_b32 v167, 0
    v_mov_b32 v175, 0
    ds_write_b32 v14, v151 offset:12
    s_waitcnt lgkmcnt(0)
    s_barrier
    v_lshrrev_b32 v240, 5, v1
    v_and_b32 v241, 15, v1
    v_lshlrev_b32 v242, 3, v241
    v_lshl_add_u32 v242, v240, 8, v242
    v_and_b32 v240, 16, v1
    v_lshl_add_u32 v242, v240, 9, v242
    v_add_u32 v242, 131072, v242
    ds_read_b64_tr_b16 v[100:101], v242 offset:0
    ds_read_b64_tr_b16 v[102:103], v242 offset:128
    ds_read_b64_tr_b16 v[104:105], v242 offset:512
    ds_read_b64_tr_b16 v[106:107], v242 offset:640
    ds_read_b64_tr_b16 v[108:109], v242 offset:1024
    ds_read_b64_tr_b16 v[110:111], v242 offset:1152
    ds_read_b64_tr_b16 v[112:113], v242 offset:1536
    ds_read_b64_tr_b16 v[114:115], v242 offset:1664
    v_lshlrev_b32 v247, 1, v1
    v_add_u32 v247, 135168, v247
    ds_read_u16 v248, v247
    v_lshrrev_b32 v243, 4, v1
    s_lshr_b32 s91, s86, 2
    v_min_u32 v241, 12, v241
    v_lshl_add_u32 v244, v241, 1, s91
    v_mul_i32_i24 v245, s96, v244
    v_add_u32 v245, s97, v245
    v_subrev_u32 v246, 26, v245
    v_min_u32 v245, v245, v246
    v_subrev_u32 v246, 26, v245
    v_min_u32 v245, v245, v246
    v_mul_u32_u24 v246, 208, v243
    v_lshl_add_u32 v245, v245, 1, v246
    v_add_u32 v245, 134144, v245
    ds_read_u16 v92, v245 offset:0
    ds_read_u16 v93, v245 offset:52
    ds_read_u16 v94, v245 offset:104
    ds_read_u16 v95, v245 offset:156
    v_mul_i32_i24 v245, s96, v243
    v_add_u32 v245, s97, v245
    v_subrev_u32 v246, 26, v245
    v_min_u32 v245, v245, v246
    v_subrev_u32 v246, 26, v245
    v_min_u32 v245, v245, v246
    v_lshlrev_b32 v241, 1, v241
    v_mad_u32_u24 v245, v245, 26, v241
    s_cmp_eq_u32 s96, 1
    s_cselect_b32 s91, 4, 22
    s_mul_i32 s91, s91, 26
    s_waitcnt lgkmcnt(4)
    v_lshlrev_b32 v248, 16, v248
    v_lshlrev_b32 v247, 2, v1
    v_add_u32 v247, 159744, v247
    ds_write_b32 v247, v248
    v_add_u32 v249, 133120, v245
    ds_read_u16 v84, v249
    v_add_u32 v245, s91, v245
    v_subrev_u32 v246, 676, v245
    v_min_u32 v245, v245, v246
    v_add_u32 v250, 133120, v245
    ds_read_u16 v85, v250
    v_add_u32 v245, s91, v245
    v_subrev_u32 v246, 676, v245
    v_min_u32 v245, v245, v246
    v_add_u32 v249, 133120, v245
    ds_read_u16 v86, v249
    v_add_u32 v245, s91, v245
    v_subrev_u32 v246, 676, v245
    v_min_u32 v245, v245, v246
    v_add_u32 v250, 133120, v245
    ds_read_u16 v87, v250
    v_add_u32 v245, s91, v245
    v_subrev_u32 v246, 676, v245
    v_min_u32 v245, v245, v246
    v_add_u32 v249, 133120, v245
    ds_read_u16 v88, v249
    v_add_u32 v245, s91, v245
    v_subrev_u32 v246, 676, v245
    v_min_u32 v245, v245, v246
    v_add_u32 v250, 133120, v245
    ds_read_u16 v89, v250
    v_add_u32 v245, s91, v245
    v_subrev_u32 v246, 676, v245
    v_min_u32 v245, v245, v246
    v_add_u32 v249, 133120, v245
    ds_read_u16 v23, v249
    s_waitcnt lgkmcnt(8)
    v_lshl_or_b32 v24, v93, 16, v92
    v_lshl_or_b32 v25, v95, 16, v94
    s_waitcnt lgkmcnt(0)
    v_lshl_or_b32 v20, v85, 16, v84
    v_lshl_or_b32 v21, v87, 16, v86
    v_lshl_or_b32 v22, v89, 16, v88
    s_branch L_loop
L_proB:
    s_lshr_b32 s91, s2, 3
    s_mul_i32 s91, s91, 5504
    buffer_load_dword v243, v250, s[36:39], s91 offen
    s_and_b32 s45, s45, 0xffff
    s_mov_b32 s47, 0x00020000
    s_lshl_b32 s91, s88, 7
    s_movk_i32 s46, 676
    s_cmp_ge_u32 s86, 4
    s_cselect_b32 s46, 512, s46
    s_cselect_b32 s91, s91, 0
    s_lshl_b32 s92, s86, 12
    s_lshl_b32 s93, s88, 5
    s_add_u32 s92, s92, s93
    v_and_b32 v248, 16, v246
    v_lshrrev_b32 v247, 1, v1
    s_cmp_lt_u32 s86, 2
    s_cselect_b32 s46, 8192, s46
    s_cselect_b32 s91, s92, s91
    s_cselect_b32 s92, 7, 5
    s_add_u32 m0, s89, 131072
    v_lshl_add_u32 v247, v247, s92, v248
    buffer_load_dwordx4 v247, s[44:47], s91 offen lds
    s_mul_i32 s28, s86, s96
    s_add_u32 s28, s28, s97
    v_lshrrev_b32 v251, 4, v1
    s_sub_u32 s93, s28, 26
    s_min_u32 s28, s28, s93
    s_sub_u32 s93, s28, 26
    s_min_u32 s28, s28, s93
    v_bfe_u32 v252, v1, 1, 2
    s_mul_i32 s28, s28, 3328
    v_lshl_add_u32 v252, v251, 2, v252
    s_cmp_eq_u32 s96, 1
    s_cselect_b32 s92, 8, 18
    s_mul_i32 s92, s92, 3328
    v_bfe_u32 v253, v1, 3, 1
    v_lshl_add_u32 v253, v252, 1, v253
    s_add_u32 s29, s28, s92
    s_sub_u32 s93, s29, 86528
    s_min_u32 s29, s29, s93
    s_add_u32 s30, s29, s92
    s_sub_u32 s93, s30, 86528
    s_min_u32 s30, s30, s93
    v_mul_i32_i24 v254, s96, v253
    v_add_u32 v254, s97, v254
    v_subrev_u32 v255, 26, v254
    v_min_u32 v254, v254, v255
    v_subrev_u32 v255, 26, v254
    v_min_u32 v254, v254, v255
    s_and_b32 s92, s86, 1
    s_add_u32 s92, s92, 24
    s_mul_i32 s31, s92, s96
    s_add_u32 s31, s31, s97
    v_xor_b32 v251, v251, v1
    s_sub_u32 s93, s31, 26
    s_min_u32 s31, s31, s93
    s_sub_u32 s93, s31, 26
    s_min_u32 s31, s31, s93
    v_and_b32 v251, 1, v251
    s_and_b32 s92, s86, 2
    s_mul_i32 s92, s92, 13
    s_add_u32 s31, s31, s92
    s_lshl_b32 s92, s88, 5
    v_lshl_add_u32 v251, v251, 4, s92
    s_mul_i32 s31, s31, 3328
    v_lshl_add_u32 v251, v254, 7, v251
    v_add_u32 v252, 3, v252
    v_lshrrev_b32 v252, 4, v252
    v_lshl_add_u32 v13, v252, 30, v251
    s_add_u32 m0, s89, 0
    s_nop 0
    buffer_load_dwordx4 v13, s[36:39], s28 offen lds
    s_add_u32 m0, s89, 8192
    s_nop 0
    buffer_load_dwordx4 v13, s[36:39], s29 offen lds
    s_add_u32 m0, s89, 26624
    s_add_u32 s91, s28, 86528
    buffer_load_dwordx4 v13, s[36:39], s91 offen lds
    s_add_u32 m0, s89, 34816
    s_add_u32 s91, s29, 86528
    buffer_load_dwordx4 v13, s[36:39], s91 offen lds
    s_add_u32 m0, s89, 16384
    s_nop 0
    buffer_load_dwordx4 v13, s[36:39], s30 offen lds
    s_add_u32 m0, s89, 43008
    s_add_u32 s91, s30, 86528
    buffer_load_dwordx4 v13, s[36:39], s91 offen lds
    s_cmp_ge_u32 s86, 4
    s_cbranch_scc1 L_wc2
    s_cmp_ge_u32 s86, 2
    s_mov_b32 s93, 24576
    s_cselect_b32 s93, 49152, s93
    s_add_u32 m0, s89, s93
    s_nop 0
    buffer_load_dwordx4 v13, s[36:39], s31 offen lds
L_wc2:
    s_mov_b32 s48, s20
    s_and_b32 s49, s21, 0xffff
    s_mov_b32 s50, 8192
    s_mov_b32 s51, 0x00020000
    s_mov_b32 s52, s22
    s_and_b32 s53, s23, 0xffff
    s_mov_b32 s54, 256
    s_mov_b32 s55, 0x00020000
    s_mov_b32 s56, s24
    s_and_b32 s57, s25, 0xffff
    s_mov_b32 s58, 268435456
    s_mov_b32 s59, 0x00020000
    s_lshl_b32 s91, s88, 3
    s_add_u32 s91, s91, s86
    s_cmp_lg_u32 s91, 23
    s_cbranch_scc1 L_z3
    v_mov_b32 v76, 0
    v_mov_b32 v77, 0
    v_mov_b32 v78, 0
    v_mov_b32 v79, 0
    s_lshl_b32 s91, s87, 10
    buffer_store_dwordx4 v[76:79], v246, s[56:59], s91 offen sc0 sc1
L_z3:
    v_and_b32 v247, 5, v0
    v_cmp_eq_u32 s[92:93], 0, v247
    v_mov_b32 v247, 0x3c80
    v_lshlrev_b32 v248, 2, v0
    v_cndmask_b32 v247, 0, v247, s[92:93]
    v_add_u32 v248, 139264, v248
    ds_write_b32 v248, v247
    s_barrier
    s_lshr_b32 s91, s2, 5
    s_mul_i32 s91, s91, 106496
    buffer_load_dword v243, v249, s[40:43], s91 offen
    s_add_u32 m0, s89, 65536
    s_lshl_b32 s91, s60, 13
    buffer_load_dwordx4 v10, s[40:43], s91 offen lds
    s_add_u32 m0, s89, 73728
    s_lshl_b32 s91, s61, 13
    buffer_load_dwordx4 v10, s[40:43], s91 offen lds
    s_add_u32 m0, s89, 81920
    s_lshl_b32 s91, s62, 13
    buffer_load_dwordx4 v10, s[40:43], s91 offen lds
    s_add_u32 m0, s89, 90112
    s_lshl_b32 s91, s63, 13
    buffer_load_dwordx4 v10, s[40:43], s91 offen lds
    s_add_u32 m0, s89, 98304
    s_lshl_b32 s91, s64, 13
    buffer_load_dwordx4 v10, s[40:43], s91 offen lds
    s_add_u32 m0, s89, 106496
    s_lshl_b32 s91, s65, 13
    buffer_load_dwordx4 v10, s[40:43], s91 offen lds
    s_add_u32 m0, s89, 114688
    s_lshl_b32 s91, s66, 13
    buffer_load_dwordx4 v10, s[40:43], s91 offen lds
    s_add_u32 m0, s89, 122880
    s_lshl_b32 s91, s67, 13
    buffer_load_dwordx4 v10, s[40:43], s91 offen lds
    s_mov_b32 s32, s6
    s_and_b32 s33, s7, 0xffff
    v_lshrrev_b32 v244, 3, v1
    s_add_u32 s91, s89, 147456
    v_mul_u32_u24 v12, 104, v244
    v_add_u32 v12, s91, v12
    s_add_u32 s68, s67, s3
    s_sub_u32 s93, s68, 104
    s_min_u32 s68, s68, s93
    s_add_u32 s69, s68, s3
    s_sub_u32 s93, s69, 104
    s_min_u32 s69, s69, s93
    s_add_u32 s70, s69, s3
    s_sub_u32 s93, s70, 104
    s_min_u32 s70, s70, s93
    s_add_u32 s71, s70, s3
    s_sub_u32 s93, s71, 104
    s_min_u32 s71, s71, s93
    s_add_u32 s72, s71, s3
    s_sub_u32 s93, s72, 104
    s_min_u32 s72, s72, s93
    s_add_u32 s73, s72, s3
    s_sub_u32 s93, s73, 104
    s_min_u32 s73, s73, s93
    s_add_u32 s74, s73, s3
    s_sub_u32 s93, s74, 104
    s_min_u32 s74, s74, s93
    s_add_u32 s75, s74, s3
    s_sub_u32 s93, s75, 104
    s_min_u32 s75, s75, s93
    s_add_u32 s76, s75, s3
    s_sub_u32 s93, s76, 104
    s_min_u32 s76, s76, s93
    s_add_u32 s77, s76, s3
    s_sub_u32 s93, s77, 104
    s_min_u32 s77, s77, s93
    s_add_u32 s78, s77, s3
    s_sub_u32 s93, s78, 104
    s_min_u32 s78, s78, s93
    s_add_u32 s79, s78, s3
    s_sub_u32 s93, s79, 104
    s_min_u32 s79, s79, s93
    s_add_u32 s80, s79, s3
    s_sub_u32 s93, s80, 104
    s_min_u32 s80, s80, s93
    s_add_u32 s81, s80, s3
    s_sub_u32 s93, s81, 104
    s_min_u32 s81, s81, s93
    s_add_u32 s82, s81, s3
    s_sub_u32 s93, s82, 104
    s_min_u32 s82, s82, s93
    s_add_u32 s83, s82, s3
    s_sub_u32 s93, s83, 104
    s_min_u32 s83, s83, s93
    s_add_u32 s84, s83, s3
    s_sub_u32 s93, s84, 104
    s_min_u32 s84, s84, s93
    s_add_u32 s85, s84, s3
    s_sub_u32 s93, s85, 104
    s_min_u32 s85, s85, s93
    s_mov_b32 s94, 0x05040100
    s_mov_b32 s95, 0x07060302
    s_lshr_b32 s91, s86, 1
    s_lshr_b32 s92, s86, 2
    s_add_u32 s90, s91, s92
    s_and_b32 s90, s90, 1
    v_and_b32 v100, 31, v1
    v_lshrrev_b32 v101, 5, v1
    v_bfe_u32 v102, v1, 1, 3
    s_and_b32 s91, s86, 1
    s_lshl_b32 s91, s91, 5
    v_add_u32 v103, s91, v100
    s_lshl_b32 s92, s92, 13
    v_lshl_add_u32 v104, v103, 7, s92
    v_xor_b32 v105, v101, v102
    v_lshl_add_u32 v2, v105, 4, v104
    v_xor_b32 v3, 32, v2
    v_xor_b32 v4, 64, v2
    v_xor_b32 v5, 96, v2
    v_bfe_u32 v104, v1, 2, 2
    v_lshl_add_u32 v105, v101, 3, v104
    s_add_u32 s92, s92, 65536
    v_lshl_add_u32 v105, v105, 7, s92
    v_bfe_u32 v106, v1, 4, 1
    s_lshr_b32 s91, s86, 2
    v_xor_b32 v106, s91, v106
    v_bfe_u32 v107, v1, 1, 1
    v_lshl_add_u32 v106, v106, 1, v107
    s_and_b32 s91, s86, 2
    s_lshl_b32 s91, s91, 1
    v_or_b32 v106, s91, v106
    v_lshrrev_b32 v107, 1, v1
    v_and_b32 v107, 4, v107
    v_xor_b32 v106, v106, v107
    v_lshl_add_u32 v105, v106, 4, v105
    v_and_b32 v107, 1, v1
    v_lshl_add_u32 v6, v107, 3, v105
    s_lshl_b32 s91, s88, 1
    s_lshr_b32 s92, s86, 2
    s_add_u32 s91, s91, s92
    v_xor_b32 v104, s91, v102
    v_lshlrev_b32 v105, 13, v101
    v_lshl_add_u32 v105, v103, 7, v105
    v_lshl_add_u32 v105, v104, 4, v105
    s_and_b32 s91, s86, 2
    s_lshl_b32 s91, s91, 2
    v_add_u32 v7, s91, v105
    v_bfe_u32 v104, v1, 3, 1
    v_xor_b32 v104, s92, v104
    v_lshl_add_u32 v105, v1, 5, s91
    v_lshl_add_u32 v26, v104, 4, v105
    s_lshl_b32 s91, s90, 13
    s_lshl_b32 s92, s92, 7
    s_add_u32 s91, s91, s92
    s_and_b32 s92, s86, 1
    s_lshl_b32 s92, s92, 8
    s_add_u32 s91, s91, s92
    s_add_u32 s91, s91, 131072
    v_lshl_add_u32 v104, v101, 11, s91
    v_lshl_add_u32 v8, v100, 2, v104
    s_lshr_b32 s91, s86, 1
    s_lshl_b32 s91, s91, 11
    s_add_u32 s91, s91, s92
    s_add_u32 s91, s91, 131072
    v_lshl_add_u32 v9, v1, 2, s91
    s_lshl_b32 s91, s90, 1
    s_lshr_b32 s92, s86, 2
    s_add_u32 s91, s91, s92
    s_lshl_b32 s91, s91, 10
    s_add_u32 s91, s91, 155648
    v_lshl_add_u32 v14, v103, 4, s91
    v_mov_b32 v142, 0xbdd2d3e8
    v_mov_b32 v143, 0xc0135761
    v_mov_b32 v151, 0
    v_mov_b32 v159, 0
    v_mov_b32 v167, 0
    v_mov_b32 v175, 0
    ds_write_b32 v14, v151 offset:12
    s_waitcnt vmcnt(9)
    v_add_u32 v44, s60, v12
    ds_read_b32 v44, v44
    v_add_u32 v45, s61, v12
    ds_read_b32 v45, v45
    v_add_u32 v46, s62, v12
    ds_read_b32 v46, v46
    v_add_u32 v47, s63, v12
    ds_read_b32 v47, v47
    v_add_u32 v48, s64, v12
    ds_read_b32 v48, v48
    v_add_u32 v49, s65, v12
    ds_read_b32 v49, v49
    v_add_u32 v50, s66, v12
    ds_read_b32 v50, v50
    v_add_u32 v51, s67, v12
    ds_read_b32 v51, v51
    s_waitcnt lgkmcnt(0)
    s_barrier
    ds_read_b64 v[60:61], v26 offset:0
    ds_read_b64 v[62:63], v26 offset:4096
    ds_read_b64 v[64:65], v26 offset:8192
    ds_read_b64 v[66:67], v26 offset:12288
    ds_read_b64 v[68:69], v26 offset:16384
    ds_read_b64 v[70:71], v26 offset:20480
    ds_read_b64 v[72:73], v26 offset:24576
    ds_read_b64 v[74:75], v26 offset:2048
    ds_read_b64 v[76:77], v26 offset:6144
    ds_read_b64 v[78:79], v26 offset:10240
    ds_read_b64 v[80:81], v26 offset:14336
    ds_read_b64 v[82:83], v26 offset:18432
    ds_read_b64 v[84:85], v26 offset:22528
    v_lshl_add_u32 v44, v44, 7, v11
    v_lshl_add_u32 v45, v45, 7, v11
    v_lshl_add_u32 v46, v46, 7, v11
    v_lshl_add_u32 v47, v47, 7, v11
    v_lshl_add_u32 v48, v48, 7, v11
    v_lshl_add_u32 v49, v49, 7, v11
    v_lshl_add_u32 v50, v50, 7, v11
    v_lshl_add_u32 v51, v51, 7, v11
    v_mov_b32 v183, 0
    v_mov_b32 v215, 0
    v_mov_b32 v191, 0
    v_mov_b32 v223, 0
    v_mov_b32 v199, 0
    v_mov_b32 v231, 0
    v_mov_b32 v207, 0
    v_mov_b32 v239, 0
    s_waitcnt lgkmcnt(6)
    ds_read_b64 v[116:117], v26 offset:26624
    ds_read_b64 v[118:119], v26 offset:30720
    ds_read_b64 v[120:121], v26 offset:34816
    ds_read_b64 v[122:123], v26 offset:38912
    ds_read_b64 v[124:125], v26 offset:43008
    ds_read_b64 v[126:127], v26 offset:47104
    ds_read_b64 v[128:129], v26 offset:51200
    s_waitcnt lgkmcnt(7)
    ds_read_b64 v[130:131], v26 offset:28672
    ds_read_b64 v[132:133], v26 offset:32768
    ds_read_b64 v[134:135], v26 offset:36864
    ds_read_b64 v[136:137], v26 offset:40960
    ds_read_b64 v[138:139], v26 offset:45056
    ds_read_b64 v[140:141], v26 offset:49152
    s_waitcnt lgkmcnt(0)
    s_barrier
    s_add_u32 m0, s89, 0
    s_nop 0
    buffer_load_dwordx4 v44, s[32:35], 0 offen lds
    s_add_u32 m0, s89, 8192
    s_nop 0
    buffer_load_dwordx4 v45, s[32:35], 0 offen lds
    s_add_u32 m0, s89, 16384
    s_nop 0
    buffer_load_dwordx4 v46, s[32:35], 0 offen lds
    s_add_u32 m0, s89, 24576
    s_nop 0
    buffer_load_dwordx4 v47, s[32:35], 0 offen lds
    s_add_u32 m0, s89, 32768
    s_nop 0
    buffer_load_dwordx4 v48, s[32:35], 0 offen lds
    s_add_u32 m0, s89, 40960
    s_nop 0
    buffer_load_dwordx4 v49, s[32:35], 0 offen lds
    s_add_u32 m0, s89, 49152
    s_nop 0
    buffer_load_dwordx4 v50, s[32:35], 0 offen lds
    s_add_u32 m0, s89, 57344
    s_nop 0
    buffer_load_dwordx4 v51, s[32:35], 0 offen lds
    v_perm_b32 v176, v62, v60, s94
    v_perm_b32 v184, v62, v60, s95
    v_perm_b32 v192, v63, v61, s94
    v_perm_b32 v200, v63, v61, s95
    v_perm_b32 v177, v66, v64, s94
    v_perm_b32 v185, v66, v64, s95
    v_perm_b32 v193, v67, v65, s94
    v_perm_b32 v201, v67, v65, s95
    v_perm_b32 v178, v70, v68, s94
    v_perm_b32 v186, v70, v68, s95
    v_perm_b32 v194, v71, v69, s94
    v_perm_b32 v202, v71, v69, s95
    v_and_b32 v179, 0xffff, v72
    v_lshrrev_b32 v187, 16, v72
    v_and_b32 v195, 0xffff, v73
    v_lshrrev_b32 v203, 16, v73
    v_perm_b32 v180, v76, v74, s94
    v_perm_b32 v188, v76, v74, s95
    v_perm_b32 v196, v77, v75, s94
    v_perm_b32 v204, v77, v75, s95
    v_perm_b32 v181, v80, v78, s94
    v_perm_b32 v189, v80, v78, s95
    v_perm_b32 v197, v81, v79, s94
    v_perm_b32 v205, v81, v79, s95
    v_perm_b32 v182, v84, v82, s94
    v_perm_b32 v190, v84, v82, s95
    v_perm_b32 v198, v85, v83, s94
    v_perm_b32 v206, v85, v83, s95
    v_perm_b32 v208, v118, v116, s94
    v_perm_b32 v216, v118, v116, s95
    v_perm_b32 v224, v119, v117, s94
    v_perm_b32 v232, v119, v117, s95
    v_perm_b32 v209, v122, v120, s94
    v_perm_b32 v217, v122, v120, s95
    v_perm_b32 v225, v123, v121, s94
    v_perm_b32 v233, v123, v121, s95
    v_perm_b32 v210, v126, v124, s94
    v_perm_b32 v218, v126, v124, s95
    v_perm_b32 v226, v127, v125, s94
    v_perm_b32 v234, v127, v125, s95
    v_and_b32 v211, 0xffff, v128
    v_lshrrev_b32 v219, 16, v128
    v_and_b32 v227, 0xffff, v129
    v_lshrrev_b32 v235, 16, v129
    v_perm_b32 v212, v132, v130, s94
    v_perm_b32 v220, v132, v130, s95
    v_perm_b32 v228, v133, v131, s94
    v_perm_b32 v236, v133, v131, s95
    v_perm_b32 v213, v136, v134, s94
    v_perm_b32 v221, v136, v134, s95
    v_perm_b32 v229, v137, v135, s94
    v_perm_b32 v237, v137, v135, s95
    v_perm_b32 v214, v140, v138, s94
    v_perm_b32 v222, v140, v138, s95
    v_perm_b32 v230, v141, v139, s94
    v_perm_b32 v238, v141, v139, s95
    s_waitcnt vmcnt(16)
    v_lshrrev_b32 v240, 5, v1
    v_and_b32 v241, 15, v1
    v_lshlrev_b32 v242, 3, v241
    v_lshl_add_u32 v242, v240, 8, v242
    v_and_b32 v240, 16, v1
    v_lshl_add_u32 v242, v240, 9, v242
    v_add_u32 v242, 131072, v242
    ds_read_b64_tr_b16 v[100:101], v242 offset:0
    ds_read_b64_tr_b16 v[102:103], v242 offset:128
    ds_read_b64_tr_b16 v[104:105], v242 offset:512
    ds_read_b64_tr_b16 v[106:107], v242 offset:640
    ds_read_b64_tr_b16 v[108:109], v242 offset:1024
    ds_read_b64_tr_b16 v[110:111], v242 offset:1152
    ds_read_b64_tr_b16 v[112:113], v242 offset:1536
    ds_read_b64_tr_b16 v[114:115], v242 offset:1664
    v_lshlrev_b32 v247, 1, v1
    v_add_u32 v247, 135168, v247
    ds_read_u16 v248, v247
    v_lshrrev_b32 v243, 4, v1
    s_lshr_b32 s91, s86, 2
    v_min_u32 v241, 12, v241
    v_lshl_add_u32 v244, v241, 1, s91
    v_mul_i32_i24 v245, s96, v244
    v_add_u32 v245, s97, v245
    v_subrev_u32 v246, 26, v245
    v_min_u32 v245, v245, v246
    v_subrev_u32 v246, 26, v245
    v_min_u32 v245, v245, v246
    v_mul_u32_u24 v246, 208, v243
    v_lshl_add_u32 v245, v245, 1, v246
    v_add_u32 v245, 134144, v245
    ds_read_u16 v92, v245 offset:0
    ds_read_u16 v93, v245 offset:52
    ds_read_u16 v94, v245 offset:104
    ds_read_u16 v95, v245 offset:156
    v_mul_i32_i24 v245, s96, v243
    v_add_u32 v245, s97, v245
    v_subrev_u32 v246, 26, v245
    v_min_u32 v245, v245, v246
    v_subrev_u32 v246, 26, v245
    v_min_u32 v245, v245, v246
    v_lshlrev_b32 v241, 1, v241
    v_mad_u32_u24 v245, v245, 26, v241
    s_cmp_eq_u32 s96, 1
    s_cselect_b32 s91, 4, 22
    s_mul_i32 s91, s91, 26
    s_waitcnt lgkmcnt(4)
    v_lshlrev_b32 v248, 16, v248
    v_lshlrev_b32 v247, 2, v1
    v_add_u32 v247, 159744, v247
    ds_write_b32 v247, v248
    v_add_u32 v249, 133120, v245
    ds_read_u16 v84, v249
    v_add_u32 v245, s91, v245
    v_subrev_u32 v246, 676, v245
    v_min_u32 v245, v245, v246
    v_add_u32 v250, 133120, v245
    ds_read_u16 v85, v250
    v_add_u32 v245, s91, v245
    v_subrev_u32 v246, 676, v245
    v_min_u32 v245, v245, v246
    v_add_u32 v249, 133120, v245
    ds_read_u16 v86, v249
    v_add_u32 v245, s91, v245
    v_subrev_u32 v246, 676, v245
    v_min_u32 v245, v245, v246
    v_add_u32 v250, 133120, v245
    ds_read_u16 v87, v250
    v_add_u32 v245, s91, v245
    v_subrev_u32 v246, 676, v245
    v_min_u32 v245, v245, v246
    v_add_u32 v249, 133120, v245
    ds_read_u16 v88, v249
    v_add_u32 v245, s91, v245
    v_subrev_u32 v246, 676, v245
    v_min_u32 v245, v245, v246
    v_add_u32 v250, 133120, v245
    ds_read_u16 v89, v250
    v_add_u32 v245, s91, v245
    v_subrev_u32 v246, 676, v245
    v_min_u32 v245, v245, v246
    v_add_u32 v249, 133120, v245
    ds_read_u16 v23, v249
    s_waitcnt lgkmcnt(8)
    v_lshl_or_b32 v24, v93, 16, v92
    v_lshl_or_b32 v25, v95, 16, v94
    s_waitcnt lgkmcnt(0)
    v_lshl_or_b32 v20, v85, 16, v84
    v_lshl_or_b32 v21, v87, 16, v86
    v_lshl_or_b32 v22, v89, 16, v88
L_loop:
    s_lshl_b32 s91, s88, 3
    s_add_u32 s91, s91, s86
    s_cmp_lg_u32 s91, 23
    s_cbranch_scc1 L_z4
    v_mov_b32 v16, 1
    v_mov_b32 v17, 0
    s_lshl_b32 s91, s87, 2
    s_mov_b64 exec, 1
    buffer_store_dword v16, v17, s[52:55], s91 offen sc0 sc1
    s_mov_b64 exec, -1
L_z4:
    s_cmp_eq_u32 s90, 1
    s_cbranch_scc1 L_k1
    s_waitcnt vmcnt(6)
    s_barrier
    ds_read_b128 v[60:63], v2 offset:0
    ds_read_b64_tr_b16 v[44:45], v6 offset:0
    ds_read_b64_tr_b16 v[46:47], v6 offset:512
    ds_read_b64 v[116:117], v7 offset:0
    ds_read_b128 v[64:67], v3 offset:0
    ds_read_b64_tr_b16 v[48:49], v6 offset:2048
    ds_read_b64_tr_b16 v[50:51], v6 offset:2560
    ds_read_b128 v[68:71], v4 offset:0
    ds_read_b64_tr_b16 v[52:53], v6 offset:4096
    ds_read_b64_tr_b16 v[54:55], v6 offset:4608
    ds_read_b128 v[72:75], v5 offset:0
    ds_read_b64_tr_b16 v[56:57], v6 offset:6144
    ds_read_b64_tr_b16 v[58:59], v6 offset:6656
    s_cmp_eq_u32 s27, 1
    s_cbranch_scc1 L_c5
    s_add_u32 m0, s89, 81920
    s_lshl_b32 s91, s62, 13
    buffer_load_dwordx4 v10, s[40:43], s91 offen lds
    s_add_u32 m0, s89, 90112
    s_lshl_b32 s91, s63, 13
    buffer_load_dwordx4 v10, s[40:43], s91 offen lds
    s_add_u32 m0, s89, 98304
    s_lshl_b32 s91, s64, 13
    buffer_load_dwordx4 v10, s[40:43], s91 offen lds
    s_add_u32 m0, s89, 106496
    s_lshl_b32 s91, s65, 13
    buffer_load_dwordx4 v10, s[40:43], s91 offen lds
    s_add_u32 m0, s89, 114688
    s_lshl_b32 s91, s66, 13
    buffer_load_dwordx4 v10, s[40:43], s91 offen lds
    s_add_u32 m0, s89, 122880
    s_lshl_b32 s91, s67, 13
    buffer_load_dwordx4 v10, s[40:43], s91 offen lds
L_c5:
    s_waitcnt vmcnt(4)
    s_barrier
    s_waitcnt lgkmcnt(10)
    v_mfma_f32_32x32x16_bf16 v[76:91], v[100:103], v[60:63], 0
    v_mfma_f32_32x32x16_bf16 v[28:43], v[44:47], v[60:63], 0
    ds_read_b128 v[60:63], v2 offset:16384
    ds_read_b64_tr_b16 v[44:45], v6 offset:16384
    ds_read_b64_tr_b16 v[46:47], v6 offset:16896
    ds_read_b64 v[118:119], v7 offset:16384
    s_waitcnt lgkmcnt(10)
    v_mfma_f32_32x32x16_bf16 v[76:91], v[104:107], v[64:67], v[76:91]
    v_mfma_f32_32x32x16_bf16 v[28:43], v[48:51], v[64:67], v[28:43]
    ds_read_b128 v[64:67], v3 offset:16384
    ds_read_b64_tr_b16 v[48:49], v6 offset:18432
    ds_read_b64_tr_b16 v[50:51], v6 offset:18944
    v_add_u32 v16, s68, v12
    ds_read_b32 v16, v16
    v_add_u32 v17, s69, v12
    ds_read_b32 v17, v17
    s_waitcnt lgkmcnt(12)
    v_mfma_f32_32x32x16_bf16 v[76:91], v[108:111], v[68:71], v[76:91]
    v_mfma_f32_32x32x16_bf16 v[28:43], v[52:55], v[68:71], v[28:43]
    ds_read_b128 v[68:71], v4 offset:16384
    ds_read_b64_tr_b16 v[52:53], v6 offset:20480
    ds_read_b64_tr_b16 v[54:55], v6 offset:20992
    s_waitcnt lgkmcnt(12)
    v_mfma_f32_32x32x16_bf16 v[76:91], v[112:115], v[72:75], v[76:91]
    v_mfma_f32_32x32x16_bf16 v[28:43], v[56:59], v[72:75], v[28:43]
    ds_read_b128 v[72:75], v5 offset:16384
    ds_read_b64_tr_b16 v[56:57], v6 offset:22528
    ds_read_b64_tr_b16 v[58:59], v6 offset:23040
    s_waitcnt lgkmcnt(6)
    v_lshl_add_u32 v16, v16, 7, v11
    v_lshl_add_u32 v17, v17, 7, v11
    s_waitcnt vmcnt(2)
    s_barrier
    v_mfma_f32_32x32x16_bf16 v[28:43], v[44:47], v[60:63], v[28:43]
    ds_read_b128 v[60:63], v2 offset:32768
    ds_read_b64_tr_b16 v[44:45], v6 offset:32768
    ds_read_b64_tr_b16 v[46:47], v6 offset:33280
    ds_read_b64 v[120:121], v7 offset:32768
    v_mov_b32 v15, v84
    s_add_u32 m0, s89, 0
    s_nop 0
    buffer_load_dwordx4 v16, s[32:35], 0 offen lds
    v_mfma_f32_32x32x16_bf16 v[28:43], v[48:51], v[64:67], v[28:43]
    ds_read_b128 v[64:67], v3 offset:32768
    ds_read_b64_tr_b16 v[48:49], v6 offset:34816
    ds_read_b64_tr_b16 v[50:51], v6 offset:35328
    v_add_u32 v18, s70, v12
    ds_read_b32 v18, v18
    v_add_u32 v19, s71, v12
    ds_read_b32 v19, v19
    s_add_u32 m0, s89, 8192
    s_nop 0
    buffer_load_dwordx4 v17, s[32:35], 0 offen lds
    s_waitcnt lgkmcnt(12)
    v_mfma_f32_32x32x16_bf16 v[28:43], v[52:55], v[68:71], v[28:43]
    ds_read_b128 v[68:71], v4 offset:32768
    ds_read_b64_tr_b16 v[52:53], v6 offset:36864
    ds_read_b64_tr_b16 v[54:55], v6 offset:37376
    s_add_u32 m0, s89, 65536
    s_lshl_b32 s91, s68, 13
    buffer_load_dwordx4 v10, s[40:43], s91 offen lds
    s_waitcnt lgkmcnt(12)
    v_mfma_f32_32x32x16_bf16 v[28:43], v[56:59], v[72:75], v[28:43]
    ds_read_b128 v[72:75], v5 offset:32768
    ds_read_b64_tr_b16 v[56:57], v6 offset:38912
    ds_read_b64_tr_b16 v[58:59], v6 offset:39424
    s_add_u32 m0, s89, 73728
    s_lshl_b32 s91, s69, 13
    buffer_load_dwordx4 v10, s[40:43], s91 offen lds
    s_waitcnt lgkmcnt(6)
    v_lshl_add_u32 v18, v18, 7, v11
    v_lshl_add_u32 v19, v19, 7, v11
    s_waitcnt vmcnt(4)
    s_barrier
    v_mfma_f32_32x32x16_bf16 v[84:99], v[100:103], v[60:63], 0
    v_mfma_f32_32x32x16_bf16 v[28:43], v[44:47], v[60:63], v[28:43]
    ds_read_b128 v[60:63], v2 offset:49152
    ds_read_b64_tr_b16 v[44:45], v6 offset:49152
    ds_read_b64_tr_b16 v[46:47], v6 offset:49664
    ds_read_b64 v[122:123], v7 offset:49152
    s_add_u32 m0, s89, 16384
    s_nop 0
    buffer_load_dwordx4 v18, s[32:35], 0 offen lds
    v_mfma_f32_32x32x16_bf16 v[84:99], v[104:107], v[64:67], v[84:99]
    v_mfma_f32_32x32x16_bf16 v[28:43], v[48:51], v[64:67], v[28:43]
    ds_read_b128 v[64:67], v3 offset:49152
    ds_read_b64_tr_b16 v[48:49], v6 offset:51200
    ds_read_b64_tr_b16 v[50:51], v6 offset:51712
    v_add_u32 v16, s72, v12
    ds_read_b32 v16, v16
    v_add_u32 v17, s73, v12
    ds_read_b32 v17, v17
    s_add_u32 m0, s89, 24576
    s_nop 0
    buffer_load_dwordx4 v19, s[32:35], 0 offen lds
    s_waitcnt lgkmcnt(12)
    v_mfma_f32_32x32x16_bf16 v[84:99], v[108:111], v[68:71], v[84:99]
    v_mfma_f32_32x32x16_bf16 v[28:43], v[52:55], v[68:71], v[28:43]
    ds_read_b128 v[68:71], v4 offset:49152
    ds_read_b64_tr_b16 v[52:53], v6 offset:53248
    ds_read_b64_tr_b16 v[54:55], v6 offset:53760
    s_add_u32 m0, s89, 81920
    s_lshl_b32 s91, s70, 13
    buffer_load_dwordx4 v10, s[40:43], s91 offen lds
    s_waitcnt lgkmcnt(12)
    v_mfma_f32_32x32x16_bf16 v[84:99], v[112:115], v[72:75], v[84:99]
    v_mfma_f32_32x32x16_bf16 v[28:43], v[56:59], v[72:75], v[28:43]
    ds_read_b128 v[72:75], v5 offset:49152
    ds_read_b64_tr_b16 v[56:57], v6 offset:55296
    ds_read_b64_tr_b16 v[58:59], v6 offset:55808
    s_add_u32 m0, s89, 90112
    s_lshl_b32 s91, s71, 13
    buffer_load_dwordx4 v10, s[40:43], s91 offen lds
    s_waitcnt lgkmcnt(6)
    v_lshl_add_u32 v16, v16, 7, v11
    v_lshl_add_u32 v17, v17, 7, v11
    s_waitcnt vmcnt(4)
    s_barrier
    v_mfma_f32_32x32x16_bf16 v[28:43], v[44:47], v[60:63], v[28:43]
    ds_read_b128 v[60:63], v2 offset:0
    ds_read_b64_tr_b16 v[44:45], v6 offset:0
    ds_read_b64_tr_b16 v[46:47], v6 offset:512
    ds_read_b64 v[124:125], v7 offset:0
    v_cvt_pk_bf16_f32 v240, v76, v84
    v_cvt_pk_bf16_f32 v241, v77, v85
    v_cvt_pk_bf16_f32 v242, v78, v86
    v_cvt_pk_bf16_f32 v243, v79, v87
    v_cvt_pk_bf16_f32 v244, v80, v88
    v_cvt_pk_bf16_f32 v245, v81, v89
    v_cvt_pk_bf16_f32 v246, v82, v90
    v_cvt_pk_bf16_f32 v247, v83, v91
    v_cvt_pk_bf16_f32 v248, v15, v92
    ds_write_b32 v14, v248 offset:0
    ds_write2st64_b32 v8, v240, v241 offset0:0 offset1:2
    ds_write2st64_b32 v8, v242, v243 offset0:4 offset1:6
    ds_write2st64_b32 v8, v244, v245 offset0:16 offset1:18
    ds_write2st64_b32 v8, v246, v247 offset0:20 offset1:22
    s_add_u32 m0, s89, 32768
    s_nop 0
    buffer_load_dwordx4 v16, s[32:35], 0 offen lds
    v_mfma_f32_32x32x16_bf16 v[28:43], v[48:51], v[64:67], v[28:43]
    s_waitcnt lgkmcnt(9)
    ds_read_b128 v[64:67], v3 offset:0
    ds_read_b64_tr_b16 v[48:49], v6 offset:2048
    ds_read_b64_tr_b16 v[50:51], v6 offset:2560
    v_add_u32 v18, s74, v12
    ds_read_b32 v18, v18
    v_add_u32 v19, s75, v12
    ds_read_b32 v19, v19
    s_add_u32 m0, s89, 40960
    s_nop 0
    buffer_load_dwordx4 v17, s[32:35], 0 offen lds
    v_mfma_f32_32x32x16_bf16 v[28:43], v[52:55], v[68:71], v[28:43]
    ds_read_b128 v[68:71], v4 offset:0
    s_waitcnt lgkmcnt(9)
    ds_read_b64_tr_b16 v[52:53], v6 offset:4096
    ds_read_b64_tr_b16 v[54:55], v6 offset:4608
    s_add_u32 m0, s89, 98304
    s_lshl_b32 s91, s72, 13
    buffer_load_dwordx4 v10, s[40:43], s91 offen lds
    v_mfma_f32_32x32x16_bf16 v[28:43], v[56:59], v[72:75], v[28:43]
    ds_read_b128 v[72:75], v5 offset:0
    ds_read_b64_tr_b16 v[56:57], v6 offset:6144
    ds_read_b64_tr_b16 v[58:59], v6 offset:6656
    s_add_u32 m0, s89, 106496
    s_lshl_b32 s91, s73, 13
    buffer_load_dwordx4 v10, s[40:43], s91 offen lds
    s_waitcnt lgkmcnt(6)
    v_lshl_add_u32 v18, v18, 7, v11
    v_lshl_add_u32 v19, v19, 7, v11
    s_waitcnt vmcnt(4)
    s_barrier
    v_mfma_f32_32x32x16_bf16 v[76:91], v[100:103], v[60:63], 0
    v_mfma_f32_32x32x16_bf16 v[28:43], v[44:47], v[60:63], v[28:43]
    ds_read_b128 v[60:63], v2 offset:16384
    ds_read_b64_tr_b16 v[44:45], v6 offset:16384
    ds_read_b64_tr_b16 v[46:47], v6 offset:16896
    ds_read_b64 v[126:127], v7 offset:16384
    s_add_u32 m0, s89, 49152
    s_nop 0
    buffer_load_dwordx4 v18, s[32:35], 0 offen lds
    v_mfma_f32_32x32x16_bf16 v[76:91], v[104:107], v[64:67], v[76:91]
    v_mfma_f32_32x32x16_bf16 v[28:43], v[48:51], v[64:67], v[28:43]
    ds_read_b128 v[64:67], v3 offset:16384
    ds_read_b64_tr_b16 v[48:49], v6 offset:18432
    ds_read_b64_tr_b16 v[50:51], v6 offset:18944
    v_add_u32 v16, s76, v12
    ds_read_b32 v16, v16
    v_add_u32 v17, s77, v12
    ds_read_b32 v17, v17
    s_waitcnt lgkmcnt(9)
    ds_read_b32 v144, v9 offset:0
    ds_read_b32 v152, v9 offset:512
    ds_read_b32 v160, v9 offset:1024
    ds_read_b32 v168, v9 offset:1536
    s_add_u32 m0, s89, 57344
    s_nop 0
    buffer_load_dwordx4 v19, s[32:35], 0 offen lds
    v_mfma_f32_32x32x16_bf16 v[76:91], v[108:111], v[68:71], v[76:91]
    v_mfma_f32_32x32x16_bf16 v[28:43], v[52:55], v[68:71], v[28:43]
    ds_read_b128 v[68:71], v4 offset:16384
    ds_read_b64_tr_b16 v[52:53], v6 offset:20480
    s_waitcnt lgkmcnt(9)
    ds_read_b64_tr_b16 v[54:55], v6 offset:20992
    s_add_u32 m0, s89, 114688
    s_lshl_b32 s91, s74, 13
    buffer_load_dwordx4 v10, s[40:43], s91 offen lds
    v_mfma_f32_32x32x16_bf16 v[76:91], v[112:115], v[72:75], v[76:91]
    v_mfma_f32_32x32x16_bf16 v[28:43], v[56:59], v[72:75], v[28:43]
    ds_read_b128 v[72:75], v5 offset:16384
    ds_read_b64_tr_b16 v[56:57], v6 offset:22528
    ds_read_b64_tr_b16 v[58:59], v6 offset:23040
    s_add_u32 m0, s89, 122880
    s_lshl_b32 s91, s75, 13
    buffer_load_dwordx4 v10, s[40:43], s91 offen lds
    s_waitcnt lgkmcnt(10)
    v_lshl_add_u32 v16, v16, 7, v11
    v_lshl_add_u32 v17, v17, 7, v11
    s_waitcnt vmcnt(4)
    s_barrier
    v_mfma_f32_32x32x16_bf16 v[28:43], v[44:47], v[60:63], v[28:43]
    ds_read_b128 v[60:63], v2 offset:32768
    ds_read_b64_tr_b16 v[44:45], v6 offset:32768
    ds_read_b64_tr_b16 v[46:47], v6 offset:33280
    ds_read_b64 v[128:129], v7 offset:32768
    v_mov_b32 v15, v84
    s_add_u32 m0, s89, 0
    s_nop 0
    buffer_load_dwordx4 v16, s[32:35], 0 offen lds
    v_mfma_f32_32x32x16_bf16 v[28:43], v[48:51], v[64:67], v[28:43]
    ds_read_b128 v[64:67], v3 offset:32768
    s_waitcnt lgkmcnt(9)
    ds_read_b64_tr_b16 v[48:49], v6 offset:34816
    ds_read_b64_tr_b16 v[50:51], v6 offset:35328
    v_add_u32 v18, s78, v12
    ds_read_b32 v18, v18
    v_add_u32 v19, s79, v12
    ds_read_b32 v19, v19
    ds_read_b32 v148, v9 offset:8192
    ds_read_b32 v156, v9 offset:8704
    s_waitcnt lgkmcnt(9)
    ds_read_b32 v164, v9 offset:9216
    ds_read_b32 v172, v9 offset:9728
    s_add_u32 m0, s89, 8192
    s_nop 0
    buffer_load_dwordx4 v17, s[32:35], 0 offen lds
    v_mfma_f32_32x32x16_bf16 v[28:43], v[52:55], v[68:71], v[28:43]
    ds_read_b128 v[68:71], v4 offset:32768
    ds_read_b64_tr_b16 v[52:53], v6 offset:36864
    ds_read_b64_tr_b16 v[54:55], v6 offset:37376
    s_add_u32 m0, s89, 65536
    s_lshl_b32 s91, s76, 13
    buffer_load_dwordx4 v10, s[40:43], s91 offen lds
    v_mfma_f32_32x32x16_bf16 v[28:43], v[56:59], v[72:75], v[28:43]
    ds_read_b128 v[72:75], v5 offset:32768
    s_waitcnt lgkmcnt(9)
    ds_read_b64_tr_b16 v[56:57], v6 offset:38912
    ds_read_b64_tr_b16 v[58:59], v6 offset:39424
    s_add_u32 m0, s89, 73728
    s_lshl_b32 s91, s77, 13
    buffer_load_dwordx4 v10, s[40:43], s91 offen lds
    s_waitcnt lgkmcnt(10)
    v_lshl_add_u32 v18, v18, 7, v11
    v_lshl_add_u32 v19, v19, 7, v11
    s_waitcnt vmcnt(4)
    s_barrier
    v_mfma_f32_32x32x16_bf16 v[84:99], v[100:103], v[60:63], 0
    v_mfma_f32_32x32x16_bf16 v[28:43], v[44:47], v[60:63], v[28:43]
    ds_read_b128 v[60:63], v2 offset:49152
    ds_read_b64_tr_b16 v[44:45], v6 offset:49152
    ds_read_b64_tr_b16 v[46:47], v6 offset:49664
    ds_read_b64 v[130:131], v7 offset:49152
    s_add_u32 m0, s89, 16384
    s_nop 0
    buffer_load_dwordx4 v18, s[32:35], 0 offen lds
    v_mfma_f32_32x32x16_bf16 v[84:99], v[104:107], v[64:67], v[84:99]
    v_mfma_f32_32x32x16_bf16 v[28:43], v[48:51], v[64:67], v[28:43]
    ds_read_b128 v[64:67], v3 offset:49152
    s_waitcnt lgkmcnt(9)
    ds_read_b64_tr_b16 v[48:49], v6 offset:51200
    ds_read_b64_tr_b16 v[50:51], v6 offset:51712
    v_add_u32 v16, s80, v12
    ds_read_b32 v16, v16
    v_add_u32 v17, s81, v12
    ds_read_b32 v17, v17
    s_add_u32 m0, s89, 24576
    s_nop 0
    buffer_load_dwordx4 v19, s[32:35], 0 offen lds
    s_waitcnt lgkmcnt(12)
    v_mfma_f32_32x32x16_bf16 v[84:99], v[108:111], v[68:71], v[84:99]
    v_mfma_f32_32x32x16_bf16 v[28:43], v[52:55], v[68:71], v[28:43]
    ds_read_b128 v[68:71], v4 offset:49152
    ds_read_b64_tr_b16 v[52:53], v6 offset:53248
    ds_read_b64_tr_b16 v[54:55], v6 offset:53760
    s_add_u32 m0, s89, 81920
    s_lshl_b32 s91, s78, 13
    buffer_load_dwordx4 v10, s[40:43], s91 offen lds
    s_waitcnt lgkmcnt(12)
    v_mfma_f32_32x32x16_bf16 v[84:99], v[112:115], v[72:75], v[84:99]
    v_mfma_f32_32x32x16_bf16 v[28:43], v[56:59], v[72:75], v[28:43]
    ds_read_b128 v[72:75], v5 offset:49152
    ds_read_b64_tr_b16 v[56:57], v6 offset:55296
    ds_read_b64_tr_b16 v[58:59], v6 offset:55808
    s_add_u32 m0, s89, 90112
    s_lshl_b32 s91, s79, 13
    buffer_load_dwordx4 v10, s[40:43], s91 offen lds
    s_waitcnt lgkmcnt(6)
    v_lshl_add_u32 v16, v16, 7, v11
    v_lshl_add_u32 v17, v17, 7, v11
    s_waitcnt vmcnt(4)
    s_barrier
    v_mfma_f32_32x32x16_bf16 v[28:43], v[44:47], v[60:63], v[28:43]
    ds_read_b128 v[60:63], v2 offset:0
    ds_read_b64_tr_b16 v[44:45], v6 offset:0
    ds_read_b64_tr_b16 v[46:47], v6 offset:512
    ds_read_b64 v[132:133], v7 offset:0
    v_cvt_pk_bf16_f32 v240, v76, v84
    v_cvt_pk_bf16_f32 v241, v77, v85
    v_cvt_pk_bf16_f32 v242, v78, v86
    v_cvt_pk_bf16_f32 v243, v79, v87
    v_cvt_pk_bf16_f32 v244, v80, v88
    v_cvt_pk_bf16_f32 v245, v81, v89
    v_cvt_pk_bf16_f32 v246, v82, v90
    v_cvt_pk_bf16_f32 v247, v83, v91
    v_cvt_pk_bf16_f32 v248, v15, v92
    ds_write_b32 v14, v248 offset:4
    ds_write2st64_b32 v8, v240, v241 offset0:0 offset1:2
    ds_write2st64_b32 v8, v242, v243 offset0:4 offset1:6
    ds_write2st64_b32 v8, v244, v245 offset0:16 offset1:18
    ds_write2st64_b32 v8, v246, v247 offset0:20 offset1:22
    s_add_u32 m0, s89, 32768
    s_nop 0
    buffer_load_dwordx4 v16, s[32:35], 0 offen lds
    v_mfma_f32_32x32x16_bf16 v[28:43], v[48:51], v[64:67], v[28:43]
    s_waitcnt lgkmcnt(9)
    ds_read_b128 v[64:67], v3 offset:0
    ds_read_b64_tr_b16 v[48:49], v6 offset:2048
    ds_read_b64_tr_b16 v[50:51], v6 offset:2560
    v_add_u32 v18, s82, v12
    ds_read_b32 v18, v18
    v_add_u32 v19, s83, v12
    ds_read_b32 v19, v19
    s_add_u32 m0, s89, 40960
    s_nop 0
    buffer_load_dwordx4 v17, s[32:35], 0 offen lds
    v_mfma_f32_32x32x16_bf16 v[28:43], v[52:55], v[68:71], v[28:43]
    ds_read_b128 v[68:71], v4 offset:0
    s_waitcnt lgkmcnt(9)
    ds_read_b64_tr_b16 v[52:53], v6 offset:4096
    ds_read_b64_tr_b16 v[54:55], v6 offset:4608
    s_add_u32 m0, s89, 98304
    s_lshl_b32 s91, s80, 13
    buffer_load_dwordx4 v10, s[40:43], s91 offen lds
    v_mfma_f32_32x32x16_bf16 v[28:43], v[56:59], v[72:75], v[28:43]
    ds_read_b128 v[72:75], v5 offset:0
    ds_read_b64_tr_b16 v[56:57], v6 offset:6144
    ds_read_b64_tr_b16 v[58:59], v6 offset:6656
    s_add_u32 m0, s89, 106496
    s_lshl_b32 s91, s81, 13
    buffer_load_dwordx4 v10, s[40:43], s91 offen lds
    s_waitcnt lgkmcnt(6)
    v_lshl_add_u32 v18, v18, 7, v11
    v_lshl_add_u32 v19, v19, 7, v11
    s_waitcnt vmcnt(4)
    s_barrier
    v_mfma_f32_32x32x16_bf16 v[76:91], v[100:103], v[60:63], 0
    v_mfma_f32_32x32x16_bf16 v[28:43], v[44:47], v[60:63], v[28:43]
    ds_read_b128 v[60:63], v2 offset:16384
    ds_read_b64_tr_b16 v[44:45], v6 offset:16384
    ds_read_b64_tr_b16 v[46:47], v6 offset:16896
    ds_read_b64 v[134:135], v7 offset:16384
    s_add_u32 m0, s89, 49152
    s_nop 0
    buffer_load_dwordx4 v18, s[32:35], 0 offen lds
    v_mfma_f32_32x32x16_bf16 v[76:91], v[104:107], v[64:67], v[76:91]
    v_mfma_f32_32x32x16_bf16 v[28:43], v[48:51], v[64:67], v[28:43]
    ds_read_b128 v[64:67], v3 offset:16384
    ds_read_b64_tr_b16 v[48:49], v6 offset:18432
    ds_read_b64_tr_b16 v[50:51], v6 offset:18944
    v_add_u32 v16, s84, v12
    ds_read_b32 v16, v16
    v_add_u32 v17, s85, v12
    ds_read_b32 v17, v17
    s_waitcnt lgkmcnt(9)
    ds_read_b32 v145, v9 offset:0
    ds_read_b32 v153, v9 offset:512
    ds_read_b32 v161, v9 offset:1024
    ds_read_b32 v169, v9 offset:1536
    s_add_u32 m0, s89, 57344
    s_nop 0
    buffer_load_dwordx4 v19, s[32:35], 0 offen lds
    v_mfma_f32_32x32x16_bf16 v[76:91], v[108:111], v[68:71], v[76:91]
    v_mfma_f32_32x32x16_bf16 v[28:43], v[52:55], v[68:71], v[28:43]
    ds_read_b128 v[68:71], v4 offset:16384
    ds_read_b64_tr_b16 v[52:53], v6 offset:20480
    s_waitcnt lgkmcnt(9)
    ds_read_b64_tr_b16 v[54:55], v6 offset:20992
    s_add_u32 m0, s89, 114688
    s_lshl_b32 s91, s82, 13
    buffer_load_dwordx4 v10, s[40:43], s91 offen lds
    v_mfma_f32_32x32x16_bf16 v[76:91], v[112:115], v[72:75], v[76:91]
    v_mfma_f32_32x32x16_bf16 v[28:43], v[56:59], v[72:75], v[28:43]
    ds_read_b128 v[72:75], v5 offset:16384
    ds_read_b64_tr_b16 v[56:57], v6 offset:22528
    ds_read_b64_tr_b16 v[58:59], v6 offset:23040
    s_add_u32 m0, s89, 122880
    s_lshl_b32 s91, s83, 13
    buffer_load_dwordx4 v10, s[40:43], s91 offen lds
    s_waitcnt lgkmcnt(10)
    v_lshl_add_u32 v16, v16, 7, v11
    v_lshl_add_u32 v17, v17, 7, v11
    s_waitcnt vmcnt(4)
    s_barrier
    v_mfma_f32_32x32x16_bf16 v[28:43], v[44:47], v[60:63], v[28:43]
    ds_read_b128 v[60:63], v2 offset:32768
    ds_read_b64_tr_b16 v[44:45], v6 offset:32768
    ds_read_b64_tr_b16 v[46:47], v6 offset:33280
    ds_read_b64 v[136:137], v7 offset:32768
    v_mov_b32 v15, v84
    s_add_u32 m0, s89, 0
    s_nop 0
    buffer_load_dwordx4 v16, s[32:35], 0 offen lds
    v_mfma_f32_32x32x16_bf16 v[28:43], v[48:51], v[64:67], v[28:43]
    ds_read_b128 v[64:67], v3 offset:32768
    s_waitcnt lgkmcnt(9)
    ds_read_b64_tr_b16 v[48:49], v6 offset:34816
    ds_read_b64_tr_b16 v[50:51], v6 offset:35328
    ds_read_b32 v149, v9 offset:8192
    ds_read_b32 v157, v9 offset:8704
    ds_read_b32 v165, v9 offset:9216
    ds_read_b32 v173, v9 offset:9728
    s_add_u32 m0, s89, 8192
    s_nop 0
    buffer_load_dwordx4 v17, s[32:35], 0 offen lds
    s_waitcnt lgkmcnt(14)
    v_mfma_f32_32x32x16_bf16 v[28:43], v[52:55], v[68:71], v[28:43]
    ds_read_b128 v[68:71], v4 offset:32768
    s_waitcnt lgkmcnt(9)
    ds_read_b64_tr_b16 v[52:53], v6 offset:36864
    ds_read_b64_tr_b16 v[54:55], v6 offset:37376
    s_add_u32 m0, s89, 65536
    s_lshl_b32 s91, s84, 13
    buffer_load_dwordx4 v10, s[40:43], s91 offen lds
    v_mfma_f32_32x32x16_bf16 v[28:43], v[56:59], v[72:75], v[28:43]
    ds_read_b128 v[72:75], v5 offset:32768
    ds_read_b64_tr_b16 v[56:57], v6 offset:38912
    ds_read_b64_tr_b16 v[58:59], v6 offset:39424
    s_add_u32 m0, s89, 73728
    s_lshl_b32 s91, s85, 13
    buffer_load_dwordx4 v10, s[40:43], s91 offen lds
    s_waitcnt vmcnt(4)
    s_barrier
    v_mfma_f32_32x32x16_bf16 v[84:99], v[100:103], v[60:63], 0
    v_mfma_f32_32x32x16_bf16 v[28:43], v[44:47], v[60:63], v[28:43]
    ds_read_b128 v[60:63], v2 offset:49152
    s_waitcnt lgkmcnt(9)
    ds_read_b64_tr_b16 v[44:45], v6 offset:49152
    ds_read_b64_tr_b16 v[46:47], v6 offset:49664
    ds_read_b64 v[138:139], v7 offset:49152
    v_mfma_f32_32x32x16_bf16 v[84:99], v[104:107], v[64:67], v[84:99]
    v_mfma_f32_32x32x16_bf16 v[28:43], v[48:51], v[64:67], v[28:43]
    ds_read_b128 v[64:67], v3 offset:49152
    ds_read_b64_tr_b16 v[48:49], v6 offset:51200
    ds_read_b64_tr_b16 v[50:51], v6 offset:51712
    s_waitcnt lgkmcnt(10)
    v_mfma_f32_32x32x16_bf16 v[84:99], v[108:111], v[68:71], v[84:99]
    v_mfma_f32_32x32x16_bf16 v[28:43], v[52:55], v[68:71], v[28:43]
    ds_read_b128 v[68:71], v4 offset:49152
    ds_read_b64_tr_b16 v[52:53], v6 offset:53248
    ds_read_b64_tr_b16 v[54:55], v6 offset:53760
    s_lshl_b32 s91, s86, 11
    s_add_u32 s92, s91, 49152
    v_lshl_add_u32 v16, v1, 4, s92
    v_xor_b32 v17, 8192, v16
    v_lshrrev_b32 v250, 4, v1
    s_and_b32 s92, s86, 3
    s_lshl_b32 s92, s92, 8
    s_add_u32 s92, s92, 155648
    v_lshl_add_u32 v250, v250, 10, s92
    v_and_b32 v251, 15, v1
    v_lshl_add_u32 v18, v251, 4, v250
    s_and_b32 s91, s86, 2
    s_lshl_b32 s91, s91, 6
    s_lshr_b32 s92, s86, 2
    s_lshl_b32 s93, s92, 6
    s_add_u32 s91, s91, s93
    s_add_u32 s91, s91, 159744
    v_lshrrev_b32 v250, 5, v1
    v_lshl_add_u32 v19, v250, 4, s91
    s_lshl_b32 s91, s92, 12
    s_add_u32 s91, s91, 4294926336
    v_add_u32 v12, s91, v18
    s_waitcnt lgkmcnt(10)
    v_mfma_f32_32x32x16_bf16 v[84:99], v[112:115], v[72:75], v[84:99]
    v_mfma_f32_32x32x16_bf16 v[28:43], v[56:59], v[72:75], v[28:43]
    ds_read_b128 v[72:75], v5 offset:49152
    ds_read_b64_tr_b16 v[56:57], v6 offset:55296
    ds_read_b64_tr_b16 v[58:59], v6 offset:55808
    s_cmp_eq_u32 s27, 1
    s_cbranch_scc1 L_c6
    s_add_u32 m0, s89, 16384
    s_nop 0
    buffer_load_dwordx4 v13, s[36:39], s28 offen lds
    s_add_u32 m0, s89, 24576
    s_nop 0
    buffer_load_dwordx4 v13, s[36:39], s29 offen lds
    s_add_u32 m0, s89, 81920
    s_add_u32 s91, s28, 86528
    buffer_load_dwordx4 v13, s[36:39], s91 offen lds
    s_add_u32 m0, s89, 90112
    s_add_u32 s91, s29, 86528
    buffer_load_dwordx4 v13, s[36:39], s91 offen lds
L_c6:
    s_cmp_eq_u32 s27, 1
    s_cbranch_scc1 L_c7
    s_waitcnt vmcnt(4)
    s_branch L_c8
L_c7:
    s_waitcnt vmcnt(0)
L_c8:
    s_waitcnt lgkmcnt(0)
    s_barrier
    v_mfma_f32_32x32x16_bf16 v[28:43], v[44:47], v[60:63], v[28:43]
    ds_read_b128 v[60:63], v2 offset:0
    ds_read_b64_tr_b16 v[44:45], v6 offset:0
    ds_read_b64_tr_b16 v[46:47], v6 offset:512
    ds_read_b64 v[140:141], v7 offset:0
    v_cvt_pk_bf16_f32 v240, v76, v84
    v_cvt_pk_bf16_f32 v241, v77, v85
    v_cvt_pk_bf16_f32 v242, v78, v86
    v_cvt_pk_bf16_f32 v243, v79, v87
    v_cvt_pk_bf16_f32 v244, v80, v88
    v_cvt_pk_bf16_f32 v245, v81, v89
    v_cvt_pk_bf16_f32 v246, v82, v90
    v_cvt_pk_bf16_f32 v247, v83, v91
    v_cvt_pk_bf16_f32 v248, v15, v92
    ds_write_b32 v14, v248 offset:8
    ds_write2st64_b32 v8, v240, v241 offset0:0 offset1:2
    ds_write2st64_b32 v8, v242, v243 offset0:4 offset1:6
    ds_write2st64_b32 v8, v244, v245 offset0:16 offset1:18
    ds_write2st64_b32 v8, v246, v247 offset0:20 offset1:22
    v_mfma_f32_32x32x16_bf16 v[28:43], v[48:51], v[64:67], v[28:43]
    ds_read_b128 v[64:67], v3 offset:0
    ds_read_b64_tr_b16 v[48:49], v6 offset:2048
    ds_read_b64_tr_b16 v[50:51], v6 offset:2560
    v_mfma_f32_32x32x16_bf16 v[28:43], v[52:55], v[68:71], v[28:43]
    ds_read_b128 v[68:71], v4 offset:0
    ds_read_b64_tr_b16 v[52:53], v6 offset:4096
    ds_read_b64_tr_b16 v[54:55], v6 offset:4608
    v_lshrrev_b32 v250, 5, v1
    v_and_b32 v251, 31, v1
    s_and_b32 s91, s86, 1
    s_lshl_b32 s92, s91, 9
    s_add_u32 s92, s92, 114688
    v_lshl_add_u32 v252, v250, 12, s92
    v_lshl_add_u32 v11, v251, 4, v252
    s_lshl_b32 s91, s91, 10
    s_lshr_b32 s92, s86, 1
    s_lshl_b32 s92, s92, 3
    s_add_u32 s91, s91, s92
    s_add_u32 s91, s91, 139264
    v_lshl_add_u32 v252, v250, 2, s91
    v_lshl_add_u32 v10, v251, 5, v252
    v_mfma_f32_32x32x16_bf16 v[28:43], v[56:59], v[72:75], v[28:43]
    s_waitcnt lgkmcnt(9)
    ds_read_b128 v[72:75], v5 offset:0
    ds_read_b64_tr_b16 v[56:57], v6 offset:6144
    ds_read_b64_tr_b16 v[58:59], v6 offset:6656
    s_cmp_eq_u32 s27, 1
    s_cbranch_scc1 L_c9
    s_add_u32 m0, s89, 32768
    s_nop 0
    buffer_load_dwordx4 v13, s[36:39], s30 offen lds
    s_add_u32 m0, s89, 98304
    s_add_u32 s91, s30, 86528
    buffer_load_dwordx4 v13, s[36:39], s91 offen lds
    s_cmp_ge_u32 s86, 4
    s_cbranch_scc1 L_wc10
    s_cmp_ge_u32 s86, 2
    s_mov_b32 s93, 40960
    s_cselect_b32 s93, 104448, s93
    s_add_u32 m0, s89, s93
    s_nop 0
    buffer_load_dwordx4 v13, s[36:39], s31 offen lds
L_wc10:
L_c9:
    s_cmp_lg_u32 s86, 0
    s_cbranch_scc1 L_f11
    v_mov_b32 v0, 0
    s_lshl_b32 s91, s87, 2
    buffer_load_dword v27, v0, s[52:55], s91 offen sc0 sc1
L_f11:
    v_mfma_f32_32x32x16_bf16 v[76:91], v[100:103], v[60:63], 0
    s_waitcnt lgkmcnt(6)
    v_mfma_f32_32x32x16_bf16 v[76:91], v[104:107], v[64:67], v[76:91]
    s_waitcnt lgkmcnt(3)
    v_mfma_f32_32x32x16_bf16 v[76:91], v[108:111], v[68:71], v[76:91]
    s_waitcnt lgkmcnt(0)
    v_mfma_f32_32x32x16_bf16 v[76:91], v[112:115], v[72:75], v[76:91]
    v_mfma_f32_32x32x16_bf16 v[28:43], v[44:47], v[60:63], v[28:43]
    v_mfma_f32_32x32x16_bf16 v[28:43], v[48:51], v[64:67], v[28:43]
    v_mfma_f32_32x32x16_bf16 v[28:43], v[52:55], v[68:71], v[28:43]
    v_mfma_f32_32x32x16_bf16 v[28:43], v[56:59], v[72:75], v[28:43]
    s_nop 7
    v_cvt_pk_bf16_f32 v240, v76, 0
    v_cvt_pk_bf16_f32 v241, v77, 0
    v_cvt_pk_bf16_f32 v242, v78, 0
    v_cvt_pk_bf16_f32 v243, v79, 0
    v_cvt_pk_bf16_f32 v244, v80, 0
    v_cvt_pk_bf16_f32 v245, v81, 0
    v_cvt_pk_bf16_f32 v246, v82, 0
    v_cvt_pk_bf16_f32 v247, v83, 0
    v_cvt_pk_bf16_f32 v248, v84, 0
    ds_write_b32 v14, v248 offset:12
    ds_write2st64_b32 v8, v240, v241 offset0:64 offset1:66
    ds_write2st64_b32 v8, v242, v243 offset0:68 offset1:70
    ds_write2st64_b32 v8, v244, v245 offset0:80 offset1:82
    ds_write2st64_b32 v8, v246, v247 offset0:84 offset1:86
    ds_write_b128 v16, v[36:39] offset:0
    ds_write_b128 v16, v[40:43] offset:1024
    s_branch L_tail
L_k1:
    s_waitcnt vmcnt(6)
    s_barrier
    ds_read_b128 v[60:63], v2 offset:0
    ds_read_b64_tr_b16 v[44:45], v6 offset:0
    ds_read_b64_tr_b16 v[46:47], v6 offset:512
    ds_read_b64 v[116:117], v7 offset:0
    ds_read_b128 v[64:67], v3 offset:0
    ds_read_b64_tr_b16 v[48:49], v6 offset:2048
    ds_read_b64_tr_b16 v[50:51], v6 offset:2560
    ds_read_b128 v[68:71], v4 offset:0
    ds_read_b64_tr_b16 v[52:53], v6 offset:4096
    ds_read_b64_tr_b16 v[54:55], v6 offset:4608
    ds_read_b128 v[72:75], v5 offset:0
    ds_read_b64_tr_b16 v[56:57], v6 offset:6144
    ds_read_b64_tr_b16 v[58:59], v6 offset:6656
    s_cmp_eq_u32 s27, 1
    s_cbranch_scc1 L_c12
    s_add_u32 m0, s89, 81920
    s_lshl_b32 s91, s62, 13
    buffer_load_dwordx4 v10, s[40:43], s91 offen lds
    s_add_u32 m0, s89, 90112
    s_lshl_b32 s91, s63, 13
    buffer_load_dwordx4 v10, s[40:43], s91 offen lds
    s_add_u32 m0, s89, 98304
    s_lshl_b32 s91, s64, 13
    buffer_load_dwordx4 v10, s[40:43], s91 offen lds
    s_add_u32 m0, s89, 106496
    s_lshl_b32 s91, s65, 13
    buffer_load_dwordx4 v10, s[40:43], s91 offen lds
    s_add_u32 m0, s89, 114688
    s_lshl_b32 s91, s66, 13
    buffer_load_dwordx4 v10, s[40:43], s91 offen lds
    s_add_u32 m0, s89, 122880
    s_lshl_b32 s91, s67, 13
    buffer_load_dwordx4 v10, s[40:43], s91 offen lds
L_c12:
    s_waitcnt vmcnt(4)
    s_barrier
    s_waitcnt lgkmcnt(10)
    v_mfma_f32_32x32x16_bf16 v[28:43], v[44:47], v[60:63], 0
    ds_read_b128 v[60:63], v2 offset:16384
    ds_read_b64_tr_b16 v[44:45], v6 offset:16384
    ds_read_b64_tr_b16 v[46:47], v6 offset:16896
    ds_read_b64 v[118:119], v7 offset:16384
    s_waitcnt lgkmcnt(10)
    v_mfma_f32_32x32x16_bf16 v[28:43], v[48:51], v[64:67], v[28:43]
    ds_read_b128 v[64:67], v3 offset:16384
    ds_read_b64_tr_b16 v[48:49], v6 offset:18432
    ds_read_b64_tr_b16 v[50:51], v6 offset:18944
    v_add_u32 v16, s68, v12
    ds_read_b32 v16, v16
    v_add_u32 v17, s69, v12
    ds_read_b32 v17, v17
    s_waitcnt lgkmcnt(12)
    v_mfma_f32_32x32x16_bf16 v[28:43], v[52:55], v[68:71], v[28:43]
    ds_read_b128 v[68:71], v4 offset:16384
    ds_read_b64_tr_b16 v[52:53], v6 offset:20480
    ds_read_b64_tr_b16 v[54:55], v6 offset:20992
    s_waitcnt lgkmcnt(12)
    v_mfma_f32_32x32x16_bf16 v[28:43], v[56:59], v[72:75], v[28:43]
    ds_read_b128 v[72:75], v5 offset:16384
    ds_read_b64_tr_b16 v[56:57], v6 offset:22528
    ds_read_b64_tr_b16 v[58:59], v6 offset:23040
    s_waitcnt lgkmcnt(6)
    v_lshl_add_u32 v16, v16, 7, v11
    v_lshl_add_u32 v17, v17, 7, v11
    s_waitcnt vmcnt(2)
    s_barrier
    v_mfma_f32_32x32x16_bf16 v[76:91], v[100:103], v[60:63], 0
    v_mfma_f32_32x32x16_bf16 v[28:43], v[44:47], v[60:63], v[28:43]
    ds_read_b128 v[60:63], v2 offset:32768
    ds_read_b64_tr_b16 v[44:45], v6 offset:32768
    ds_read_b64_tr_b16 v[46:47], v6 offset:33280
    ds_read_b64 v[120:121], v7 offset:32768
    s_add_u32 m0, s89, 0
    s_nop 0
    buffer_load_dwordx4 v16, s[32:35], 0 offen lds
    v_mfma_f32_32x32x16_bf16 v[76:91], v[104:107], v[64:67], v[76:91]
    v_mfma_f32_32x32x16_bf16 v[28:43], v[48:51], v[64:67], v[28:43]
    ds_read_b128 v[64:67], v3 offset:32768
    ds_read_b64_tr_b16 v[48:49], v6 offset:34816
    ds_read_b64_tr_b16 v[50:51], v6 offset:35328
    v_add_u32 v18, s70, v12
    ds_read_b32 v18, v18
    v_add_u32 v19, s71, v12
    ds_read_b32 v19, v19
    s_add_u32 m0, s89, 8192
    s_nop 0
    buffer_load_dwordx4 v17, s[32:35], 0 offen lds
    s_waitcnt lgkmcnt(12)
    v_mfma_f32_32x32x16_bf16 v[76:91], v[108:111], v[68:71], v[76:91]
    v_mfma_f32_32x32x16_bf16 v[28:43], v[52:55], v[68:71], v[28:43]
    ds_read_b128 v[68:71], v4 offset:32768
    ds_read_b64_tr_b16 v[52:53], v6 offset:36864
    ds_read_b64_tr_b16 v[54:55], v6 offset:37376
    s_add_u32 m0, s89, 65536
    s_lshl_b32 s91, s68, 13
    buffer_load_dwordx4 v10, s[40:43], s91 offen lds
    s_waitcnt lgkmcnt(12)
    v_mfma_f32_32x32x16_bf16 v[76:91], v[112:115], v[72:75], v[76:91]
    v_mfma_f32_32x32x16_bf16 v[28:43], v[56:59], v[72:75], v[28:43]
    ds_read_b128 v[72:75], v5 offset:32768
    ds_read_b64_tr_b16 v[56:57], v6 offset:38912
    ds_read_b64_tr_b16 v[58:59], v6 offset:39424
    s_add_u32 m0, s89, 73728
    s_lshl_b32 s91, s69, 13
    buffer_load_dwordx4 v10, s[40:43], s91 offen lds
    s_waitcnt lgkmcnt(6)
    v_lshl_add_u32 v18, v18, 7, v11
    v_lshl_add_u32 v19, v19, 7, v11
    s_waitcnt vmcnt(4)
    s_barrier
    v_mfma_f32_32x32x16_bf16 v[28:43], v[44:47], v[60:63], v[28:43]
    ds_read_b128 v[60:63], v2 offset:49152
    ds_read_b64_tr_b16 v[44:45], v6 offset:49152
    ds_read_b64_tr_b16 v[46:47], v6 offset:49664
    ds_read_b64 v[122:123], v7 offset:49152
    v_mov_b32 v15, v84
    s_add_u32 m0, s89, 16384
    s_nop 0
    buffer_load_dwordx4 v18, s[32:35], 0 offen lds
    v_mfma_f32_32x32x16_bf16 v[28:43], v[48:51], v[64:67], v[28:43]
    ds_read_b128 v[64:67], v3 offset:49152
    ds_read_b64_tr_b16 v[48:49], v6 offset:51200
    ds_read_b64_tr_b16 v[50:51], v6 offset:51712
    v_add_u32 v16, s72, v12
    ds_read_b32 v16, v16
    v_add_u32 v17, s73, v12
    ds_read_b32 v17, v17
    s_add_u32 m0, s89, 24576
    s_nop 0
    buffer_load_dwordx4 v19, s[32:35], 0 offen lds
    s_waitcnt lgkmcnt(12)
    v_mfma_f32_32x32x16_bf16 v[28:43], v[52:55], v[68:71], v[28:43]
    ds_read_b128 v[68:71], v4 offset:49152
    ds_read_b64_tr_b16 v[52:53], v6 offset:53248
    ds_read_b64_tr_b16 v[54:55], v6 offset:53760
    s_add_u32 m0, s89, 81920
    s_lshl_b32 s91, s70, 13
    buffer_load_dwordx4 v10, s[40:43], s91 offen lds
    s_waitcnt lgkmcnt(12)
    v_mfma_f32_32x32x16_bf16 v[28:43], v[56:59], v[72:75], v[28:43]
    ds_read_b128 v[72:75], v5 offset:49152
    ds_read_b64_tr_b16 v[56:57], v6 offset:55296
    ds_read_b64_tr_b16 v[58:59], v6 offset:55808
    s_add_u32 m0, s89, 90112
    s_lshl_b32 s91, s71, 13
    buffer_load_dwordx4 v10, s[40:43], s91 offen lds
    s_waitcnt lgkmcnt(6)
    v_lshl_add_u32 v16, v16, 7, v11
    v_lshl_add_u32 v17, v17, 7, v11
    s_waitcnt vmcnt(4)
    s_barrier
    v_mfma_f32_32x32x16_bf16 v[84:99], v[100:103], v[60:63], 0
    v_mfma_f32_32x32x16_bf16 v[28:43], v[44:47], v[60:63], v[28:43]
    ds_read_b128 v[60:63], v2 offset:0
    ds_read_b64_tr_b16 v[44:45], v6 offset:0
    ds_read_b64_tr_b16 v[46:47], v6 offset:512
    ds_read_b64 v[124:125], v7 offset:0
    s_add_u32 m0, s89, 32768
    s_nop 0
    buffer_load_dwordx4 v16, s[32:35], 0 offen lds
    v_mfma_f32_32x32x16_bf16 v[84:99], v[104:107], v[64:67], v[84:99]
    v_mfma_f32_32x32x16_bf16 v[28:43], v[48:51], v[64:67], v[28:43]
    ds_read_b128 v[64:67], v3 offset:0
    ds_read_b64_tr_b16 v[48:49], v6 offset:2048
    ds_read_b64_tr_b16 v[50:51], v6 offset:2560
    v_add_u32 v18, s74, v12
    ds_read_b32 v18, v18
    v_add_u32 v19, s75, v12
    ds_read_b32 v19, v19
    s_add_u32 m0, s89, 40960
    s_nop 0
    buffer_load_dwordx4 v17, s[32:35], 0 offen lds
    s_waitcnt lgkmcnt(12)
    v_mfma_f32_32x32x16_bf16 v[84:99], v[108:111], v[68:71], v[84:99]
    v_mfma_f32_32x32x16_bf16 v[28:43], v[52:55], v[68:71], v[28:43]
    ds_read_b128 v[68:71], v4 offset:0
    ds_read_b64_tr_b16 v[52:53], v6 offset:4096
    ds_read_b64_tr_b16 v[54:55], v6 offset:4608
    s_add_u32 m0, s89, 98304
    s_lshl_b32 s91, s72, 13
    buffer_load_dwordx4 v10, s[40:43], s91 offen lds
    s_waitcnt lgkmcnt(12)
    v_mfma_f32_32x32x16_bf16 v[84:99], v[112:115], v[72:75], v[84:99]
    v_mfma_f32_32x32x16_bf16 v[28:43], v[56:59], v[72:75], v[28:43]
    ds_read_b128 v[72:75], v5 offset:0
    ds_read_b64_tr_b16 v[56:57], v6 offset:6144
    ds_read_b64_tr_b16 v[58:59], v6 offset:6656
    s_add_u32 m0, s89, 106496
    s_lshl_b32 s91, s73, 13
    buffer_load_dwordx4 v10, s[40:43], s91 offen lds
    s_waitcnt lgkmcnt(6)
    v_lshl_add_u32 v18, v18, 7, v11
    v_lshl_add_u32 v19, v19, 7, v11
    s_waitcnt vmcnt(4)
    s_barrier
    v_mfma_f32_32x32x16_bf16 v[28:43], v[44:47], v[60:63], v[28:43]
    ds_read_b128 v[60:63], v2 offset:16384
    ds_read_b64_tr_b16 v[44:45], v6 offset:16384
    ds_read_b64_tr_b16 v[46:47], v6 offset:16896
    ds_read_b64 v[126:127], v7 offset:16384
    v_cvt_pk_bf16_f32 v240, v76, v84
    v_cvt_pk_bf16_f32 v241, v77, v85
    v_cvt_pk_bf16_f32 v242, v78, v86
    v_cvt_pk_bf16_f32 v243, v79, v87
    v_cvt_pk_bf16_f32 v244, v80, v88
    v_cvt_pk_bf16_f32 v245, v81, v89
    v_cvt_pk_bf16_f32 v246, v82, v90
    v_cvt_pk_bf16_f32 v247, v83, v91
    v_cvt_pk_bf16_f32 v248, v15, v92
    ds_write_b32 v14, v248 offset:0
    ds_write2st64_b32 v8, v240, v241 offset0:0 offset1:2
    ds_write2st64_b32 v8, v242, v243 offset0:4 offset1:6
    ds_write2st64_b32 v8, v244, v245 offset0:16 offset1:18
    ds_write2st64_b32 v8, v246, v247 offset0:20 offset1:22
    s_add_u32 m0, s89, 49152
    s_nop 0
    buffer_load_dwordx4 v18, s[32:35], 0 offen lds
    v_mfma_f32_32x32x16_bf16 v[28:43], v[48:51], v[64:67], v[28:43]
    s_waitcnt lgkmcnt(9)
    ds_read_b128 v[64:67], v3 offset:16384
    ds_read_b64_tr_b16 v[48:49], v6 offset:18432
    ds_read_b64_tr_b16 v[50:51], v6 offset:18944
    v_add_u32 v16, s76, v12
    ds_read_b32 v16, v16
    v_add_u32 v17, s77, v12
    ds_read_b32 v17, v17
    ds_read_b32 v144, v9 offset:0
    s_waitcnt lgkmcnt(9)
    ds_read_b32 v152, v9 offset:512
    ds_read_b32 v160, v9 offset:1024
    ds_read_b32 v168, v9 offset:1536
    s_add_u32 m0, s89, 57344
    s_nop 0
    buffer_load_dwordx4 v19, s[32:35], 0 offen lds
    v_mfma_f32_32x32x16_bf16 v[28:43], v[52:55], v[68:71], v[28:43]
    ds_read_b128 v[68:71], v4 offset:16384
    ds_read_b64_tr_b16 v[52:53], v6 offset:20480
    ds_read_b64_tr_b16 v[54:55], v6 offset:20992
    s_add_u32 m0, s89, 114688
    s_lshl_b32 s91, s74, 13
    buffer_load_dwordx4 v10, s[40:43], s91 offen lds
    v_mfma_f32_32x32x16_bf16 v[28:43], v[56:59], v[72:75], v[28:43]
    s_waitcnt lgkmcnt(9)
    ds_read_b128 v[72:75], v5 offset:16384
    ds_read_b64_tr_b16 v[56:57], v6 offset:22528
    ds_read_b64_tr_b16 v[58:59], v6 offset:23040
    s_add_u32 m0, s89, 122880
    s_lshl_b32 s91, s75, 13
    buffer_load_dwordx4 v10, s[40:43], s91 offen lds
    s_waitcnt lgkmcnt(10)
    v_lshl_add_u32 v16, v16, 7, v11
    v_lshl_add_u32 v17, v17, 7, v11
    s_waitcnt vmcnt(4)
    s_barrier
    v_mfma_f32_32x32x16_bf16 v[76:91], v[100:103], v[60:63], 0
    v_mfma_f32_32x32x16_bf16 v[28:43], v[44:47], v[60:63], v[28:43]
    ds_read_b128 v[60:63], v2 offset:32768
    ds_read_b64_tr_b16 v[44:45], v6 offset:32768
    ds_read_b64_tr_b16 v[46:47], v6 offset:33280
    ds_read_b64 v[128:129], v7 offset:32768
    s_add_u32 m0, s89, 0
    s_nop 0
    buffer_load_dwordx4 v16, s[32:35], 0 offen lds
    v_mfma_f32_32x32x16_bf16 v[76:91], v[104:107], v[64:67], v[76:91]
    v_mfma_f32_32x32x16_bf16 v[28:43], v[48:51], v[64:67], v[28:43]
    ds_read_b128 v[64:67], v3 offset:32768
    s_waitcnt lgkmcnt(9)
    ds_read_b64_tr_b16 v[48:49], v6 offset:34816
    ds_read_b64_tr_b16 v[50:51], v6 offset:35328
    v_add_u32 v18, s78, v12
    ds_read_b32 v18, v18
    v_add_u32 v19, s79, v12
    ds_read_b32 v19, v19
    ds_read_b32 v148, v9 offset:8192
    ds_read_b32 v156, v9 offset:8704
    s_waitcnt lgkmcnt(9)
    ds_read_b32 v164, v9 offset:9216
    ds_read_b32 v172, v9 offset:9728
    s_add_u32 m0, s89, 8192
    s_nop 0
    buffer_load_dwordx4 v17, s[32:35], 0 offen lds
    v_mfma_f32_32x32x16_bf16 v[76:91], v[108:111], v[68:71], v[76:91]
    v_mfma_f32_32x32x16_bf16 v[28:43], v[52:55], v[68:71], v[28:43]
    ds_read_b128 v[68:71], v4 offset:32768
    ds_read_b64_tr_b16 v[52:53], v6 offset:36864
    ds_read_b64_tr_b16 v[54:55], v6 offset:37376
    s_add_u32 m0, s89, 65536
    s_lshl_b32 s91, s76, 13
    buffer_load_dwordx4 v10, s[40:43], s91 offen lds
    v_mfma_f32_32x32x16_bf16 v[76:91], v[112:115], v[72:75], v[76:91]
    v_mfma_f32_32x32x16_bf16 v[28:43], v[56:59], v[72:75], v[28:43]
    ds_read_b128 v[72:75], v5 offset:32768
    s_waitcnt lgkmcnt(9)
    ds_read_b64_tr_b16 v[56:57], v6 offset:38912
    ds_read_b64_tr_b16 v[58:59], v6 offset:39424
    s_add_u32 m0, s89, 73728
    s_lshl_b32 s91, s77, 13
    buffer_load_dwordx4 v10, s[40:43], s91 offen lds
    s_waitcnt lgkmcnt(10)
    v_lshl_add_u32 v18, v18, 7, v11
    v_lshl_add_u32 v19, v19, 7, v11
    s_waitcnt vmcnt(4)
    s_barrier
    v_mfma_f32_32x32x16_bf16 v[28:43], v[44:47], v[60:63], v[28:43]
    ds_read_b128 v[60:63], v2 offset:49152
    ds_read_b64_tr_b16 v[44:45], v6 offset:49152
    ds_read_b64_tr_b16 v[46:47], v6 offset:49664
    ds_read_b64 v[130:131], v7 offset:49152
    v_mov_b32 v15, v84
    s_add_u32 m0, s89, 16384
    s_nop 0
    buffer_load_dwordx4 v18, s[32:35], 0 offen lds
    v_mfma_f32_32x32x16_bf16 v[28:43], v[48:51], v[64:67], v[28:43]
    ds_read_b128 v[64:67], v3 offset:49152
    s_waitcnt lgkmcnt(9)
    ds_read_b64_tr_b16 v[48:49], v6 offset:51200
    ds_read_b64_tr_b16 v[50:51], v6 offset:51712
    v_add_u32 v16, s80, v12
    ds_read_b32 v16, v16
    v_add_u32 v17, s81, v12
    ds_read_b32 v17, v17
    s_add_u32 m0, s89, 24576
    s_nop 0
    buffer_load_dwordx4 v19, s[32:35], 0 offen lds
    s_waitcnt lgkmcnt(12)
    v_mfma_f32_32x32x16_bf16 v[28:43], v[52:55], v[68:71], v[28:43]
    ds_read_b128 v[68:71], v4 offset:49152
    ds_read_b64_tr_b16 v[52:53], v6 offset:53248
    ds_read_b64_tr_b16 v[54:55], v6 offset:53760
    s_add_u32 m0, s89, 81920
    s_lshl_b32 s91, s78, 13
    buffer_load_dwordx4 v10, s[40:43], s91 offen lds
    s_waitcnt lgkmcnt(12)
    v_mfma_f32_32x32x16_bf16 v[28:43], v[56:59], v[72:75], v[28:43]
    ds_read_b128 v[72:75], v5 offset:49152
    ds_read_b64_tr_b16 v[56:57], v6 offset:55296
    ds_read_b64_tr_b16 v[58:59], v6 offset:55808
    s_add_u32 m0, s89, 90112
    s_lshl_b32 s91, s79, 13
    buffer_load_dwordx4 v10, s[40:43], s91 offen lds
    s_waitcnt lgkmcnt(6)
    v_lshl_add_u32 v16, v16, 7, v11
    v_lshl_add_u32 v17, v17, 7, v11
    s_waitcnt vmcnt(4)
    s_barrier
    v_mfma_f32_32x32x16_bf16 v[84:99], v[100:103], v[60:63], 0
    v_mfma_f32_32x32x16_bf16 v[28:43], v[44:47], v[60:63], v[28:43]
    ds_read_b128 v[60:63], v2 offset:0
    ds_read_b64_tr_b16 v[44:45], v6 offset:0
    ds_read_b64_tr_b16 v[46:47], v6 offset:512
    ds_read_b64 v[132:133], v7 offset:0
    s_add_u32 m0, s89, 32768
    s_nop 0
    buffer_load_dwordx4 v16, s[32:35], 0 offen lds
    v_mfma_f32_32x32x16_bf16 v[84:99], v[104:107], v[64:67], v[84:99]
    v_mfma_f32_32x32x16_bf16 v[28:43], v[48:51], v[64:67], v[28:43]
    ds_read_b128 v[64:67], v3 offset:0
    ds_read_b64_tr_b16 v[48:49], v6 offset:2048
    ds_read_b64_tr_b16 v[50:51], v6 offset:2560
    v_add_u32 v18, s82, v12
    ds_read_b32 v18, v18
    v_add_u32 v19, s83, v12
    ds_read_b32 v19, v19
    s_add_u32 m0, s89, 40960
    s_nop 0
    buffer_load_dwordx4 v17, s[32:35], 0 offen lds
    s_waitcnt lgkmcnt(12)
    v_mfma_f32_32x32x16_bf16 v[84:99], v[108:111], v[68:71], v[84:99]
    v_mfma_f32_32x32x16_bf16 v[28:43], v[52:55], v[68:71], v[28:43]
    ds_read_b128 v[68:71], v4 offset:0
    ds_read_b64_tr_b16 v[52:53], v6 offset:4096
    ds_read_b64_tr_b16 v[54:55], v6 offset:4608
    s_add_u32 m0, s89, 98304
    s_lshl_b32 s91, s80, 13
    buffer_load_dwordx4 v10, s[40:43], s91 offen lds
    s_waitcnt lgkmcnt(12)
    v_mfma_f32_32x32x16_bf16 v[84:99], v[112:115], v[72:75], v[84:99]
    v_mfma_f32_32x32x16_bf16 v[28:43], v[56:59], v[72:75], v[28:43]
    ds_read_b128 v[72:75], v5 offset:0
    ds_read_b64_tr_b16 v[56:57], v6 offset:6144
    ds_read_b64_tr_b16 v[58:59], v6 offset:6656
    s_add_u32 m0, s89, 106496
    s_lshl_b32 s91, s81, 13
    buffer_load_dwordx4 v10, s[40:43], s91 offen lds
    s_waitcnt lgkmcnt(6)
    v_lshl_add_u32 v18, v18, 7, v11
    v_lshl_add_u32 v19, v19, 7, v11
    s_waitcnt vmcnt(4)
    s_barrier
    v_mfma_f32_32x32x16_bf16 v[28:43], v[44:47], v[60:63], v[28:43]
    ds_read_b128 v[60:63], v2 offset:16384
    ds_read_b64_tr_b16 v[44:45], v6 offset:16384
    ds_read_b64_tr_b16 v[46:47], v6 offset:16896
    ds_read_b64 v[134:135], v7 offset:16384
    v_cvt_pk_bf16_f32 v240, v76, v84
    v_cvt_pk_bf16_f32 v241, v77, v85
    v_cvt_pk_bf16_f32 v242, v78, v86
    v_cvt_pk_bf16_f32 v243, v79, v87
    v_cvt_pk_bf16_f32 v244, v80, v88
    v_cvt_pk_bf16_f32 v245, v81, v89
    v_cvt_pk_bf16_f32 v246, v82, v90
    v_cvt_pk_bf16_f32 v247, v83, v91
    v_cvt_pk_bf16_f32 v248, v15, v92
    ds_write_b32 v14, v248 offset:4
    ds_write2st64_b32 v8, v240, v241 offset0:0 offset1:2
    ds_write2st64_b32 v8, v242, v243 offset0:4 offset1:6
    ds_write2st64_b32 v8, v244, v245 offset0:16 offset1:18
    ds_write2st64_b32 v8, v246, v247 offset0:20 offset1:22
    s_add_u32 m0, s89, 49152
    s_nop 0
    buffer_load_dwordx4 v18, s[32:35], 0 offen lds
    v_mfma_f32_32x32x16_bf16 v[28:43], v[48:51], v[64:67], v[28:43]
    s_waitcnt lgkmcnt(9)
    ds_read_b128 v[64:67], v3 offset:16384
    ds_read_b64_tr_b16 v[48:49], v6 offset:18432
    ds_read_b64_tr_b16 v[50:51], v6 offset:18944
    v_add_u32 v16, s84, v12
    ds_read_b32 v16, v16
    v_add_u32 v17, s85, v12
    ds_read_b32 v17, v17
    ds_read_b32 v145, v9 offset:0
    s_waitcnt lgkmcnt(9)
    ds_read_b32 v153, v9 offset:512
    ds_read_b32 v161, v9 offset:1024
    ds_read_b32 v169, v9 offset:1536
    s_add_u32 m0, s89, 57344
    s_nop 0
    buffer_load_dwordx4 v19, s[32:35], 0 offen lds
    v_mfma_f32_32x32x16_bf16 v[28:43], v[52:55], v[68:71], v[28:43]
    ds_read_b128 v[68:71], v4 offset:16384
    ds_read_b64_tr_b16 v[52:53], v6 offset:20480
    ds_read_b64_tr_b16 v[54:55], v6 offset:20992
    s_add_u32 m0, s89, 114688
    s_lshl_b32 s91, s82, 13
    buffer_load_dwordx4 v10, s[40:43], s91 offen lds
    v_mfma_f32_32x32x16_bf16 v[28:43], v[56:59], v[72:75], v[28:43]
    s_waitcnt lgkmcnt(9)
    ds_read_b128 v[72:75], v5 offset:16384
    ds_read_b64_tr_b16 v[56:57], v6 offset:22528
    ds_read_b64_tr_b16 v[58:59], v6 offset:23040
    s_add_u32 m0, s89, 122880
    s_lshl_b32 s91, s83, 13
    buffer_load_dwordx4 v10, s[40:43], s91 offen lds
    s_waitcnt lgkmcnt(10)
    v_lshl_add_u32 v16, v16, 7, v11
    v_lshl_add_u32 v17, v17, 7, v11
    s_waitcnt vmcnt(4)
    s_barrier
    v_mfma_f32_32x32x16_bf16 v[76:91], v[100:103], v[60:63], 0
    v_mfma_f32_32x32x16_bf16 v[28:43], v[44:47], v[60:63], v[28:43]
    ds_read_b128 v[60:63], v2 offset:32768
    ds_read_b64_tr_b16 v[44:45], v6 offset:32768
    ds_read_b64_tr_b16 v[46:47], v6 offset:33280
    ds_read_b64 v[136:137], v7 offset:32768
    s_add_u32 m0, s89, 0
    s_nop 0
    buffer_load_dwordx4 v16, s[32:35], 0 offen lds
    v_mfma_f32_32x32x16_bf16 v[76:91], v[104:107], v[64:67], v[76:91]
    v_mfma_f32_32x32x16_bf16 v[28:43], v[48:51], v[64:67], v[28:43]
    ds_read_b128 v[64:67], v3 offset:32768
    s_waitcnt lgkmcnt(9)
    ds_read_b64_tr_b16 v[48:49], v6 offset:34816
    ds_read_b64_tr_b16 v[50:51], v6 offset:35328
    ds_read_b32 v149, v9 offset:8192
    ds_read_b32 v157, v9 offset:8704
    ds_read_b32 v165, v9 offset:9216
    ds_read_b32 v173, v9 offset:9728
    s_add_u32 m0, s89, 8192
    s_nop 0
    buffer_load_dwordx4 v17, s[32:35], 0 offen lds
    s_waitcnt lgkmcnt(14)
    v_mfma_f32_32x32x16_bf16 v[76:91], v[108:111], v[68:71], v[76:91]
    v_mfma_f32_32x32x16_bf16 v[28:43], v[52:55], v[68:71], v[28:43]
    ds_read_b128 v[68:71], v4 offset:32768
    s_waitcnt lgkmcnt(9)
    ds_read_b64_tr_b16 v[52:53], v6 offset:36864
    ds_read_b64_tr_b16 v[54:55], v6 offset:37376
    s_add_u32 m0, s89, 65536
    s_lshl_b32 s91, s84, 13
    buffer_load_dwordx4 v10, s[40:43], s91 offen lds
    v_mfma_f32_32x32x16_bf16 v[76:91], v[112:115], v[72:75], v[76:91]
    v_mfma_f32_32x32x16_bf16 v[28:43], v[56:59], v[72:75], v[28:43]
    ds_read_b128 v[72:75], v5 offset:32768
    ds_read_b64_tr_b16 v[56:57], v6 offset:38912
    ds_read_b64_tr_b16 v[58:59], v6 offset:39424
    s_add_u32 m0, s89, 73728
    s_lshl_b32 s91, s85, 13
    buffer_load_dwordx4 v10, s[40:43], s91 offen lds
    s_waitcnt vmcnt(4)
    s_barrier
    v_mfma_f32_32x32x16_bf16 v[28:43], v[44:47], v[60:63], v[28:43]
    ds_read_b128 v[60:63], v2 offset:49152
    s_waitcnt lgkmcnt(9)
    ds_read_b64_tr_b16 v[44:45], v6 offset:49152
    ds_read_b64_tr_b16 v[46:47], v6 offset:49664
    ds_read_b64 v[138:139], v7 offset:49152
    v_mov_b32 v15, v84
    v_mfma_f32_32x32x16_bf16 v[28:43], v[48:51], v[64:67], v[28:43]
    ds_read_b128 v[64:67], v3 offset:49152
    ds_read_b64_tr_b16 v[48:49], v6 offset:51200
    ds_read_b64_tr_b16 v[50:51], v6 offset:51712
    s_waitcnt lgkmcnt(10)
    v_mfma_f32_32x32x16_bf16 v[28:43], v[52:55], v[68:71], v[28:43]
    ds_read_b128 v[68:71], v4 offset:49152
    ds_read_b64_tr_b16 v[52:53], v6 offset:53248
    ds_read_b64_tr_b16 v[54:55], v6 offset:53760
    s_lshl_b32 s91, s86, 11
    s_add_u32 s92, s91, 49152
    v_lshl_add_u32 v16, v1, 4, s92
    v_xor_b32 v17, 8192, v16
    v_lshrrev_b32 v250, 4, v1
    s_and_b32 s92, s86, 3
    s_lshl_b32 s92, s92, 8
    s_add_u32 s92, s92, 155648
    v_lshl_add_u32 v250, v250, 10, s92
    v_and_b32 v251, 15, v1
    v_lshl_add_u32 v18, v251, 4, v250
    s_and_b32 s91, s86, 2
    s_lshl_b32 s91, s91, 6
    s_lshr_b32 s92, s86, 2
    s_lshl_b32 s93, s92, 6
    s_add_u32 s91, s91, s93
    s_add_u32 s91, s91, 159744
    v_lshrrev_b32 v250, 5, v1
    v_lshl_add_u32 v19, v250, 4, s91
    s_lshl_b32 s91, s92, 12
    s_add_u32 s91, s91, 4294926336
    v_add_u32 v12, s91, v18
    s_waitcnt lgkmcnt(10)
    v_mfma_f32_32x32x16_bf16 v[28:43], v[56:59], v[72:75], v[28:43]
    ds_read_b128 v[72:75], v5 offset:49152
    ds_read_b64_tr_b16 v[56:57], v6 offset:55296
    ds_read_b64_tr_b16 v[58:59], v6 offset:55808
    s_cmp_eq_u32 s27, 1
    s_cbranch_scc1 L_c13
    s_add_u32 m0, s89, 16384
    s_nop 0
    buffer_load_dwordx4 v13, s[36:39], s28 offen lds
    s_add_u32 m0, s89, 24576
    s_nop 0
    buffer_load_dwordx4 v13, s[36:39], s29 offen lds
    s_add_u32 m0, s89, 81920
    s_add_u32 s91, s28, 86528
    buffer_load_dwordx4 v13, s[36:39], s91 offen lds
    s_add_u32 m0, s89, 90112
    s_add_u32 s91, s29, 86528
    buffer_load_dwordx4 v13, s[36:39], s91 offen lds
L_c13:
    s_cmp_eq_u32 s27, 1
    s_cbranch_scc1 L_c14
    s_waitcnt vmcnt(4)
    s_branch L_c15
L_c14:
    s_waitcnt vmcnt(0)
L_c15:
    s_waitcnt lgkmcnt(0)
    s_barrier
    v_mfma_f32_32x32x16_bf16 v[84:99], v[100:103], v[60:63], 0
    v_mfma_f32_32x32x16_bf16 v[28:43], v[44:47], v[60:63], v[28:43]
    ds_read_b128 v[60:63], v2 offset:0
    ds_read_b64_tr_b16 v[44:45], v6 offset:0
    ds_read_b64_tr_b16 v[46:47], v6 offset:512
    ds_read_b64 v[140:141], v7 offset:0
    v_mfma_f32_32x32x16_bf16 v[84:99], v[104:107], v[64:67], v[84:99]
    v_mfma_f32_32x32x16_bf16 v[28:43], v[48:51], v[64:67], v[28:43]
    ds_read_b128 v[64:67], v3 offset:0
    ds_read_b64_tr_b16 v[48:49], v6 offset:2048
    ds_read_b64_tr_b16 v[50:51], v6 offset:2560
    v_mfma_f32_32x32x16_bf16 v[84:99], v[108:111], v[68:71], v[84:99]
    v_mfma_f32_32x32x16_bf16 v[28:43], v[52:55], v[68:71], v[28:43]
    ds_read_b128 v[68:71], v4 offset:0
    ds_read_b64_tr_b16 v[52:53], v6 offset:4096
    ds_read_b64_tr_b16 v[54:55], v6 offset:4608
    v_lshrrev_b32 v250, 5, v1
    v_and_b32 v251, 31, v1
    s_and_b32 s91, s86, 1
    s_lshl_b32 s92, s91, 9
    s_add_u32 s92, s92, 114688
    v_lshl_add_u32 v252, v250, 12, s92
    v_lshl_add_u32 v11, v251, 4, v252
    s_lshl_b32 s91, s91, 10
    s_lshr_b32 s92, s86, 1
    s_lshl_b32 s92, s92, 3
    s_add_u32 s91, s91, s92
    s_add_u32 s91, s91, 139264
    v_lshl_add_u32 v252, v250, 2, s91
    v_lshl_add_u32 v10, v251, 5, v252
    v_mfma_f32_32x32x16_bf16 v[84:99], v[112:115], v[72:75], v[84:99]
    v_mfma_f32_32x32x16_bf16 v[28:43], v[56:59], v[72:75], v[28:43]
    ds_read_b128 v[72:75], v5 offset:0
    ds_read_b64_tr_b16 v[56:57], v6 offset:6144
    ds_read_b64_tr_b16 v[58:59], v6 offset:6656
    s_cmp_eq_u32 s27, 1
    s_cbranch_scc1 L_c16
    s_add_u32 m0, s89, 32768
    s_nop 0
    buffer_load_dwordx4 v13, s[36:39], s30 offen lds
    s_add_u32 m0, s89, 98304
    s_add_u32 s91, s30, 86528
    buffer_load_dwordx4 v13, s[36:39], s91 offen lds
    s_cmp_ge_u32 s86, 4
    s_cbranch_scc1 L_wc17
    s_cmp_ge_u32 s86, 2
    s_mov_b32 s93, 40960
    s_cselect_b32 s93, 104448, s93
    s_add_u32 m0, s89, s93
    s_nop 0
    buffer_load_dwordx4 v13, s[36:39], s31 offen lds
L_wc17:
L_c16:
    s_waitcnt lgkmcnt(10)
    v_mfma_f32_32x32x16_bf16 v[28:43], v[44:47], v[60:63], v[28:43]
    s_waitcnt lgkmcnt(6)
    v_mfma_f32_32x32x16_bf16 v[28:43], v[48:51], v[64:67], v[28:43]
    s_waitcnt lgkmcnt(3)
    v_mfma_f32_32x32x16_bf16 v[28:43], v[52:55], v[68:71], v[28:43]
    s_waitcnt lgkmcnt(0)
    v_mfma_f32_32x32x16_bf16 v[28:43], v[56:59], v[72:75], v[28:43]
    v_cvt_pk_bf16_f32 v240, v76, v84
    v_cvt_pk_bf16_f32 v241, v77, v85
    v_cvt_pk_bf16_f32 v242, v78, v86
    v_cvt_pk_bf16_f32 v243, v79, v87
    v_cvt_pk_bf16_f32 v244, v80, v88
    v_cvt_pk_bf16_f32 v245, v81, v89
    v_cvt_pk_bf16_f32 v246, v82, v90
    v_cvt_pk_bf16_f32 v247, v83, v91
    v_cvt_pk_bf16_f32 v248, v15, v92
    ds_write_b32 v14, v248 offset:8
    ds_write2st64_b32 v8, v240, v241 offset0:0 offset1:2
    ds_write2st64_b32 v8, v242, v243 offset0:4 offset1:6
    ds_write2st64_b32 v8, v244, v245 offset0:16 offset1:18
    ds_write2st64_b32 v8, v246, v247 offset0:20 offset1:22
    ds_write_b128 v16, v[36:39] offset:0
    ds_write_b128 v16, v[40:43] offset:1024
L_tail:
    s_cmp_eq_u32 s27, 1
    s_cbranch_scc1 L_tailB
    s_waitcnt lgkmcnt(0)
    s_barrier
    ds_read_b128 v[240:243], v18
    ds_read_b128 v[36:39], v17 offset:0
    ds_read_b128 v[40:43], v17 offset:1024
    ds_read_b128 v[108:111], v19 offset:0
    ds_read_b128 v[112:115], v19 offset:32
    ds_read_b32 v146, v9 offset:0
    ds_read_b32 v154, v9 offset:512
    ds_read_b32 v162, v9 offset:1024
    ds_read_b32 v170, v9 offset:1536
    ds_read_b32 v150, v9 offset:8192
    ds_read_b32 v158, v9 offset:8704
    ds_read_b32 v166, v9 offset:9216
    ds_read_b32 v174, v9 offset:9728
    s_mov_b32 s92, 0xbfb8aa3b
    s_mov_b32 s93, 0xbfb8aa3b
    s_waitcnt lgkmcnt(12)
    v_mfma_f32_16x16x32_bf16 v[244:247], v[20:23], v[240:243], 0
    ds_read_b32 v147, v9 offset:16384
    ds_read_b32 v155, v9 offset:16896
    ds_read_b32 v163, v9 offset:17408
    s_waitcnt lgkmcnt(9)
    ds_read_b32 v171, v9 offset:17920
    v_pk_add_f32 v[28:29], v[28:29], v[36:37]
    v_pk_add_f32 v[30:31], v[30:31], v[38:39]
    v_pk_add_f32 v[32:33], v[32:33], v[40:41]
    v_pk_add_f32 v[34:35], v[34:35], v[42:43]
    v_pk_mul_f32 v[36:37], v[28:29], v[28:29]
    v_pk_mul_f32 v[38:39], v[30:31], v[30:31]
    v_pk_mul_f32 v[40:41], v[32:33], v[32:33]
    v_pk_mul_f32 v[42:43], v[34:35], v[34:35]
    v_pk_mul_f32 v[248:249], v[244:245], v[244:245]
    v_pk_mul_f32 v[250:251], v[246:247], v[246:247]
    v_pk_fma_f32 v[248:249], v[248:249], v[142:143], v[142:143] op_sel:[0,0,1] op_sel_hi:[1,0,1]
    v_pk_fma_f32 v[250:251], v[250:251], v[142:143], v[142:143] op_sel:[0,0,1] op_sel_hi:[1,0,1]
    v_pk_mul_f32 v[248:249], v[248:249], v[244:245]
    v_pk_mul_f32 v[250:251], v[250:251], v[246:247]
    v_exp_f32 v248, v248
    v_exp_f32 v249, v249
    v_exp_f32 v250, v250
    v_exp_f32 v251, v251
    v_pk_add_f32 v[248:249], v[248:249], 1.0 op_sel_hi:[1,0]
    v_pk_add_f32 v[250:251], v[250:251], 1.0 op_sel_hi:[1,0]
    v_rcp_f32 v248, v248
    v_rcp_f32 v249, v249
    v_rcp_f32 v250, v250
    v_rcp_f32 v251, v251
    v_pk_mul_f32 v[248:249], v[248:249], v[244:245]
    v_pk_mul_f32 v[250:251], v[250:251], v[246:247]
    v_cvt_pk_bf16_f32 v240, v248, v249
    v_cvt_pk_bf16_f32 v241, v250, v251
    v_pk_fma_f32 v[36:37], v[36:37], v[142:143], v[142:143] op_sel:[0,0,1] op_sel_hi:[1,0,1]
    v_pk_fma_f32 v[38:39], v[38:39], v[142:143], v[142:143] op_sel:[0,0,1] op_sel_hi:[1,0,1]
    v_mfma_f32_16x16x16_bf16 v[244:247], v[24:25], v[240:241], 0
    v_pk_fma_f32 v[40:41], v[40:41], v[142:143], v[142:143] op_sel:[0,0,1] op_sel_hi:[1,0,1]
    v_pk_fma_f32 v[42:43], v[42:43], v[142:143], v[142:143] op_sel:[0,0,1] op_sel_hi:[1,0,1]
    v_pk_mul_f32 v[36:37], v[36:37], v[28:29]
    v_pk_mul_f32 v[38:39], v[38:39], v[30:31]
    v_pk_mul_f32 v[40:41], v[40:41], v[32:33]
    v_pk_mul_f32 v[42:43], v[42:43], v[34:35]
    s_waitcnt lgkmcnt(0)
    s_nop 0
    v_pk_mul_f32 v[248:249], v[244:245], s[92:93]
    v_pk_mul_f32 v[250:251], v[246:247], s[92:93]
    v_exp_f32 v248, v248
    v_exp_f32 v249, v249
    v_exp_f32 v250, v250
    v_exp_f32 v251, v251
    v_pk_add_f32 v[248:249], v[248:249], 1.0 op_sel_hi:[1,0]
    v_pk_add_f32 v[250:251], v[250:251], 1.0 op_sel_hi:[1,0]
    v_rcp_f32 v248, v248
    v_rcp_f32 v249, v249
    v_rcp_f32 v250, v250
    v_rcp_f32 v251, v251
    v_cvt_pk_bf16_f32 v240, v248, v249
    v_cvt_pk_bf16_f32 v241, v250, v251
    v_lshlrev_b32 v248, 16, v240
    v_and_b32 v249, 0xffff0000, v240
    v_lshlrev_b32 v250, 16, v241
    v_and_b32 v251, 0xffff0000, v241
    ds_write_b128 v12, v[248:251]
    v_and_b32 v242, 0xffff, v240
    v_lshrrev_b32 v243, 16, v240
    ds_write_b64 v12, v[242:243] offset:8192
    v_exp_f32 v36, v36
    v_exp_f32 v37, v37
    v_exp_f32 v38, v38
    v_exp_f32 v39, v39
    v_exp_f32 v40, v40
    v_exp_f32 v41, v41
    v_exp_f32 v42, v42
    v_exp_f32 v43, v43
    v_pk_add_f32 v[36:37], v[36:37], 1.0 op_sel_hi:[1,0]
    v_pk_add_f32 v[38:39], v[38:39], 1.0 op_sel_hi:[1,0]
    v_pk_add_f32 v[40:41], v[40:41], 1.0 op_sel_hi:[1,0]
    v_pk_add_f32 v[42:43], v[42:43], 1.0 op_sel_hi:[1,0]
    v_rcp_f32 v36, v36
    v_rcp_f32 v37, v37
    v_rcp_f32 v38, v38
    v_rcp_f32 v39, v39
    v_rcp_f32 v40, v40
    v_rcp_f32 v41, v41
    v_rcp_f32 v42, v42
    v_rcp_f32 v43, v43
    v_pk_mul_f32 v[108:109], v[108:109], v[28:29]
    v_pk_mul_f32 v[110:111], v[110:111], v[30:31]
    v_pk_mul_f32 v[112:113], v[112:113], v[32:33]
    v_pk_mul_f32 v[114:115], v[114:115], v[34:35]
    v_pk_mul_f32 v[2:3], v[108:109], v[36:37]
    v_pk_fma_f32 v[2:3], v[110:111], v[38:39], v[2:3]
    v_pk_fma_f32 v[2:3], v[112:113], v[40:41], v[2:3]
    v_pk_fma_f32 v[2:3], v[114:115], v[42:43], v[2:3]
    s_waitcnt lgkmcnt(0)
    s_barrier
    ds_read_b64 v[108:109], v11 offset:8192
    ds_read_b128 v[28:31], v11 offset:0
    ds_read_b64 v[110:111], v11 offset:9216
    ds_read_b128 v[32:35], v11 offset:1024
    ds_read_b64 v[112:113], v11 offset:10240
    ds_read_b128 v[36:39], v11 offset:2048
    ds_read_b64 v[114:115], v11 offset:11264
    ds_read_b128 v[40:43], v11 offset:3072
    v_mov_b32 v215, 0
    v_mov_b32 v183, 0
    v_mov_b32 v223, 0
    v_mov_b32 v191, 0
    v_mov_b32 v231, 0
    v_mov_b32 v199, 0
    v_mov_b32 v239, 0
    v_mov_b32 v207, 0
    s_waitcnt lgkmcnt(6)
    v_dot2_f32_bf16 v240, v144, v108, 0
    v_dot2_f32_bf16 v241, v144, v30, 0
    v_dot2_f32_bf16 v242, v148, v109, 0
    v_dot2_f32_bf16 v243, v148, v31, 0
    s_waitcnt lgkmcnt(4)
    v_dot2_f32_bf16 v244, v145, v110, 0
    v_dot2_f32_bf16 v245, v145, v34, 0
    v_dot2_f32_bf16 v246, v149, v111, 0
    v_dot2_f32_bf16 v247, v149, v35, 0
    s_waitcnt lgkmcnt(2)
    v_dot2_f32_bf16 v248, v146, v112, 0
    v_dot2_f32_bf16 v249, v146, v38, 0
    v_dot2_f32_bf16 v250, v150, v113, 0
    v_dot2_f32_bf16 v251, v150, v39, 0
    s_waitcnt lgkmcnt(0)
    v_dot2_f32_bf16 v252, v147, v114, 0
    v_cvt_pk_bf16_f32 v208, v240, v241
    v_cvt_pk_bf16_f32 v212, v242, v243
    v_cvt_pk_bf16_f32 v209, v244, v245
    v_cvt_pk_bf16_f32 v213, v246, v247
    v_cvt_pk_bf16_f32 v210, v248, v249
    v_cvt_pk_bf16_f32 v214, v250, v251
    v_cvt_pk_bf16_f32 v211, v252, 0
    v_dot2_f32_bf16 v240, v152, v108, 0
    v_dot2_f32_bf16 v241, v152, v30, 0
    v_dot2_f32_bf16 v242, v156, v109, 0
    v_dot2_f32_bf16 v243, v156, v31, 0
    v_dot2_f32_bf16 v244, v153, v110, 0
    v_dot2_f32_bf16 v245, v153, v34, 0
    v_dot2_f32_bf16 v246, v157, v111, 0
    v_dot2_f32_bf16 v247, v157, v35, 0
    v_dot2_f32_bf16 v248, v154, v112, 0
    v_dot2_f32_bf16 v249, v154, v38, 0
    v_dot2_f32_bf16 v250, v158, v113, 0
    v_dot2_f32_bf16 v251, v158, v39, 0
    v_dot2_f32_bf16 v252, v155, v114, 0
    v_cvt_pk_bf16_f32 v216, v240, v241
    v_cvt_pk_bf16_f32 v220, v242, v243
    v_cvt_pk_bf16_f32 v217, v244, v245
    v_cvt_pk_bf16_f32 v221, v246, v247
    v_cvt_pk_bf16_f32 v218, v248, v249
    v_cvt_pk_bf16_f32 v222, v250, v251
    v_cvt_pk_bf16_f32 v219, v252, 0
    v_dot2_f32_bf16 v240, v160, v108, 0
    v_dot2_f32_bf16 v241, v160, v30, 0
    v_dot2_f32_bf16 v242, v164, v109, 0
    v_dot2_f32_bf16 v243, v164, v31, 0
    v_dot2_f32_bf16 v244, v161, v110, 0
    v_dot2_f32_bf16 v245, v161, v34, 0
    v_dot2_f32_bf16 v246, v165, v111, 0
    v_dot2_f32_bf16 v247, v165, v35, 0
    v_dot2_f32_bf16 v248, v162, v112, 0
    v_dot2_f32_bf16 v249, v162, v38, 0
    v_dot2_f32_bf16 v250, v166, v113, 0
    v_dot2_f32_bf16 v251, v166, v39, 0
    v_dot2_f32_bf16 v252, v163, v114, 0
    v_cvt_pk_bf16_f32 v224, v240, v241
    v_cvt_pk_bf16_f32 v228, v242, v243
    v_cvt_pk_bf16_f32 v225, v244, v245
    v_cvt_pk_bf16_f32 v229, v246, v247
    v_cvt_pk_bf16_f32 v226, v248, v249
    v_cvt_pk_bf16_f32 v230, v250, v251
    v_cvt_pk_bf16_f32 v227, v252, 0
    v_dot2_f32_bf16 v240, v168, v108, 0
    v_dot2_f32_bf16 v241, v168, v30, 0
    v_dot2_f32_bf16 v242, v172, v109, 0
    v_dot2_f32_bf16 v243, v172, v31, 0
    v_dot2_f32_bf16 v244, v169, v110, 0
    v_dot2_f32_bf16 v245, v169, v34, 0
    v_dot2_f32_bf16 v246, v173, v111, 0
    v_dot2_f32_bf16 v247, v173, v35, 0
    v_dot2_f32_bf16 v248, v170, v112, 0
    v_dot2_f32_bf16 v249, v170, v38, 0
    v_dot2_f32_bf16 v250, v174, v113, 0
    v_dot2_f32_bf16 v251, v174, v39, 0
    v_dot2_f32_bf16 v252, v171, v114, 0
    v_cvt_pk_bf16_f32 v232, v240, v241
    v_cvt_pk_bf16_f32 v236, v242, v243
    v_cvt_pk_bf16_f32 v233, v244, v245
    v_cvt_pk_bf16_f32 v237, v246, v247
    v_cvt_pk_bf16_f32 v234, v248, v249
    v_cvt_pk_bf16_f32 v238, v250, v251
    v_cvt_pk_bf16_f32 v235, v252, 0
    v_add_u32 v4, 65536, v26
    s_waitcnt vmcnt(0)
    s_barrier
    ds_read_b64 v[76:77], v26 offset:16384
    ds_read_b64 v[78:79], v26 offset:20480
    ds_read_b64 v[80:81], v26 offset:24576
    ds_read_b64 v[82:83], v26 offset:28672
    ds_read_b64 v[84:85], v26 offset:32768
    ds_read_b64 v[86:87], v26 offset:36864
    ds_read_b64 v[88:89], v26 offset:40960
    ds_read_b64 v[90:91], v26 offset:18432
    ds_read_b64 v[92:93], v26 offset:22528
    ds_read_b64 v[94:95], v26 offset:26624
    ds_read_b64 v[96:97], v26 offset:30720
    ds_read_b64 v[98:99], v26 offset:34816
    ds_read_b64 v[100:101], v26 offset:38912
    s_waitcnt lgkmcnt(11)
    v_perm_b32 v176, v78, v76, s94
    v_perm_b32 v184, v78, v76, s95
    v_perm_b32 v192, v79, v77, s94
    v_perm_b32 v200, v79, v77, s95
    s_waitcnt lgkmcnt(9)
    v_perm_b32 v177, v82, v80, s94
    v_perm_b32 v185, v82, v80, s95
    v_perm_b32 v193, v83, v81, s94
    v_perm_b32 v201, v83, v81, s95
    s_waitcnt lgkmcnt(7)
    v_perm_b32 v178, v86, v84, s94
    v_perm_b32 v186, v86, v84, s95
    v_perm_b32 v194, v87, v85, s94
    v_perm_b32 v202, v87, v85, s95
    s_waitcnt lgkmcnt(6)
    v_and_b32 v179, 0xffff, v88
    v_lshrrev_b32 v187, 16, v88
    v_and_b32 v195, 0xffff, v89
    v_lshrrev_b32 v203, 16, v89
    ds_read_b64 v[240:241], v4 offset:16384
    ds_read_b64 v[242:243], v4 offset:20480
    ds_read_b64 v[244:245], v4 offset:24576
    ds_read_b64 v[246:247], v4 offset:28672
    ds_read_b64 v[248:249], v4 offset:32768
    ds_read_b64 v[250:251], v4 offset:36864
    ds_read_b64 v[252:253], v4 offset:40960
    s_waitcnt lgkmcnt(11)
    v_perm_b32 v180, v92, v90, s94
    v_perm_b32 v188, v92, v90, s95
    v_perm_b32 v196, v93, v91, s94
    v_perm_b32 v204, v93, v91, s95
    s_waitcnt lgkmcnt(9)
    v_perm_b32 v181, v96, v94, s94
    v_perm_b32 v189, v96, v94, s95
    v_perm_b32 v197, v97, v95, s94
    v_perm_b32 v205, v97, v95, s95
    s_waitcnt lgkmcnt(7)
    v_perm_b32 v182, v100, v98, s94
    v_perm_b32 v190, v100, v98, s95
    v_perm_b32 v198, v101, v99, s94
    v_perm_b32 v206, v101, v99, s95
    v_mfma_f32_32x32x16_bf16 v[44:59], v[176:179], v[144:147], 0
    v_mfma_f32_32x32x16_bf16 v[44:59], v[180:183], v[148:151], v[44:59]
    v_mfma_f32_32x32x16_bf16 v[60:75], v[184:187], v[152:155], 0
    v_mfma_f32_32x32x16_bf16 v[60:75], v[188:191], v[156:159], v[60:75]
    v_mfma_f32_32x32x16_bf16 v[76:91], v[192:195], v[160:163], 0
    v_mfma_f32_32x32x16_bf16 v[76:91], v[196:199], v[164:167], v[76:91]
    v_mfma_f32_32x32x16_bf16 v[92:107], v[200:203], v[168:171], 0
    v_mfma_f32_32x32x16_bf16 v[92:107], v[204:207], v[172:175], v[92:107]
    s_waitcnt lgkmcnt(5)
    v_perm_b32 v176, v242, v240, s94
    v_perm_b32 v184, v242, v240, s95
    v_perm_b32 v192, v243, v241, s94
    v_perm_b32 v200, v243, v241, s95
    s_waitcnt lgkmcnt(3)
    v_perm_b32 v177, v246, v244, s94
    v_perm_b32 v185, v246, v244, s95
    v_perm_b32 v193, v247, v245, s94
    v_perm_b32 v201, v247, v245, s95
    s_waitcnt lgkmcnt(1)
    v_perm_b32 v178, v250, v248, s94
    v_perm_b32 v186, v250, v248, s95
    v_perm_b32 v194, v251, v249, s94
    v_perm_b32 v202, v251, v249, s95
    s_waitcnt lgkmcnt(0)
    v_and_b32 v179, 0xffff, v252
    v_lshrrev_b32 v187, 16, v252
    v_and_b32 v195, 0xffff, v253
    v_lshrrev_b32 v203, 16, v253
    ds_read_b64 v[240:241], v4 offset:18432
    ds_read_b64 v[242:243], v4 offset:22528
    ds_read_b64 v[244:245], v4 offset:26624
    ds_read_b64 v[246:247], v4 offset:30720
    ds_read_b64 v[248:249], v4 offset:34816
    ds_read_b64 v[250:251], v4 offset:38912
    s_waitcnt lgkmcnt(4)
    v_perm_b32 v180, v242, v240, s94
    v_perm_b32 v188, v242, v240, s95
    v_perm_b32 v196, v243, v241, s94
    v_perm_b32 v204, v243, v241, s95
    s_waitcnt lgkmcnt(2)
    v_perm_b32 v181, v246, v244, s94
    v_perm_b32 v189, v246, v244, s95
    v_perm_b32 v197, v247, v245, s94
    v_perm_b32 v205, v247, v245, s95
    s_waitcnt lgkmcnt(0)
    v_perm_b32 v182, v250, v248, s94
    v_perm_b32 v190, v250, v248, s95
    v_perm_b32 v198, v251, v249, s94
    v_perm_b32 v206, v251, v249, s95
    v_mfma_f32_32x32x16_bf16 v[144:159], v[176:179], v[208:211], 0
    v_mfma_f32_32x32x16_bf16 v[144:159], v[180:183], v[212:215], v[144:159]
    v_mfma_f32_32x32x16_bf16 v[160:175], v[184:187], v[216:219], 0
    v_mfma_f32_32x32x16_bf16 v[160:175], v[188:191], v[220:223], v[160:175]
    s_nop 9
    v_pk_fma_f32 v[44:45], v[28:29], v[144:145], v[44:45]
    v_pk_fma_f32 v[46:47], v[30:31], v[146:147], v[46:47]
    v_pk_fma_f32 v[48:49], v[32:33], v[148:149], v[48:49]
    v_pk_fma_f32 v[50:51], v[34:35], v[150:151], v[50:51]
    v_pk_fma_f32 v[52:53], v[36:37], v[152:153], v[52:53]
    v_pk_fma_f32 v[54:55], v[38:39], v[154:155], v[54:55]
    v_fmac_f32 v56, v40, v156
    v_mfma_f32_32x32x16_bf16 v[144:159], v[192:195], v[224:227], 0
    v_mfma_f32_32x32x16_bf16 v[144:159], v[196:199], v[228:231], v[144:159]
    v_pk_fma_f32 v[60:61], v[28:29], v[160:161], v[60:61]
    v_pk_fma_f32 v[62:63], v[30:31], v[162:163], v[62:63]
    v_pk_fma_f32 v[64:65], v[32:33], v[164:165], v[64:65]
    v_pk_fma_f32 v[66:67], v[34:35], v[166:167], v[66:67]
    v_pk_fma_f32 v[68:69], v[36:37], v[168:169], v[68:69]
    v_pk_fma_f32 v[70:71], v[38:39], v[170:171], v[70:71]
    v_fmac_f32 v72, v40, v172
    v_mfma_f32_32x32x16_bf16 v[160:175], v[200:203], v[232:235], 0
    v_mfma_f32_32x32x16_bf16 v[160:175], v[204:207], v[236:239], v[160:175]
    v_cvt_pk_bf16_f32 v44, v44, v60
    v_cvt_pk_bf16_f32 v45, v45, v61
    v_cvt_pk_bf16_f32 v46, v46, v62
    v_cvt_pk_bf16_f32 v47, v47, v63
    v_cvt_pk_bf16_f32 v48, v48, v64
    v_cvt_pk_bf16_f32 v49, v49, v65
    v_cvt_pk_bf16_f32 v50, v50, v66
    v_cvt_pk_bf16_f32 v51, v51, v67
    v_cvt_pk_bf16_f32 v52, v52, v68
    v_cvt_pk_bf16_f32 v53, v53, v69
    v_cvt_pk_bf16_f32 v54, v54, v70
    v_cvt_pk_bf16_f32 v55, v55, v71
    v_cvt_pk_bf16_f32 v56, v56, v72
    v_dot2c_f32_bf16 v2, v44, v116
    v_dot2c_f32_bf16 v3, v45, v118
    v_dot2c_f32_bf16 v2, v46, v120
    v_dot2c_f32_bf16 v3, v47, v122
    v_dot2c_f32_bf16 v2, v48, v124
    v_dot2c_f32_bf16 v3, v49, v126
    v_dot2c_f32_bf16 v2, v50, v128
    v_dot2c_f32_bf16 v3, v51, v130
    v_dot2c_f32_bf16 v2, v52, v132
    v_dot2c_f32_bf16 v3, v53, v134
    v_dot2c_f32_bf16 v2, v54, v136
    v_dot2c_f32_bf16 v3, v55, v138
    v_dot2c_f32_bf16 v2, v56, v140
    v_pk_fma_f32 v[76:77], v[28:29], v[144:145], v[76:77]
    v_pk_fma_f32 v[78:79], v[30:31], v[146:147], v[78:79]
    v_pk_fma_f32 v[80:81], v[32:33], v[148:149], v[80:81]
    v_pk_fma_f32 v[82:83], v[34:35], v[150:151], v[82:83]
    v_pk_fma_f32 v[84:85], v[36:37], v[152:153], v[84:85]
    v_pk_fma_f32 v[86:87], v[38:39], v[154:155], v[86:87]
    v_fmac_f32 v88, v40, v156
    v_pk_fma_f32 v[92:93], v[28:29], v[160:161], v[92:93]
    v_pk_fma_f32 v[94:95], v[30:31], v[162:163], v[94:95]
    v_pk_fma_f32 v[96:97], v[32:33], v[164:165], v[96:97]
    v_pk_fma_f32 v[98:99], v[34:35], v[166:167], v[98:99]
    v_pk_fma_f32 v[100:101], v[36:37], v[168:169], v[100:101]
    v_pk_fma_f32 v[102:103], v[38:39], v[170:171], v[102:103]
    v_fmac_f32 v104, v40, v172
    v_cvt_pk_bf16_f32 v76, v76, v92
    v_cvt_pk_bf16_f32 v77, v77, v93
    v_cvt_pk_bf16_f32 v78, v78, v94
    v_cvt_pk_bf16_f32 v79, v79, v95
    v_cvt_pk_bf16_f32 v80, v80, v96
    v_cvt_pk_bf16_f32 v81, v81, v97
    v_cvt_pk_bf16_f32 v82, v82, v98
    v_cvt_pk_bf16_f32 v83, v83, v99
    v_cvt_pk_bf16_f32 v84, v84, v100
    v_cvt_pk_bf16_f32 v85, v85, v101
    v_cvt_pk_bf16_f32 v86, v86, v102
    v_cvt_pk_bf16_f32 v87, v87, v103
    v_cvt_pk_bf16_f32 v88, v88, v104
    v_dot2c_f32_bf16 v2, v76, v117
    v_dot2c_f32_bf16 v3, v77, v119
    v_dot2c_f32_bf16 v2, v78, v121
    v_dot2c_f32_bf16 v3, v79, v123
    v_dot2c_f32_bf16 v2, v80, v125
    v_dot2c_f32_bf16 v3, v81, v127
    v_dot2c_f32_bf16 v2, v82, v129
    v_dot2c_f32_bf16 v3, v83, v131
    v_dot2c_f32_bf16 v2, v84, v133
    v_dot2c_f32_bf16 v3, v85, v135
    v_dot2c_f32_bf16 v2, v86, v137
    v_dot2c_f32_bf16 v3, v87, v139
    v_dot2c_f32_bf16 v2, v88, v141
    s_nop 2
    v_add_f32 v2, v2, v3
    ds_write_b32 v10, v2
    s_branch L_final
L_tailB:
    s_waitcnt lgkmcnt(0)
    s_barrier
    ds_read_b128 v[240:243], v18
    ds_read_b128 v[36:39], v17 offset:0
    ds_read_b128 v[40:43], v17 offset:1024
    ds_read_b128 v[108:111], v19 offset:0
    ds_read_b128 v[112:115], v19 offset:32
    ds_read_b32 v146, v9 offset:0
    ds_read_b32 v154, v9 offset:512
    ds_read_b32 v162, v9 offset:1024
    ds_read_b32 v170, v9 offset:1536
    ds_read_b32 v150, v9 offset:8192
    ds_read_b32 v158, v9 offset:8704
    ds_read_b32 v166, v9 offset:9216
    ds_read_b32 v174, v9 offset:9728
    s_mov_b32 s92, 0xbfb8aa3b
    s_mov_b32 s93, 0xbfb8aa3b
    s_waitcnt lgkmcnt(12)
    v_mfma_f32_16x16x32_bf16 v[244:247], v[20:23], v[240:243], 0
    ds_read_b32 v147, v9 offset:16384
    ds_read_b32 v155, v9 offset:16896
    ds_read_b32 v163, v9 offset:17408
    s_waitcnt lgkmcnt(9)
    ds_read_b32 v171, v9 offset:17920
    v_pk_add_f32 v[28:29], v[28:29], v[36:37]
    v_pk_add_f32 v[30:31], v[30:31], v[38:39]
    v_pk_add_f32 v[32:33], v[32:33], v[40:41]
    v_pk_add_f32 v[34:35], v[34:35], v[42:43]
    v_pk_mul_f32 v[36:37], v[28:29], v[28:29]
    v_pk_mul_f32 v[38:39], v[30:31], v[30:31]
    v_pk_mul_f32 v[40:41], v[32:33], v[32:33]
    v_pk_mul_f32 v[42:43], v[34:35], v[34:35]
    v_pk_mul_f32 v[248:249], v[244:245], v[244:245]
    v_pk_mul_f32 v[250:251], v[246:247], v[246:247]
    v_pk_fma_f32 v[248:249], v[248:249], v[142:143], v[142:143] op_sel:[0,0,1] op_sel_hi:[1,0,1]
    v_pk_fma_f32 v[250:251], v[250:251], v[142:143], v[142:143] op_sel:[0,0,1] op_sel_hi:[1,0,1]
    v_pk_mul_f32 v[248:249], v[248:249], v[244:245]
    v_pk_mul_f32 v[250:251], v[250:251], v[246:247]
    v_exp_f32 v248, v248
    v_exp_f32 v249, v249
    v_exp_f32 v250, v250
    v_exp_f32 v251, v251
    v_pk_add_f32 v[248:249], v[248:249], 1.0 op_sel_hi:[1,0]
    v_pk_add_f32 v[250:251], v[250:251], 1.0 op_sel_hi:[1,0]
    v_rcp_f32 v248, v248
    v_rcp_f32 v249, v249
    v_rcp_f32 v250, v250
    v_rcp_f32 v251, v251
    v_pk_mul_f32 v[248:249], v[248:249], v[244:245]
    v_pk_mul_f32 v[250:251], v[250:251], v[246:247]
    v_cvt_pk_bf16_f32 v240, v248, v249
    v_cvt_pk_bf16_f32 v241, v250, v251
    v_pk_fma_f32 v[36:37], v[36:37], v[142:143], v[142:143] op_sel:[0,0,1] op_sel_hi:[1,0,1]
    v_pk_fma_f32 v[38:39], v[38:39], v[142:143], v[142:143] op_sel:[0,0,1] op_sel_hi:[1,0,1]
    v_mfma_f32_16x16x16_bf16 v[244:247], v[24:25], v[240:241], 0
    v_pk_fma_f32 v[40:41], v[40:41], v[142:143], v[142:143] op_sel:[0,0,1] op_sel_hi:[1,0,1]
    v_pk_fma_f32 v[42:43], v[42:43], v[142:143], v[142:143] op_sel:[0,0,1] op_sel_hi:[1,0,1]
    v_pk_mul_f32 v[36:37], v[36:37], v[28:29]
    v_pk_mul_f32 v[38:39], v[38:39], v[30:31]
    v_pk_mul_f32 v[40:41], v[40:41], v[32:33]
    v_pk_mul_f32 v[42:43], v[42:43], v[34:35]
    s_waitcnt lgkmcnt(0)
    v_mfma_f32_32x32x16_bf16 v[44:59], v[176:179], v[144:147], 0
    v_mfma_f32_32x32x16_bf16 v[44:59], v[180:183], v[148:151], v[44:59]
    v_pk_mul_f32 v[248:249], v[244:245], s[92:93]
    v_pk_mul_f32 v[250:251], v[246:247], s[92:93]
    v_exp_f32 v248, v248
    v_exp_f32 v249, v249
    v_exp_f32 v250, v250
    v_exp_f32 v251, v251
    v_pk_add_f32 v[248:249], v[248:249], 1.0 op_sel_hi:[1,0]
    v_pk_add_f32 v[250:251], v[250:251], 1.0 op_sel_hi:[1,0]
    v_mfma_f32_32x32x16_bf16 v[60:75], v[184:187], v[152:155], 0
    v_rcp_f32 v248, v248
    v_rcp_f32 v249, v249
    v_rcp_f32 v250, v250
    v_rcp_f32 v251, v251
    v_cvt_pk_bf16_f32 v240, v248, v249
    v_cvt_pk_bf16_f32 v241, v250, v251
    v_lshlrev_b32 v248, 16, v240
    v_mfma_f32_32x32x16_bf16 v[60:75], v[188:191], v[156:159], v[60:75]
    v_and_b32 v249, 0xffff0000, v240
    v_lshlrev_b32 v250, 16, v241
    v_and_b32 v251, 0xffff0000, v241
    ds_write_b128 v12, v[248:251]
    v_and_b32 v242, 0xffff, v240
    v_lshrrev_b32 v243, 16, v240
    ds_write_b64 v12, v[242:243] offset:8192
    v_mfma_f32_32x32x16_bf16 v[76:91], v[192:195], v[160:163], 0
    v_exp_f32 v36, v36
    v_exp_f32 v37, v37
    v_exp_f32 v38, v38
    v_exp_f32 v39, v39
    v_exp_f32 v40, v40
    v_exp_f32 v41, v41
    v_exp_f32 v42, v42
    v_exp_f32 v43, v43
    v_pk_add_f32 v[36:37], v[36:37], 1.0 op_sel_hi:[1,0]
    v_pk_add_f32 v[38:39], v[38:39], 1.0 op_sel_hi:[1,0]
    v_mfma_f32_32x32x16_bf16 v[76:91], v[196:199], v[164:167], v[76:91]
    v_pk_add_f32 v[40:41], v[40:41], 1.0 op_sel_hi:[1,0]
    v_pk_add_f32 v[42:43], v[42:43], 1.0 op_sel_hi:[1,0]
    v_rcp_f32 v36, v36
    v_rcp_f32 v37, v37
    v_rcp_f32 v38, v38
    v_rcp_f32 v39, v39
    v_rcp_f32 v40, v40
    v_rcp_f32 v41, v41
    v_rcp_f32 v42, v42
    v_mfma_f32_32x32x16_bf16 v[92:107], v[200:203], v[168:171], 0
    v_rcp_f32 v43, v43
    v_pk_mul_f32 v[108:109], v[108:109], v[28:29]
    v_pk_mul_f32 v[110:111], v[110:111], v[30:31]
    v_pk_mul_f32 v[112:113], v[112:113], v[32:33]
    v_pk_mul_f32 v[114:115], v[114:115], v[34:35]
    v_pk_mul_f32 v[2:3], v[108:109], v[36:37]
    v_pk_fma_f32 v[2:3], v[110:111], v[38:39], v[2:3]
    v_pk_fma_f32 v[2:3], v[112:113], v[40:41], v[2:3]
    v_pk_fma_f32 v[2:3], v[114:115], v[42:43], v[2:3]
    v_mfma_f32_32x32x16_bf16 v[92:107], v[204:207], v[172:175], v[92:107]
    s_waitcnt lgkmcnt(0)
    s_barrier
    ds_read_b64 v[108:109], v11 offset:8192
    ds_read_b128 v[28:31], v11 offset:0
    ds_read_b64 v[110:111], v11 offset:9216
    ds_read_b128 v[32:35], v11 offset:1024
    ds_read_b64 v[112:113], v11 offset:10240
    ds_read_b128 v[36:39], v11 offset:2048
    ds_read_b64 v[114:115], v11 offset:11264
    ds_read_b128 v[40:43], v11 offset:3072
    s_waitcnt lgkmcnt(6)
    v_dot2_f32_bf16 v240, v144, v108, 0
    v_dot2_f32_bf16 v241, v144, v30, 0
    v_dot2_f32_bf16 v242, v148, v109, 0
    v_dot2_f32_bf16 v243, v148, v31, 0
    s_waitcnt lgkmcnt(4)
    v_dot2_f32_bf16 v244, v145, v110, 0
    v_dot2_f32_bf16 v245, v145, v34, 0
    v_dot2_f32_bf16 v246, v149, v111, 0
    v_dot2_f32_bf16 v247, v149, v35, 0
    s_waitcnt lgkmcnt(2)
    v_dot2_f32_bf16 v248, v146, v112, 0
    v_dot2_f32_bf16 v249, v146, v38, 0
    v_dot2_f32_bf16 v250, v150, v113, 0
    v_dot2_f32_bf16 v251, v150, v39, 0
    s_waitcnt lgkmcnt(0)
    v_dot2_f32_bf16 v252, v147, v114, 0
    v_cvt_pk_bf16_f32 v144, v240, v241
    v_cvt_pk_bf16_f32 v148, v242, v243
    v_cvt_pk_bf16_f32 v145, v244, v245
    v_cvt_pk_bf16_f32 v149, v246, v247
    v_cvt_pk_bf16_f32 v146, v248, v249
    v_cvt_pk_bf16_f32 v150, v250, v251
    v_cvt_pk_bf16_f32 v147, v252, 0
    s_nop 1
    v_mfma_f32_32x32x16_bf16 v[176:191], v[208:211], v[144:147], 0
    v_mfma_f32_32x32x16_bf16 v[176:191], v[212:215], v[148:151], v[176:191]
    v_dot2_f32_bf16 v240, v152, v108, 0
    v_dot2_f32_bf16 v241, v152, v30, 0
    v_dot2_f32_bf16 v242, v156, v109, 0
    v_dot2_f32_bf16 v243, v156, v31, 0
    v_dot2_f32_bf16 v244, v153, v110, 0
    v_dot2_f32_bf16 v245, v153, v34, 0
    v_dot2_f32_bf16 v246, v157, v111, 0
    v_dot2_f32_bf16 v247, v157, v35, 0
    v_dot2_f32_bf16 v248, v154, v112, 0
    v_dot2_f32_bf16 v249, v154, v38, 0
    v_dot2_f32_bf16 v250, v158, v113, 0
    v_dot2_f32_bf16 v251, v158, v39, 0
    v_dot2_f32_bf16 v252, v155, v114, 0
    v_cvt_pk_bf16_f32 v152, v240, v241
    v_cvt_pk_bf16_f32 v156, v242, v243
    v_cvt_pk_bf16_f32 v153, v244, v245
    v_cvt_pk_bf16_f32 v157, v246, v247
    v_cvt_pk_bf16_f32 v154, v248, v249
    v_cvt_pk_bf16_f32 v158, v250, v251
    v_cvt_pk_bf16_f32 v155, v252, 0
    s_nop 1
    v_mfma_f32_32x32x16_bf16 v[192:207], v[216:219], v[152:155], 0
    v_mfma_f32_32x32x16_bf16 v[192:207], v[220:223], v[156:159], v[192:207]
    v_dot2_f32_bf16 v240, v160, v108, 0
    v_dot2_f32_bf16 v241, v160, v30, 0
    v_dot2_f32_bf16 v242, v164, v109, 0
    v_dot2_f32_bf16 v243, v164, v31, 0
    v_dot2_f32_bf16 v244, v161, v110, 0
    v_dot2_f32_bf16 v245, v161, v34, 0
    v_dot2_f32_bf16 v246, v165, v111, 0
    v_dot2_f32_bf16 v247, v165, v35, 0
    v_dot2_f32_bf16 v248, v162, v112, 0
    v_dot2_f32_bf16 v249, v162, v38, 0
    v_dot2_f32_bf16 v250, v166, v113, 0
    v_dot2_f32_bf16 v251, v166, v39, 0
    v_dot2_f32_bf16 v252, v163, v114, 0
    v_cvt_pk_bf16_f32 v160, v240, v241
    v_cvt_pk_bf16_f32 v164, v242, v243
    v_cvt_pk_bf16_f32 v161, v244, v245
    v_cvt_pk_bf16_f32 v165, v246, v247
    v_cvt_pk_bf16_f32 v162, v248, v249
    v_cvt_pk_bf16_f32 v166, v250, v251
    v_cvt_pk_bf16_f32 v163, v252, 0
    v_pk_fma_f32 v[44:45], v[28:29], v[176:177], v[44:45]
    v_pk_fma_f32 v[46:47], v[30:31], v[178:179], v[46:47]
    v_pk_fma_f32 v[48:49], v[32:33], v[180:181], v[48:49]
    v_pk_fma_f32 v[50:51], v[34:35], v[182:183], v[50:51]
    v_pk_fma_f32 v[52:53], v[36:37], v[184:185], v[52:53]
    v_pk_fma_f32 v[54:55], v[38:39], v[186:187], v[54:55]
    v_fmac_f32 v56, v40, v188
    v_mfma_f32_32x32x16_bf16 v[176:191], v[224:227], v[160:163], 0
    v_mfma_f32_32x32x16_bf16 v[176:191], v[228:231], v[164:167], v[176:191]
    v_dot2_f32_bf16 v240, v168, v108, 0
    v_dot2_f32_bf16 v241, v168, v30, 0
    v_dot2_f32_bf16 v242, v172, v109, 0
    v_dot2_f32_bf16 v243, v172, v31, 0
    v_dot2_f32_bf16 v244, v169, v110, 0
    v_dot2_f32_bf16 v245, v169, v34, 0
    v_dot2_f32_bf16 v246, v173, v111, 0
    v_dot2_f32_bf16 v247, v173, v35, 0
    v_dot2_f32_bf16 v248, v170, v112, 0
    v_dot2_f32_bf16 v249, v170, v38, 0
    v_dot2_f32_bf16 v250, v174, v113, 0
    v_dot2_f32_bf16 v251, v174, v39, 0
    v_dot2_f32_bf16 v252, v171, v114, 0
    v_cvt_pk_bf16_f32 v168, v240, v241
    v_cvt_pk_bf16_f32 v172, v242, v243
    v_cvt_pk_bf16_f32 v169, v244, v245
    v_cvt_pk_bf16_f32 v173, v246, v247
    v_cvt_pk_bf16_f32 v170, v248, v249
    v_cvt_pk_bf16_f32 v174, v250, v251
    v_cvt_pk_bf16_f32 v171, v252, 0
    v_pk_fma_f32 v[60:61], v[28:29], v[192:193], v[60:61]
    v_pk_fma_f32 v[62:63], v[30:31], v[194:195], v[62:63]
    v_pk_fma_f32 v[64:65], v[32:33], v[196:197], v[64:65]
    v_pk_fma_f32 v[66:67], v[34:35], v[198:199], v[66:67]
    v_pk_fma_f32 v[68:69], v[36:37], v[200:201], v[68:69]
    v_pk_fma_f32 v[70:71], v[38:39], v[202:203], v[70:71]
    v_fmac_f32 v72, v40, v204
    v_mfma_f32_32x32x16_bf16 v[192:207], v[232:235], v[168:171], 0
    v_mfma_f32_32x32x16_bf16 v[192:207], v[236:239], v[172:175], v[192:207]
    v_cvt_pk_bf16_f32 v44, v44, v60
    v_cvt_pk_bf16_f32 v45, v45, v61
    v_cvt_pk_bf16_f32 v46, v46, v62
    v_cvt_pk_bf16_f32 v47, v47, v63
    v_cvt_pk_bf16_f32 v48, v48, v64
    v_cvt_pk_bf16_f32 v49, v49, v65
    v_cvt_pk_bf16_f32 v50, v50, v66
    v_cvt_pk_bf16_f32 v51, v51, v67
    v_cvt_pk_bf16_f32 v52, v52, v68
    v_cvt_pk_bf16_f32 v53, v53, v69
    v_cvt_pk_bf16_f32 v54, v54, v70
    v_cvt_pk_bf16_f32 v55, v55, v71
    v_cvt_pk_bf16_f32 v56, v56, v72
    v_dot2c_f32_bf16 v2, v44, v116
    v_dot2c_f32_bf16 v3, v45, v118
    v_dot2c_f32_bf16 v2, v46, v120
    v_dot2c_f32_bf16 v3, v47, v122
    v_dot2c_f32_bf16 v2, v48, v124
    v_dot2c_f32_bf16 v3, v49, v126
    v_dot2c_f32_bf16 v2, v50, v128
    v_dot2c_f32_bf16 v3, v51, v130
    v_dot2c_f32_bf16 v2, v52, v132
    v_dot2c_f32_bf16 v3, v53, v134
    v_dot2c_f32_bf16 v2, v54, v136
    v_dot2c_f32_bf16 v3, v55, v138
    v_dot2c_f32_bf16 v2, v56, v140
    v_pk_fma_f32 v[76:77], v[28:29], v[176:177], v[76:77]
    v_pk_fma_f32 v[78:79], v[30:31], v[178:179], v[78:79]
    v_pk_fma_f32 v[80:81], v[32:33], v[180:181], v[80:81]
    v_pk_fma_f32 v[82:83], v[34:35], v[182:183], v[82:83]
    v_pk_fma_f32 v[84:85], v[36:37], v[184:185], v[84:85]
    v_pk_fma_f32 v[86:87], v[38:39], v[186:187], v[86:87]
    v_fmac_f32 v88, v40, v188
    v_pk_fma_f32 v[92:93], v[28:29], v[192:193], v[92:93]
    v_pk_fma_f32 v[94:95], v[30:31], v[194:195], v[94:95]
    v_pk_fma_f32 v[96:97], v[32:33], v[196:197], v[96:97]
    v_pk_fma_f32 v[98:99], v[34:35], v[198:199], v[98:99]
    v_pk_fma_f32 v[100:101], v[36:37], v[200:201], v[100:101]
    v_pk_fma_f32 v[102:103], v[38:39], v[202:203], v[102:103]
    v_fmac_f32 v104, v40, v204
    v_cvt_pk_bf16_f32 v76, v76, v92
    v_cvt_pk_bf16_f32 v77, v77, v93
    v_cvt_pk_bf16_f32 v78, v78, v94
    v_cvt_pk_bf16_f32 v79, v79, v95
    v_cvt_pk_bf16_f32 v80, v80, v96
    v_cvt_pk_bf16_f32 v81, v81, v97
    v_cvt_pk_bf16_f32 v82, v82, v98
    v_cvt_pk_bf16_f32 v83, v83, v99
    v_cvt_pk_bf16_f32 v84, v84, v100
    v_cvt_pk_bf16_f32 v85, v85, v101
    v_cvt_pk_bf16_f32 v86, v86, v102
    v_cvt_pk_bf16_f32 v87, v87, v103
    v_cvt_pk_bf16_f32 v88, v88, v104
    v_dot2c_f32_bf16 v2, v76, v117
    v_dot2c_f32_bf16 v3, v77, v119
    v_dot2c_f32_bf16 v2, v78, v121
    v_dot2c_f32_bf16 v3, v79, v123
    v_dot2c_f32_bf16 v2, v80, v125
    v_dot2c_f32_bf16 v3, v81, v127
    v_dot2c_f32_bf16 v2, v82, v129
    v_dot2c_f32_bf16 v3, v83, v131
    v_dot2c_f32_bf16 v2, v84, v133
    v_dot2c_f32_bf16 v3, v85, v135
    v_dot2c_f32_bf16 v2, v86, v137
    v_dot2c_f32_bf16 v3, v87, v139
    v_dot2c_f32_bf16 v2, v88, v141
    s_nop 2
    v_add_f32 v2, v2, v3
    ds_write_b32 v10, v2
L_final:
    v_lshlrev_b32 v17, 4, v1
    v_lshlrev_b32 v16, 5, v1
    v_add_u32 v16, 139264, v16
    s_and_b32 s91, s88, 1
    s_lshl_b32 s91, s91, 4
    s_cmp_lt_u32 s88, 2
    s_cselect_b32 s92, -1, 0
    s_cselect_b32 s93, 0, -1
    s_lshl_b32 s90, s87, 10
    s_waitcnt lgkmcnt(0)
    s_barrier
    s_cmp_lg_u32 s86, 0
    s_cbranch_scc1 L_end
    ds_read_b128 v[240:243], v16 offset:0
    ds_read_b128 v[244:247], v16 offset:16
    s_mov_b32 s3, 0x40000
    s_waitcnt vmcnt(0)
L_spin:
    v_readfirstlane_b32 s89, v27
    s_nop 0
    s_cmp_eq_u32 s89, 1
    s_cbranch_scc1 L_go
    s_sleep 2
    s_lshl_b32 s89, s87, 2
    buffer_load_dword v27, v0, s[52:55], s89 offen sc0 sc1
    s_waitcnt vmcnt(0)
    s_sub_u32 s3, s3, 1
    s_cbranch_scc0 L_spin
L_go:
    s_waitcnt lgkmcnt(0)
    v_pk_add_f32 v[240:241], v[240:241], v[244:245]
    v_pk_add_f32 v[242:243], v[242:243], v[246:247]
    v_pk_add_f32 v[240:241], v[240:241], v[242:243]
    v_add_f32 v240, v240, v241
    v_bfe_u32 v242, v240, 1, 16
    v_lshrrev_b32 v241, 16, v240
    v_or_b32 v242, 1, v242
    v_or_b32 v241, 1, v241
    v_lshlrev_b32 v242, s91, v242
    v_lshlrev_b32 v241, s91, v241
    v_and_b32 v250, s92, v242
    v_and_b32 v251, s93, v242
    buffer_atomic_or_x2 v[250:251], v17, s[56:59], s90 offen offset:8 sc0 sc1
    v_and_b32 v248, s92, v241
    v_and_b32 v249, s93, v241
    buffer_atomic_or_x2 v[248:249], v17, s[56:59], s90 offen sc0 sc1
    v_and_b32 v246, s92, v242
    v_and_b32 v247, s93, v242
    v_and_b32 v244, s92, v241
    v_and_b32 v245, s93, v241
    s_mov_b32 s91, 0x00010001
    v_lshlrev_b32 v18, 1, v1
    s_lshl_b32 s92, s87, 7
    s_waitcnt vmcnt(0)
    v_or_b32 v248, v248, v244
    v_or_b32 v249, v249, v245
    v_and_b32 v240, v248, v249
    v_and_b32 v240, s91, v240
    v_cmp_eq_u32 vcc, s91, v240
    v_or_b32 v250, v250, v246
    v_or_b32 v251, v251, v247
    s_and_b64 exec, exec, vcc
    s_cbranch_execz L_end
L_lchk:
    v_and_b32 v240, v250, v251
    v_and_b32 v240, s91, v240
    v_cmp_ne_u32 vcc, s91, v240
    v_lshlrev_b32 v240, 16, v248
    v_and_b32 v241, 0xfffe0000, v248
    v_and_b32 v240, 0xfffe0000, v240
    v_lshlrev_b32 v242, 16, v249
    v_and_b32 v243, 0xfffe0000, v249
    v_and_b32 v242, 0xfffe0000, v242
    s_cbranch_vccz L_sum
    buffer_load_dwordx2 v[250:251], v17, s[56:59], s90 offen offset:8 sc0 sc1
    s_waitcnt vmcnt(0)
    s_sub_u32 s3, s3, 1
    s_cbranch_scc0 L_lchk
L_sum:
    v_and_b32 v244, 0xfffe, v250
    v_lshrrev_b32 v245, 17, v250
    v_and_b32 v246, 0xfffe, v251
    v_lshrrev_b32 v247, 17, v251
    v_lshl_or_b32 v240, v244, 1, v240
    v_lshl_or_b32 v241, v245, 2, v241
    v_lshl_or_b32 v242, v246, 1, v242
    v_lshl_or_b32 v243, v247, 2, v243
    v_pk_add_f32 v[240:241], v[240:241], v[242:243]
    v_add_f32 v240, v240, v241
    v_cvt_pk_bf16_f32 v240, v240, v240
    buffer_store_short v240, v18, s[48:51], s92 offen
L_end:
    s_endpgm
.section .rodata,"a"
.p2align 6
.amdhsa_kernel standalone__deep_cross_fibinet__recsys_kernel
  .amdhsa_next_free_vgpr 256
  .amdhsa_next_free_sgpr 102
  .amdhsa_accum_offset 256
  .amdhsa_group_segment_fixed_size 0
  .amdhsa_kernarg_size 88
  .amdhsa_user_sgpr_count 2
  .amdhsa_user_sgpr_kernarg_segment_ptr 1
  .amdhsa_system_sgpr_workgroup_id_x 1
.end_amdhsa_kernel
```

```asm
; @launch grid=(256,1,1) block=(512,1,1) lds=163840
.amdgcn_target "amdgcn-amd-amdhsa--gfx950"
.text
.globl standalone__deep_cross_fibinet__recsys_kernel
.p2align 8
.type standalone__deep_cross_fibinet__recsys_kernel,@function
standalone__deep_cross_fibinet__recsys_kernel:
    s_cmp_ge_u32 s2, 256
    s_cbranch_scc1 L_end
    v_lshrrev_b32 v242, 6, v0
    s_load_dwordx4 s[4:7], s[0:1], 0
    s_load_dwordx4 s[12:15], s[0:1], 40
    v_readfirstlane_b32 s86, v242
    s_load_dwordx4 s[20:23], s[0:1], 64
    s_load_dwordx2 s[24:25], s[0:1], 80
    s_getpc_b64 s[92:93]
    s_bfe_u32 s88, s2, 0x20003
    s_lshl_b32 s91, s86, 2
    s_lshr_b32 s91, 0x77773244, s91
    s_and_b32 s91, s91, 15
    s_lshl_b32 s91, s91, 3
    s_load_dwordx2 s[44:45], s[0:1], s91
    s_mul_i32 s91, s88, 3712
    v_lshl_add_u32 v240, v0, 7, s91
    v_min_u32 v240, 14388, v240
    v_mov_b32 v241, s93
    v_add_co_u32 v240, vcc, s92, v240
    v_and_b32 v1, 63, v0
    s_lshl_b32 s89, s86, 10
    v_addc_co_u32 v241, vcc, 0, v241, vcc
    v_cmp_gt_u32 vcc, 29, v0
    v_and_b32 v244, 31, v0
    s_and_saveexec_b64 s[92:93], vcc
    s_cbranch_execz L_cpf
    global_load_dword v6, v[240:241], off
L_cpf:
    s_mov_b64 exec, -1
    s_lshl_b32 s91, s88, 3
    s_lshr_b32 s91, 336398080, s91
    s_bitcmp1_b32 s91, 6
    s_cselect_b32 s96, -1, 1
    s_cselect_b32 s61, 25, 1
    s_cselect_b32 s92, 52, 0
    s_and_b32 s91, s91, 31
    s_add_u32 s97, s91, s92
    s_lshl_b32 s60, s91, 15
    s_lshl_b32 s61, s61, 15
    v_mul_i32_i24 v245, s96, v244
    s_lshr_b32 s91, s2, 5
    v_add_u32 v245, s97, v245
    s_lshl_b32 s91, s91, 3
    v_subrev_u32 v246, 26, v245
    s_and_b32 s92, s2, 7
    s_add_u32 s87, s91, s92
    v_min_u32 v245, v245, v246
    s_lshl_b32 s91, s87, 3
    v_subrev_u32 v246, 26, v245
    s_add_u32 s91, s91, s86
    v_min_u32 v245, v245, v246
    s_mul_i32 s90, s91, 832
    s_mov_b32 s30, 425984
    v_lshrrev_b32 v246, 5, v1
    s_mov_b32 s31, 0x00020000
    v_mul_u32_u24 v246, 104, v246
    s_add_u32 m0, s89, 131072
    v_lshl_add_u32 v246, v245, 2, v246
    s_waitcnt lgkmcnt(0)
    s_mov_b32 s28, s4
    s_and_b32 s29, s5, 0xffff
    buffer_load_dword v246, s[28:31], s90 offen offset:0 lds
    s_add_u32 m0, m0, 48
    s_nop 0
    buffer_load_dword v246, s[28:31], s90 offen offset:208 lds
    s_add_u32 m0, m0, 48
    s_nop 0
    buffer_load_dword v246, s[28:31], s90 offen offset:416 lds
    s_add_u32 m0, m0, 48
    s_nop 0
    buffer_load_dword v246, s[28:31], s90 offen offset:624 lds
    s_and_b32 s45, s45, 0xffff
    s_mov_b32 s47, 0x00020000
    s_lshl_b32 s91, s88, 7
    v_lshlrev_b32 v246, 4, v1
    s_movk_i32 s46, 676
    s_cmp_ge_u32 s86, 4
    s_cselect_b32 s46, 512, s46
    s_cselect_b32 s91, s91, 0
    v_and_b32 v248, 16, v246
    s_lshl_b32 s92, s86, 12
    s_lshl_b32 s93, s88, 5
    s_add_u32 s92, s92, s93
    v_lshrrev_b32 v247, 1, v1
    s_cmp_lt_u32 s86, 2
    s_cselect_b32 s46, 8192, s46
    s_cselect_b32 s91, s92, s91
    s_cselect_b32 s92, 7, 5
    s_add_u32 m0, s89, 139264
    v_lshl_add_u32 v247, v247, s92, v248
    buffer_load_dwordx4 v247, s[44:47], s91 offen lds
    s_mov_b32 s40, s14
    v_and_b32 v245, 7, v1
    s_and_b32 s41, s15, 0xffff
    v_lshrrev_b32 v247, 2, v1
    s_mov_b32 s42, 851968
    v_and_b32 v247, 4, v247
    s_mov_b32 s43, 0x00020000
    v_xor_b32 v247, v247, v245
    s_mov_b32 s32, s6
    v_lshrrev_b32 v248, 3, v0
    s_and_b32 s33, s7, 0xffff
    v_lshlrev_b32 v248, 9, v248
    s_mov_b32 s34, 12800000
    v_lshl_add_u32 v247, v247, 4, v248
    s_mov_b32 s35, 0x00020000
    v_mov_b32 v248, s88
    s_mov_b32 s36, s12
    v_lshl_add_u32 v2, v248, 7, v247
    s_and_b32 s37, s13, 0xffff
    v_bfe_u32 v247, v0, 4, 3
    s_mov_b32 s38, 173056
    v_xor_b32 v247, v247, v245
    s_mov_b32 s39, 0x00020000
    v_lshlrev_b32 v3, 4, v247
    s_add_u32 s91, s89, 131072
    v_lshrrev_b32 v244, 3, v1
    v_lshl_add_u32 v26, v244, 7, s91
    s_add_u32 m0, s89, 65536
    s_nop 0
    buffer_load_dwordx4 v2, s[40:43], s60 offen lds
    s_add_u32 m0, s89, 73728
    s_add_u32 s60, s60, s61
    s_sub_u32 s93, s60, 851968
    s_min_u32 s60, s60, s93
    buffer_load_dwordx4 v2, s[40:43], s60 offen lds
    v_min_u32 v249, 17, v1
    v_mad_u32_u24 v249, v242, 18, v249
    s_lshr_b32 s91, s2, 5
    s_mul_i32 s91, s91, 144
    s_add_u32 s92, s97, 8
    s_lshl_b32 s92, s92, 6
    s_add_u32 s91, s91, s92
    v_add_u32 v249, s91, v249
    v_subrev_u32 v251, 1664, v249
    v_min_u32 v249, v249, v251
    v_lshlrev_b32 v249, 9, v249
    v_lshl_add_u32 v249, v248, 7, v249
    v_min_u32 v250, 5, v1
    v_mad_u32_u24 v250, v242, 6, v250
    v_lshlrev_b32 v250, 7, v250
    v_and_b32 v247, 5, v0
    v_cmp_eq_u32 s[92:93], 0, v247
    v_mov_b32 v247, 0x3c80
    v_lshlrev_b32 v248, 2, v0
    v_cndmask_b32 v247, 0, v247, s[92:93]
    v_add_u32 v248, 147456, v248
    ds_write_b32 v248, v247
    s_mov_b32 s94, 0x05040100
    s_mov_b32 s95, 0x07060302
    s_lshr_b32 s91, s86, 1
    s_lshr_b32 s92, s86, 2
    s_add_u32 s90, s91, s92
    s_and_b32 s90, s90, 1
    v_and_b32 v100, 31, v1
    v_lshrrev_b32 v101, 5, v1
    v_bfe_u32 v102, v1, 1, 3
    s_and_b32 s91, s86, 1
    s_lshl_b32 s91, s91, 5
    v_add_u32 v103, s91, v100
    s_lshl_b32 s92, s92, 13
    v_lshl_add_u32 v104, v103, 7, s92
    v_xor_b32 v105, v101, v102
    v_lshl_add_u32 v8, v105, 4, v104
    v_xor_b32 v9, 32, v8
    v_xor_b32 v10, 64, v8
    v_xor_b32 v11, 96, v8
    v_bfe_u32 v104, v1, 2, 2
    v_lshl_add_u32 v105, v101, 3, v104
    s_add_u32 s92, s92, 65536
    v_lshl_add_u32 v105, v105, 7, s92
    v_bfe_u32 v106, v1, 4, 1
    s_lshr_b32 s91, s86, 2
    v_xor_b32 v106, s91, v106
    v_bfe_u32 v107, v1, 1, 1
    v_lshl_add_u32 v106, v106, 1, v107
    s_and_b32 s91, s86, 2
    s_lshl_b32 s91, s91, 1
    v_or_b32 v106, s91, v106
    v_lshrrev_b32 v107, 1, v1
    v_and_b32 v107, 4, v107
    v_xor_b32 v106, v106, v107
    v_lshl_add_u32 v105, v106, 4, v105
    v_and_b32 v107, 1, v1
    v_lshl_add_u32 v12, v107, 3, v105
    s_lshl_b32 s91, s88, 1
    s_lshr_b32 s92, s86, 2
    s_add_u32 s91, s91, s92
    s_waitcnt vmcnt(3)
    ds_read_b128 v[44:47], v26 offset:0
    ds_read_b128 v[48:51], v26 offset:16
    s_add_u32 m0, s89, 0
    s_waitcnt lgkmcnt(1)
    v_lshl_add_u32 v44, v44, 7, v3
    buffer_load_dwordx4 v44, s[32:35], 0 offen lds
    s_add_u32 m0, s89, 8192
    v_lshl_add_u32 v45, v45, 7, v3
    buffer_load_dwordx4 v45, s[32:35], 0 offen lds
    s_add_u32 m0, s89, 16384
    v_lshl_add_u32 v46, v46, 7, v3
    buffer_load_dwordx4 v46, s[32:35], 0 offen lds
    s_add_u32 m0, s89, 24576
    v_lshl_add_u32 v47, v47, 7, v3
    buffer_load_dwordx4 v47, s[32:35], 0 offen lds
    s_add_u32 m0, s89, 32768
    s_waitcnt lgkmcnt(0)
    v_lshl_add_u32 v48, v48, 7, v3
    buffer_load_dwordx4 v48, s[32:35], 0 offen lds
    s_add_u32 m0, s89, 40960
    v_lshl_add_u32 v49, v49, 7, v3
    buffer_load_dwordx4 v49, s[32:35], 0 offen lds
    v_xor_b32 v104, s91, v102
    v_lshlrev_b32 v105, 13, v101
    v_lshl_add_u32 v105, v103, 7, v105
    v_lshl_add_u32 v105, v104, 4, v105
    s_and_b32 s91, s86, 2
    s_lshl_b32 s91, s91, 2
    v_add_u32 v13, s91, v105
    v_bfe_u32 v104, v1, 3, 1
    v_xor_b32 v104, s92, v104
    v_lshl_add_u32 v105, v1, 5, s91
    v_lshl_add_u32 v5, v104, 4, v105
    s_lshl_b32 s91, s90, 1
    s_add_u32 s91, s91, s92
    s_lshl_b32 s92, s91, 10
    s_add_u32 s92, s92, 43008
    v_lshl_add_u32 v27, v103, 4, s92
    s_lshl_b32 s91, s91, 9
    s_and_b32 s92, s86, 1
    s_lshl_b32 s92, s92, 11
    s_add_u32 s91, s91, s92
    v_lshl_add_u32 v104, v100, 4, s91
    v_lshl_add_u32 v14, v101, 16, v104
    v_add_u32 v14, 49152, v14
    v_lshl_add_u32 v15, v101, 14, v104
    v_add_u32 v15, 131072, v15
    s_bitcmp1_b32 s86, 1
    s_cselect_b32 s91, 65536, 0
    s_cselect_b32 s93, 16384, 0
    s_add_u32 s91, s91, 49152
    s_add_u32 s93, s93, 131072
    s_bitcmp1_b32 s86, 2
    s_cselect_b32 s91, s93, s91
    s_add_u32 s91, s91, s92
    v_lshl_add_u32 v4, v1, 4, s91
    v_mov_b32 v142, 0xbdd2d3e8
    v_mov_b32 v143, 0xc0135761
    v_mov_b32 v179, 0
    v_mov_b32 v183, 0
    v_mov_b32 v187, 0
    v_mov_b32 v191, 0
    v_mov_b32 v195, 0
    v_mov_b32 v199, 0
    v_mov_b32 v203, 0
    v_mov_b32 v207, 0
    v_mov_b32 v211, 0
    s_mov_b32 s48, s20
    s_and_b32 s49, s21, 0xffff
    s_mov_b32 s50, 8192
    s_mov_b32 s51, 0x00020000
    s_mov_b32 s52, s22
    s_and_b32 s53, s23, 0xffff
    s_mov_b32 s54, 256
    s_mov_b32 s55, 0x00020000
    s_mov_b32 s56, s24
    s_and_b32 s57, s25, 0xffff
    s_mov_b32 s58, 268435456
    s_mov_b32 s59, 0x00020000
    s_waitcnt vmcnt(8)
    s_barrier
    v_lshrrev_b32 v116, 5, v1
    v_and_b32 v117, 15, v1
    v_lshlrev_b32 v118, 3, v117
    v_lshl_add_u32 v118, v116, 8, v118
    v_and_b32 v116, 16, v1
    v_lshl_add_u32 v118, v116, 9, v118
    v_add_u32 v118, 139264, v118
    ds_read_b64_tr_b16 v[100:101], v118 offset:0
    ds_read_b64_tr_b16 v[102:103], v118 offset:128
    ds_read_b64_tr_b16 v[104:105], v118 offset:512
    ds_read_b64_tr_b16 v[106:107], v118 offset:640
    ds_read_b64_tr_b16 v[108:109], v118 offset:1024
    ds_read_b64_tr_b16 v[110:111], v118 offset:1152
    ds_read_b64_tr_b16 v[112:113], v118 offset:1536
    ds_read_b64_tr_b16 v[114:115], v118 offset:1664
    v_lshlrev_b32 v123, 1, v1
    v_add_u32 v123, 143360, v123
    ds_read_u16 v212, v123
    v_lshrrev_b32 v119, 4, v1
    s_lshr_b32 s91, s86, 2
    v_min_u32 v117, 12, v117
    v_lshl_add_u32 v120, v117, 1, s91
    v_mul_i32_i24 v121, s96, v120
    v_add_u32 v121, s97, v121
    v_subrev_u32 v122, 26, v121
    v_min_u32 v121, v121, v122
    v_subrev_u32 v122, 26, v121
    v_min_u32 v121, v121, v122
    v_mul_u32_u24 v122, 208, v119
    v_lshl_add_u32 v121, v121, 1, v122
    v_add_u32 v121, 142336, v121
    ds_read_u16 v92, v121 offset:0
    ds_read_u16 v93, v121 offset:52
    ds_read_u16 v94, v121 offset:104
    ds_read_u16 v95, v121 offset:156
    v_mul_i32_i24 v121, s96, v119
    v_add_u32 v121, s97, v121
    v_subrev_u32 v122, 26, v121
    v_min_u32 v121, v121, v122
    v_subrev_u32 v122, 26, v121
    v_min_u32 v121, v121, v122
    v_lshlrev_b32 v117, 1, v117
    v_mad_u32_u24 v121, v121, 26, v117
    s_cmp_eq_u32 s96, 1
    s_cselect_b32 s91, 4, 22
    s_mul_i32 s91, s91, 26
    s_waitcnt lgkmcnt(4)
    v_lshlrev_b32 v212, 16, v212
    v_add_u32 v125, 141312, v121
    ds_read_u16 v84, v125
    v_add_u32 v121, s91, v121
    v_subrev_u32 v122, 676, v121
    v_min_u32 v121, v121, v122
    v_add_u32 v126, 141312, v121
    ds_read_u16 v85, v126
    v_add_u32 v121, s91, v121
    v_subrev_u32 v122, 676, v121
    v_min_u32 v121, v121, v122
    v_add_u32 v125, 141312, v121
    ds_read_u16 v86, v125
    v_add_u32 v121, s91, v121
    v_subrev_u32 v122, 676, v121
    v_min_u32 v121, v121, v122
    v_add_u32 v126, 141312, v121
    ds_read_u16 v87, v126
    v_add_u32 v121, s91, v121
    v_subrev_u32 v122, 676, v121
    v_min_u32 v121, v121, v122
    v_add_u32 v125, 141312, v121
    ds_read_u16 v88, v125
    v_add_u32 v121, s91, v121
    v_subrev_u32 v122, 676, v121
    v_min_u32 v121, v121, v122
    v_add_u32 v126, 141312, v121
    ds_read_u16 v89, v126
    v_add_u32 v121, s91, v121
    v_subrev_u32 v122, 676, v121
    v_min_u32 v121, v121, v122
    v_add_u32 v125, 141312, v121
    ds_read_u16 v23, v125
    s_waitcnt lgkmcnt(7)
    v_lshl_or_b32 v24, v93, 16, v92
    v_lshl_or_b32 v25, v95, 16, v94
    s_waitcnt lgkmcnt(0)
    v_lshl_or_b32 v20, v85, 16, v84
    v_lshl_or_b32 v21, v87, 16, v86
    v_lshl_or_b32 v22, v89, 16, v88
    s_mul_i32 s28, s86, s96
    s_add_u32 s28, s28, s97
    v_lshrrev_b32 v60, 4, v1
    s_sub_u32 s93, s28, 26
    s_min_u32 s28, s28, s93
    s_sub_u32 s93, s28, 26
    s_min_u32 s28, s28, s93
    v_bfe_u32 v61, v1, 1, 2
    s_mul_i32 s28, s28, 3328
    v_lshl_add_u32 v61, v60, 2, v61
    s_cmp_eq_u32 s96, 1
    s_cselect_b32 s92, 8, 18
    s_mul_i32 s92, s92, 3328
    v_bfe_u32 v62, v1, 3, 1
    v_lshl_add_u32 v62, v61, 1, v62
    s_add_u32 s29, s28, s92
    s_sub_u32 s93, s29, 86528
    s_min_u32 s29, s29, s93
    s_add_u32 s30, s29, s92
    s_sub_u32 s93, s30, 86528
    s_min_u32 s30, s30, s93
    v_mul_i32_i24 v63, s96, v62
    v_add_u32 v63, s97, v63
    v_subrev_u32 v64, 26, v63
    v_min_u32 v63, v63, v64
    v_subrev_u32 v64, 26, v63
    v_min_u32 v63, v63, v64
    s_and_b32 s92, s86, 1
    s_add_u32 s92, s92, 24
    s_mul_i32 s31, s92, s96
    s_add_u32 s31, s31, s97
    v_xor_b32 v60, v60, v1
    s_sub_u32 s93, s31, 26
    s_min_u32 s31, s31, s93
    s_sub_u32 s93, s31, 26
    s_min_u32 s31, s31, s93
    v_and_b32 v60, 1, v60
    s_lshl_b32 s92, s88, 5
    v_lshl_add_u32 v60, v60, 4, s92
    s_mul_i32 s31, s31, 3328
    v_lshl_add_u32 v60, v63, 7, v60
    v_add_u32 v61, 3, v61
    v_lshrrev_b32 v61, 4, v61
    v_lshl_add_u32 v7, v61, 30, v60
    s_lshl_b32 s91, s88, 3
    s_add_u32 s91, s91, s86
    s_cmp_lg_u32 s91, 23
    s_cbranch_scc1 L_z1
    v_mov_b32 v76, 0
    v_mov_b32 v77, 0
    v_mov_b32 v78, 0
    v_mov_b32 v79, 0
    s_lshl_b32 s91, s87, 10
    buffer_store_dwordx4 v[76:79], v246, s[56:59], s91 offen sc0 sc1
L_z1:
    s_add_u32 m0, s89, 81920
    s_add_u32 s60, s60, s61
    s_sub_u32 s93, s60, 851968
    s_min_u32 s60, s60, s93
    buffer_load_dwordx4 v2, s[40:43], s60 offen lds
    s_add_u32 m0, s89, 90112
    s_add_u32 s60, s60, s61
    s_sub_u32 s93, s60, 851968
    s_min_u32 s60, s60, s93
    buffer_load_dwordx4 v2, s[40:43], s60 offen lds
    s_add_u32 m0, s89, 98304
    s_add_u32 s60, s60, s61
    s_sub_u32 s93, s60, 851968
    s_min_u32 s60, s60, s93
    buffer_load_dwordx4 v2, s[40:43], s60 offen lds
    s_add_u32 m0, s89, 106496
    s_add_u32 s60, s60, s61
    s_sub_u32 s93, s60, 851968
    s_min_u32 s60, s60, s93
    buffer_load_dwordx4 v2, s[40:43], s60 offen lds
    s_barrier
    s_add_u32 m0, s89, 49152
    v_lshl_add_u32 v50, v50, 7, v3
    buffer_load_dwordx4 v50, s[32:35], 0 offen lds
    s_add_u32 m0, s89, 57344
    v_lshl_add_u32 v51, v51, 7, v3
    buffer_load_dwordx4 v51, s[32:35], 0 offen lds
    buffer_load_dword v6, v249, s[40:43], 0 offen
    s_lshr_b32 s91, s2, 3
    s_mul_i32 s91, s91, 5504
    buffer_load_dword v6, v250, s[36:39], s91 offen
    s_cmp_eq_u32 s90, 1
    s_cbranch_scc1 L_k1
    s_waitcnt vmcnt(12)
    s_barrier
    ds_read_b128 v[60:63], v8 offset:0
    ds_read_b64_tr_b16 v[44:45], v12 offset:0
    ds_read_b64_tr_b16 v[46:47], v12 offset:512
    ds_read_b64 v[116:117], v13 offset:0
    ds_read_b128 v[64:67], v9 offset:0
    ds_read_b64_tr_b16 v[48:49], v12 offset:2048
    ds_read_b64_tr_b16 v[50:51], v12 offset:2560
    ds_read_b128 v[68:71], v10 offset:0
    ds_read_b64_tr_b16 v[52:53], v12 offset:4096
    ds_read_b64_tr_b16 v[54:55], v12 offset:4608
    s_add_u32 m0, s89, 114688
    s_add_u32 s60, s60, s61
    s_sub_u32 s93, s60, 851968
    s_min_u32 s60, s60, s93
    buffer_load_dwordx4 v2, s[40:43], s60 offen lds
    ds_read_b128 v[72:75], v11 offset:0
    ds_read_b64_tr_b16 v[56:57], v12 offset:6144
    ds_read_b64_tr_b16 v[58:59], v12 offset:6656
    s_add_u32 m0, s89, 122880
    s_add_u32 s60, s60, s61
    s_sub_u32 s93, s60, 851968
    s_min_u32 s60, s60, s93
    buffer_load_dwordx4 v2, s[40:43], s60 offen lds
    s_waitcnt vmcnt(8)
    s_barrier
    s_waitcnt lgkmcnt(10)
    v_mfma_f32_32x32x16_bf16 v[76:91], v[100:103], v[60:63], 0
    v_mfma_f32_32x32x16_bf16 v[28:43], v[44:47], v[60:63], 0
    ds_read_b128 v[60:63], v8 offset:16384
    ds_read_b64_tr_b16 v[44:45], v12 offset:16384
    ds_read_b64_tr_b16 v[46:47], v12 offset:16896
    ds_read_b64 v[118:119], v13 offset:16384
    ds_read_b64 v[16:17], v26 offset:32
    s_waitcnt lgkmcnt(11)
    v_mfma_f32_32x32x16_bf16 v[76:91], v[104:107], v[64:67], v[76:91]
    v_mfma_f32_32x32x16_bf16 v[28:43], v[48:51], v[64:67], v[28:43]
    ds_read_b128 v[64:67], v9 offset:16384
    ds_read_b64_tr_b16 v[48:49], v12 offset:18432
    ds_read_b64_tr_b16 v[50:51], v12 offset:18944
    s_waitcnt lgkmcnt(11)
    v_mfma_f32_32x32x16_bf16 v[76:91], v[108:111], v[68:71], v[76:91]
    v_mfma_f32_32x32x16_bf16 v[28:43], v[52:55], v[68:71], v[28:43]
    ds_read_b128 v[68:71], v10 offset:16384
    ds_read_b64_tr_b16 v[52:53], v12 offset:20480
    ds_read_b64_tr_b16 v[54:55], v12 offset:20992
    s_waitcnt lgkmcnt(11)
    v_mfma_f32_32x32x16_bf16 v[76:91], v[112:115], v[72:75], v[76:91]
    v_mfma_f32_32x32x16_bf16 v[28:43], v[56:59], v[72:75], v[28:43]
    ds_read_b128 v[72:75], v11 offset:16384
    ds_read_b64_tr_b16 v[56:57], v12 offset:22528
    ds_read_b64_tr_b16 v[58:59], v12 offset:23040
    s_waitcnt lgkmcnt(9)
    v_lshl_add_u32 v16, v16, 7, v3
    v_lshl_add_u32 v17, v17, 7, v3
    s_waitcnt vmcnt(6)
    s_barrier
    v_mfma_f32_32x32x16_bf16 v[28:43], v[44:47], v[60:63], v[28:43]
    ds_read_b128 v[60:63], v8 offset:32768
    ds_read_b64_tr_b16 v[44:45], v12 offset:32768
    ds_read_b64_tr_b16 v[46:47], v12 offset:33280
    ds_read_b64 v[120:121], v13 offset:32768
    ds_read_b64 v[18:19], v26 offset:40
    v_mov_b32 v213, v84
    s_add_u32 m0, s89, 0
    s_nop 0
    buffer_load_dwordx4 v16, s[32:35], 0 offen lds
    s_waitcnt lgkmcnt(11)
    v_mfma_f32_32x32x16_bf16 v[28:43], v[48:51], v[64:67], v[28:43]
    ds_read_b128 v[64:67], v9 offset:32768
    ds_read_b64_tr_b16 v[48:49], v12 offset:34816
    ds_read_b64_tr_b16 v[50:51], v12 offset:35328
    s_add_u32 m0, s89, 8192
    s_nop 0
    buffer_load_dwordx4 v17, s[32:35], 0 offen lds
    s_waitcnt lgkmcnt(11)
    v_mfma_f32_32x32x16_bf16 v[28:43], v[52:55], v[68:71], v[28:43]
    ds_read_b128 v[68:71], v10 offset:32768
    ds_read_b64_tr_b16 v[52:53], v12 offset:36864
    ds_read_b64_tr_b16 v[54:55], v12 offset:37376
    s_add_u32 m0, s89, 65536
    s_add_u32 s60, s60, s61
    s_sub_u32 s93, s60, 851968
    s_min_u32 s60, s60, s93
    buffer_load_dwordx4 v2, s[40:43], s60 offen lds
    s_waitcnt lgkmcnt(11)
    v_mfma_f32_32x32x16_bf16 v[28:43], v[56:59], v[72:75], v[28:43]
    ds_read_b128 v[72:75], v11 offset:32768
    ds_read_b64_tr_b16 v[56:57], v12 offset:38912
    ds_read_b64_tr_b16 v[58:59], v12 offset:39424
    s_add_u32 m0, s89, 73728
    s_add_u32 s60, s60, s61
    s_sub_u32 s93, s60, 851968
    s_min_u32 s60, s60, s93
    buffer_load_dwordx4 v2, s[40:43], s60 offen lds
    s_waitcnt lgkmcnt(9)
    v_lshl_add_u32 v18, v18, 7, v3
    v_lshl_add_u32 v19, v19, 7, v3
    s_waitcnt vmcnt(4)
    s_barrier
    v_mfma_f32_32x32x16_bf16 v[84:99], v[100:103], v[60:63], 0
    v_mfma_f32_32x32x16_bf16 v[28:43], v[44:47], v[60:63], v[28:43]
    ds_read_b128 v[60:63], v8 offset:49152
    ds_read_b64_tr_b16 v[44:45], v12 offset:49152
    ds_read_b64_tr_b16 v[46:47], v12 offset:49664
    ds_read_b64 v[122:123], v13 offset:49152
    ds_read_b64 v[16:17], v26 offset:48
    s_add_u32 m0, s89, 16384
    s_nop 0
    buffer_load_dwordx4 v18, s[32:35], 0 offen lds
    s_waitcnt lgkmcnt(11)
    v_mfma_f32_32x32x16_bf16 v[84:99], v[104:107], v[64:67], v[84:99]
    v_mfma_f32_32x32x16_bf16 v[28:43], v[48:51], v[64:67], v[28:43]
    ds_read_b128 v[64:67], v9 offset:49152
    ds_read_b64_tr_b16 v[48:49], v12 offset:51200
    ds_read_b64_tr_b16 v[50:51], v12 offset:51712
    s_add_u32 m0, s89, 24576
    s_nop 0
    buffer_load_dwordx4 v19, s[32:35], 0 offen lds
    s_waitcnt lgkmcnt(11)
    v_mfma_f32_32x32x16_bf16 v[84:99], v[108:111], v[68:71], v[84:99]
    v_mfma_f32_32x32x16_bf16 v[28:43], v[52:55], v[68:71], v[28:43]
    ds_read_b128 v[68:71], v10 offset:49152
    ds_read_b64_tr_b16 v[52:53], v12 offset:53248
    ds_read_b64_tr_b16 v[54:55], v12 offset:53760
    s_add_u32 m0, s89, 81920
    s_add_u32 s60, s60, s61
    s_sub_u32 s93, s60, 851968
    s_min_u32 s60, s60, s93
    buffer_load_dwordx4 v2, s[40:43], s60 offen lds
    s_waitcnt lgkmcnt(11)
    v_mfma_f32_32x32x16_bf16 v[84:99], v[112:115], v[72:75], v[84:99]
    v_mfma_f32_32x32x16_bf16 v[28:43], v[56:59], v[72:75], v[28:43]
    ds_read_b128 v[72:75], v11 offset:49152
    ds_read_b64_tr_b16 v[56:57], v12 offset:55296
    ds_read_b64_tr_b16 v[58:59], v12 offset:55808
    s_add_u32 m0, s89, 90112
    s_add_u32 s60, s60, s61
    s_sub_u32 s93, s60, 851968
    s_min_u32 s60, s60, s93
    buffer_load_dwordx4 v2, s[40:43], s60 offen lds
    s_waitcnt lgkmcnt(9)
    v_lshl_add_u32 v16, v16, 7, v3
    v_lshl_add_u32 v17, v17, 7, v3
    s_lshl_b32 s91, s88, 3
    s_add_u32 s91, s91, s86
    s_cmp_lg_u32 s91, 23
    s_cbranch_scc1 L_z2
    v_mov_b32 v240, 1
    v_mov_b32 v241, 0
    s_lshl_b32 s91, s87, 2
    s_mov_b64 exec, 1
    buffer_store_dword v240, v241, s[52:55], s91 offen sc0 sc1
    s_mov_b64 exec, -1
L_z2:
    s_waitcnt vmcnt(4)
    s_barrier
    v_mfma_f32_32x32x16_bf16 v[28:43], v[44:47], v[60:63], v[28:43]
    ds_read_b128 v[60:63], v8 offset:0
    ds_read_b64_tr_b16 v[44:45], v12 offset:0
    ds_read_b64_tr_b16 v[46:47], v12 offset:512
    ds_read_b64 v[124:125], v13 offset:0
    ds_read_b64 v[18:19], v26 offset:56
    v_cvt_pk_bf16_f32 v208, v213, v92
    v_cvt_pk_bf16_f32 v176, v76, v84
    v_cvt_pk_bf16_f32 v180, v77, v85
    v_cvt_pk_bf16_f32 v184, v78, v86
    v_cvt_pk_bf16_f32 v188, v79, v87
    v_cvt_pk_bf16_f32 v192, v80, v88
    v_cvt_pk_bf16_f32 v196, v81, v89
    v_cvt_pk_bf16_f32 v200, v82, v90
    v_cvt_pk_bf16_f32 v204, v83, v91
    s_add_u32 m0, s89, 32768
    s_nop 0
    buffer_load_dwordx4 v16, s[32:35], 0 offen lds
    s_waitcnt lgkmcnt(11)
    v_mfma_f32_32x32x16_bf16 v[28:43], v[48:51], v[64:67], v[28:43]
    ds_read_b128 v[64:67], v9 offset:0
    ds_read_b64_tr_b16 v[48:49], v12 offset:2048
    ds_read_b64_tr_b16 v[50:51], v12 offset:2560
    s_add_u32 m0, s89, 40960
    s_nop 0
    buffer_load_dwordx4 v17, s[32:35], 0 offen lds
    s_waitcnt lgkmcnt(11)
    v_mfma_f32_32x32x16_bf16 v[28:43], v[52:55], v[68:71], v[28:43]
    ds_read_b128 v[68:71], v10 offset:0
    ds_read_b64_tr_b16 v[52:53], v12 offset:4096
    ds_read_b64_tr_b16 v[54:55], v12 offset:4608
    s_add_u32 m0, s89, 98304
    s_add_u32 s60, s60, s61
    s_sub_u32 s93, s60, 851968
    s_min_u32 s60, s60, s93
    buffer_load_dwordx4 v2, s[40:43], s60 offen lds
    s_waitcnt lgkmcnt(11)
    v_mfma_f32_32x32x16_bf16 v[28:43], v[56:59], v[72:75], v[28:43]
    ds_read_b128 v[72:75], v11 offset:0
    ds_read_b64_tr_b16 v[56:57], v12 offset:6144
    ds_read_b64_tr_b16 v[58:59], v12 offset:6656
    s_add_u32 m0, s89, 106496
    s_add_u32 s60, s60, s61
    s_sub_u32 s93, s60, 851968
    s_min_u32 s60, s60, s93
    buffer_load_dwordx4 v2, s[40:43], s60 offen lds
    s_waitcnt lgkmcnt(9)
    v_lshl_add_u32 v18, v18, 7, v3
    v_lshl_add_u32 v19, v19, 7, v3
    s_waitcnt vmcnt(4)
    s_barrier
    v_mfma_f32_32x32x16_bf16 v[76:91], v[100:103], v[60:63], 0
    v_mfma_f32_32x32x16_bf16 v[28:43], v[44:47], v[60:63], v[28:43]
    ds_read_b128 v[60:63], v8 offset:16384
    ds_read_b64_tr_b16 v[44:45], v12 offset:16384
    ds_read_b64_tr_b16 v[46:47], v12 offset:16896
    ds_read_b64 v[126:127], v13 offset:16384
    ds_read_b64 v[16:17], v26 offset:64
    s_add_u32 m0, s89, 49152
    s_nop 0
    buffer_load_dwordx4 v18, s[32:35], 0 offen lds
    s_waitcnt lgkmcnt(11)
    v_mfma_f32_32x32x16_bf16 v[76:91], v[104:107], v[64:67], v[76:91]
    v_mfma_f32_32x32x16_bf16 v[28:43], v[48:51], v[64:67], v[28:43]
    ds_read_b128 v[64:67], v9 offset:16384
    ds_read_b64_tr_b16 v[48:49], v12 offset:18432
    ds_read_b64_tr_b16 v[50:51], v12 offset:18944
    s_add_u32 m0, s89, 57344
    s_nop 0
    buffer_load_dwordx4 v19, s[32:35], 0 offen lds
    s_waitcnt lgkmcnt(11)
    v_mfma_f32_32x32x16_bf16 v[76:91], v[108:111], v[68:71], v[76:91]
    v_mfma_f32_32x32x16_bf16 v[28:43], v[52:55], v[68:71], v[28:43]
    ds_read_b128 v[68:71], v10 offset:16384
    ds_read_b64_tr_b16 v[52:53], v12 offset:20480
    ds_read_b64_tr_b16 v[54:55], v12 offset:20992
    s_add_u32 m0, s89, 114688
    s_add_u32 s60, s60, s61
    s_sub_u32 s93, s60, 851968
    s_min_u32 s60, s60, s93
    buffer_load_dwordx4 v2, s[40:43], s60 offen lds
    s_waitcnt lgkmcnt(11)
    v_mfma_f32_32x32x16_bf16 v[76:91], v[112:115], v[72:75], v[76:91]
    v_mfma_f32_32x32x16_bf16 v[28:43], v[56:59], v[72:75], v[28:43]
    ds_read_b128 v[72:75], v11 offset:16384
    ds_read_b64_tr_b16 v[56:57], v12 offset:22528
    ds_read_b64_tr_b16 v[58:59], v12 offset:23040
    s_add_u32 m0, s89, 122880
    s_add_u32 s60, s60, s61
    s_sub_u32 s93, s60, 851968
    s_min_u32 s60, s60, s93
    buffer_load_dwordx4 v2, s[40:43], s60 offen lds
    s_waitcnt lgkmcnt(9)
    v_lshl_add_u32 v16, v16, 7, v3
    v_lshl_add_u32 v17, v17, 7, v3
    s_waitcnt vmcnt(4)
    s_barrier
    v_mfma_f32_32x32x16_bf16 v[28:43], v[44:47], v[60:63], v[28:43]
    ds_read_b128 v[60:63], v8 offset:32768
    ds_read_b64_tr_b16 v[44:45], v12 offset:32768
    ds_read_b64_tr_b16 v[46:47], v12 offset:33280
    ds_read_b64 v[128:129], v13 offset:32768
    ds_read_b64 v[18:19], v26 offset:72
    v_mov_b32 v213, v84
    s_add_u32 m0, s89, 0
    s_nop 0
    buffer_load_dwordx4 v16, s[32:35], 0 offen lds
    s_waitcnt lgkmcnt(11)
    v_mfma_f32_32x32x16_bf16 v[28:43], v[48:51], v[64:67], v[28:43]
    ds_read_b128 v[64:67], v9 offset:32768
    ds_read_b64_tr_b16 v[48:49], v12 offset:34816
    ds_read_b64_tr_b16 v[50:51], v12 offset:35328
    s_add_u32 m0, s89, 8192
    s_nop 0
    buffer_load_dwordx4 v17, s[32:35], 0 offen lds
    s_waitcnt lgkmcnt(11)
    v_mfma_f32_32x32x16_bf16 v[28:43], v[52:55], v[68:71], v[28:43]
    ds_read_b128 v[68:71], v10 offset:32768
    ds_read_b64_tr_b16 v[52:53], v12 offset:36864
    ds_read_b64_tr_b16 v[54:55], v12 offset:37376
    s_add_u32 m0, s89, 65536
    s_add_u32 s60, s60, s61
    s_sub_u32 s93, s60, 851968
    s_min_u32 s60, s60, s93
    buffer_load_dwordx4 v2, s[40:43], s60 offen lds
    s_waitcnt lgkmcnt(11)
    v_mfma_f32_32x32x16_bf16 v[28:43], v[56:59], v[72:75], v[28:43]
    ds_read_b128 v[72:75], v11 offset:32768
    ds_read_b64_tr_b16 v[56:57], v12 offset:38912
    ds_read_b64_tr_b16 v[58:59], v12 offset:39424
    s_add_u32 m0, s89, 73728
    s_add_u32 s60, s60, s61
    s_sub_u32 s93, s60, 851968
    s_min_u32 s60, s60, s93
    buffer_load_dwordx4 v2, s[40:43], s60 offen lds
    s_waitcnt lgkmcnt(9)
    v_lshl_add_u32 v18, v18, 7, v3
    v_lshl_add_u32 v19, v19, 7, v3
    s_waitcnt vmcnt(4)
    s_barrier
    v_mfma_f32_32x32x16_bf16 v[84:99], v[100:103], v[60:63], 0
    v_mfma_f32_32x32x16_bf16 v[28:43], v[44:47], v[60:63], v[28:43]
    ds_read_b128 v[60:63], v8 offset:49152
    ds_read_b64_tr_b16 v[44:45], v12 offset:49152
    ds_read_b64_tr_b16 v[46:47], v12 offset:49664
    ds_read_b64 v[130:131], v13 offset:49152
    ds_read_b64 v[16:17], v26 offset:80
    s_add_u32 m0, s89, 16384
    s_nop 0
    buffer_load_dwordx4 v18, s[32:35], 0 offen lds
    s_waitcnt lgkmcnt(11)
    v_mfma_f32_32x32x16_bf16 v[84:99], v[104:107], v[64:67], v[84:99]
    v_mfma_f32_32x32x16_bf16 v[28:43], v[48:51], v[64:67], v[28:43]
    ds_read_b128 v[64:67], v9 offset:49152
    ds_read_b64_tr_b16 v[48:49], v12 offset:51200
    ds_read_b64_tr_b16 v[50:51], v12 offset:51712
    s_add_u32 m0, s89, 24576
    s_nop 0
    buffer_load_dwordx4 v19, s[32:35], 0 offen lds
    s_waitcnt lgkmcnt(11)
    v_mfma_f32_32x32x16_bf16 v[84:99], v[108:111], v[68:71], v[84:99]
    v_mfma_f32_32x32x16_bf16 v[28:43], v[52:55], v[68:71], v[28:43]
    ds_read_b128 v[68:71], v10 offset:49152
    ds_read_b64_tr_b16 v[52:53], v12 offset:53248
    ds_read_b64_tr_b16 v[54:55], v12 offset:53760
    s_add_u32 m0, s89, 81920
    s_add_u32 s60, s60, s61
    s_sub_u32 s93, s60, 851968
    s_min_u32 s60, s60, s93
    buffer_load_dwordx4 v2, s[40:43], s60 offen lds
    s_waitcnt lgkmcnt(11)
    v_mfma_f32_32x32x16_bf16 v[84:99], v[112:115], v[72:75], v[84:99]
    v_mfma_f32_32x32x16_bf16 v[28:43], v[56:59], v[72:75], v[28:43]
    ds_read_b128 v[72:75], v11 offset:49152
    ds_read_b64_tr_b16 v[56:57], v12 offset:55296
    ds_read_b64_tr_b16 v[58:59], v12 offset:55808
    s_add_u32 m0, s89, 90112
    s_add_u32 s60, s60, s61
    s_sub_u32 s93, s60, 851968
    s_min_u32 s60, s60, s93
    buffer_load_dwordx4 v2, s[40:43], s60 offen lds
    s_waitcnt lgkmcnt(9)
    v_lshl_add_u32 v16, v16, 7, v3
    v_lshl_add_u32 v17, v17, 7, v3
    s_waitcnt vmcnt(4)
    s_barrier
    v_mfma_f32_32x32x16_bf16 v[28:43], v[44:47], v[60:63], v[28:43]
    ds_read_b128 v[60:63], v8 offset:0
    ds_read_b64_tr_b16 v[44:45], v12 offset:0
    ds_read_b64_tr_b16 v[46:47], v12 offset:512
    ds_read_b64 v[132:133], v13 offset:0
    ds_read_b64 v[18:19], v26 offset:88
    v_cvt_pk_bf16_f32 v209, v213, v92
    v_cvt_pk_bf16_f32 v177, v76, v84
    v_cvt_pk_bf16_f32 v181, v77, v85
    v_cvt_pk_bf16_f32 v185, v78, v86
    v_cvt_pk_bf16_f32 v189, v79, v87
    v_cvt_pk_bf16_f32 v193, v80, v88
    v_cvt_pk_bf16_f32 v197, v81, v89
    v_cvt_pk_bf16_f32 v201, v82, v90
    v_cvt_pk_bf16_f32 v205, v83, v91
    s_add_u32 m0, s89, 32768
    s_nop 0
    buffer_load_dwordx4 v16, s[32:35], 0 offen lds
    s_waitcnt lgkmcnt(11)
    v_mfma_f32_32x32x16_bf16 v[28:43], v[48:51], v[64:67], v[28:43]
    ds_read_b128 v[64:67], v9 offset:0
    ds_read_b64_tr_b16 v[48:49], v12 offset:2048
    ds_read_b64_tr_b16 v[50:51], v12 offset:2560
    s_add_u32 m0, s89, 40960
    s_nop 0
    buffer_load_dwordx4 v17, s[32:35], 0 offen lds
    s_waitcnt lgkmcnt(11)
    v_mfma_f32_32x32x16_bf16 v[28:43], v[52:55], v[68:71], v[28:43]
    ds_read_b128 v[68:71], v10 offset:0
    ds_read_b64_tr_b16 v[52:53], v12 offset:4096
    ds_read_b64_tr_b16 v[54:55], v12 offset:4608
    s_add_u32 m0, s89, 98304
    s_add_u32 s60, s60, s61
    s_sub_u32 s93, s60, 851968
    s_min_u32 s60, s60, s93
    buffer_load_dwordx4 v2, s[40:43], s60 offen lds
    s_waitcnt lgkmcnt(11)
    v_mfma_f32_32x32x16_bf16 v[28:43], v[56:59], v[72:75], v[28:43]
    ds_read_b128 v[72:75], v11 offset:0
    ds_read_b64_tr_b16 v[56:57], v12 offset:6144
    ds_read_b64_tr_b16 v[58:59], v12 offset:6656
    s_add_u32 m0, s89, 106496
    s_add_u32 s60, s60, s61
    s_sub_u32 s93, s60, 851968
    s_min_u32 s60, s60, s93
    buffer_load_dwordx4 v2, s[40:43], s60 offen lds
    s_waitcnt lgkmcnt(9)
    v_lshl_add_u32 v18, v18, 7, v3
    v_lshl_add_u32 v19, v19, 7, v3
    s_waitcnt vmcnt(4)
    s_barrier
    v_mfma_f32_32x32x16_bf16 v[76:91], v[100:103], v[60:63], 0
    v_mfma_f32_32x32x16_bf16 v[28:43], v[44:47], v[60:63], v[28:43]
    ds_read_b128 v[60:63], v8 offset:16384
    ds_read_b64_tr_b16 v[44:45], v12 offset:16384
    ds_read_b64_tr_b16 v[46:47], v12 offset:16896
    ds_read_b64 v[134:135], v13 offset:16384
    ds_read_b64 v[16:17], v26 offset:96
    s_add_u32 m0, s89, 49152
    s_nop 0
    buffer_load_dwordx4 v18, s[32:35], 0 offen lds
    s_waitcnt lgkmcnt(11)
    v_mfma_f32_32x32x16_bf16 v[76:91], v[104:107], v[64:67], v[76:91]
    v_mfma_f32_32x32x16_bf16 v[28:43], v[48:51], v[64:67], v[28:43]
    ds_read_b128 v[64:67], v9 offset:16384
    ds_read_b64_tr_b16 v[48:49], v12 offset:18432
    ds_read_b64_tr_b16 v[50:51], v12 offset:18944
    s_add_u32 m0, s89, 57344
    s_nop 0
    buffer_load_dwordx4 v19, s[32:35], 0 offen lds
    s_waitcnt lgkmcnt(11)
    v_mfma_f32_32x32x16_bf16 v[76:91], v[108:111], v[68:71], v[76:91]
    v_mfma_f32_32x32x16_bf16 v[28:43], v[52:55], v[68:71], v[28:43]
    ds_read_b128 v[68:71], v10 offset:16384
    ds_read_b64_tr_b16 v[52:53], v12 offset:20480
    ds_read_b64_tr_b16 v[54:55], v12 offset:20992
    s_add_u32 m0, s89, 114688
    s_add_u32 s60, s60, s61
    s_sub_u32 s93, s60, 851968
    s_min_u32 s60, s60, s93
    buffer_load_dwordx4 v2, s[40:43], s60 offen lds
    s_waitcnt lgkmcnt(11)
    v_mfma_f32_32x32x16_bf16 v[76:91], v[112:115], v[72:75], v[76:91]
    v_mfma_f32_32x32x16_bf16 v[28:43], v[56:59], v[72:75], v[28:43]
    ds_read_b128 v[72:75], v11 offset:16384
    ds_read_b64_tr_b16 v[56:57], v12 offset:22528
    ds_read_b64_tr_b16 v[58:59], v12 offset:23040
    s_add_u32 m0, s89, 122880
    s_add_u32 s60, s60, s61
    s_sub_u32 s93, s60, 851968
    s_min_u32 s60, s60, s93
    buffer_load_dwordx4 v2, s[40:43], s60 offen lds
    s_waitcnt lgkmcnt(9)
    v_lshl_add_u32 v16, v16, 7, v3
    v_lshl_add_u32 v17, v17, 7, v3
    s_waitcnt vmcnt(4)
    s_barrier
    v_mfma_f32_32x32x16_bf16 v[28:43], v[44:47], v[60:63], v[28:43]
    ds_read_b128 v[60:63], v8 offset:32768
    ds_read_b64_tr_b16 v[44:45], v12 offset:32768
    ds_read_b64_tr_b16 v[46:47], v12 offset:33280
    ds_read_b64 v[136:137], v13 offset:32768
    v_mov_b32 v213, v84
    s_add_u32 m0, s89, 0
    s_nop 0
    buffer_load_dwordx4 v16, s[32:35], 0 offen lds
    s_waitcnt lgkmcnt(10)
    v_mfma_f32_32x32x16_bf16 v[28:43], v[48:51], v[64:67], v[28:43]
    ds_read_b128 v[64:67], v9 offset:32768
    ds_read_b64_tr_b16 v[48:49], v12 offset:34816
    ds_read_b64_tr_b16 v[50:51], v12 offset:35328
    s_add_u32 m0, s89, 8192
    s_nop 0
    buffer_load_dwordx4 v17, s[32:35], 0 offen lds
    s_waitcnt lgkmcnt(10)
    v_mfma_f32_32x32x16_bf16 v[28:43], v[52:55], v[68:71], v[28:43]
    ds_read_b128 v[68:71], v10 offset:32768
    ds_read_b64_tr_b16 v[52:53], v12 offset:36864
    ds_read_b64_tr_b16 v[54:55], v12 offset:37376
    s_add_u32 m0, s89, 65536
    s_add_u32 s60, s60, s61
    s_sub_u32 s93, s60, 851968
    s_min_u32 s60, s60, s93
    buffer_load_dwordx4 v2, s[40:43], s60 offen lds
    s_waitcnt lgkmcnt(10)
    v_mfma_f32_32x32x16_bf16 v[28:43], v[56:59], v[72:75], v[28:43]
    ds_read_b128 v[72:75], v11 offset:32768
    ds_read_b64_tr_b16 v[56:57], v12 offset:38912
    ds_read_b64_tr_b16 v[58:59], v12 offset:39424
    s_add_u32 m0, s89, 73728
    s_add_u32 s60, s60, s61
    s_sub_u32 s93, s60, 851968
    s_min_u32 s60, s60, s93
    buffer_load_dwordx4 v2, s[40:43], s60 offen lds
    s_waitcnt vmcnt(4)
    s_barrier
    s_waitcnt lgkmcnt(10)
    v_mfma_f32_32x32x16_bf16 v[84:99], v[100:103], v[60:63], 0
    v_mfma_f32_32x32x16_bf16 v[28:43], v[44:47], v[60:63], v[28:43]
    ds_read_b128 v[60:63], v8 offset:49152
    ds_read_b64_tr_b16 v[44:45], v12 offset:49152
    ds_read_b64_tr_b16 v[46:47], v12 offset:49664
    ds_read_b64 v[138:139], v13 offset:49152
    s_add_u32 m0, s89, 16384
    s_nop 0
    buffer_load_dwordx4 v7, s[36:39], s28 offen lds
    s_waitcnt lgkmcnt(10)
    v_mfma_f32_32x32x16_bf16 v[84:99], v[104:107], v[64:67], v[84:99]
    v_mfma_f32_32x32x16_bf16 v[28:43], v[48:51], v[64:67], v[28:43]
    ds_read_b128 v[64:67], v9 offset:49152
    ds_read_b64_tr_b16 v[48:49], v12 offset:51200
    ds_read_b64_tr_b16 v[50:51], v12 offset:51712
    s_lshl_b32 s91, s86, 11
    s_add_u32 s91, s91, 81920
    v_lshl_add_u32 v16, v1, 4, s91
    v_xor_b32 v17, 8192, v16
    v_lshrrev_b32 v250, 4, v1
    s_and_b32 s92, s86, 3
    s_lshl_b32 s92, s92, 8
    v_lshl_add_u32 v250, v250, 10, s92
    v_and_b32 v251, 15, v1
    v_lshl_add_u32 v18, v251, 4, v250
    s_and_b32 s91, s86, 2
    s_lshl_b32 s91, s91, 6
    s_lshr_b32 s92, s86, 2
    s_lshl_b32 s93, s92, 6
    s_add_u32 s91, s91, s93
    s_add_u32 s91, s91, 47104
    v_lshrrev_b32 v250, 5, v1
    v_lshl_add_u32 v19, v250, 4, s91
    s_lshl_b32 s91, s92, 12
    s_add_u32 s91, s91, 98304
    v_add_u32 v26, s91, v18
    s_waitcnt lgkmcnt(10)
    v_mfma_f32_32x32x16_bf16 v[84:99], v[108:111], v[68:71], v[84:99]
    v_mfma_f32_32x32x16_bf16 v[28:43], v[52:55], v[68:71], v[28:43]
    ds_read_b128 v[68:71], v10 offset:49152
    ds_read_b64_tr_b16 v[52:53], v12 offset:53248
    ds_read_b64_tr_b16 v[54:55], v12 offset:53760
    v_lshrrev_b32 v250, 5, v1
    v_and_b32 v251, 31, v1
    s_and_b32 s91, s86, 1
    s_lshl_b32 s92, s91, 9
    s_add_u32 s92, s92, 98304
    v_lshl_add_u32 v252, v250, 12, s92
    v_lshl_add_u32 v3, v251, 4, v252
    s_lshl_b32 s91, s91, 10
    s_lshr_b32 s92, s86, 1
    s_lshl_b32 s92, s92, 3
    s_add_u32 s91, s91, s92
    s_add_u32 s91, s91, 131072
    v_lshl_add_u32 v252, v250, 2, s91
    v_lshl_add_u32 v2, v251, 5, v252
    v_lshlrev_b32 v253, 2, v1
    v_add_u32 v253, 47104, v253
    s_waitcnt lgkmcnt(10)
    v_mfma_f32_32x32x16_bf16 v[84:99], v[112:115], v[72:75], v[84:99]
    v_mfma_f32_32x32x16_bf16 v[28:43], v[56:59], v[72:75], v[28:43]
    ds_read_b128 v[72:75], v11 offset:49152
    ds_read_b64_tr_b16 v[56:57], v12 offset:55296
    ds_read_b64_tr_b16 v[58:59], v12 offset:55808
    s_add_u32 m0, s89, 24576
    s_nop 0
    buffer_load_dwordx4 v7, s[36:39], s29 offen lds
    s_waitcnt vmcnt(2) lgkmcnt(0)
    s_barrier
    v_mfma_f32_32x32x16_bf16 v[28:43], v[44:47], v[60:63], v[28:43]
    ds_read_b128 v[60:63], v8 offset:0
    ds_read_b64_tr_b16 v[44:45], v12 offset:0
    ds_read_b64_tr_b16 v[46:47], v12 offset:512
    ds_read_b64 v[140:141], v13 offset:0
    v_cvt_pk_bf16_f32 v210, v213, v92
    v_cvt_pk_bf16_f32 v178, v76, v84
    v_cvt_pk_bf16_f32 v182, v77, v85
    v_cvt_pk_bf16_f32 v186, v78, v86
    v_cvt_pk_bf16_f32 v190, v79, v87
    v_cvt_pk_bf16_f32 v194, v80, v88
    v_cvt_pk_bf16_f32 v198, v81, v89
    v_cvt_pk_bf16_f32 v202, v82, v90
    v_cvt_pk_bf16_f32 v206, v83, v91
    s_add_u32 m0, s89, 32768
    s_nop 0
    buffer_load_dwordx4 v7, s[36:39], s30 offen lds
    v_mfma_f32_32x32x16_bf16 v[28:43], v[48:51], v[64:67], v[28:43]
    ds_read_b128 v[64:67], v9 offset:0
    ds_read_b64_tr_b16 v[48:49], v12 offset:2048
    ds_read_b64_tr_b16 v[50:51], v12 offset:2560
    ds_write_b96 v14, v[176:178] offset:0
    ds_write_b96 v14, v[180:182] offset:4096
    ds_write_b96 v14, v[184:186] offset:8192
    v_mfma_f32_32x32x16_bf16 v[28:43], v[52:55], v[68:71], v[28:43]
    ds_read_b128 v[68:71], v10 offset:0
    ds_read_b64_tr_b16 v[52:53], v12 offset:4096
    ds_read_b64_tr_b16 v[54:55], v12 offset:4608
    ds_write_b96 v14, v[188:190] offset:12288
    ds_write_b96 v15, v[192:194] offset:0
    s_waitcnt lgkmcnt(9)
    ds_write_b96 v15, v[196:198] offset:4096
    v_mfma_f32_32x32x16_bf16 v[28:43], v[56:59], v[72:75], v[28:43]
    ds_read_b128 v[72:75], v11 offset:0
    ds_read_b64_tr_b16 v[56:57], v12 offset:6144
    ds_read_b64_tr_b16 v[58:59], v12 offset:6656
    s_lshr_b32 s91, s86, 1
    s_cmp_lg_u32 s91, 0
    s_cbranch_scc1 L_wc3
    s_add_u32 m0, s89, 40960
    s_nop 0
    buffer_load_dwordx4 v7, s[36:39], s31 offen lds
L_wc3:
    ds_write_b96 v15, v[200:202] offset:8192
    ds_write_b96 v15, v[204:206] offset:12288
    s_cmp_lg_u32 s86, 0
    s_cbranch_scc1 L_f4
    v_mov_b32 v0, 0
    s_lshl_b32 s91, s87, 2
    buffer_load_dword v6, v0, s[52:55], s91 offen sc0 sc1
L_f4:
    v_mfma_f32_32x32x16_bf16 v[76:91], v[100:103], v[60:63], 0
    s_waitcnt lgkmcnt(14)
    v_mfma_f32_32x32x16_bf16 v[76:91], v[104:107], v[64:67], v[76:91]
    s_waitcnt lgkmcnt(8)
    v_mfma_f32_32x32x16_bf16 v[76:91], v[108:111], v[68:71], v[76:91]
    s_waitcnt lgkmcnt(2)
    v_mfma_f32_32x32x16_bf16 v[76:91], v[112:115], v[72:75], v[76:91]
    v_mfma_f32_32x32x16_bf16 v[28:43], v[44:47], v[60:63], v[28:43]
    v_mfma_f32_32x32x16_bf16 v[28:43], v[48:51], v[64:67], v[28:43]
    v_mfma_f32_32x32x16_bf16 v[28:43], v[52:55], v[68:71], v[28:43]
    v_mfma_f32_32x32x16_bf16 v[28:43], v[56:59], v[72:75], v[28:43]
    v_add_u32 v14, 12, v14
    v_add_u32 v15, 12, v15
    s_nop 5
    v_cvt_pk_bf16_f32 v211, v84, 0
    ds_write_b128 v27, v[208:211]
    v_cvt_pk_bf16_f32 v179, v76, 0
    v_cvt_pk_bf16_f32 v183, v77, 0
    v_cvt_pk_bf16_f32 v187, v78, 0
    v_cvt_pk_bf16_f32 v191, v79, 0
    v_cvt_pk_bf16_f32 v195, v80, 0
    v_cvt_pk_bf16_f32 v199, v81, 0
    v_cvt_pk_bf16_f32 v203, v82, 0
    v_cvt_pk_bf16_f32 v207, v83, 0
    ds_write_b128 v16, v[36:39] offset:0
    ds_write_b128 v16, v[40:43] offset:1024
    s_waitcnt lgkmcnt(0)
    s_barrier
    ds_read_b128 v[240:243], v18 offset:43008
    ds_read_b128 v[36:39], v17 offset:0
    ds_read_b128 v[40:43], v17 offset:1024
    ds_read_b128 v[108:111], v19 offset:0
    ds_read_b128 v[112:115], v19 offset:32
    s_add_u32 m0, s89, 0
    s_add_u32 s91, s28, 86528
    buffer_load_dwordx4 v7, s[36:39], s91 offen lds
    s_waitcnt lgkmcnt(4)
    v_mfma_f32_16x16x32_bf16 v[244:247], v[20:23], v[240:243], 0
    ds_write2st64_b32 v14, v179, v183 offset0:0 offset1:16
    ds_write2st64_b32 v14, v187, v191 offset0:32 offset1:48
    ds_write2st64_b32 v15, v195, v199 offset0:0 offset1:16
    ds_write2st64_b32 v15, v203, v207 offset0:32 offset1:48
    s_branch L_tail
L_k1:
    s_waitcnt vmcnt(12)
    s_barrier
    ds_read_b128 v[60:63], v8 offset:0
    ds_read_b64_tr_b16 v[44:45], v12 offset:0
    ds_read_b64_tr_b16 v[46:47], v12 offset:512
    ds_read_b64 v[116:117], v13 offset:0
    ds_read_b128 v[64:67], v9 offset:0
    ds_read_b64_tr_b16 v[48:49], v12 offset:2048
    ds_read_b64_tr_b16 v[50:51], v12 offset:2560
    ds_read_b128 v[68:71], v10 offset:0
    ds_read_b64_tr_b16 v[52:53], v12 offset:4096
    ds_read_b64_tr_b16 v[54:55], v12 offset:4608
    s_add_u32 m0, s89, 114688
    s_add_u32 s60, s60, s61
    s_sub_u32 s93, s60, 851968
    s_min_u32 s60, s60, s93
    buffer_load_dwordx4 v2, s[40:43], s60 offen lds
    ds_read_b128 v[72:75], v11 offset:0
    ds_read_b64_tr_b16 v[56:57], v12 offset:6144
    ds_read_b64_tr_b16 v[58:59], v12 offset:6656
    s_add_u32 m0, s89, 122880
    s_add_u32 s60, s60, s61
    s_sub_u32 s93, s60, 851968
    s_min_u32 s60, s60, s93
    buffer_load_dwordx4 v2, s[40:43], s60 offen lds
    s_waitcnt vmcnt(8)
    s_barrier
    s_waitcnt lgkmcnt(10)
    v_mfma_f32_32x32x16_bf16 v[28:43], v[44:47], v[60:63], 0
    ds_read_b128 v[60:63], v8 offset:16384
    ds_read_b64_tr_b16 v[44:45], v12 offset:16384
    ds_read_b64_tr_b16 v[46:47], v12 offset:16896
    ds_read_b64 v[118:119], v13 offset:16384
    ds_read_b64 v[16:17], v26 offset:32
    s_waitcnt lgkmcnt(11)
    v_mfma_f32_32x32x16_bf16 v[28:43], v[48:51], v[64:67], v[28:43]
    ds_read_b128 v[64:67], v9 offset:16384
    ds_read_b64_tr_b16 v[48:49], v12 offset:18432
    ds_read_b64_tr_b16 v[50:51], v12 offset:18944
    s_waitcnt lgkmcnt(11)
    v_mfma_f32_32x32x16_bf16 v[28:43], v[52:55], v[68:71], v[28:43]
    ds_read_b128 v[68:71], v10 offset:16384
    ds_read_b64_tr_b16 v[52:53], v12 offset:20480
    ds_read_b64_tr_b16 v[54:55], v12 offset:20992
    s_waitcnt lgkmcnt(11)
    v_mfma_f32_32x32x16_bf16 v[28:43], v[56:59], v[72:75], v[28:43]
    ds_read_b128 v[72:75], v11 offset:16384
    ds_read_b64_tr_b16 v[56:57], v12 offset:22528
    ds_read_b64_tr_b16 v[58:59], v12 offset:23040
    s_waitcnt lgkmcnt(9)
    v_lshl_add_u32 v16, v16, 7, v3
    v_lshl_add_u32 v17, v17, 7, v3
    s_waitcnt vmcnt(6)
    s_barrier
    v_mfma_f32_32x32x16_bf16 v[76:91], v[100:103], v[60:63], 0
    v_mfma_f32_32x32x16_bf16 v[28:43], v[44:47], v[60:63], v[28:43]
    ds_read_b128 v[60:63], v8 offset:32768
    ds_read_b64_tr_b16 v[44:45], v12 offset:32768
    ds_read_b64_tr_b16 v[46:47], v12 offset:33280
    ds_read_b64 v[120:121], v13 offset:32768
    ds_read_b64 v[18:19], v26 offset:40
    s_add_u32 m0, s89, 0
    s_nop 0
    buffer_load_dwordx4 v16, s[32:35], 0 offen lds
    s_waitcnt lgkmcnt(11)
    v_mfma_f32_32x32x16_bf16 v[76:91], v[104:107], v[64:67], v[76:91]
    v_mfma_f32_32x32x16_bf16 v[28:43], v[48:51], v[64:67], v[28:43]
    ds_read_b128 v[64:67], v9 offset:32768
    ds_read_b64_tr_b16 v[48:49], v12 offset:34816
    ds_read_b64_tr_b16 v[50:51], v12 offset:35328
    s_add_u32 m0, s89, 8192
    s_nop 0
    buffer_load_dwordx4 v17, s[32:35], 0 offen lds
    s_waitcnt lgkmcnt(11)
    v_mfma_f32_32x32x16_bf16 v[76:91], v[108:111], v[68:71], v[76:91]
    v_mfma_f32_32x32x16_bf16 v[28:43], v[52:55], v[68:71], v[28:43]
    ds_read_b128 v[68:71], v10 offset:32768
    ds_read_b64_tr_b16 v[52:53], v12 offset:36864
    ds_read_b64_tr_b16 v[54:55], v12 offset:37376
    s_add_u32 m0, s89, 65536
    s_add_u32 s60, s60, s61
    s_sub_u32 s93, s60, 851968
    s_min_u32 s60, s60, s93
    buffer_load_dwordx4 v2, s[40:43], s60 offen lds
    s_waitcnt lgkmcnt(11)
    v_mfma_f32_32x32x16_bf16 v[76:91], v[112:115], v[72:75], v[76:91]
    v_mfma_f32_32x32x16_bf16 v[28:43], v[56:59], v[72:75], v[28:43]
    ds_read_b128 v[72:75], v11 offset:32768
    ds_read_b64_tr_b16 v[56:57], v12 offset:38912
    ds_read_b64_tr_b16 v[58:59], v12 offset:39424
    s_add_u32 m0, s89, 73728
    s_add_u32 s60, s60, s61
    s_sub_u32 s93, s60, 851968
    s_min_u32 s60, s60, s93
    buffer_load_dwordx4 v2, s[40:43], s60 offen lds
    s_waitcnt lgkmcnt(9)
    v_lshl_add_u32 v18, v18, 7, v3
    v_lshl_add_u32 v19, v19, 7, v3
    s_waitcnt vmcnt(4)
    s_barrier
    v_mfma_f32_32x32x16_bf16 v[28:43], v[44:47], v[60:63], v[28:43]
    ds_read_b128 v[60:63], v8 offset:49152
    ds_read_b64_tr_b16 v[44:45], v12 offset:49152
    ds_read_b64_tr_b16 v[46:47], v12 offset:49664
    ds_read_b64 v[122:123], v13 offset:49152
    ds_read_b64 v[16:17], v26 offset:48
    v_mov_b32 v213, v84
    s_add_u32 m0, s89, 16384
    s_nop 0
    buffer_load_dwordx4 v18, s[32:35], 0 offen lds
    s_waitcnt lgkmcnt(11)
    v_mfma_f32_32x32x16_bf16 v[28:43], v[48:51], v[64:67], v[28:43]
    ds_read_b128 v[64:67], v9 offset:49152
    ds_read_b64_tr_b16 v[48:49], v12 offset:51200
    ds_read_b64_tr_b16 v[50:51], v12 offset:51712
    s_add_u32 m0, s89, 24576
    s_nop 0
    buffer_load_dwordx4 v19, s[32:35], 0 offen lds
    s_waitcnt lgkmcnt(11)
    v_mfma_f32_32x32x16_bf16 v[28:43], v[52:55], v[68:71], v[28:43]
    ds_read_b128 v[68:71], v10 offset:49152
    ds_read_b64_tr_b16 v[52:53], v12 offset:53248
    ds_read_b64_tr_b16 v[54:55], v12 offset:53760
    s_add_u32 m0, s89, 81920
    s_add_u32 s60, s60, s61
    s_sub_u32 s93, s60, 851968
    s_min_u32 s60, s60, s93
    buffer_load_dwordx4 v2, s[40:43], s60 offen lds
    s_waitcnt lgkmcnt(11)
    v_mfma_f32_32x32x16_bf16 v[28:43], v[56:59], v[72:75], v[28:43]
    ds_read_b128 v[72:75], v11 offset:49152
    ds_read_b64_tr_b16 v[56:57], v12 offset:55296
    ds_read_b64_tr_b16 v[58:59], v12 offset:55808
    s_add_u32 m0, s89, 90112
    s_add_u32 s60, s60, s61
    s_sub_u32 s93, s60, 851968
    s_min_u32 s60, s60, s93
    buffer_load_dwordx4 v2, s[40:43], s60 offen lds
    s_waitcnt lgkmcnt(9)
    v_lshl_add_u32 v16, v16, 7, v3
    v_lshl_add_u32 v17, v17, 7, v3
    s_waitcnt vmcnt(4)
    s_barrier
    v_mfma_f32_32x32x16_bf16 v[84:99], v[100:103], v[60:63], 0
    v_mfma_f32_32x32x16_bf16 v[28:43], v[44:47], v[60:63], v[28:43]
    ds_read_b128 v[60:63], v8 offset:0
    ds_read_b64_tr_b16 v[44:45], v12 offset:0
    ds_read_b64_tr_b16 v[46:47], v12 offset:512
    ds_read_b64 v[124:125], v13 offset:0
    ds_read_b64 v[18:19], v26 offset:56
    s_add_u32 m0, s89, 32768
    s_nop 0
    buffer_load_dwordx4 v16, s[32:35], 0 offen lds
    s_waitcnt lgkmcnt(11)
    v_mfma_f32_32x32x16_bf16 v[84:99], v[104:107], v[64:67], v[84:99]
    v_mfma_f32_32x32x16_bf16 v[28:43], v[48:51], v[64:67], v[28:43]
    ds_read_b128 v[64:67], v9 offset:0
    ds_read_b64_tr_b16 v[48:49], v12 offset:2048
    ds_read_b64_tr_b16 v[50:51], v12 offset:2560
    s_add_u32 m0, s89, 40960
    s_nop 0
    buffer_load_dwordx4 v17, s[32:35], 0 offen lds
    s_waitcnt lgkmcnt(11)
    v_mfma_f32_32x32x16_bf16 v[84:99], v[108:111], v[68:71], v[84:99]
    v_mfma_f32_32x32x16_bf16 v[28:43], v[52:55], v[68:71], v[28:43]
    ds_read_b128 v[68:71], v10 offset:0
    ds_read_b64_tr_b16 v[52:53], v12 offset:4096
    ds_read_b64_tr_b16 v[54:55], v12 offset:4608
    s_add_u32 m0, s89, 98304
    s_add_u32 s60, s60, s61
    s_sub_u32 s93, s60, 851968
    s_min_u32 s60, s60, s93
    buffer_load_dwordx4 v2, s[40:43], s60 offen lds
    s_waitcnt lgkmcnt(11)
    v_mfma_f32_32x32x16_bf16 v[84:99], v[112:115], v[72:75], v[84:99]
    v_mfma_f32_32x32x16_bf16 v[28:43], v[56:59], v[72:75], v[28:43]
    ds_read_b128 v[72:75], v11 offset:0
    ds_read_b64_tr_b16 v[56:57], v12 offset:6144
    ds_read_b64_tr_b16 v[58:59], v12 offset:6656
    s_add_u32 m0, s89, 106496
    s_add_u32 s60, s60, s61
    s_sub_u32 s93, s60, 851968
    s_min_u32 s60, s60, s93
    buffer_load_dwordx4 v2, s[40:43], s60 offen lds
    s_waitcnt lgkmcnt(9)
    v_lshl_add_u32 v18, v18, 7, v3
    v_lshl_add_u32 v19, v19, 7, v3
    s_waitcnt vmcnt(4)
    s_barrier
    v_mfma_f32_32x32x16_bf16 v[28:43], v[44:47], v[60:63], v[28:43]
    ds_read_b128 v[60:63], v8 offset:16384
    ds_read_b64_tr_b16 v[44:45], v12 offset:16384
    ds_read_b64_tr_b16 v[46:47], v12 offset:16896
    ds_read_b64 v[126:127], v13 offset:16384
    ds_read_b64 v[16:17], v26 offset:64
    v_cvt_pk_bf16_f32 v208, v213, v92
    v_cvt_pk_bf16_f32 v176, v76, v84
    v_cvt_pk_bf16_f32 v180, v77, v85
    v_cvt_pk_bf16_f32 v184, v78, v86
    v_cvt_pk_bf16_f32 v188, v79, v87
    v_cvt_pk_bf16_f32 v192, v80, v88
    v_cvt_pk_bf16_f32 v196, v81, v89
    v_cvt_pk_bf16_f32 v200, v82, v90
    v_cvt_pk_bf16_f32 v204, v83, v91
    s_add_u32 m0, s89, 49152
    s_nop 0
    buffer_load_dwordx4 v18, s[32:35], 0 offen lds
    s_waitcnt lgkmcnt(11)
    v_mfma_f32_32x32x16_bf16 v[28:43], v[48:51], v[64:67], v[28:43]
    ds_read_b128 v[64:67], v9 offset:16384
    ds_read_b64_tr_b16 v[48:49], v12 offset:18432
    ds_read_b64_tr_b16 v[50:51], v12 offset:18944
    s_add_u32 m0, s89, 57344
    s_nop 0
    buffer_load_dwordx4 v19, s[32:35], 0 offen lds
    s_waitcnt lgkmcnt(11)
    v_mfma_f32_32x32x16_bf16 v[28:43], v[52:55], v[68:71], v[28:43]
    ds_read_b128 v[68:71], v10 offset:16384
    ds_read_b64_tr_b16 v[52:53], v12 offset:20480
    ds_read_b64_tr_b16 v[54:55], v12 offset:20992
    s_add_u32 m0, s89, 114688
    s_add_u32 s60, s60, s61
    s_sub_u32 s93, s60, 851968
    s_min_u32 s60, s60, s93
    buffer_load_dwordx4 v2, s[40:43], s60 offen lds
    s_waitcnt lgkmcnt(11)
    v_mfma_f32_32x32x16_bf16 v[28:43], v[56:59], v[72:75], v[28:43]
    ds_read_b128 v[72:75], v11 offset:16384
    ds_read_b64_tr_b16 v[56:57], v12 offset:22528
    ds_read_b64_tr_b16 v[58:59], v12 offset:23040
    s_add_u32 m0, s89, 122880
    s_add_u32 s60, s60, s61
    s_sub_u32 s93, s60, 851968
    s_min_u32 s60, s60, s93
    buffer_load_dwordx4 v2, s[40:43], s60 offen lds
    s_waitcnt lgkmcnt(9)
    v_lshl_add_u32 v16, v16, 7, v3
    v_lshl_add_u32 v17, v17, 7, v3
    s_waitcnt vmcnt(4)
    s_barrier
    v_mfma_f32_32x32x16_bf16 v[76:91], v[100:103], v[60:63], 0
    v_mfma_f32_32x32x16_bf16 v[28:43], v[44:47], v[60:63], v[28:43]
    ds_read_b128 v[60:63], v8 offset:32768
    ds_read_b64_tr_b16 v[44:45], v12 offset:32768
    ds_read_b64_tr_b16 v[46:47], v12 offset:33280
    ds_read_b64 v[128:129], v13 offset:32768
    ds_read_b64 v[18:19], v26 offset:72
    s_add_u32 m0, s89, 0
    s_nop 0
    buffer_load_dwordx4 v16, s[32:35], 0 offen lds
    s_waitcnt lgkmcnt(11)
    v_mfma_f32_32x32x16_bf16 v[76:91], v[104:107], v[64:67], v[76:91]
    v_mfma_f32_32x32x16_bf16 v[28:43], v[48:51], v[64:67], v[28:43]
    ds_read_b128 v[64:67], v9 offset:32768
    ds_read_b64_tr_b16 v[48:49], v12 offset:34816
    ds_read_b64_tr_b16 v[50:51], v12 offset:35328
    s_add_u32 m0, s89, 8192
    s_nop 0
    buffer_load_dwordx4 v17, s[32:35], 0 offen lds
    s_waitcnt lgkmcnt(11)
    v_mfma_f32_32x32x16_bf16 v[76:91], v[108:111], v[68:71], v[76:91]
    v_mfma_f32_32x32x16_bf16 v[28:43], v[52:55], v[68:71], v[28:43]
    ds_read_b128 v[68:71], v10 offset:32768
    ds_read_b64_tr_b16 v[52:53], v12 offset:36864
    ds_read_b64_tr_b16 v[54:55], v12 offset:37376
    s_add_u32 m0, s89, 65536
    s_add_u32 s60, s60, s61
    s_sub_u32 s93, s60, 851968
    s_min_u32 s60, s60, s93
    buffer_load_dwordx4 v2, s[40:43], s60 offen lds
    s_waitcnt lgkmcnt(11)
    v_mfma_f32_32x32x16_bf16 v[76:91], v[112:115], v[72:75], v[76:91]
    v_mfma_f32_32x32x16_bf16 v[28:43], v[56:59], v[72:75], v[28:43]
    ds_read_b128 v[72:75], v11 offset:32768
    ds_read_b64_tr_b16 v[56:57], v12 offset:38912
    ds_read_b64_tr_b16 v[58:59], v12 offset:39424
    s_add_u32 m0, s89, 73728
    s_add_u32 s60, s60, s61
    s_sub_u32 s93, s60, 851968
    s_min_u32 s60, s60, s93
    buffer_load_dwordx4 v2, s[40:43], s60 offen lds
    s_waitcnt lgkmcnt(9)
    v_lshl_add_u32 v18, v18, 7, v3
    v_lshl_add_u32 v19, v19, 7, v3
    s_waitcnt vmcnt(4)
    s_barrier
    v_mfma_f32_32x32x16_bf16 v[28:43], v[44:47], v[60:63], v[28:43]
    ds_read_b128 v[60:63], v8 offset:49152
    ds_read_b64_tr_b16 v[44:45], v12 offset:49152
    ds_read_b64_tr_b16 v[46:47], v12 offset:49664
    ds_read_b64 v[130:131], v13 offset:49152
    ds_read_b64 v[16:17], v26 offset:80
    v_mov_b32 v213, v84
    s_add_u32 m0, s89, 16384
    s_nop 0
    buffer_load_dwordx4 v18, s[32:35], 0 offen lds
    s_waitcnt lgkmcnt(11)
    v_mfma_f32_32x32x16_bf16 v[28:43], v[48:51], v[64:67], v[28:43]
    ds_read_b128 v[64:67], v9 offset:49152
    ds_read_b64_tr_b16 v[48:49], v12 offset:51200
    ds_read_b64_tr_b16 v[50:51], v12 offset:51712
    s_add_u32 m0, s89, 24576
    s_nop 0
    buffer_load_dwordx4 v19, s[32:35], 0 offen lds
    s_waitcnt lgkmcnt(11)
    v_mfma_f32_32x32x16_bf16 v[28:43], v[52:55], v[68:71], v[28:43]
    ds_read_b128 v[68:71], v10 offset:49152
    ds_read_b64_tr_b16 v[52:53], v12 offset:53248
    ds_read_b64_tr_b16 v[54:55], v12 offset:53760
    s_add_u32 m0, s89, 81920
    s_add_u32 s60, s60, s61
    s_sub_u32 s93, s60, 851968
    s_min_u32 s60, s60, s93
    buffer_load_dwordx4 v2, s[40:43], s60 offen lds
    s_waitcnt lgkmcnt(11)
    v_mfma_f32_32x32x16_bf16 v[28:43], v[56:59], v[72:75], v[28:43]
    ds_read_b128 v[72:75], v11 offset:49152
    ds_read_b64_tr_b16 v[56:57], v12 offset:55296
    ds_read_b64_tr_b16 v[58:59], v12 offset:55808
    s_add_u32 m0, s89, 90112
    s_add_u32 s60, s60, s61
    s_sub_u32 s93, s60, 851968
    s_min_u32 s60, s60, s93
    buffer_load_dwordx4 v2, s[40:43], s60 offen lds
    s_waitcnt lgkmcnt(9)
    v_lshl_add_u32 v16, v16, 7, v3
    v_lshl_add_u32 v17, v17, 7, v3
    s_waitcnt vmcnt(4)
    s_barrier
    v_mfma_f32_32x32x16_bf16 v[84:99], v[100:103], v[60:63], 0
    v_mfma_f32_32x32x16_bf16 v[28:43], v[44:47], v[60:63], v[28:43]
    ds_read_b128 v[60:63], v8 offset:0
    ds_read_b64_tr_b16 v[44:45], v12 offset:0
    ds_read_b64_tr_b16 v[46:47], v12 offset:512
    ds_read_b64 v[132:133], v13 offset:0
    ds_read_b64 v[18:19], v26 offset:88
    s_add_u32 m0, s89, 32768
    s_nop 0
    buffer_load_dwordx4 v16, s[32:35], 0 offen lds
    s_waitcnt lgkmcnt(11)
    v_mfma_f32_32x32x16_bf16 v[84:99], v[104:107], v[64:67], v[84:99]
    v_mfma_f32_32x32x16_bf16 v[28:43], v[48:51], v[64:67], v[28:43]
    ds_read_b128 v[64:67], v9 offset:0
    ds_read_b64_tr_b16 v[48:49], v12 offset:2048
    ds_read_b64_tr_b16 v[50:51], v12 offset:2560
    s_add_u32 m0, s89, 40960
    s_nop 0
    buffer_load_dwordx4 v17, s[32:35], 0 offen lds
    s_waitcnt lgkmcnt(11)
    v_mfma_f32_32x32x16_bf16 v[84:99], v[108:111], v[68:71], v[84:99]
    v_mfma_f32_32x32x16_bf16 v[28:43], v[52:55], v[68:71], v[28:43]
    ds_read_b128 v[68:71], v10 offset:0
    ds_read_b64_tr_b16 v[52:53], v12 offset:4096
    ds_read_b64_tr_b16 v[54:55], v12 offset:4608
    s_add_u32 m0, s89, 98304
    s_add_u32 s60, s60, s61
    s_sub_u32 s93, s60, 851968
    s_min_u32 s60, s60, s93
    buffer_load_dwordx4 v2, s[40:43], s60 offen lds
    s_waitcnt lgkmcnt(11)
    v_mfma_f32_32x32x16_bf16 v[84:99], v[112:115], v[72:75], v[84:99]
    v_mfma_f32_32x32x16_bf16 v[28:43], v[56:59], v[72:75], v[28:43]
    ds_read_b128 v[72:75], v11 offset:0
    ds_read_b64_tr_b16 v[56:57], v12 offset:6144
    ds_read_b64_tr_b16 v[58:59], v12 offset:6656
    s_add_u32 m0, s89, 106496
    s_add_u32 s60, s60, s61
    s_sub_u32 s93, s60, 851968
    s_min_u32 s60, s60, s93
    buffer_load_dwordx4 v2, s[40:43], s60 offen lds
    s_waitcnt lgkmcnt(9)
    v_lshl_add_u32 v18, v18, 7, v3
    v_lshl_add_u32 v19, v19, 7, v3
    s_waitcnt vmcnt(4)
    s_barrier
    v_mfma_f32_32x32x16_bf16 v[28:43], v[44:47], v[60:63], v[28:43]
    ds_read_b128 v[60:63], v8 offset:16384
    ds_read_b64_tr_b16 v[44:45], v12 offset:16384
    ds_read_b64_tr_b16 v[46:47], v12 offset:16896
    ds_read_b64 v[134:135], v13 offset:16384
    ds_read_b64 v[16:17], v26 offset:96
    v_cvt_pk_bf16_f32 v209, v213, v92
    v_cvt_pk_bf16_f32 v177, v76, v84
    v_cvt_pk_bf16_f32 v181, v77, v85
    v_cvt_pk_bf16_f32 v185, v78, v86
    v_cvt_pk_bf16_f32 v189, v79, v87
    v_cvt_pk_bf16_f32 v193, v80, v88
    v_cvt_pk_bf16_f32 v197, v81, v89
    v_cvt_pk_bf16_f32 v201, v82, v90
    v_cvt_pk_bf16_f32 v205, v83, v91
    s_add_u32 m0, s89, 49152
    s_nop 0
    buffer_load_dwordx4 v18, s[32:35], 0 offen lds
    s_waitcnt lgkmcnt(11)
    v_mfma_f32_32x32x16_bf16 v[28:43], v[48:51], v[64:67], v[28:43]
    ds_read_b128 v[64:67], v9 offset:16384
    ds_read_b64_tr_b16 v[48:49], v12 offset:18432
    ds_read_b64_tr_b16 v[50:51], v12 offset:18944
    s_add_u32 m0, s89, 57344
    s_nop 0
    buffer_load_dwordx4 v19, s[32:35], 0 offen lds
    s_waitcnt lgkmcnt(11)
    v_mfma_f32_32x32x16_bf16 v[28:43], v[52:55], v[68:71], v[28:43]
    ds_read_b128 v[68:71], v10 offset:16384
    ds_read_b64_tr_b16 v[52:53], v12 offset:20480
    ds_read_b64_tr_b16 v[54:55], v12 offset:20992
    s_add_u32 m0, s89, 114688
    s_add_u32 s60, s60, s61
    s_sub_u32 s93, s60, 851968
    s_min_u32 s60, s60, s93
    buffer_load_dwordx4 v2, s[40:43], s60 offen lds
    s_waitcnt lgkmcnt(11)
    v_mfma_f32_32x32x16_bf16 v[28:43], v[56:59], v[72:75], v[28:43]
    ds_read_b128 v[72:75], v11 offset:16384
    ds_read_b64_tr_b16 v[56:57], v12 offset:22528
    ds_read_b64_tr_b16 v[58:59], v12 offset:23040
    s_add_u32 m0, s89, 122880
    s_add_u32 s60, s60, s61
    s_sub_u32 s93, s60, 851968
    s_min_u32 s60, s60, s93
    buffer_load_dwordx4 v2, s[40:43], s60 offen lds
    s_waitcnt lgkmcnt(9)
    v_lshl_add_u32 v16, v16, 7, v3
    v_lshl_add_u32 v17, v17, 7, v3
    s_waitcnt vmcnt(4)
    s_barrier
    v_mfma_f32_32x32x16_bf16 v[76:91], v[100:103], v[60:63], 0
    v_mfma_f32_32x32x16_bf16 v[28:43], v[44:47], v[60:63], v[28:43]
    ds_read_b128 v[60:63], v8 offset:32768
    ds_read_b64_tr_b16 v[44:45], v12 offset:32768
    ds_read_b64_tr_b16 v[46:47], v12 offset:33280
    ds_read_b64 v[136:137], v13 offset:32768
    s_add_u32 m0, s89, 0
    s_nop 0
    buffer_load_dwordx4 v16, s[32:35], 0 offen lds
    s_waitcnt lgkmcnt(10)
    v_mfma_f32_32x32x16_bf16 v[76:91], v[104:107], v[64:67], v[76:91]
    v_mfma_f32_32x32x16_bf16 v[28:43], v[48:51], v[64:67], v[28:43]
    ds_read_b128 v[64:67], v9 offset:32768
    ds_read_b64_tr_b16 v[48:49], v12 offset:34816
    ds_read_b64_tr_b16 v[50:51], v12 offset:35328
    s_add_u32 m0, s89, 8192
    s_nop 0
    buffer_load_dwordx4 v17, s[32:35], 0 offen lds
    s_waitcnt lgkmcnt(10)
    v_mfma_f32_32x32x16_bf16 v[76:91], v[108:111], v[68:71], v[76:91]
    v_mfma_f32_32x32x16_bf16 v[28:43], v[52:55], v[68:71], v[28:43]
    ds_read_b128 v[68:71], v10 offset:32768
    ds_read_b64_tr_b16 v[52:53], v12 offset:36864
    ds_read_b64_tr_b16 v[54:55], v12 offset:37376
    s_add_u32 m0, s89, 65536
    s_add_u32 s60, s60, s61
    s_sub_u32 s93, s60, 851968
    s_min_u32 s60, s60, s93
    buffer_load_dwordx4 v2, s[40:43], s60 offen lds
    s_waitcnt lgkmcnt(10)
    v_mfma_f32_32x32x16_bf16 v[76:91], v[112:115], v[72:75], v[76:91]
    v_mfma_f32_32x32x16_bf16 v[28:43], v[56:59], v[72:75], v[28:43]
    ds_read_b128 v[72:75], v11 offset:32768
    ds_read_b64_tr_b16 v[56:57], v12 offset:38912
    ds_read_b64_tr_b16 v[58:59], v12 offset:39424
    s_add_u32 m0, s89, 73728
    s_add_u32 s60, s60, s61
    s_sub_u32 s93, s60, 851968
    s_min_u32 s60, s60, s93
    buffer_load_dwordx4 v2, s[40:43], s60 offen lds
    s_waitcnt vmcnt(4)
    s_barrier
    s_waitcnt lgkmcnt(10)
    v_mfma_f32_32x32x16_bf16 v[28:43], v[44:47], v[60:63], v[28:43]
    ds_read_b128 v[60:63], v8 offset:49152
    ds_read_b64_tr_b16 v[44:45], v12 offset:49152
    ds_read_b64_tr_b16 v[46:47], v12 offset:49664
    ds_read_b64 v[138:139], v13 offset:49152
    v_mov_b32 v213, v84
    s_add_u32 m0, s89, 16384
    s_nop 0
    buffer_load_dwordx4 v7, s[36:39], s28 offen lds
    s_waitcnt lgkmcnt(10)
    v_mfma_f32_32x32x16_bf16 v[28:43], v[48:51], v[64:67], v[28:43]
    ds_read_b128 v[64:67], v9 offset:49152
    ds_read_b64_tr_b16 v[48:49], v12 offset:51200
    ds_read_b64_tr_b16 v[50:51], v12 offset:51712
    s_lshl_b32 s91, s86, 11
    s_add_u32 s91, s91, 81920
    v_lshl_add_u32 v16, v1, 4, s91
    v_xor_b32 v17, 8192, v16
    v_lshrrev_b32 v250, 4, v1
    s_and_b32 s92, s86, 3
    s_lshl_b32 s92, s92, 8
    v_lshl_add_u32 v250, v250, 10, s92
    v_and_b32 v251, 15, v1
    v_lshl_add_u32 v18, v251, 4, v250
    s_and_b32 s91, s86, 2
    s_lshl_b32 s91, s91, 6
    s_lshr_b32 s92, s86, 2
    s_lshl_b32 s93, s92, 6
    s_add_u32 s91, s91, s93
    s_add_u32 s91, s91, 47104
    v_lshrrev_b32 v250, 5, v1
    v_lshl_add_u32 v19, v250, 4, s91
    s_lshl_b32 s91, s92, 12
    s_add_u32 s91, s91, 98304
    v_add_u32 v26, s91, v18
    s_waitcnt lgkmcnt(10)
    v_mfma_f32_32x32x16_bf16 v[28:43], v[52:55], v[68:71], v[28:43]
    ds_read_b128 v[68:71], v10 offset:49152
    ds_read_b64_tr_b16 v[52:53], v12 offset:53248
    ds_read_b64_tr_b16 v[54:55], v12 offset:53760
    v_lshrrev_b32 v250, 5, v1
    v_and_b32 v251, 31, v1
    s_and_b32 s91, s86, 1
    s_lshl_b32 s92, s91, 9
    s_add_u32 s92, s92, 98304
    v_lshl_add_u32 v252, v250, 12, s92
    v_lshl_add_u32 v3, v251, 4, v252
    s_lshl_b32 s91, s91, 10
    s_lshr_b32 s92, s86, 1
    s_lshl_b32 s92, s92, 3
    s_add_u32 s91, s91, s92
    s_add_u32 s91, s91, 131072
    v_lshl_add_u32 v252, v250, 2, s91
    v_lshl_add_u32 v2, v251, 5, v252
    v_lshlrev_b32 v253, 2, v1
    v_add_u32 v253, 47104, v253
    s_waitcnt lgkmcnt(10)
    v_mfma_f32_32x32x16_bf16 v[28:43], v[56:59], v[72:75], v[28:43]
    ds_read_b128 v[72:75], v11 offset:49152
    ds_read_b64_tr_b16 v[56:57], v12 offset:55296
    ds_read_b64_tr_b16 v[58:59], v12 offset:55808
    s_add_u32 m0, s89, 24576
    s_nop 0
    buffer_load_dwordx4 v7, s[36:39], s29 offen lds
    s_waitcnt vmcnt(2) lgkmcnt(0)
    s_barrier
    v_mfma_f32_32x32x16_bf16 v[84:99], v[100:103], v[60:63], 0
    v_mfma_f32_32x32x16_bf16 v[28:43], v[44:47], v[60:63], v[28:43]
    ds_read_b128 v[60:63], v8 offset:0
    ds_read_b64_tr_b16 v[44:45], v12 offset:0
    ds_read_b64_tr_b16 v[46:47], v12 offset:512
    ds_read_b64 v[140:141], v13 offset:0
    s_add_u32 m0, s89, 32768
    s_nop 0
    buffer_load_dwordx4 v7, s[36:39], s30 offen lds
    v_mfma_f32_32x32x16_bf16 v[84:99], v[104:107], v[64:67], v[84:99]
    v_mfma_f32_32x32x16_bf16 v[28:43], v[48:51], v[64:67], v[28:43]
    ds_read_b128 v[64:67], v9 offset:0
    ds_read_b64_tr_b16 v[48:49], v12 offset:2048
    ds_read_b64_tr_b16 v[50:51], v12 offset:2560
    v_mfma_f32_32x32x16_bf16 v[84:99], v[108:111], v[68:71], v[84:99]
    v_mfma_f32_32x32x16_bf16 v[28:43], v[52:55], v[68:71], v[28:43]
    ds_read_b128 v[68:71], v10 offset:0
    ds_read_b64_tr_b16 v[52:53], v12 offset:4096
    ds_read_b64_tr_b16 v[54:55], v12 offset:4608
    v_mfma_f32_32x32x16_bf16 v[84:99], v[112:115], v[72:75], v[84:99]
    v_mfma_f32_32x32x16_bf16 v[28:43], v[56:59], v[72:75], v[28:43]
    ds_read_b128 v[72:75], v11 offset:0
    ds_read_b64_tr_b16 v[56:57], v12 offset:6144
    ds_read_b64_tr_b16 v[58:59], v12 offset:6656
    s_lshr_b32 s91, s86, 1
    s_cmp_lg_u32 s91, 0
    s_cbranch_scc1 L_wc5
    s_add_u32 m0, s89, 40960
    buffer_load_dwordx4 v7, s[36:39], s31 offen lds
L_wc5:
    ds_write_b32 v253, v212
    s_nop 3
    v_cvt_pk_bf16_f32 v210, v213, v92
    s_waitcnt lgkmcnt(11)
    v_mfma_f32_32x32x16_bf16 v[28:43], v[44:47], v[60:63], v[28:43]
    ds_write_b128 v27, v[208:211]
    s_waitcnt lgkmcnt(8)
    v_mfma_f32_32x32x16_bf16 v[28:43], v[48:51], v[64:67], v[28:43]
    s_waitcnt lgkmcnt(5)
    v_mfma_f32_32x32x16_bf16 v[28:43], v[52:55], v[68:71], v[28:43]
    s_waitcnt lgkmcnt(2)
    v_mfma_f32_32x32x16_bf16 v[28:43], v[56:59], v[72:75], v[28:43]
    v_cvt_pk_bf16_f32 v178, v76, v84
    v_cvt_pk_bf16_f32 v182, v77, v85
    v_cvt_pk_bf16_f32 v186, v78, v86
    v_cvt_pk_bf16_f32 v190, v79, v87
    v_cvt_pk_bf16_f32 v194, v80, v88
    v_cvt_pk_bf16_f32 v198, v81, v89
    v_cvt_pk_bf16_f32 v202, v82, v90
    v_cvt_pk_bf16_f32 v206, v83, v91
    s_nop 3
    ds_write_b128 v16, v[36:39] offset:0
    ds_write_b128 v16, v[40:43] offset:1024
    s_waitcnt lgkmcnt(0)
    s_barrier
    ds_read_b128 v[240:243], v18 offset:43008
    ds_read_b128 v[36:39], v17 offset:0
    ds_read_b128 v[40:43], v17 offset:1024
    ds_read_b128 v[108:111], v19 offset:0
    ds_read_b128 v[112:115], v19 offset:32
    s_add_u32 m0, s89, 0
    s_add_u32 s91, s28, 86528
    buffer_load_dwordx4 v7, s[36:39], s91 offen lds
    s_waitcnt lgkmcnt(4)
    v_mfma_f32_16x16x32_bf16 v[244:247], v[20:23], v[240:243], 0
    ds_write_b128 v14, v[176:179] offset:0
    ds_write_b128 v14, v[180:183] offset:4096
    ds_write_b128 v14, v[184:187] offset:8192
    ds_write_b128 v14, v[188:191] offset:12288
    ds_write_b128 v15, v[192:195] offset:0
    ds_write_b128 v15, v[196:199] offset:4096
    ds_write_b128 v15, v[200:203] offset:8192
    ds_write_b128 v15, v[204:207] offset:12288
L_tail:
    s_add_u32 m0, s89, 8192
    s_add_u32 s91, s29, 86528
    buffer_load_dwordx4 v7, s[36:39], s91 offen lds
    v_pk_mul_f32 v[248:249], v[244:245], v[244:245]
    v_pk_mul_f32 v[250:251], v[246:247], v[246:247]
    v_pk_fma_f32 v[248:249], v[248:249], v[142:143], v[142:143] op_sel:[0,0,1] op_sel_hi:[1,0,1]
    v_pk_fma_f32 v[250:251], v[250:251], v[142:143], v[142:143] op_sel:[0,0,1] op_sel_hi:[1,0,1]
    v_pk_mul_f32 v[248:249], v[248:249], v[244:245]
    v_pk_mul_f32 v[250:251], v[250:251], v[246:247]
    v_exp_f32 v248, v248
    v_exp_f32 v249, v249
    v_exp_f32 v250, v250
    v_exp_f32 v251, v251
    v_pk_add_f32 v[248:249], v[248:249], 1.0 op_sel_hi:[1,0]
    v_pk_add_f32 v[250:251], v[250:251], 1.0 op_sel_hi:[1,0]
    v_rcp_f32 v248, v248
    v_rcp_f32 v249, v249
    v_rcp_f32 v250, v250
    v_rcp_f32 v251, v251
    v_pk_mul_f32 v[248:249], v[248:249], v[244:245]
    v_pk_mul_f32 v[250:251], v[250:251], v[246:247]
    v_cvt_pk_bf16_f32 v240, v248, v249
    v_cvt_pk_bf16_f32 v241, v250, v251
    s_add_u32 m0, s89, 65536
    s_add_u32 s91, s30, 86528
    buffer_load_dwordx4 v7, s[36:39], s91 offen lds
    v_mfma_f32_16x16x16_bf16 v[244:247], v[24:25], v[240:241], 0
    s_lshr_b32 s91, s86, 1
    s_cmp_lg_u32 s91, 1
    s_cbranch_scc1 L_wc6
    s_add_u32 m0, s89, 71680
    s_add_u32 s91, s31, 86528
    buffer_load_dwordx4 v7, s[36:39], s91 offen lds
L_wc6:
    s_mov_b32 s92, 0xbfb8aa3b
    s_mov_b32 s93, 0xbfb8aa3b
    s_waitcnt lgkmcnt(4)
    v_pk_add_f32 v[28:29], v[28:29], v[36:37]
    v_pk_add_f32 v[30:31], v[30:31], v[38:39]
    v_pk_add_f32 v[32:33], v[32:33], v[40:41]
    v_pk_add_f32 v[34:35], v[34:35], v[42:43]
    v_pk_mul_f32 v[248:249], v[244:245], s[92:93]
    v_pk_mul_f32 v[250:251], v[246:247], s[92:93]
    v_exp_f32 v248, v248
    v_exp_f32 v249, v249
    v_exp_f32 v250, v250
    v_exp_f32 v251, v251
    v_pk_add_f32 v[248:249], v[248:249], 1.0 op_sel_hi:[1,0]
    v_pk_add_f32 v[250:251], v[250:251], 1.0 op_sel_hi:[1,0]
    v_rcp_f32 v248, v248
    v_rcp_f32 v249, v249
    v_rcp_f32 v250, v250
    v_rcp_f32 v251, v251
    v_cvt_pk_bf16_f32 v240, v248, v249
    v_cvt_pk_bf16_f32 v241, v250, v251
    v_and_b32 v242, 0xffff, v240
    v_lshrrev_b32 v243, 16, v240
    ds_write_b64 v26, v[242:243] offset:8192
    v_lshlrev_b32 v248, 16, v240
    v_and_b32 v249, 0xffff0000, v240
    v_lshlrev_b32 v250, 16, v241
    v_and_b32 v251, 0xffff0000, v241
    ds_write_b128 v26, v[248:251]
    v_pk_mul_f32 v[36:37], v[28:29], v[28:29]
    v_pk_mul_f32 v[38:39], v[30:31], v[30:31]
    v_pk_mul_f32 v[40:41], v[32:33], v[32:33]
    v_pk_mul_f32 v[42:43], v[34:35], v[34:35]
    v_pk_fma_f32 v[36:37], v[36:37], v[142:143], v[142:143] op_sel:[0,0,1] op_sel_hi:[1,0,1]
    v_pk_fma_f32 v[38:39], v[38:39], v[142:143], v[142:143] op_sel:[0,0,1] op_sel_hi:[1,0,1]
    v_pk_fma_f32 v[40:41], v[40:41], v[142:143], v[142:143] op_sel:[0,0,1] op_sel_hi:[1,0,1]
    v_pk_fma_f32 v[42:43], v[42:43], v[142:143], v[142:143] op_sel:[0,0,1] op_sel_hi:[1,0,1]
    v_pk_mul_f32 v[36:37], v[36:37], v[28:29]
    v_pk_mul_f32 v[38:39], v[38:39], v[30:31]
    v_pk_mul_f32 v[40:41], v[40:41], v[32:33]
    v_pk_mul_f32 v[42:43], v[42:43], v[34:35]
    v_pk_mul_f32 v[108:109], v[108:109], v[28:29]
    v_pk_mul_f32 v[110:111], v[110:111], v[30:31]
    v_pk_mul_f32 v[112:113], v[112:113], v[32:33]
    v_pk_mul_f32 v[114:115], v[114:115], v[34:35]
    s_waitcnt vmcnt(3) lgkmcnt(0)
    s_barrier
    ds_read_b64 v[208:209], v5 offset:16384
    ds_read_b64 v[210:211], v5 offset:20480
    ds_read_b64 v[212:213], v5 offset:24576
    ds_read_b64 v[214:215], v5 offset:28672
    ds_read_b64 v[216:217], v5 offset:32768
    ds_read_b64 v[218:219], v5 offset:36864
    ds_read_b64 v[220:221], v5 offset:40960
    ds_read_b128 v[144:147], v4 offset:0
    ds_read_b128 v[152:155], v4 offset:4096
    ds_read_b128 v[160:163], v4 offset:8192
    ds_read_b128 v[168:171], v4 offset:12288
    v_exp_f32 v36, v36
    v_exp_f32 v37, v37
    v_exp_f32 v38, v38
    v_exp_f32 v39, v39
    v_exp_f32 v40, v40
    v_exp_f32 v41, v41
    v_exp_f32 v42, v42
    v_exp_f32 v43, v43
    s_waitcnt lgkmcnt(9)
    v_perm_b32 v176, v210, v208, s94
    v_perm_b32 v184, v210, v208, s95
    v_perm_b32 v192, v211, v209, s94
    v_perm_b32 v200, v211, v209, s95
    ds_read_b64 v[222:223], v5 offset:18432
    ds_read_b64 v[224:225], v5 offset:22528
    ds_read_b64 v[226:227], v5 offset:26624
    ds_read_b64 v[228:229], v5 offset:30720
    ds_read_b64 v[230:231], v5 offset:34816
    ds_read_b64 v[232:233], v5 offset:38912
    s_waitcnt lgkmcnt(13)
    v_perm_b32 v177, v214, v212, s94
    v_perm_b32 v185, v214, v212, s95
    v_perm_b32 v193, v215, v213, s94
    v_perm_b32 v201, v215, v213, s95
    s_waitcnt lgkmcnt(11)
    v_perm_b32 v178, v218, v216, s94
    v_perm_b32 v186, v218, v216, s95
    v_perm_b32 v194, v219, v217, s94
    v_perm_b32 v202, v219, v217, s95
    ds_read_b128 v[148:151], v4 offset:1024
    ds_read_b128 v[156:159], v4 offset:5120
    ds_read_b128 v[164:167], v4 offset:9216
    ds_read_b128 v[172:175], v4 offset:13312
    s_waitcnt lgkmcnt(14)
    v_and_b32 v179, 0xffff, v220
    v_lshrrev_b32 v187, 16, v220
    v_and_b32 v195, 0xffff, v221
    v_lshrrev_b32 v203, 16, v221
    s_waitcnt lgkmcnt(10)
    v_mfma_f32_32x32x16_bf16 v[44:59], v[176:179], v[144:147], 0
    v_add_f32 v36, 1.0, v36
    v_add_f32 v37, 1.0, v37
    v_add_f32 v38, 1.0, v38
    v_add_f32 v39, 1.0, v39
    v_add_f32 v40, 1.0, v40
    v_add_f32 v41, 1.0, v41
    v_add_f32 v42, 1.0, v42
    v_mfma_f32_32x32x16_bf16 v[60:75], v[184:187], v[152:155], 0
    v_add_f32 v43, 1.0, v43
    v_mov_b32 v183, 0
    v_mov_b32 v191, 0
    v_mov_b32 v199, 0
    v_mov_b32 v207, 0
    ds_read_b64 v[28:29], v3 offset:8192
    ds_read_b128 v[8:11], v3 offset:0
    ds_read_b64 v[30:31], v3 offset:9216
    v_mfma_f32_32x32x16_bf16 v[76:91], v[192:195], v[160:163], 0
    ds_read_b128 v[12:15], v3 offset:1024
    s_waitcnt lgkmcnt(12)
    v_perm_b32 v180, v224, v222, s94
    v_perm_b32 v188, v224, v222, s95
    v_perm_b32 v196, v225, v223, s94
    v_perm_b32 v204, v225, v223, s95
    s_waitcnt lgkmcnt(10)
    v_perm_b32 v181, v228, v226, s94
    v_mfma_f32_32x32x16_bf16 v[92:107], v[200:203], v[168:171], 0
    v_perm_b32 v189, v228, v226, s95
    v_perm_b32 v197, v229, v227, s94
    v_perm_b32 v205, v229, v227, s95
    s_waitcnt lgkmcnt(8)
    v_perm_b32 v182, v232, v230, s94
    v_perm_b32 v190, v232, v230, s95
    v_perm_b32 v198, v233, v231, s94
    v_perm_b32 v206, v233, v231, s95
    s_waitcnt lgkmcnt(4)
    v_mfma_f32_32x32x16_bf16 v[44:59], v[180:183], v[148:151], v[44:59]
    ds_read_b64 v[32:33], v3 offset:10240
    ds_read_b128 v[16:19], v3 offset:2048
    ds_read_b64 v[34:35], v3 offset:11264
    ds_read_b128 v[20:23], v3 offset:3072
    v_rcp_f32 v36, v36
    v_rcp_f32 v37, v37
    v_mfma_f32_32x32x16_bf16 v[60:75], v[188:191], v[156:159], v[60:75]
    v_rcp_f32 v38, v38
    v_rcp_f32 v39, v39
    v_rcp_f32 v40, v40
    v_rcp_f32 v41, v41
    v_rcp_f32 v42, v42
    v_rcp_f32 v43, v43
    v_mfma_f32_32x32x16_bf16 v[76:91], v[196:199], v[164:167], v[76:91]
    v_mov_b32 v215, 0
    v_mov_b32 v223, 0
    v_mov_b32 v231, 0
    v_mov_b32 v239, 0
    v_add_u32 v7, 65536, v5
    v_mul_f32 v24, v108, v36
    v_mfma_f32_32x32x16_bf16 v[92:107], v[204:207], v[172:175], v[92:107]
    v_mul_f32 v25, v109, v37
    v_fmac_f32 v24, v110, v38
    v_fmac_f32 v25, v111, v39
    v_fmac_f32 v24, v112, v40
    v_fmac_f32 v25, v113, v41
    v_fmac_f32 v24, v114, v42
    v_fmac_f32 v25, v115, v43
    s_waitcnt lgkmcnt(6)
    v_dot2_f32_bf16 v240, v144, v28, 0
    v_dot2_f32_bf16 v241, v144, v10, 0
    v_dot2_f32_bf16 v242, v148, v29, 0
    v_dot2_f32_bf16 v243, v148, v11, 0
    s_waitcnt lgkmcnt(4)
    v_dot2_f32_bf16 v244, v145, v30, 0
    v_dot2_f32_bf16 v245, v145, v14, 0
    v_dot2_f32_bf16 v246, v149, v31, 0
    v_dot2_f32_bf16 v247, v149, v15, 0
    s_waitcnt lgkmcnt(2)
    v_dot2_f32_bf16 v248, v146, v32, 0
    v_dot2_f32_bf16 v249, v146, v18, 0
    v_dot2_f32_bf16 v250, v150, v33, 0
    v_dot2_f32_bf16 v251, v150, v19, 0
    s_waitcnt lgkmcnt(0)
    v_dot2_f32_bf16 v252, v147, v34, 0
    v_dot2_f32_bf16 v253, v152, v28, 0
    v_dot2_f32_bf16 v254, v152, v10, 0
    v_dot2_f32_bf16 v255, v156, v29, 0
    v_dot2_f32_bf16 v36, v156, v11, 0
    v_dot2_f32_bf16 v37, v153, v30, 0
    v_dot2_f32_bf16 v38, v153, v14, 0
    v_dot2_f32_bf16 v39, v157, v31, 0
    v_dot2_f32_bf16 v40, v157, v15, 0
    v_dot2_f32_bf16 v41, v154, v32, 0
    v_dot2_f32_bf16 v42, v154, v18, 0
    v_dot2_f32_bf16 v43, v158, v33, 0
    v_dot2_f32_bf16 v108, v158, v19, 0
    v_dot2_f32_bf16 v109, v155, v34, 0
    s_waitcnt vmcnt(0)
    s_barrier
    ds_read_b64 v[176:177], v5 offset:0
    ds_read_b64 v[178:179], v5 offset:4096
    ds_read_b64 v[180:181], v5 offset:8192
    ds_read_b64 v[182:183], v5 offset:12288
    ds_read_b64 v[184:185], v7 offset:0
    ds_read_b64 v[186:187], v7 offset:4096
    ds_read_b64 v[188:189], v7 offset:8192
    ds_read_b64 v[190:191], v5 offset:2048
    ds_read_b64 v[192:193], v5 offset:6144
    ds_read_b64 v[194:195], v5 offset:10240
    ds_read_b64 v[196:197], v5 offset:14336
    ds_read_b64 v[198:199], v7 offset:2048
    ds_read_b64 v[200:201], v7 offset:6144
    v_cvt_pk_bf16_f32 v144, v240, v241
    v_cvt_pk_bf16_f32 v148, v242, v243
    v_cvt_pk_bf16_f32 v145, v244, v245
    v_cvt_pk_bf16_f32 v149, v246, v247
    v_cvt_pk_bf16_f32 v146, v248, v249
    v_cvt_pk_bf16_f32 v150, v250, v251
    v_cvt_pk_bf16_f32 v147, v252, 0
    v_cvt_pk_bf16_f32 v152, v253, v254
    v_cvt_pk_bf16_f32 v156, v255, v36
    v_cvt_pk_bf16_f32 v153, v37, v38
    v_cvt_pk_bf16_f32 v157, v39, v40
    v_cvt_pk_bf16_f32 v154, v41, v42
    v_cvt_pk_bf16_f32 v158, v43, v108
    v_cvt_pk_bf16_f32 v155, v109, 0
    v_dot2_f32_bf16 v240, v160, v28, 0
    v_dot2_f32_bf16 v241, v160, v10, 0
    v_dot2_f32_bf16 v242, v164, v29, 0
    v_dot2_f32_bf16 v243, v164, v11, 0
    v_dot2_f32_bf16 v244, v161, v30, 0
    v_dot2_f32_bf16 v245, v161, v14, 0
    v_dot2_f32_bf16 v246, v165, v31, 0
    v_dot2_f32_bf16 v247, v165, v15, 0
    v_dot2_f32_bf16 v248, v162, v32, 0
    v_dot2_f32_bf16 v249, v162, v18, 0
    v_dot2_f32_bf16 v250, v166, v33, 0
    v_dot2_f32_bf16 v251, v166, v19, 0
    v_dot2_f32_bf16 v252, v163, v34, 0
    v_dot2_f32_bf16 v253, v168, v28, 0
    v_dot2_f32_bf16 v254, v168, v10, 0
    v_dot2_f32_bf16 v255, v172, v29, 0
    v_dot2_f32_bf16 v36, v172, v11, 0
    v_dot2_f32_bf16 v37, v169, v30, 0
    v_dot2_f32_bf16 v38, v169, v14, 0
    v_dot2_f32_bf16 v39, v173, v31, 0
    v_dot2_f32_bf16 v40, v173, v15, 0
    v_dot2_f32_bf16 v41, v170, v32, 0
    v_dot2_f32_bf16 v42, v170, v18, 0
    v_dot2_f32_bf16 v43, v174, v33, 0
    v_dot2_f32_bf16 v108, v174, v19, 0
    v_dot2_f32_bf16 v109, v171, v34, 0
    s_waitcnt lgkmcnt(11)
    v_perm_b32 v208, v178, v176, s94
    v_perm_b32 v216, v178, v176, s95
    v_perm_b32 v224, v179, v177, s94
    v_perm_b32 v232, v179, v177, s95
    s_waitcnt lgkmcnt(9)
    v_perm_b32 v209, v182, v180, s94
    v_perm_b32 v217, v182, v180, s95
    v_perm_b32 v225, v183, v181, s94
    v_perm_b32 v233, v183, v181, s95
    s_waitcnt lgkmcnt(7)
    v_perm_b32 v210, v186, v184, s94
    v_perm_b32 v218, v186, v184, s95
    v_perm_b32 v226, v187, v185, s94
    v_perm_b32 v234, v187, v185, s95
    s_waitcnt lgkmcnt(6)
    v_and_b32 v211, 0xffff, v188
    v_lshrrev_b32 v219, 16, v188
    v_and_b32 v227, 0xffff, v189
    v_lshrrev_b32 v235, 16, v189
    s_waitcnt lgkmcnt(4)
    v_perm_b32 v212, v192, v190, s94
    v_perm_b32 v220, v192, v190, s95
    v_perm_b32 v228, v193, v191, s94
    v_perm_b32 v236, v193, v191, s95
    s_waitcnt lgkmcnt(2)
    v_perm_b32 v213, v196, v194, s94
    v_perm_b32 v221, v196, v194, s95
    v_perm_b32 v229, v197, v195, s94
    v_perm_b32 v237, v197, v195, s95
    s_waitcnt lgkmcnt(0)
    v_perm_b32 v214, v200, v198, s94
    v_perm_b32 v222, v200, v198, s95
    v_perm_b32 v230, v201, v199, s94
    v_perm_b32 v238, v201, v199, s95
    v_mfma_f32_32x32x16_bf16 v[176:191], v[208:211], v[144:147], 0
    v_cvt_pk_bf16_f32 v160, v240, v241
    v_cvt_pk_bf16_f32 v164, v242, v243
    v_cvt_pk_bf16_f32 v161, v244, v245
    v_cvt_pk_bf16_f32 v165, v246, v247
    v_cvt_pk_bf16_f32 v162, v248, v249
    v_cvt_pk_bf16_f32 v166, v250, v251
    v_mfma_f32_32x32x16_bf16 v[176:191], v[212:215], v[148:151], v[176:191]
    v_cvt_pk_bf16_f32 v163, v252, 0
    v_cvt_pk_bf16_f32 v168, v253, v254
    v_cvt_pk_bf16_f32 v172, v255, v36
    v_cvt_pk_bf16_f32 v169, v37, v38
    v_cvt_pk_bf16_f32 v173, v39, v40
    v_cvt_pk_bf16_f32 v170, v41, v42
    v_mfma_f32_32x32x16_bf16 v[192:207], v[216:219], v[152:155], 0
    v_cvt_pk_bf16_f32 v174, v43, v108
    v_cvt_pk_bf16_f32 v171, v109, 0
    v_lshlrev_b32 v27, 4, v1
    v_lshlrev_b32 v26, 5, v1
    v_add_u32 v26, 131072, v26
    s_and_b32 s91, s88, 1
    v_mfma_f32_32x32x16_bf16 v[192:207], v[220:223], v[156:159], v[192:207]
    s_lshl_b32 s91, s91, 4
    s_cmp_lt_u32 s88, 2
    s_cselect_b32 s92, -1, 0
    s_cselect_b32 s93, 0, -1
    s_lshl_b32 s90, s87, 10
    s_mov_b32 s3, 0x40000
    v_mfma_f32_32x32x16_bf16 v[144:159], v[224:227], v[160:163], 0
    v_fmac_f32 v44, v8, v176
    v_fmac_f32 v45, v9, v177
    v_fmac_f32 v46, v10, v178
    v_fmac_f32 v47, v11, v179
    v_fmac_f32 v48, v12, v180
    v_fmac_f32 v49, v13, v181
    v_mfma_f32_32x32x16_bf16 v[144:159], v[228:231], v[164:167], v[144:159]
    v_fmac_f32 v50, v14, v182
    v_fmac_f32 v51, v15, v183
    v_fmac_f32 v52, v16, v184
    v_fmac_f32 v53, v17, v185
    v_fmac_f32 v54, v18, v186
    v_fmac_f32 v55, v19, v187
    v_fmac_f32 v56, v20, v188
    v_mfma_f32_32x32x16_bf16 v[208:223], v[232:235], v[168:171], 0
    v_fmac_f32 v60, v8, v192
    v_fmac_f32 v61, v9, v193
    v_fmac_f32 v62, v10, v194
    v_fmac_f32 v63, v11, v195
    v_fmac_f32 v64, v12, v196
    v_fmac_f32 v65, v13, v197
    v_mfma_f32_32x32x16_bf16 v[208:223], v[236:239], v[172:175], v[208:223]
    v_fmac_f32 v66, v14, v198
    v_fmac_f32 v67, v15, v199
    v_fmac_f32 v68, v16, v200
    v_fmac_f32 v69, v17, v201
    v_fmac_f32 v70, v18, v202
    v_fmac_f32 v71, v19, v203
    v_fmac_f32 v72, v20, v204
    v_cvt_pk_bf16_f32 v44, v44, v60
    v_cvt_pk_bf16_f32 v45, v45, v61
    v_cvt_pk_bf16_f32 v46, v46, v62
    v_cvt_pk_bf16_f32 v47, v47, v63
    v_cvt_pk_bf16_f32 v48, v48, v64
    v_cvt_pk_bf16_f32 v49, v49, v65
    v_cvt_pk_bf16_f32 v50, v50, v66
    v_cvt_pk_bf16_f32 v51, v51, v67
    v_cvt_pk_bf16_f32 v52, v52, v68
    v_cvt_pk_bf16_f32 v53, v53, v69
    v_cvt_pk_bf16_f32 v54, v54, v70
    v_cvt_pk_bf16_f32 v55, v55, v71
    v_cvt_pk_bf16_f32 v56, v56, v72
    v_dot2c_f32_bf16 v24, v44, v116
    v_dot2c_f32_bf16 v25, v45, v118
    v_dot2c_f32_bf16 v24, v46, v120
    v_dot2c_f32_bf16 v25, v47, v122
    v_dot2c_f32_bf16 v24, v48, v124
    v_dot2c_f32_bf16 v25, v49, v126
    v_dot2c_f32_bf16 v24, v50, v128
    v_dot2c_f32_bf16 v25, v51, v130
    v_dot2c_f32_bf16 v24, v52, v132
    v_dot2c_f32_bf16 v25, v53, v134
    v_dot2c_f32_bf16 v24, v54, v136
    v_dot2c_f32_bf16 v25, v55, v138
    v_dot2c_f32_bf16 v24, v56, v140
    v_pk_fma_f32 v[76:77], v[8:9], v[144:145], v[76:77]
    v_pk_fma_f32 v[78:79], v[10:11], v[146:147], v[78:79]
    v_pk_fma_f32 v[80:81], v[12:13], v[148:149], v[80:81]
    v_pk_fma_f32 v[82:83], v[14:15], v[150:151], v[82:83]
    v_pk_fma_f32 v[84:85], v[16:17], v[152:153], v[84:85]
    v_pk_fma_f32 v[86:87], v[18:19], v[154:155], v[86:87]
    v_fmac_f32 v88, v20, v156
    v_pk_fma_f32 v[92:93], v[8:9], v[208:209], v[92:93]
    v_pk_fma_f32 v[94:95], v[10:11], v[210:211], v[94:95]
    v_pk_fma_f32 v[96:97], v[12:13], v[212:213], v[96:97]
    v_pk_fma_f32 v[98:99], v[14:15], v[214:215], v[98:99]
    v_pk_fma_f32 v[100:101], v[16:17], v[216:217], v[100:101]
    v_pk_fma_f32 v[102:103], v[18:19], v[218:219], v[102:103]
    v_fmac_f32 v104, v20, v220
    v_cvt_pk_bf16_f32 v76, v76, v92
    v_cvt_pk_bf16_f32 v77, v77, v93
    v_cvt_pk_bf16_f32 v78, v78, v94
    v_cvt_pk_bf16_f32 v79, v79, v95
    v_cvt_pk_bf16_f32 v80, v80, v96
    v_cvt_pk_bf16_f32 v81, v81, v97
    v_cvt_pk_bf16_f32 v82, v82, v98
    v_cvt_pk_bf16_f32 v83, v83, v99
    v_cvt_pk_bf16_f32 v84, v84, v100
    v_cvt_pk_bf16_f32 v85, v85, v101
    v_cvt_pk_bf16_f32 v86, v86, v102
    v_cvt_pk_bf16_f32 v87, v87, v103
    v_cvt_pk_bf16_f32 v88, v88, v104
    v_dot2c_f32_bf16 v24, v76, v117
    v_dot2c_f32_bf16 v25, v77, v119
    v_dot2c_f32_bf16 v24, v78, v121
    v_dot2c_f32_bf16 v25, v79, v123
    v_dot2c_f32_bf16 v24, v80, v125
    v_dot2c_f32_bf16 v25, v81, v127
    v_dot2c_f32_bf16 v24, v82, v129
    v_dot2c_f32_bf16 v25, v83, v131
    v_dot2c_f32_bf16 v24, v84, v133
    v_dot2c_f32_bf16 v25, v85, v135
    v_dot2c_f32_bf16 v24, v86, v137
    v_dot2c_f32_bf16 v25, v87, v139
    v_dot2c_f32_bf16 v24, v88, v141
    s_nop 2
    v_add_f32 v24, v24, v25
    ds_write_b32 v2, v24
    s_waitcnt lgkmcnt(0)
    s_barrier
    s_cmp_lg_u32 s86, 0
    s_cbranch_scc1 L_end
    ds_read_b128 v[240:243], v26 offset:0
    ds_read_b128 v[244:247], v26 offset:16
L_spin:
    v_readfirstlane_b32 s89, v6
    s_nop 0
    s_cmp_eq_u32 s89, 1
    s_cbranch_scc1 L_go
    s_sleep 2
    s_lshl_b32 s89, s87, 2
    buffer_load_dword v6, v0, s[52:55], s89 offen sc0 sc1
    s_waitcnt vmcnt(0)
    s_sub_u32 s3, s3, 1
    s_cbranch_scc0 L_spin
L_go:
    s_waitcnt lgkmcnt(0)
    v_pk_add_f32 v[240:241], v[240:241], v[244:245]
    v_pk_add_f32 v[242:243], v[242:243], v[246:247]
    v_pk_add_f32 v[240:241], v[240:241], v[242:243]
    v_add_f32 v240, v240, v241
    v_bfe_u32 v242, v240, 1, 16
    v_lshrrev_b32 v241, 16, v240
    v_or_b32 v242, 1, v242
    v_or_b32 v241, 1, v241
    v_lshlrev_b32 v242, s91, v242
    v_lshlrev_b32 v241, s91, v241
    v_and_b32 v250, s92, v242
    v_and_b32 v251, s93, v242
    buffer_atomic_or_x2 v[250:251], v27, s[56:59], s90 offen offset:8 sc0 sc1
    v_and_b32 v248, s92, v241
    v_and_b32 v249, s93, v241
    buffer_atomic_or_x2 v[248:249], v27, s[56:59], s90 offen sc0 sc1
    v_and_b32 v246, s92, v242
    v_and_b32 v247, s93, v242
    v_and_b32 v244, s92, v241
    v_and_b32 v245, s93, v241
    s_mov_b32 s91, 0x00010001
    v_lshlrev_b32 v4, 1, v1
    s_lshl_b32 s92, s87, 7
    s_waitcnt vmcnt(0)
    v_or_b32 v248, v248, v244
    v_or_b32 v249, v249, v245
    v_and_b32 v240, v248, v249
    v_and_b32 v240, s91, v240
    v_cmp_eq_u32 vcc, s91, v240
    v_or_b32 v250, v250, v246
    v_or_b32 v251, v251, v247
    s_and_b64 exec, exec, vcc
    s_cbranch_execz L_end
L_lchk:
    v_and_b32 v240, v250, v251
    v_and_b32 v240, s91, v240
    v_cmp_ne_u32 vcc, s91, v240
    v_lshlrev_b32 v240, 16, v248
    v_and_b32 v241, 0xfffe0000, v248
    v_and_b32 v240, 0xfffe0000, v240
    v_lshlrev_b32 v242, 16, v249
    v_and_b32 v243, 0xfffe0000, v249
    v_and_b32 v242, 0xfffe0000, v242
    s_cbranch_vccz L_sum
    buffer_load_dwordx2 v[250:251], v27, s[56:59], s90 offen offset:8 sc0 sc1
    s_waitcnt vmcnt(0)
    s_sub_u32 s3, s3, 1
    s_cbranch_scc0 L_lchk
L_sum:
    v_and_b32 v244, 0xfffe, v250
    v_lshrrev_b32 v245, 17, v250
    v_and_b32 v246, 0xfffe, v251
    v_lshrrev_b32 v247, 17, v251
    v_lshl_or_b32 v240, v244, 1, v240
    v_lshl_or_b32 v241, v245, 2, v241
    v_lshl_or_b32 v242, v246, 1, v242
    v_lshl_or_b32 v243, v247, 2, v243
    v_pk_add_f32 v[240:241], v[240:241], v[242:243]
    v_add_f32 v240, v240, v241
    v_cvt_pk_bf16_f32 v240, v240, v240
    buffer_store_short v240, v4, s[48:51], s92 offen
L_end:
    s_endpgm
.section .rodata,"a"
.p2align 6
.amdhsa_kernel standalone__deep_cross_fibinet__recsys_kernel
  .amdhsa_next_free_vgpr 256
  .amdhsa_next_free_sgpr 102
  .amdhsa_accum_offset 256
  .amdhsa_group_segment_fixed_size 0
  .amdhsa_kernarg_size 88
  .amdhsa_user_sgpr_count 2
  .amdhsa_user_sgpr_kernarg_segment_ptr 1
  .amdhsa_system_sgpr_workgroup_id_x 1
.end_amdhsa_kernel
```

```asm
; @launch grid=(256,1,1) block=(512,1,1) lds=163840
.amdgcn_target "amdgcn-amd-amdhsa--gfx950"
.text
.globl standalone__deep_cross_fibinet__recsys_kernel
.p2align 8
.type standalone__deep_cross_fibinet__recsys_kernel,@function
standalone__deep_cross_fibinet__recsys_kernel:
    s_cmp_ge_u32 s2, 256
    s_cbranch_scc1 L_end
    v_lshrrev_b32 v242, 6, v0
    s_load_dwordx4 s[4:7], s[0:1], 0
    s_load_dwordx4 s[12:15], s[0:1], 40
    v_readfirstlane_b32 s86, v242
    s_load_dwordx4 s[20:23], s[0:1], 64
    s_load_dwordx2 s[24:25], s[0:1], 80
    s_getpc_b64 s[92:93]
    s_bfe_u32 s88, s2, 0x20003
    s_lshl_b32 s91, s86, 2
    s_lshr_b32 s91, 0x77773244, s91
    s_and_b32 s91, s91, 15
    s_lshl_b32 s91, s91, 3
    s_load_dwordx2 s[44:45], s[0:1], s91
    s_mul_i32 s91, s88, 3840
    v_lshl_add_u32 v240, v0, 7, s91
    v_min_u32 v240, 15040, v240
    v_mov_b32 v241, s93
    v_add_co_u32 v240, vcc, s92, v240
    v_and_b32 v1, 63, v0
    s_lshl_b32 s89, s86, 10
    v_addc_co_u32 v241, vcc, 0, v241, vcc
    v_cmp_gt_u32 vcc, 30, v0
    v_and_b32 v244, 31, v0
    s_and_saveexec_b64 s[92:93], vcc
    s_cbranch_execz L_cpf
    global_load_dword v6, v[240:241], off
L_cpf:
    s_mov_b64 exec, -1
    s_lshl_b32 s91, s88, 3
    s_lshr_b32 s91, 336398080, s91
    s_bitcmp1_b32 s91, 6
    s_cselect_b32 s96, -1, 1
    s_cselect_b32 s61, 25, 1
    s_cselect_b32 s92, 52, 0
    s_and_b32 s91, s91, 31
    s_add_u32 s97, s91, s92
    s_lshl_b32 s60, s91, 15
    s_lshl_b32 s61, s61, 15
    v_mul_i32_i24 v245, s96, v244
    s_lshr_b32 s91, s2, 5
    v_add_u32 v245, s97, v245
    s_lshl_b32 s91, s91, 3
    v_subrev_u32 v246, 26, v245
    s_and_b32 s92, s2, 7
    s_add_u32 s87, s91, s92
    v_min_u32 v245, v245, v246
    s_lshl_b32 s91, s87, 3
    v_subrev_u32 v246, 26, v245
    s_add_u32 s91, s91, s86
    v_min_u32 v245, v245, v246
    s_mul_i32 s90, s91, 832
    s_mov_b32 s30, 425984
    v_lshrrev_b32 v246, 5, v1
    s_mov_b32 s31, 0x00020000
    v_mul_u32_u24 v246, 104, v246
    s_add_u32 m0, s89, 131072
    v_lshl_add_u32 v246, v245, 2, v246
    s_waitcnt lgkmcnt(0)
    s_mov_b32 s28, s4
    s_and_b32 s29, s5, 0xffff
    buffer_load_dword v246, s[28:31], s90 offen offset:0  lds
    s_add_u32 m0, m0, 48
    s_nop 0
    buffer_load_dword v246, s[28:31], s90 offen offset:208  lds
    s_add_u32 m0, m0, 48
    s_nop 0
    buffer_load_dword v246, s[28:31], s90 offen offset:416  lds
    s_add_u32 m0, m0, 48
    s_nop 0
    buffer_load_dword v246, s[28:31], s90 offen offset:624  lds
    s_mov_b32 s40, s14
    s_and_b32 s41, s15, 0xffff
    s_mov_b32 s42, 851968
    s_mov_b32 s43, 0x00020000
    s_mov_b32 s36, s12
    s_and_b32 s37, s13, 0xffff
    s_mov_b32 s38, 173056
    s_mov_b32 s39, 0x00020000
    v_min_u32 v247, 3, v1
    v_lshlrev_b32 v247, 7, v247
    s_mul_i32 s91, s2, 3328
    s_lshl_b32 s92, s86, 9
    s_add_u32 s91, s91, s92
    buffer_load_dword v6, v247, s[40:43], s91 offen
    s_mul_i32 s91, s2, 768
    s_lshl_b32 s92, s86, 7
    s_add_u32 s91, s91, s92
    buffer_load_dword v6, off, s[36:39], s91
    s_and_b32 s45, s45, 0xffff
    s_mov_b32 s47, 0x00020000
    s_lshl_b32 s91, s88, 7
    v_lshlrev_b32 v246, 4, v1
    s_movk_i32 s46, 676
    s_cmp_ge_u32 s86, 4
    s_cselect_b32 s46, 512, s46
    s_cselect_b32 s91, s91, 0
    v_and_b32 v248, 16, v246
    s_lshl_b32 s92, s86, 12
    s_lshl_b32 s93, s88, 5
    s_add_u32 s92, s92, s93
    v_lshrrev_b32 v247, 1, v1
    s_cmp_lt_u32 s86, 2
    s_cselect_b32 s46, 8192, s46
    s_cselect_b32 s91, s92, s91
    s_cselect_b32 s92, 7, 5
    s_add_u32 m0, s89, 139264
    v_lshl_add_u32 v247, v247, s92, v248
    buffer_load_dwordx4 v247, s[44:47], s91 offen lds
    v_and_b32 v245, 7, v1
    v_lshrrev_b32 v247, 2, v1
    s_mov_b32 s32, s6
    v_and_b32 v247, 4, v247
    v_xor_b32 v247, v247, v245
    v_lshrrev_b32 v248, 3, v0
    s_and_b32 s33, s7, 0xffff
    v_lshlrev_b32 v248, 9, v248
    v_lshl_add_u32 v247, v247, 4, v248
    s_mov_b32 s34, 12800000
    v_mov_b32 v248, s88
    v_lshl_add_u32 v2, v248, 7, v247
    v_bfe_u32 v247, v0, 4, 3
    s_mov_b32 s35, 0x00020000
    v_xor_b32 v247, v247, v245
    v_lshlrev_b32 v3, 4, v247
    s_add_u32 s91, s89, 131072
    v_lshrrev_b32 v244, 3, v1
    v_lshl_add_u32 v26, v244, 7, s91
    v_and_b32 v247, 5, v0
    v_cmp_eq_u32 s[92:93], 0, v247
    v_mov_b32 v247, 0x3c80
    v_lshlrev_b32 v248, 2, v0
    v_cndmask_b32 v247, 0, v247, s[92:93]
    v_add_u32 v248, 147456, v248
    ds_write_b32 v248, v247
    s_lshr_b32 s91, s86, 1
    s_lshr_b32 s92, s86, 2
    s_add_u32 s90, s91, s92
    s_and_b32 s90, s90, 1
    v_and_b32 v100, 31, v1
    v_lshrrev_b32 v101, 5, v1
    v_bfe_u32 v102, v1, 1, 3
    s_and_b32 s91, s86, 1
    s_lshl_b32 s91, s91, 5
    v_add_u32 v103, s91, v100
    s_lshl_b32 s92, s92, 13
    v_lshl_add_u32 v104, v103, 7, s92
    v_xor_b32 v105, v101, v102
    v_lshl_add_u32 v8, v105, 4, v104
    v_xor_b32 v9, 32, v8
    v_xor_b32 v10, 64, v8
    v_xor_b32 v11, 96, v8
    v_bfe_u32 v104, v1, 2, 2
    v_lshl_add_u32 v105, v101, 3, v104
    s_add_u32 s92, s92, 65536
    v_lshl_add_u32 v105, v105, 7, s92
    v_bfe_u32 v106, v1, 4, 1
    s_lshr_b32 s91, s86, 2
    v_xor_b32 v106, s91, v106
    v_bfe_u32 v107, v1, 1, 1
    v_lshl_add_u32 v106, v106, 1, v107
    s_and_b32 s91, s86, 2
    s_lshl_b32 s91, s91, 1
    v_or_b32 v106, s91, v106
    v_lshrrev_b32 v107, 1, v1
    v_and_b32 v107, 4, v107
    v_xor_b32 v106, v106, v107
    v_lshl_add_u32 v105, v106, 4, v105
    v_and_b32 v107, 1, v1
    v_lshl_add_u32 v12, v107, 3, v105
    s_lshl_b32 s91, s88, 1
    s_lshr_b32 s92, s86, 2
    s_add_u32 s91, s91, s92
    v_xor_b32 v104, s91, v102
    v_lshlrev_b32 v105, 13, v101
    v_lshl_add_u32 v105, v103, 7, v105
    v_lshl_add_u32 v105, v104, 4, v105
    s_and_b32 s91, s86, 2
    s_lshl_b32 s91, s91, 2
    v_add_u32 v13, s91, v105
    v_and_b32 v104, 15, v1
    v_lshlrev_b32 v104, 3, v104
    v_lshl_add_u32 v104, v101, 8, v104
    v_and_b32 v105, 16, v1
    v_lshl_add_u32 v104, v105, 9, v104
    v_add_u32 v76, 139264, v104
    s_waitcnt vmcnt(3)
    ds_read_b128 v[44:47], v26
    ds_read_b128 v[16:19], v26 offset:16
    s_add_u32 m0, s89, 0
    s_waitcnt lgkmcnt(1)
    v_lshl_add_u32 v44, v44, 7, v3
    buffer_load_dwordx4 v44, s[32:35], 0 offen  lds
    s_add_u32 m0, s89, 8192
    v_lshl_add_u32 v45, v45, 7, v3
    buffer_load_dwordx4 v45, s[32:35], 0 offen  lds
    s_add_u32 m0, s89, 65536
    s_nop 0
    buffer_load_dwordx4 v2, s[40:43], s60 offen lds
    s_add_u32 m0, s89, 73728
    s_add_u32 s60, s60, s61
    s_sub_u32 s93, s60, 851968
    s_min_u32 s60, s60, s93
    buffer_load_dwordx4 v2, s[40:43], s60 offen lds
    s_add_u32 m0, s89, 16384
    v_lshl_add_u32 v46, v46, 7, v3
    buffer_load_dwordx4 v46, s[32:35], 0 offen  lds
    s_add_u32 m0, s89, 24576
    v_lshl_add_u32 v47, v47, 7, v3
    buffer_load_dwordx4 v47, s[32:35], 0 offen  lds
    s_waitcnt vmcnt(6) lgkmcnt(0)
    v_lshl_add_u32 v16, v16, 7, v3
    v_lshl_add_u32 v17, v17, 7, v3
    v_lshl_add_u32 v18, v18, 7, v3
    v_lshl_add_u32 v19, v19, 7, v3
    s_barrier
    ds_read_b64_tr_b16 v[100:101], v76 offset:0
    ds_read_b64_tr_b16 v[102:103], v76 offset:128
    ds_read_b64_tr_b16 v[104:105], v76 offset:512
    ds_read_b64_tr_b16 v[106:107], v76 offset:640
    ds_read_b64_tr_b16 v[108:109], v76 offset:1024
    ds_read_b64_tr_b16 v[110:111], v76 offset:1152
    ds_read_b64_tr_b16 v[112:113], v76 offset:1536
    ds_read_b64_tr_b16 v[114:115], v76 offset:1664
    s_mov_b32 s48, s20
    s_and_b32 s49, s21, 0xffff
    s_mov_b32 s50, 8192
    s_mov_b32 s51, 0x00020000
    s_mov_b32 s52, s22
    s_and_b32 s53, s23, 0xffff
    s_mov_b32 s54, 256
    s_mov_b32 s55, 0x00020000
    s_mov_b32 s56, s24
    s_and_b32 s57, s25, 0xffff
    s_mov_b32 s58, 268435456
    s_mov_b32 s59, 0x00020000
    s_mov_b32 s94, 0x05040100
    s_mov_b32 s95, 0x07060302
    v_and_b32 v144, 31, v1
    v_lshrrev_b32 v145, 5, v1
    s_and_b32 s8, s86, 1
    s_lshl_b32 s8, s8, 5
    v_add_u32 v147, s8, v144
    s_and_b32 s8, s86, 2
    s_lshl_b32 s8, s8, 2
    s_lshr_b32 s9, s86, 2
    v_bfe_u32 v148, v1, 3, 1
    v_xor_b32 v148, s9, v148
    v_lshl_add_u32 v149, v1, 5, s8
    v_lshl_add_u32 v5, v148, 4, v149
    s_lshl_b32 s8, s90, 1
    s_add_u32 s8, s8, s9
    s_lshl_b32 s9, s8, 10
    s_add_u32 s9, s9, 43008
    v_lshl_add_u32 v27, v147, 4, s9
    s_lshl_b32 s8, s8, 9
    s_and_b32 s9, s86, 1
    s_lshl_b32 s9, s9, 11
    s_add_u32 s8, s8, s9
    v_lshl_add_u32 v148, v144, 4, s8
    v_lshl_add_u32 v14, v145, 16, v148
    v_add_u32 v14, 49152, v14
    v_lshl_add_u32 v15, v145, 14, v148
    v_add_u32 v15, 131072, v15
    s_bitcmp1_b32 s86, 1
    s_cselect_b32 s8, 65536, 0
    s_cselect_b32 s10, 16384, 0
    s_add_u32 s8, s8, 49152
    s_add_u32 s10, s10, 131072
    s_bitcmp1_b32 s86, 2
    s_cselect_b32 s8, s10, s8
    s_add_u32 s8, s8, s9
    v_lshl_add_u32 v4, v1, 4, s8
    v_mov_b32 v142, 0xbdd2d3e8
    v_mov_b32 v143, 0xc0135761
    v_mov_b32 v179, 0
    v_mov_b32 v183, 0
    v_mov_b32 v187, 0
    v_mov_b32 v191, 0
    v_mov_b32 v195, 0
    v_mov_b32 v199, 0
    v_mov_b32 v203, 0
    v_mov_b32 v207, 0
    v_mov_b32 v211, 0
    v_lshlrev_b32 v151, 1, v1
    v_add_u32 v151, 143360, v151
    ds_read_u16 v212, v151
    v_and_b32 v145, 15, v1
    v_lshrrev_b32 v147, 4, v1
    s_lshr_b32 s8, s86, 2
    v_min_u32 v145, 12, v145
    v_lshl_add_u32 v148, v145, 1, s8
    v_mul_i32_i24 v149, s96, v148
    v_add_u32 v149, s97, v149
    v_subrev_u32 v150, 26, v149
    v_min_u32 v149, v149, v150
    v_subrev_u32 v150, 26, v149
    v_min_u32 v149, v149, v150
    v_mul_u32_u24 v150, 208, v147
    v_lshl_add_u32 v149, v149, 1, v150
    v_add_u32 v149, 142336, v149
    ds_read_u16 v168, v149 offset:0
    ds_read_u16 v169, v149 offset:52
    ds_read_u16 v170, v149 offset:104
    ds_read_u16 v171, v149 offset:156
    v_mul_i32_i24 v146, s96, v147
    v_add_u32 v146, s97, v146
    v_subrev_u32 v150, 26, v146
    v_min_u32 v146, v146, v150
    v_subrev_u32 v150, 26, v146
    v_min_u32 v146, v146, v150
    v_lshlrev_b32 v145, 1, v145
    v_mad_u32_u24 v149, v146, 26, v145
    s_cmp_eq_u32 s96, 1
    s_cselect_b32 s8, 4, 22
    s_mul_i32 s8, s8, 26
    s_waitcnt lgkmcnt(4)
    v_lshlrev_b32 v212, 16, v212
    v_add_u32 v153, 141312, v149
    ds_read_u16 v160, v153
    v_add_u32 v149, s8, v149
    v_subrev_u32 v150, 676, v149
    v_min_u32 v149, v149, v150
    v_add_u32 v154, 141312, v149
    ds_read_u16 v161, v154
    v_add_u32 v149, s8, v149
    v_subrev_u32 v150, 676, v149
    v_min_u32 v149, v149, v150
    v_add_u32 v153, 141312, v149
    ds_read_u16 v162, v153
    v_add_u32 v149, s8, v149
    v_subrev_u32 v150, 676, v149
    v_min_u32 v149, v149, v150
    v_add_u32 v154, 141312, v149
    ds_read_u16 v163, v154
    v_add_u32 v149, s8, v149
    v_subrev_u32 v150, 676, v149
    v_min_u32 v149, v149, v150
    v_add_u32 v153, 141312, v149
    ds_read_u16 v164, v153
    v_add_u32 v149, s8, v149
    v_subrev_u32 v150, 676, v149
    v_min_u32 v149, v149, v150
    v_add_u32 v154, 141312, v149
    ds_read_u16 v165, v154
    v_add_u32 v149, s8, v149
    v_subrev_u32 v150, 676, v149
    v_min_u32 v149, v149, v150
    v_add_u32 v153, 141312, v149
    ds_read_u16 v23, v153
    s_mul_i32 s28, s86, s96
    s_add_u32 s28, s28, s97
    v_lshrrev_b32 v144, 4, v1
    s_sub_u32 s10, s28, 26
    s_min_u32 s28, s28, s10
    s_sub_u32 s10, s28, 26
    s_min_u32 s28, s28, s10
    v_bfe_u32 v145, v1, 1, 2
    s_mul_i32 s28, s28, 3328
    v_lshl_add_u32 v145, v144, 2, v145
    s_cmp_eq_u32 s96, 1
    s_cselect_b32 s9, 8, 18
    s_mul_i32 s9, s9, 3328
    v_bfe_u32 v146, v1, 3, 1
    v_lshl_add_u32 v146, v145, 1, v146
    s_add_u32 s29, s28, s9
    s_sub_u32 s10, s29, 86528
    s_min_u32 s29, s29, s10
    s_add_u32 s30, s29, s9
    s_sub_u32 s10, s30, 86528
    s_min_u32 s30, s30, s10
    v_mul_i32_i24 v147, s96, v146
    v_add_u32 v147, s97, v147
    v_subrev_u32 v148, 26, v147
    v_min_u32 v147, v147, v148
    v_subrev_u32 v148, 26, v147
    v_min_u32 v147, v147, v148
    s_and_b32 s9, s86, 1
    s_add_u32 s9, s9, 24
    s_mul_i32 s31, s9, s96
    s_add_u32 s31, s31, s97
    v_xor_b32 v144, v144, v1
    s_sub_u32 s10, s31, 26
    s_min_u32 s31, s31, s10
    s_sub_u32 s10, s31, 26
    s_min_u32 s31, s31, s10
    v_and_b32 v144, 1, v144
    s_lshl_b32 s9, s88, 5
    v_lshl_add_u32 v144, v144, 4, s9
    s_mul_i32 s31, s31, 3328
    v_lshl_add_u32 v144, v147, 7, v144
    v_add_u32 v145, 3, v145
    v_lshrrev_b32 v145, 4, v145
    v_lshl_add_u32 v7, v145, 30, v144
    s_waitcnt lgkmcnt(0)
    v_lshl_or_b32 v24, v169, 16, v168
    v_lshl_or_b32 v25, v171, 16, v170
    v_lshl_or_b32 v20, v161, 16, v160
    v_lshl_or_b32 v21, v163, 16, v162
    v_lshl_or_b32 v22, v165, 16, v164
    s_add_u32 m0, s89, 81920
    s_add_u32 s60, s60, s61
    s_sub_u32 s93, s60, 851968
    s_min_u32 s60, s60, s93
    buffer_load_dwordx4 v2, s[40:43], s60 offen lds
    s_add_u32 m0, s89, 90112
    s_add_u32 s60, s60, s61
    s_sub_u32 s93, s60, 851968
    s_min_u32 s60, s60, s93
    buffer_load_dwordx4 v2, s[40:43], s60 offen lds
    s_add_u32 m0, s89, 32768
    s_nop 0
    buffer_load_dwordx4 v16, s[32:35], 0 offen  lds
    s_add_u32 m0, s89, 40960
    s_nop 0
    buffer_load_dwordx4 v17, s[32:35], 0 offen  lds
    s_cmp_eq_u32 s90, 1
    s_cbranch_scc1 L_k1
    s_waitcnt vmcnt(6)
    s_barrier
    ds_read_b128 v[60:63], v8 offset:0
    ds_read_b64_tr_b16 v[44:45], v12 offset:0
    ds_read_b64_tr_b16 v[46:47], v12 offset:512
    ds_read_b128 v[64:67], v9 offset:0
    ds_read_b64_tr_b16 v[48:49], v12 offset:2048
    ds_read_b64_tr_b16 v[50:51], v12 offset:2560
    s_add_u32 m0, s89, 98304
    s_add_u32 s60, s60, s61
    s_sub_u32 s93, s60, 851968
    s_min_u32 s60, s60, s93
    buffer_load_dwordx4 v2, s[40:43], s60 offen lds
    s_waitcnt lgkmcnt(3)
    v_mfma_f32_32x32x16_bf16 v[76:91], v[100:103], v[60:63], 0
    v_mfma_f32_32x32x16_bf16 v[28:43], v[44:47], v[60:63], 0
    ds_read_b128 v[68:71], v10 offset:0
    ds_read_b64_tr_b16 v[52:53], v12 offset:4096
    ds_read_b64_tr_b16 v[54:55], v12 offset:4608
    s_add_u32 m0, s89, 106496
    s_add_u32 s60, s60, s61
    s_sub_u32 s93, s60, 851968
    s_min_u32 s60, s60, s93
    buffer_load_dwordx4 v2, s[40:43], s60 offen lds
    s_waitcnt lgkmcnt(3)
    v_mfma_f32_32x32x16_bf16 v[76:91], v[104:107], v[64:67], v[76:91]
    v_mfma_f32_32x32x16_bf16 v[28:43], v[48:51], v[64:67], v[28:43]
    ds_read_b128 v[72:75], v11 offset:0
    ds_read_b64_tr_b16 v[56:57], v12 offset:6144
    ds_read_b64_tr_b16 v[58:59], v12 offset:6656
    ds_read_b64 v[116:117], v13 offset:0
    s_add_u32 m0, s89, 49152
    s_nop 0
    buffer_load_dwordx4 v18, s[32:35], 0 offen  lds
    s_waitcnt lgkmcnt(4)
    v_mfma_f32_32x32x16_bf16 v[76:91], v[108:111], v[68:71], v[76:91]
    v_mfma_f32_32x32x16_bf16 v[28:43], v[52:55], v[68:71], v[28:43]
    s_add_u32 m0, s89, 57344
    s_nop 0
    buffer_load_dwordx4 v19, s[32:35], 0 offen  lds
    s_waitcnt vmcnt(6)
    s_barrier
    ds_read_b128 v[60:63], v8 offset:16384
    ds_read_b64_tr_b16 v[44:45], v12 offset:16384
    ds_read_b64_tr_b16 v[46:47], v12 offset:16896
    s_waitcnt lgkmcnt(4)
    v_mfma_f32_32x32x16_bf16 v[76:91], v[112:115], v[72:75], v[76:91]
    v_mfma_f32_32x32x16_bf16 v[28:43], v[56:59], v[72:75], v[28:43]
    ds_read_b128 v[64:67], v9 offset:16384
    ds_read_b64_tr_b16 v[48:49], v12 offset:18432
    ds_read_b64_tr_b16 v[50:51], v12 offset:18944
    s_waitcnt lgkmcnt(3)
    v_mfma_f32_32x32x16_bf16 v[28:43], v[44:47], v[60:63], v[28:43]
    ds_read_b128 v[68:71], v10 offset:16384
    ds_read_b64_tr_b16 v[52:53], v12 offset:20480
    ds_read_b64_tr_b16 v[54:55], v12 offset:20992
    s_nop 2
    v_mov_b32 v213, v84
    s_waitcnt lgkmcnt(3)
    v_mfma_f32_32x32x16_bf16 v[28:43], v[48:51], v[64:67], v[28:43]
    ds_read_b128 v[72:75], v11 offset:16384
    ds_read_b64_tr_b16 v[56:57], v12 offset:22528
    ds_read_b64_tr_b16 v[58:59], v12 offset:23040
    ds_read_b64 v[118:119], v13 offset:16384
    ds_read_b64 v[16:17], v26 offset:32
    s_add_u32 m0, s89, 114688
    s_add_u32 s60, s60, s61
    s_sub_u32 s93, s60, 851968
    s_min_u32 s60, s60, s93
    buffer_load_dwordx4 v2, s[40:43], s60 offen lds
    s_waitcnt lgkmcnt(5)
    v_mfma_f32_32x32x16_bf16 v[28:43], v[52:55], v[68:71], v[28:43]
    s_add_u32 m0, s89, 122880
    s_add_u32 s60, s60, s61
    s_sub_u32 s93, s60, 851968
    s_min_u32 s60, s60, s93
    buffer_load_dwordx4 v2, s[40:43], s60 offen lds
    s_waitcnt lgkmcnt(0)
    v_lshl_add_u32 v16, v16, 7, v3
    v_lshl_add_u32 v17, v17, 7, v3
    s_waitcnt vmcnt(4)
    s_barrier
    ds_read_b128 v[60:63], v8 offset:32768
    ds_read_b64_tr_b16 v[44:45], v12 offset:32768
    ds_read_b64_tr_b16 v[46:47], v12 offset:33280
    v_mfma_f32_32x32x16_bf16 v[28:43], v[56:59], v[72:75], v[28:43]
    ds_read_b128 v[64:67], v9 offset:32768
    ds_read_b64_tr_b16 v[48:49], v12 offset:34816
    ds_read_b64_tr_b16 v[50:51], v12 offset:35328
    s_add_u32 m0, s89, 0
    s_nop 0
    buffer_load_dwordx4 v16, s[32:35], 0 offen  lds
    s_waitcnt lgkmcnt(3)
    v_mfma_f32_32x32x16_bf16 v[84:99], v[100:103], v[60:63], 0
    v_mfma_f32_32x32x16_bf16 v[28:43], v[44:47], v[60:63], v[28:43]
    ds_read_b128 v[68:71], v10 offset:32768
    ds_read_b64_tr_b16 v[52:53], v12 offset:36864
    ds_read_b64_tr_b16 v[54:55], v12 offset:37376
    s_add_u32 m0, s89, 8192
    s_nop 0
    buffer_load_dwordx4 v17, s[32:35], 0 offen  lds
    s_waitcnt lgkmcnt(3)
    v_mfma_f32_32x32x16_bf16 v[84:99], v[104:107], v[64:67], v[84:99]
    v_mfma_f32_32x32x16_bf16 v[28:43], v[48:51], v[64:67], v[28:43]
    ds_read_b128 v[72:75], v11 offset:32768
    ds_read_b64_tr_b16 v[56:57], v12 offset:38912
    ds_read_b64_tr_b16 v[58:59], v12 offset:39424
    ds_read_b64 v[120:121], v13 offset:32768
    ds_read_b64 v[18:19], v26 offset:40
    s_add_u32 m0, s89, 65536
    s_add_u32 s60, s60, s61
    s_sub_u32 s93, s60, 851968
    s_min_u32 s60, s60, s93
    buffer_load_dwordx4 v2, s[40:43], s60 offen lds
    s_waitcnt lgkmcnt(5)
    v_mfma_f32_32x32x16_bf16 v[84:99], v[108:111], v[68:71], v[84:99]
    v_mfma_f32_32x32x16_bf16 v[28:43], v[52:55], v[68:71], v[28:43]
    s_add_u32 m0, s89, 73728
    s_add_u32 s60, s60, s61
    s_sub_u32 s93, s60, 851968
    s_min_u32 s60, s60, s93
    buffer_load_dwordx4 v2, s[40:43], s60 offen lds
    s_waitcnt lgkmcnt(0)
    v_lshl_add_u32 v18, v18, 7, v3
    v_lshl_add_u32 v19, v19, 7, v3
    s_lshl_b32 s91, s88, 3
    s_add_u32 s91, s91, s86
    s_cmp_lg_u32 s91, 23
    s_cbranch_scc1 L_z1
    v_mov_b32 v240, 0
    v_mov_b32 v241, 0
    v_mov_b32 v242, 0
    v_mov_b32 v243, 0
    v_lshlrev_b32 v244, 4, v1
    s_lshl_b32 s91, s87, 10
    buffer_store_dwordx4 v[240:243], v244, s[56:59], s91 offen sc0 sc1
L_z1:
    s_waitcnt vmcnt(4)
    s_barrier
    ds_read_b128 v[60:63], v8 offset:49152
    ds_read_b64_tr_b16 v[44:45], v12 offset:49152
    ds_read_b64_tr_b16 v[46:47], v12 offset:49664
    v_mfma_f32_32x32x16_bf16 v[84:99], v[112:115], v[72:75], v[84:99]
    v_mfma_f32_32x32x16_bf16 v[28:43], v[56:59], v[72:75], v[28:43]
    ds_read_b128 v[64:67], v9 offset:49152
    ds_read_b64_tr_b16 v[48:49], v12 offset:51200
    ds_read_b64_tr_b16 v[50:51], v12 offset:51712
    s_add_u32 m0, s89, 16384
    s_nop 0
    buffer_load_dwordx4 v18, s[32:35], 0 offen  lds
    s_waitcnt lgkmcnt(3)
    v_mfma_f32_32x32x16_bf16 v[28:43], v[44:47], v[60:63], v[28:43]
    ds_read_b128 v[68:71], v10 offset:49152
    ds_read_b64_tr_b16 v[52:53], v12 offset:53248
    ds_read_b64_tr_b16 v[54:55], v12 offset:53760
    v_cvt_pk_bf16_f32 v208, v213, v92
    v_cvt_pk_bf16_f32 v176, v76, v84
    v_cvt_pk_bf16_f32 v180, v77, v85
    v_cvt_pk_bf16_f32 v184, v78, v86
    v_cvt_pk_bf16_f32 v188, v79, v87
    v_cvt_pk_bf16_f32 v192, v80, v88
    v_cvt_pk_bf16_f32 v196, v81, v89
    v_cvt_pk_bf16_f32 v200, v82, v90
    v_cvt_pk_bf16_f32 v204, v83, v91
    s_add_u32 m0, s89, 24576
    s_nop 0
    buffer_load_dwordx4 v19, s[32:35], 0 offen  lds
    s_waitcnt lgkmcnt(3)
    v_mfma_f32_32x32x16_bf16 v[28:43], v[48:51], v[64:67], v[28:43]
    ds_read_b128 v[72:75], v11 offset:49152
    ds_read_b64_tr_b16 v[56:57], v12 offset:55296
    ds_read_b64_tr_b16 v[58:59], v12 offset:55808
    ds_read_b64 v[122:123], v13 offset:49152
    ds_read_b64 v[16:17], v26 offset:48
    s_add_u32 m0, s89, 81920
    s_add_u32 s60, s60, s61
    s_sub_u32 s93, s60, 851968
    s_min_u32 s60, s60, s93
    buffer_load_dwordx4 v2, s[40:43], s60 offen lds
    s_waitcnt lgkmcnt(5)
    v_mfma_f32_32x32x16_bf16 v[28:43], v[52:55], v[68:71], v[28:43]
    s_add_u32 m0, s89, 90112
    s_add_u32 s60, s60, s61
    s_sub_u32 s93, s60, 851968
    s_min_u32 s60, s60, s93
    buffer_load_dwordx4 v2, s[40:43], s60 offen lds
    s_waitcnt lgkmcnt(0)
    v_lshl_add_u32 v16, v16, 7, v3
    v_lshl_add_u32 v17, v17, 7, v3
    s_waitcnt vmcnt(4)
    s_barrier
    ds_read_b128 v[60:63], v8 offset:0
    ds_read_b64_tr_b16 v[44:45], v12 offset:0
    ds_read_b64_tr_b16 v[46:47], v12 offset:512
    v_mfma_f32_32x32x16_bf16 v[28:43], v[56:59], v[72:75], v[28:43]
    ds_read_b128 v[64:67], v9 offset:0
    ds_read_b64_tr_b16 v[48:49], v12 offset:2048
    ds_read_b64_tr_b16 v[50:51], v12 offset:2560
    s_add_u32 m0, s89, 32768
    s_nop 0
    buffer_load_dwordx4 v16, s[32:35], 0 offen  lds
    s_waitcnt lgkmcnt(3)
    v_mfma_f32_32x32x16_bf16 v[76:91], v[100:103], v[60:63], 0
    v_mfma_f32_32x32x16_bf16 v[28:43], v[44:47], v[60:63], v[28:43]
    ds_read_b128 v[68:71], v10 offset:0
    ds_read_b64_tr_b16 v[52:53], v12 offset:4096
    ds_read_b64_tr_b16 v[54:55], v12 offset:4608
    s_add_u32 m0, s89, 40960
    s_nop 0
    buffer_load_dwordx4 v17, s[32:35], 0 offen  lds
    s_waitcnt lgkmcnt(3)
    v_mfma_f32_32x32x16_bf16 v[76:91], v[104:107], v[64:67], v[76:91]
    v_mfma_f32_32x32x16_bf16 v[28:43], v[48:51], v[64:67], v[28:43]
    ds_read_b128 v[72:75], v11 offset:0
    ds_read_b64_tr_b16 v[56:57], v12 offset:6144
    ds_read_b64_tr_b16 v[58:59], v12 offset:6656
    ds_read_b64 v[124:125], v13 offset:0
    ds_read_b64 v[18:19], v26 offset:56
    s_add_u32 m0, s89, 98304
    s_add_u32 s60, s60, s61
    s_sub_u32 s93, s60, 851968
    s_min_u32 s60, s60, s93
    buffer_load_dwordx4 v2, s[40:43], s60 offen lds
    s_waitcnt lgkmcnt(5)
    v_mfma_f32_32x32x16_bf16 v[76:91], v[108:111], v[68:71], v[76:91]
    v_mfma_f32_32x32x16_bf16 v[28:43], v[52:55], v[68:71], v[28:43]
    s_add_u32 m0, s89, 106496
    s_add_u32 s60, s60, s61
    s_sub_u32 s93, s60, 851968
    s_min_u32 s60, s60, s93
    buffer_load_dwordx4 v2, s[40:43], s60 offen lds
    s_waitcnt lgkmcnt(0)
    v_lshl_add_u32 v18, v18, 7, v3
    v_lshl_add_u32 v19, v19, 7, v3
    s_waitcnt vmcnt(4)
    s_barrier
    ds_read_b128 v[60:63], v8 offset:16384
    ds_read_b64_tr_b16 v[44:45], v12 offset:16384
    ds_read_b64_tr_b16 v[46:47], v12 offset:16896
    v_mfma_f32_32x32x16_bf16 v[76:91], v[112:115], v[72:75], v[76:91]
    v_mfma_f32_32x32x16_bf16 v[28:43], v[56:59], v[72:75], v[28:43]
    ds_read_b128 v[64:67], v9 offset:16384
    ds_read_b64_tr_b16 v[48:49], v12 offset:18432
    ds_read_b64_tr_b16 v[50:51], v12 offset:18944
    s_add_u32 m0, s89, 49152
    s_nop 0
    buffer_load_dwordx4 v18, s[32:35], 0 offen  lds
    s_waitcnt lgkmcnt(3)
    v_mfma_f32_32x32x16_bf16 v[28:43], v[44:47], v[60:63], v[28:43]
    ds_read_b128 v[68:71], v10 offset:16384
    ds_read_b64_tr_b16 v[52:53], v12 offset:20480
    ds_read_b64_tr_b16 v[54:55], v12 offset:20992
    v_mov_b32 v213, v84
    s_add_u32 m0, s89, 57344
    s_nop 0
    buffer_load_dwordx4 v19, s[32:35], 0 offen  lds
    s_waitcnt lgkmcnt(3)
    v_mfma_f32_32x32x16_bf16 v[28:43], v[48:51], v[64:67], v[28:43]
    ds_read_b128 v[72:75], v11 offset:16384
    ds_read_b64_tr_b16 v[56:57], v12 offset:22528
    ds_read_b64_tr_b16 v[58:59], v12 offset:23040
    ds_read_b64 v[126:127], v13 offset:16384
    ds_read_b64 v[16:17], v26 offset:64
    s_add_u32 m0, s89, 114688
    s_add_u32 s60, s60, s61
    s_sub_u32 s93, s60, 851968
    s_min_u32 s60, s60, s93
    buffer_load_dwordx4 v2, s[40:43], s60 offen lds
    s_waitcnt lgkmcnt(5)
    v_mfma_f32_32x32x16_bf16 v[28:43], v[52:55], v[68:71], v[28:43]
    s_add_u32 m0, s89, 122880
    s_add_u32 s60, s60, s61
    s_sub_u32 s93, s60, 851968
    s_min_u32 s60, s60, s93
    buffer_load_dwordx4 v2, s[40:43], s60 offen lds
    s_waitcnt lgkmcnt(0)
    v_lshl_add_u32 v16, v16, 7, v3
    v_lshl_add_u32 v17, v17, 7, v3
    s_lshl_b32 s91, s88, 3
    s_add_u32 s91, s91, s86
    s_cmp_lg_u32 s91, 23
    s_cbranch_scc1 L_z2
    v_mov_b32 v240, 1
    v_mov_b32 v241, 0
    s_lshl_b32 s91, s87, 2
    s_mov_b64 exec, 1
    buffer_store_dword v240, v241, s[52:55], s91 offen sc0 sc1
    s_mov_b64 exec, -1
L_z2:
    s_waitcnt vmcnt(4)
    s_barrier
    ds_read_b128 v[60:63], v8 offset:32768
    ds_read_b64_tr_b16 v[44:45], v12 offset:32768
    ds_read_b64_tr_b16 v[46:47], v12 offset:33280
    v_mfma_f32_32x32x16_bf16 v[28:43], v[56:59], v[72:75], v[28:43]
    ds_read_b128 v[64:67], v9 offset:32768
    ds_read_b64_tr_b16 v[48:49], v12 offset:34816
    ds_read_b64_tr_b16 v[50:51], v12 offset:35328
    s_add_u32 m0, s89, 0
    s_nop 0
    buffer_load_dwordx4 v16, s[32:35], 0 offen  lds
    s_waitcnt lgkmcnt(3)
    v_mfma_f32_32x32x16_bf16 v[84:99], v[100:103], v[60:63], 0
    v_mfma_f32_32x32x16_bf16 v[28:43], v[44:47], v[60:63], v[28:43]
    ds_read_b128 v[68:71], v10 offset:32768
    ds_read_b64_tr_b16 v[52:53], v12 offset:36864
    ds_read_b64_tr_b16 v[54:55], v12 offset:37376
    s_add_u32 m0, s89, 8192
    s_nop 0
    buffer_load_dwordx4 v17, s[32:35], 0 offen  lds
    s_waitcnt lgkmcnt(3)
    v_mfma_f32_32x32x16_bf16 v[84:99], v[104:107], v[64:67], v[84:99]
    v_mfma_f32_32x32x16_bf16 v[28:43], v[48:51], v[64:67], v[28:43]
    ds_read_b128 v[72:75], v11 offset:32768
    ds_read_b64_tr_b16 v[56:57], v12 offset:38912
    ds_read_b64_tr_b16 v[58:59], v12 offset:39424
    ds_read_b64 v[128:129], v13 offset:32768
    ds_read_b64 v[18:19], v26 offset:72
    s_add_u32 m0, s89, 65536
    s_add_u32 s60, s60, s61
    s_sub_u32 s93, s60, 851968
    s_min_u32 s60, s60, s93
    buffer_load_dwordx4 v2, s[40:43], s60 offen lds
    s_waitcnt lgkmcnt(5)
    v_mfma_f32_32x32x16_bf16 v[84:99], v[108:111], v[68:71], v[84:99]
    v_mfma_f32_32x32x16_bf16 v[28:43], v[52:55], v[68:71], v[28:43]
    s_add_u32 m0, s89, 73728
    s_add_u32 s60, s60, s61
    s_sub_u32 s93, s60, 851968
    s_min_u32 s60, s60, s93
    buffer_load_dwordx4 v2, s[40:43], s60 offen lds
    s_waitcnt lgkmcnt(0)
    v_lshl_add_u32 v18, v18, 7, v3
    v_lshl_add_u32 v19, v19, 7, v3
    s_waitcnt vmcnt(4)
    s_barrier
    ds_read_b128 v[60:63], v8 offset:49152
    ds_read_b64_tr_b16 v[44:45], v12 offset:49152
    ds_read_b64_tr_b16 v[46:47], v12 offset:49664
    v_mfma_f32_32x32x16_bf16 v[84:99], v[112:115], v[72:75], v[84:99]
    v_mfma_f32_32x32x16_bf16 v[28:43], v[56:59], v[72:75], v[28:43]
    ds_read_b128 v[64:67], v9 offset:49152
    ds_read_b64_tr_b16 v[48:49], v12 offset:51200
    ds_read_b64_tr_b16 v[50:51], v12 offset:51712
    s_add_u32 m0, s89, 16384
    s_nop 0
    buffer_load_dwordx4 v18, s[32:35], 0 offen  lds
    s_waitcnt lgkmcnt(3)
    v_mfma_f32_32x32x16_bf16 v[28:43], v[44:47], v[60:63], v[28:43]
    ds_read_b128 v[68:71], v10 offset:49152
    ds_read_b64_tr_b16 v[52:53], v12 offset:53248
    ds_read_b64_tr_b16 v[54:55], v12 offset:53760
    v_cvt_pk_bf16_f32 v209, v213, v92
    v_cvt_pk_bf16_f32 v177, v76, v84
    v_cvt_pk_bf16_f32 v181, v77, v85
    v_cvt_pk_bf16_f32 v185, v78, v86
    v_cvt_pk_bf16_f32 v189, v79, v87
    v_cvt_pk_bf16_f32 v193, v80, v88
    v_cvt_pk_bf16_f32 v197, v81, v89
    v_cvt_pk_bf16_f32 v201, v82, v90
    v_cvt_pk_bf16_f32 v205, v83, v91
    s_add_u32 m0, s89, 24576
    s_nop 0
    buffer_load_dwordx4 v19, s[32:35], 0 offen  lds
    s_waitcnt lgkmcnt(3)
    v_mfma_f32_32x32x16_bf16 v[28:43], v[48:51], v[64:67], v[28:43]
    ds_read_b128 v[72:75], v11 offset:49152
    ds_read_b64_tr_b16 v[56:57], v12 offset:55296
    ds_read_b64_tr_b16 v[58:59], v12 offset:55808
    ds_read_b64 v[130:131], v13 offset:49152
    ds_read_b64 v[16:17], v26 offset:80
    s_add_u32 m0, s89, 81920
    s_add_u32 s60, s60, s61
    s_sub_u32 s93, s60, 851968
    s_min_u32 s60, s60, s93
    buffer_load_dwordx4 v2, s[40:43], s60 offen lds
    s_waitcnt lgkmcnt(5)
    v_mfma_f32_32x32x16_bf16 v[28:43], v[52:55], v[68:71], v[28:43]
    s_add_u32 m0, s89, 90112
    s_add_u32 s60, s60, s61
    s_sub_u32 s93, s60, 851968
    s_min_u32 s60, s60, s93
    buffer_load_dwordx4 v2, s[40:43], s60 offen lds
    s_waitcnt lgkmcnt(0)
    v_lshl_add_u32 v16, v16, 7, v3
    v_lshl_add_u32 v17, v17, 7, v3
    s_waitcnt vmcnt(4)
    s_barrier
    ds_read_b128 v[60:63], v8 offset:0
    ds_read_b64_tr_b16 v[44:45], v12 offset:0
    ds_read_b64_tr_b16 v[46:47], v12 offset:512
    v_mfma_f32_32x32x16_bf16 v[28:43], v[56:59], v[72:75], v[28:43]
    ds_read_b128 v[64:67], v9 offset:0
    ds_read_b64_tr_b16 v[48:49], v12 offset:2048
    ds_read_b64_tr_b16 v[50:51], v12 offset:2560
    s_add_u32 m0, s89, 32768
    s_nop 0
    buffer_load_dwordx4 v16, s[32:35], 0 offen  lds
    s_waitcnt lgkmcnt(3)
    v_mfma_f32_32x32x16_bf16 v[76:91], v[100:103], v[60:63], 0
    v_mfma_f32_32x32x16_bf16 v[28:43], v[44:47], v[60:63], v[28:43]
    ds_read_b128 v[68:71], v10 offset:0
    ds_read_b64_tr_b16 v[52:53], v12 offset:4096
    ds_read_b64_tr_b16 v[54:55], v12 offset:4608
    s_add_u32 m0, s89, 40960
    s_nop 0
    buffer_load_dwordx4 v17, s[32:35], 0 offen  lds
    s_waitcnt lgkmcnt(3)
    v_mfma_f32_32x32x16_bf16 v[76:91], v[104:107], v[64:67], v[76:91]
    v_mfma_f32_32x32x16_bf16 v[28:43], v[48:51], v[64:67], v[28:43]
    ds_read_b128 v[72:75], v11 offset:0
    ds_read_b64_tr_b16 v[56:57], v12 offset:6144
    ds_read_b64_tr_b16 v[58:59], v12 offset:6656
    ds_read_b64 v[132:133], v13 offset:0
    ds_read_b64 v[18:19], v26 offset:88
    s_add_u32 m0, s89, 98304
    s_add_u32 s60, s60, s61
    s_sub_u32 s93, s60, 851968
    s_min_u32 s60, s60, s93
    buffer_load_dwordx4 v2, s[40:43], s60 offen lds
    s_waitcnt lgkmcnt(5)
    v_mfma_f32_32x32x16_bf16 v[76:91], v[108:111], v[68:71], v[76:91]
    v_mfma_f32_32x32x16_bf16 v[28:43], v[52:55], v[68:71], v[28:43]
    s_add_u32 m0, s89, 106496
    s_add_u32 s60, s60, s61
    s_sub_u32 s93, s60, 851968
    s_min_u32 s60, s60, s93
    buffer_load_dwordx4 v2, s[40:43], s60 offen lds
    s_waitcnt lgkmcnt(0)
    v_lshl_add_u32 v18, v18, 7, v3
    v_lshl_add_u32 v19, v19, 7, v3
    s_waitcnt vmcnt(4)
    s_barrier
    ds_read_b128 v[60:63], v8 offset:16384
    ds_read_b64_tr_b16 v[44:45], v12 offset:16384
    ds_read_b64_tr_b16 v[46:47], v12 offset:16896
    v_mfma_f32_32x32x16_bf16 v[76:91], v[112:115], v[72:75], v[76:91]
    v_mfma_f32_32x32x16_bf16 v[28:43], v[56:59], v[72:75], v[28:43]
    ds_read_b128 v[64:67], v9 offset:16384
    ds_read_b64_tr_b16 v[48:49], v12 offset:18432
    ds_read_b64_tr_b16 v[50:51], v12 offset:18944
    s_add_u32 m0, s89, 49152
    s_nop 0
    buffer_load_dwordx4 v18, s[32:35], 0 offen  lds
    s_waitcnt lgkmcnt(3)
    v_mfma_f32_32x32x16_bf16 v[28:43], v[44:47], v[60:63], v[28:43]
    ds_read_b128 v[68:71], v10 offset:16384
    ds_read_b64_tr_b16 v[52:53], v12 offset:20480
    ds_read_b64_tr_b16 v[54:55], v12 offset:20992
    v_mov_b32 v213, v84
    s_add_u32 m0, s89, 57344
    s_nop 0
    buffer_load_dwordx4 v19, s[32:35], 0 offen  lds
    s_waitcnt lgkmcnt(3)
    v_mfma_f32_32x32x16_bf16 v[28:43], v[48:51], v[64:67], v[28:43]
    ds_read_b128 v[72:75], v11 offset:16384
    ds_read_b64_tr_b16 v[56:57], v12 offset:22528
    ds_read_b64_tr_b16 v[58:59], v12 offset:23040
    ds_read_b64 v[134:135], v13 offset:16384
    ds_read_b64 v[16:17], v26 offset:96
    s_add_u32 m0, s89, 114688
    s_add_u32 s60, s60, s61
    s_sub_u32 s93, s60, 851968
    s_min_u32 s60, s60, s93
    buffer_load_dwordx4 v2, s[40:43], s60 offen lds
    s_waitcnt lgkmcnt(5)
    v_mfma_f32_32x32x16_bf16 v[28:43], v[52:55], v[68:71], v[28:43]
    s_add_u32 m0, s89, 122880
    s_add_u32 s60, s60, s61
    s_sub_u32 s93, s60, 851968
    s_min_u32 s60, s60, s93
    buffer_load_dwordx4 v2, s[40:43], s60 offen lds
    s_waitcnt lgkmcnt(0)
    v_lshl_add_u32 v16, v16, 7, v3
    v_lshl_add_u32 v17, v17, 7, v3
    s_waitcnt vmcnt(4)
    s_barrier
    ds_read_b128 v[60:63], v8 offset:32768
    ds_read_b64_tr_b16 v[44:45], v12 offset:32768
    ds_read_b64_tr_b16 v[46:47], v12 offset:33280
    v_mfma_f32_32x32x16_bf16 v[28:43], v[56:59], v[72:75], v[28:43]
    ds_read_b128 v[64:67], v9 offset:32768
    ds_read_b64_tr_b16 v[48:49], v12 offset:34816
    ds_read_b64_tr_b16 v[50:51], v12 offset:35328
    s_add_u32 m0, s89, 0
    s_nop 0
    buffer_load_dwordx4 v16, s[32:35], 0 offen  lds
    s_waitcnt lgkmcnt(3)
    v_mfma_f32_32x32x16_bf16 v[84:99], v[100:103], v[60:63], 0
    v_mfma_f32_32x32x16_bf16 v[28:43], v[44:47], v[60:63], v[28:43]
    ds_read_b128 v[68:71], v10 offset:32768
    ds_read_b64_tr_b16 v[52:53], v12 offset:36864
    ds_read_b64_tr_b16 v[54:55], v12 offset:37376
    s_add_u32 m0, s89, 8192
    s_nop 0
    buffer_load_dwordx4 v17, s[32:35], 0 offen  lds
    s_waitcnt lgkmcnt(3)
    v_mfma_f32_32x32x16_bf16 v[84:99], v[104:107], v[64:67], v[84:99]
    v_mfma_f32_32x32x16_bf16 v[28:43], v[48:51], v[64:67], v[28:43]
    ds_read_b128 v[72:75], v11 offset:32768
    ds_read_b64_tr_b16 v[56:57], v12 offset:38912
    ds_read_b64_tr_b16 v[58:59], v12 offset:39424
    ds_read_b64 v[136:137], v13 offset:32768
    s_add_u32 m0, s89, 65536
    s_add_u32 s60, s60, s61
    s_sub_u32 s93, s60, 851968
    s_min_u32 s60, s60, s93
    buffer_load_dwordx4 v2, s[40:43], s60 offen lds
    s_waitcnt lgkmcnt(4)
    v_mfma_f32_32x32x16_bf16 v[84:99], v[108:111], v[68:71], v[84:99]
    v_mfma_f32_32x32x16_bf16 v[28:43], v[52:55], v[68:71], v[28:43]
    s_add_u32 m0, s89, 73728
    s_add_u32 s60, s60, s61
    s_sub_u32 s93, s60, 851968
    s_min_u32 s60, s60, s93
    buffer_load_dwordx4 v2, s[40:43], s60 offen lds
    s_waitcnt vmcnt(4)
    s_barrier
    ds_read_b128 v[60:63], v8 offset:49152
    ds_read_b64_tr_b16 v[44:45], v12 offset:49152
    ds_read_b64_tr_b16 v[46:47], v12 offset:49664
    s_waitcnt lgkmcnt(4)
    v_mfma_f32_32x32x16_bf16 v[84:99], v[112:115], v[72:75], v[84:99]
    v_mfma_f32_32x32x16_bf16 v[28:43], v[56:59], v[72:75], v[28:43]
    ds_read_b128 v[64:67], v9 offset:49152
    ds_read_b64_tr_b16 v[48:49], v12 offset:51200
    ds_read_b64_tr_b16 v[50:51], v12 offset:51712
    s_add_u32 m0, s89, 16384
    s_nop 0
    buffer_load_dwordx4 v7, s[36:39], s28 offen lds
    s_waitcnt lgkmcnt(3)
    v_mfma_f32_32x32x16_bf16 v[28:43], v[44:47], v[60:63], v[28:43]
    ds_read_b128 v[68:71], v10 offset:49152
    ds_read_b64_tr_b16 v[52:53], v12 offset:53248
    ds_read_b64_tr_b16 v[54:55], v12 offset:53760
    v_cvt_pk_bf16_f32 v210, v213, v92
    v_cvt_pk_bf16_f32 v178, v76, v84
    v_cvt_pk_bf16_f32 v182, v77, v85
    v_cvt_pk_bf16_f32 v186, v78, v86
    v_cvt_pk_bf16_f32 v190, v79, v87
    v_cvt_pk_bf16_f32 v194, v80, v88
    v_cvt_pk_bf16_f32 v198, v81, v89
    v_cvt_pk_bf16_f32 v202, v82, v90
    v_cvt_pk_bf16_f32 v206, v83, v91
    s_lshl_b32 s91, s86, 11
    s_add_u32 s91, s91, 81920
    v_lshl_add_u32 v16, v1, 4, s91
    v_xor_b32 v17, 8192, v16
    v_lshrrev_b32 v250, 4, v1
    s_and_b32 s92, s86, 3
    s_lshl_b32 s92, s92, 8
    v_lshl_add_u32 v250, v250, 10, s92
    v_and_b32 v251, 15, v1
    v_lshl_add_u32 v18, v251, 4, v250
    s_and_b32 s91, s86, 2
    s_lshl_b32 s91, s91, 6
    s_lshr_b32 s92, s86, 2
    s_lshl_b32 s93, s92, 6
    s_add_u32 s91, s91, s93
    s_add_u32 s91, s91, 47104
    v_lshrrev_b32 v250, 5, v1
    v_lshl_add_u32 v19, v250, 4, s91
    s_lshl_b32 s91, s92, 12
    s_add_u32 s91, s91, 98304
    v_add_u32 v26, s91, v18
    s_waitcnt lgkmcnt(3)
    v_mfma_f32_32x32x16_bf16 v[28:43], v[48:51], v[64:67], v[28:43]
    ds_read_b128 v[72:75], v11 offset:49152
    ds_read_b64_tr_b16 v[56:57], v12 offset:55296
    ds_read_b64_tr_b16 v[58:59], v12 offset:55808
    ds_read_b64 v[138:139], v13 offset:49152
    v_lshrrev_b32 v250, 5, v1
    v_and_b32 v251, 31, v1
    s_and_b32 s91, s86, 1
    s_lshl_b32 s92, s91, 9
    s_add_u32 s92, s92, 98304
    v_lshl_add_u32 v252, v250, 12, s92
    v_lshl_add_u32 v3, v251, 4, v252
    s_lshl_b32 s91, s91, 10
    s_lshr_b32 s92, s86, 1
    s_lshl_b32 s92, s92, 3
    s_add_u32 s91, s91, s92
    s_add_u32 s91, s91, 131072
    v_lshl_add_u32 v252, v250, 2, s91
    v_lshl_add_u32 v2, v251, 5, v252
    v_lshlrev_b32 v253, 2, v1
    v_add_u32 v253, 47104, v253
    s_waitcnt lgkmcnt(4)
    v_mfma_f32_32x32x16_bf16 v[28:43], v[52:55], v[68:71], v[28:43]
    s_add_u32 m0, s89, 24576
    s_nop 0
    buffer_load_dwordx4 v7, s[36:39], s29 offen lds
    s_waitcnt vmcnt(2) lgkmcnt(0)
    s_barrier
    ds_read_b128 v[60:63], v8 offset:0
    ds_read_b64_tr_b16 v[44:45], v12 offset:0
    ds_read_b64_tr_b16 v[46:47], v12 offset:512
    v_mfma_f32_32x32x16_bf16 v[28:43], v[56:59], v[72:75], v[28:43]
    ds_read_b128 v[64:67], v9 offset:0
    ds_read_b64_tr_b16 v[48:49], v12 offset:2048
    ds_read_b64_tr_b16 v[50:51], v12 offset:2560
    s_add_u32 m0, s89, 32768
    s_nop 0
    buffer_load_dwordx4 v7, s[36:39], s30 offen lds
    s_waitcnt lgkmcnt(3)
    v_mfma_f32_32x32x16_bf16 v[76:91], v[100:103], v[60:63], 0
    v_mfma_f32_32x32x16_bf16 v[28:43], v[44:47], v[60:63], v[28:43]
    ds_read_b128 v[68:71], v10 offset:0
    ds_read_b64_tr_b16 v[52:53], v12 offset:4096
    ds_read_b64_tr_b16 v[54:55], v12 offset:4608
    s_lshr_b32 s91, s86, 1
    s_cmp_lg_u32 s91, 0
    s_cbranch_scc1 L_wc3
    s_add_u32 m0, s89, 40960
    s_nop 0
    buffer_load_dwordx4 v7, s[36:39], s31 offen lds
L_wc3:
    s_waitcnt lgkmcnt(3)
    v_mfma_f32_32x32x16_bf16 v[76:91], v[104:107], v[64:67], v[76:91]
    v_mfma_f32_32x32x16_bf16 v[28:43], v[48:51], v[64:67], v[28:43]
    ds_read_b128 v[72:75], v11 offset:0
    ds_read_b64_tr_b16 v[56:57], v12 offset:6144
    ds_read_b64_tr_b16 v[58:59], v12 offset:6656
    ds_read_b64 v[140:141], v13 offset:0
    s_waitcnt lgkmcnt(4)
    v_mfma_f32_32x32x16_bf16 v[76:91], v[108:111], v[68:71], v[76:91]
    s_waitcnt lgkmcnt(1)
    v_mfma_f32_32x32x16_bf16 v[76:91], v[112:115], v[72:75], v[76:91]
    v_mfma_f32_32x32x16_bf16 v[28:43], v[52:55], v[68:71], v[28:43]
    v_mfma_f32_32x32x16_bf16 v[28:43], v[56:59], v[72:75], v[28:43]
    s_cmp_lg_u32 s86, 0
    s_cbranch_scc1 L_f4
    v_mov_b32 v0, 0
    s_lshl_b32 s91, s87, 2
    buffer_load_dword v6, v0, s[52:55], s91 offen sc0 sc1
L_f4:
    s_nop 7
    v_cvt_pk_bf16_f32 v211, v84, 0
    ds_write_b128 v27, v[208:211]
    v_cvt_pk_bf16_f32 v179, v76, 0
    v_cvt_pk_bf16_f32 v183, v77, 0
    v_cvt_pk_bf16_f32 v187, v78, 0
    v_cvt_pk_bf16_f32 v191, v79, 0
    v_cvt_pk_bf16_f32 v195, v80, 0
    v_cvt_pk_bf16_f32 v199, v81, 0
    v_cvt_pk_bf16_f32 v203, v82, 0
    v_cvt_pk_bf16_f32 v207, v83, 0
    ds_write_b128 v16, v[36:39] offset:0
    ds_write_b128 v16, v[40:43] offset:1024
    s_waitcnt lgkmcnt(0)
    s_barrier
    ds_read_b128 v[240:243], v18 offset:43008
    ds_read_b128 v[36:39], v17 offset:0
    ds_read_b128 v[40:43], v17 offset:1024
    s_add_u32 m0, s89, 0
    s_add_u32 s91, s28, 86528
    buffer_load_dwordx4 v7, s[36:39], s91 offen lds
    s_waitcnt lgkmcnt(2)
    v_mfma_f32_16x16x32_bf16 v[244:247], v[20:23], v[240:243], 0
    ds_read_b128 v[108:111], v19 offset:0
    ds_read_b128 v[112:115], v19 offset:32
    s_add_u32 m0, s89, 8192
    s_add_u32 s91, s29, 86528
    buffer_load_dwordx4 v7, s[36:39], s91 offen lds
    s_nop 2
    v_pk_mul_f32 v[248:249], v[244:245], v[244:245]
    v_pk_mul_f32 v[250:251], v[246:247], v[246:247]
    ds_write_b128 v14, v[176:179] offset:0
    v_pk_fma_f32 v[248:249], v[248:249], v[142:143], v[142:143] op_sel:[0,0,1] op_sel_hi:[1,0,1]
    v_pk_fma_f32 v[250:251], v[250:251], v[142:143], v[142:143] op_sel:[0,0,1] op_sel_hi:[1,0,1]
    v_pk_mul_f32 v[248:249], v[248:249], v[244:245]
    v_pk_mul_f32 v[250:251], v[250:251], v[246:247]
    v_exp_f32 v248, v248
    v_exp_f32 v249, v249
    ds_write_b128 v14, v[180:183] offset:4096
    v_exp_f32 v250, v250
    v_exp_f32 v251, v251
    v_pk_add_f32 v[248:249], v[248:249], 1.0 op_sel_hi:[1,0]
    v_pk_add_f32 v[250:251], v[250:251], 1.0 op_sel_hi:[1,0]
    v_rcp_f32 v248, v248
    v_rcp_f32 v249, v249
    ds_write_b128 v14, v[184:187] offset:8192
    v_rcp_f32 v250, v250
    v_rcp_f32 v251, v251
    v_pk_mul_f32 v[248:249], v[248:249], v[244:245]
    v_pk_mul_f32 v[250:251], v[250:251], v[246:247]
    v_cvt_pk_bf16_f32 v240, v248, v249
    v_cvt_pk_bf16_f32 v241, v250, v251
    s_add_u32 m0, s89, 65536
    s_add_u32 s91, s30, 86528
    buffer_load_dwordx4 v7, s[36:39], s91 offen lds
    v_mfma_f32_16x16x16_bf16 v[244:247], v[24:25], v[240:241], 0
    s_lshr_b32 s91, s86, 1
    s_cmp_lg_u32 s91, 1
    s_cbranch_scc1 L_wc5
    s_add_u32 m0, s89, 71680
    s_add_u32 s91, s31, 86528
    buffer_load_dwordx4 v7, s[36:39], s91 offen lds
L_wc5:
    s_mov_b32 s92, 0xbfb8aa3b
    s_mov_b32 s93, 0xbfb8aa3b
    s_waitcnt lgkmcnt(3)
    v_pk_add_f32 v[28:29], v[28:29], v[36:37]
    ds_write_b128 v14, v[188:191] offset:12288
    v_pk_add_f32 v[30:31], v[30:31], v[38:39]
    v_pk_add_f32 v[32:33], v[32:33], v[40:41]
    v_pk_add_f32 v[34:35], v[34:35], v[42:43]
    v_pk_mul_f32 v[248:249], v[244:245], s[92:93]
    v_pk_mul_f32 v[250:251], v[246:247], s[92:93]
    v_exp_f32 v248, v248
    ds_write_b128 v15, v[192:195] offset:0
    v_exp_f32 v249, v249
    v_exp_f32 v250, v250
    v_exp_f32 v251, v251
    v_pk_add_f32 v[248:249], v[248:249], 1.0 op_sel_hi:[1,0]
    v_pk_add_f32 v[250:251], v[250:251], 1.0 op_sel_hi:[1,0]
    v_rcp_f32 v248, v248
    ds_write_b128 v15, v[196:199] offset:4096
    v_rcp_f32 v249, v249
    v_rcp_f32 v250, v250
    v_rcp_f32 v251, v251
    v_cvt_pk_bf16_f32 v240, v248, v249
    v_cvt_pk_bf16_f32 v241, v250, v251
    v_and_b32 v242, 0xffff, v240
    ds_write_b128 v15, v[200:203] offset:8192
    v_lshrrev_b32 v243, 16, v240
    v_lshlrev_b32 v248, 16, v240
    v_and_b32 v249, 0xffff0000, v240
    v_lshlrev_b32 v250, 16, v241
    v_and_b32 v251, 0xffff0000, v241
    ds_write_b64 v26, v[242:243] offset:8192
    ds_write_b128 v26, v[248:251]
    v_pk_mul_f32 v[36:37], v[28:29], v[28:29]
    v_pk_mul_f32 v[38:39], v[30:31], v[30:31]
    ds_write_b128 v15, v[204:207] offset:12288
    v_pk_mul_f32 v[40:41], v[32:33], v[32:33]
    v_pk_mul_f32 v[42:43], v[34:35], v[34:35]
    v_pk_fma_f32 v[36:37], v[36:37], v[142:143], v[142:143] op_sel:[0,0,1] op_sel_hi:[1,0,1]
    ds_read_b128 v[148:151], v4 offset:1024
    v_pk_fma_f32 v[38:39], v[38:39], v[142:143], v[142:143] op_sel:[0,0,1] op_sel_hi:[1,0,1]
    v_pk_fma_f32 v[40:41], v[40:41], v[142:143], v[142:143] op_sel:[0,0,1] op_sel_hi:[1,0,1]
    v_pk_fma_f32 v[42:43], v[42:43], v[142:143], v[142:143] op_sel:[0,0,1] op_sel_hi:[1,0,1]
    ds_read_b128 v[156:159], v4 offset:5120
    v_pk_mul_f32 v[36:37], v[36:37], v[28:29]
    v_pk_mul_f32 v[38:39], v[38:39], v[30:31]
    v_pk_mul_f32 v[40:41], v[40:41], v[32:33]
    ds_read_b128 v[164:167], v4 offset:9216
    v_pk_mul_f32 v[42:43], v[42:43], v[34:35]
    v_pk_mul_f32 v[108:109], v[108:109], v[28:29]
    v_pk_mul_f32 v[110:111], v[110:111], v[30:31]
    ds_read_b128 v[172:175], v4 offset:13312
    v_pk_mul_f32 v[112:113], v[112:113], v[32:33]
    v_pk_mul_f32 v[114:115], v[114:115], v[34:35]
    s_branch L_tail
L_k1:
    s_waitcnt vmcnt(6)
    s_barrier
    ds_read_b128 v[60:63], v8 offset:0
    ds_read_b64_tr_b16 v[44:45], v12 offset:0
    ds_read_b64_tr_b16 v[46:47], v12 offset:512
    ds_read_b128 v[64:67], v9 offset:0
    ds_read_b64_tr_b16 v[48:49], v12 offset:2048
    ds_read_b64_tr_b16 v[50:51], v12 offset:2560
    s_add_u32 m0, s89, 98304
    s_add_u32 s60, s60, s61
    s_sub_u32 s93, s60, 851968
    s_min_u32 s60, s60, s93
    buffer_load_dwordx4 v2, s[40:43], s60 offen lds
    s_waitcnt lgkmcnt(3)
    v_mfma_f32_32x32x16_bf16 v[28:43], v[44:47], v[60:63], 0
    ds_read_b128 v[68:71], v10 offset:0
    ds_read_b64_tr_b16 v[52:53], v12 offset:4096
    ds_read_b64_tr_b16 v[54:55], v12 offset:4608
    s_add_u32 m0, s89, 106496
    s_add_u32 s60, s60, s61
    s_sub_u32 s93, s60, 851968
    s_min_u32 s60, s60, s93
    buffer_load_dwordx4 v2, s[40:43], s60 offen lds
    s_waitcnt lgkmcnt(3)
    v_mfma_f32_32x32x16_bf16 v[28:43], v[48:51], v[64:67], v[28:43]
    ds_read_b128 v[72:75], v11 offset:0
    ds_read_b64_tr_b16 v[56:57], v12 offset:6144
    ds_read_b64_tr_b16 v[58:59], v12 offset:6656
    ds_read_b64 v[116:117], v13 offset:0
    s_add_u32 m0, s89, 49152
    s_nop 0
    buffer_load_dwordx4 v18, s[32:35], 0 offen  lds
    s_waitcnt lgkmcnt(4)
    v_mfma_f32_32x32x16_bf16 v[28:43], v[52:55], v[68:71], v[28:43]
    s_add_u32 m0, s89, 57344
    s_nop 0
    buffer_load_dwordx4 v19, s[32:35], 0 offen  lds
    s_waitcnt vmcnt(6)
    s_barrier
    ds_read_b128 v[60:63], v8 offset:16384
    ds_read_b64_tr_b16 v[44:45], v12 offset:16384
    ds_read_b64_tr_b16 v[46:47], v12 offset:16896
    s_waitcnt lgkmcnt(4)
    v_mfma_f32_32x32x16_bf16 v[28:43], v[56:59], v[72:75], v[28:43]
    ds_read_b128 v[64:67], v9 offset:16384
    ds_read_b64_tr_b16 v[48:49], v12 offset:18432
    ds_read_b64_tr_b16 v[50:51], v12 offset:18944
    s_waitcnt lgkmcnt(3)
    v_mfma_f32_32x32x16_bf16 v[76:91], v[100:103], v[60:63], 0
    v_mfma_f32_32x32x16_bf16 v[28:43], v[44:47], v[60:63], v[28:43]
    ds_read_b128 v[68:71], v10 offset:16384
    ds_read_b64_tr_b16 v[52:53], v12 offset:20480
    ds_read_b64_tr_b16 v[54:55], v12 offset:20992
    s_waitcnt lgkmcnt(3)
    v_mfma_f32_32x32x16_bf16 v[76:91], v[104:107], v[64:67], v[76:91]
    v_mfma_f32_32x32x16_bf16 v[28:43], v[48:51], v[64:67], v[28:43]
    ds_read_b128 v[72:75], v11 offset:16384
    ds_read_b64_tr_b16 v[56:57], v12 offset:22528
    ds_read_b64_tr_b16 v[58:59], v12 offset:23040
    ds_read_b64 v[118:119], v13 offset:16384
    ds_read_b64 v[16:17], v26 offset:32
    s_add_u32 m0, s89, 114688
    s_add_u32 s60, s60, s61
    s_sub_u32 s93, s60, 851968
    s_min_u32 s60, s60, s93
    buffer_load_dwordx4 v2, s[40:43], s60 offen lds
    s_waitcnt lgkmcnt(5)
    v_mfma_f32_32x32x16_bf16 v[76:91], v[108:111], v[68:71], v[76:91]
    v_mfma_f32_32x32x16_bf16 v[28:43], v[52:55], v[68:71], v[28:43]
    s_add_u32 m0, s89, 122880
    s_add_u32 s60, s60, s61
    s_sub_u32 s93, s60, 851968
    s_min_u32 s60, s60, s93
    buffer_load_dwordx4 v2, s[40:43], s60 offen lds
    s_waitcnt lgkmcnt(0)
    v_lshl_add_u32 v16, v16, 7, v3
    v_lshl_add_u32 v17, v17, 7, v3
    s_waitcnt vmcnt(4)
    s_barrier
    ds_read_b128 v[60:63], v8 offset:32768
    ds_read_b64_tr_b16 v[44:45], v12 offset:32768
    ds_read_b64_tr_b16 v[46:47], v12 offset:33280
    v_mfma_f32_32x32x16_bf16 v[76:91], v[112:115], v[72:75], v[76:91]
    v_mfma_f32_32x32x16_bf16 v[28:43], v[56:59], v[72:75], v[28:43]
    ds_read_b128 v[64:67], v9 offset:32768
    ds_read_b64_tr_b16 v[48:49], v12 offset:34816
    ds_read_b64_tr_b16 v[50:51], v12 offset:35328
    s_add_u32 m0, s89, 0
    s_nop 0
    buffer_load_dwordx4 v16, s[32:35], 0 offen  lds
    s_waitcnt lgkmcnt(3)
    v_mfma_f32_32x32x16_bf16 v[28:43], v[44:47], v[60:63], v[28:43]
    ds_read_b128 v[68:71], v10 offset:32768
    ds_read_b64_tr_b16 v[52:53], v12 offset:36864
    ds_read_b64_tr_b16 v[54:55], v12 offset:37376
    v_mov_b32 v213, v84
    s_add_u32 m0, s89, 8192
    s_nop 0
    buffer_load_dwordx4 v17, s[32:35], 0 offen  lds
    s_waitcnt lgkmcnt(3)
    v_mfma_f32_32x32x16_bf16 v[28:43], v[48:51], v[64:67], v[28:43]
    ds_read_b128 v[72:75], v11 offset:32768
    ds_read_b64_tr_b16 v[56:57], v12 offset:38912
    ds_read_b64_tr_b16 v[58:59], v12 offset:39424
    ds_read_b64 v[120:121], v13 offset:32768
    ds_read_b64 v[18:19], v26 offset:40
    s_add_u32 m0, s89, 65536
    s_add_u32 s60, s60, s61
    s_sub_u32 s93, s60, 851968
    s_min_u32 s60, s60, s93
    buffer_load_dwordx4 v2, s[40:43], s60 offen lds
    s_waitcnt lgkmcnt(5)
    v_mfma_f32_32x32x16_bf16 v[28:43], v[52:55], v[68:71], v[28:43]
    s_add_u32 m0, s89, 73728
    s_add_u32 s60, s60, s61
    s_sub_u32 s93, s60, 851968
    s_min_u32 s60, s60, s93
    buffer_load_dwordx4 v2, s[40:43], s60 offen lds
    s_waitcnt lgkmcnt(0)
    v_lshl_add_u32 v18, v18, 7, v3
    v_lshl_add_u32 v19, v19, 7, v3
    s_waitcnt vmcnt(4)
    s_barrier
    ds_read_b128 v[60:63], v8 offset:49152
    ds_read_b64_tr_b16 v[44:45], v12 offset:49152
    ds_read_b64_tr_b16 v[46:47], v12 offset:49664
    v_mfma_f32_32x32x16_bf16 v[28:43], v[56:59], v[72:75], v[28:43]
    ds_read_b128 v[64:67], v9 offset:49152
    ds_read_b64_tr_b16 v[48:49], v12 offset:51200
    ds_read_b64_tr_b16 v[50:51], v12 offset:51712
    s_add_u32 m0, s89, 16384
    s_nop 0
    buffer_load_dwordx4 v18, s[32:35], 0 offen  lds
    s_waitcnt lgkmcnt(3)
    v_mfma_f32_32x32x16_bf16 v[84:99], v[100:103], v[60:63], 0
    v_mfma_f32_32x32x16_bf16 v[28:43], v[44:47], v[60:63], v[28:43]
    ds_read_b128 v[68:71], v10 offset:49152
    ds_read_b64_tr_b16 v[52:53], v12 offset:53248
    ds_read_b64_tr_b16 v[54:55], v12 offset:53760
    s_add_u32 m0, s89, 24576
    s_nop 0
    buffer_load_dwordx4 v19, s[32:35], 0 offen  lds
    s_waitcnt lgkmcnt(3)
    v_mfma_f32_32x32x16_bf16 v[84:99], v[104:107], v[64:67], v[84:99]
    v_mfma_f32_32x32x16_bf16 v[28:43], v[48:51], v[64:67], v[28:43]
    ds_read_b128 v[72:75], v11 offset:49152
    ds_read_b64_tr_b16 v[56:57], v12 offset:55296
    ds_read_b64_tr_b16 v[58:59], v12 offset:55808
    ds_read_b64 v[122:123], v13 offset:49152
    ds_read_b64 v[16:17], v26 offset:48
    s_add_u32 m0, s89, 81920
    s_add_u32 s60, s60, s61
    s_sub_u32 s93, s60, 851968
    s_min_u32 s60, s60, s93
    buffer_load_dwordx4 v2, s[40:43], s60 offen lds
    s_waitcnt lgkmcnt(5)
    v_mfma_f32_32x32x16_bf16 v[84:99], v[108:111], v[68:71], v[84:99]
    v_mfma_f32_32x32x16_bf16 v[28:43], v[52:55], v[68:71], v[28:43]
    s_add_u32 m0, s89, 90112
    s_add_u32 s60, s60, s61
    s_sub_u32 s93, s60, 851968
    s_min_u32 s60, s60, s93
    buffer_load_dwordx4 v2, s[40:43], s60 offen lds
    s_waitcnt lgkmcnt(0)
    v_lshl_add_u32 v16, v16, 7, v3
    v_lshl_add_u32 v17, v17, 7, v3
    s_waitcnt vmcnt(4)
    s_barrier
    ds_read_b128 v[60:63], v8 offset:0
    ds_read_b64_tr_b16 v[44:45], v12 offset:0
    ds_read_b64_tr_b16 v[46:47], v12 offset:512
    v_mfma_f32_32x32x16_bf16 v[84:99], v[112:115], v[72:75], v[84:99]
    v_mfma_f32_32x32x16_bf16 v[28:43], v[56:59], v[72:75], v[28:43]
    ds_read_b128 v[64:67], v9 offset:0
    ds_read_b64_tr_b16 v[48:49], v12 offset:2048
    ds_read_b64_tr_b16 v[50:51], v12 offset:2560
    s_add_u32 m0, s89, 32768
    s_nop 0
    buffer_load_dwordx4 v16, s[32:35], 0 offen  lds
    s_waitcnt lgkmcnt(3)
    v_mfma_f32_32x32x16_bf16 v[28:43], v[44:47], v[60:63], v[28:43]
    ds_read_b128 v[68:71], v10 offset:0
    ds_read_b64_tr_b16 v[52:53], v12 offset:4096
    ds_read_b64_tr_b16 v[54:55], v12 offset:4608
    v_cvt_pk_bf16_f32 v208, v213, v92
    v_cvt_pk_bf16_f32 v176, v76, v84
    v_cvt_pk_bf16_f32 v180, v77, v85
    v_cvt_pk_bf16_f32 v184, v78, v86
    v_cvt_pk_bf16_f32 v188, v79, v87
    v_cvt_pk_bf16_f32 v192, v80, v88
    v_cvt_pk_bf16_f32 v196, v81, v89
    v_cvt_pk_bf16_f32 v200, v82, v90
    v_cvt_pk_bf16_f32 v204, v83, v91
    s_add_u32 m0, s89, 40960
    s_nop 0
    buffer_load_dwordx4 v17, s[32:35], 0 offen  lds
    s_waitcnt lgkmcnt(3)
    v_mfma_f32_32x32x16_bf16 v[28:43], v[48:51], v[64:67], v[28:43]
    ds_read_b128 v[72:75], v11 offset:0
    ds_read_b64_tr_b16 v[56:57], v12 offset:6144
    ds_read_b64_tr_b16 v[58:59], v12 offset:6656
    ds_read_b64 v[124:125], v13 offset:0
    ds_read_b64 v[18:19], v26 offset:56
    s_add_u32 m0, s89, 98304
    s_add_u32 s60, s60, s61
    s_sub_u32 s93, s60, 851968
    s_min_u32 s60, s60, s93
    buffer_load_dwordx4 v2, s[40:43], s60 offen lds
    s_waitcnt lgkmcnt(5)
    v_mfma_f32_32x32x16_bf16 v[28:43], v[52:55], v[68:71], v[28:43]
    s_add_u32 m0, s89, 106496
    s_add_u32 s60, s60, s61
    s_sub_u32 s93, s60, 851968
    s_min_u32 s60, s60, s93
    buffer_load_dwordx4 v2, s[40:43], s60 offen lds
    s_waitcnt lgkmcnt(0)
    v_lshl_add_u32 v18, v18, 7, v3
    v_lshl_add_u32 v19, v19, 7, v3
    s_waitcnt vmcnt(4)
    s_barrier
    ds_read_b128 v[60:63], v8 offset:16384
    ds_read_b64_tr_b16 v[44:45], v12 offset:16384
    ds_read_b64_tr_b16 v[46:47], v12 offset:16896
    v_mfma_f32_32x32x16_bf16 v[28:43], v[56:59], v[72:75], v[28:43]
    ds_read_b128 v[64:67], v9 offset:16384
    ds_read_b64_tr_b16 v[48:49], v12 offset:18432
    ds_read_b64_tr_b16 v[50:51], v12 offset:18944
    s_add_u32 m0, s89, 49152
    s_nop 0
    buffer_load_dwordx4 v18, s[32:35], 0 offen  lds
    s_waitcnt lgkmcnt(3)
    v_mfma_f32_32x32x16_bf16 v[76:91], v[100:103], v[60:63], 0
    v_mfma_f32_32x32x16_bf16 v[28:43], v[44:47], v[60:63], v[28:43]
    ds_read_b128 v[68:71], v10 offset:16384
    ds_read_b64_tr_b16 v[52:53], v12 offset:20480
    ds_read_b64_tr_b16 v[54:55], v12 offset:20992
    s_add_u32 m0, s89, 57344
    s_nop 0
    buffer_load_dwordx4 v19, s[32:35], 0 offen  lds
    s_waitcnt lgkmcnt(3)
    v_mfma_f32_32x32x16_bf16 v[76:91], v[104:107], v[64:67], v[76:91]
    v_mfma_f32_32x32x16_bf16 v[28:43], v[48:51], v[64:67], v[28:43]
    ds_read_b128 v[72:75], v11 offset:16384
    ds_read_b64_tr_b16 v[56:57], v12 offset:22528
    ds_read_b64_tr_b16 v[58:59], v12 offset:23040
    ds_read_b64 v[126:127], v13 offset:16384
    ds_read_b64 v[16:17], v26 offset:64
    s_add_u32 m0, s89, 114688
    s_add_u32 s60, s60, s61
    s_sub_u32 s93, s60, 851968
    s_min_u32 s60, s60, s93
    buffer_load_dwordx4 v2, s[40:43], s60 offen lds
    s_waitcnt lgkmcnt(5)
    v_mfma_f32_32x32x16_bf16 v[76:91], v[108:111], v[68:71], v[76:91]
    v_mfma_f32_32x32x16_bf16 v[28:43], v[52:55], v[68:71], v[28:43]
    s_add_u32 m0, s89, 122880
    s_add_u32 s60, s60, s61
    s_sub_u32 s93, s60, 851968
    s_min_u32 s60, s60, s93
    buffer_load_dwordx4 v2, s[40:43], s60 offen lds
    s_waitcnt lgkmcnt(0)
    v_lshl_add_u32 v16, v16, 7, v3
    v_lshl_add_u32 v17, v17, 7, v3
    s_waitcnt vmcnt(4)
    s_barrier
    ds_read_b128 v[60:63], v8 offset:32768
    ds_read_b64_tr_b16 v[44:45], v12 offset:32768
    ds_read_b64_tr_b16 v[46:47], v12 offset:33280
    v_mfma_f32_32x32x16_bf16 v[76:91], v[112:115], v[72:75], v[76:91]
    v_mfma_f32_32x32x16_bf16 v[28:43], v[56:59], v[72:75], v[28:43]
    ds_read_b128 v[64:67], v9 offset:32768
    ds_read_b64_tr_b16 v[48:49], v12 offset:34816
    ds_read_b64_tr_b16 v[50:51], v12 offset:35328
    s_add_u32 m0, s89, 0
    s_nop 0
    buffer_load_dwordx4 v16, s[32:35], 0 offen  lds
    s_waitcnt lgkmcnt(3)
    v_mfma_f32_32x32x16_bf16 v[28:43], v[44:47], v[60:63], v[28:43]
    ds_read_b128 v[68:71], v10 offset:32768
    ds_read_b64_tr_b16 v[52:53], v12 offset:36864
    ds_read_b64_tr_b16 v[54:55], v12 offset:37376
    v_mov_b32 v213, v84
    s_add_u32 m0, s89, 8192
    s_nop 0
    buffer_load_dwordx4 v17, s[32:35], 0 offen  lds
    s_waitcnt lgkmcnt(3)
    v_mfma_f32_32x32x16_bf16 v[28:43], v[48:51], v[64:67], v[28:43]
    ds_read_b128 v[72:75], v11 offset:32768
    ds_read_b64_tr_b16 v[56:57], v12 offset:38912
    ds_read_b64_tr_b16 v[58:59], v12 offset:39424
    ds_read_b64 v[128:129], v13 offset:32768
    ds_read_b64 v[18:19], v26 offset:72
    s_add_u32 m0, s89, 65536
    s_add_u32 s60, s60, s61
    s_sub_u32 s93, s60, 851968
    s_min_u32 s60, s60, s93
    buffer_load_dwordx4 v2, s[40:43], s60 offen lds
    s_waitcnt lgkmcnt(5)
    v_mfma_f32_32x32x16_bf16 v[28:43], v[52:55], v[68:71], v[28:43]
    s_add_u32 m0, s89, 73728
    s_add_u32 s60, s60, s61
    s_sub_u32 s93, s60, 851968
    s_min_u32 s60, s60, s93
    buffer_load_dwordx4 v2, s[40:43], s60 offen lds
    s_waitcnt lgkmcnt(0)
    v_lshl_add_u32 v18, v18, 7, v3
    v_lshl_add_u32 v19, v19, 7, v3
    s_waitcnt vmcnt(4)
    s_barrier
    ds_read_b128 v[60:63], v8 offset:49152
    ds_read_b64_tr_b16 v[44:45], v12 offset:49152
    ds_read_b64_tr_b16 v[46:47], v12 offset:49664
    v_mfma_f32_32x32x16_bf16 v[28:43], v[56:59], v[72:75], v[28:43]
    ds_read_b128 v[64:67], v9 offset:49152
    ds_read_b64_tr_b16 v[48:49], v12 offset:51200
    ds_read_b64_tr_b16 v[50:51], v12 offset:51712
    s_add_u32 m0, s89, 16384
    s_nop 0
    buffer_load_dwordx4 v18, s[32:35], 0 offen  lds
    s_waitcnt lgkmcnt(3)
    v_mfma_f32_32x32x16_bf16 v[84:99], v[100:103], v[60:63], 0
    v_mfma_f32_32x32x16_bf16 v[28:43], v[44:47], v[60:63], v[28:43]
    ds_read_b128 v[68:71], v10 offset:49152
    ds_read_b64_tr_b16 v[52:53], v12 offset:53248
    ds_read_b64_tr_b16 v[54:55], v12 offset:53760
    s_add_u32 m0, s89, 24576
    s_nop 0
    buffer_load_dwordx4 v19, s[32:35], 0 offen  lds
    s_waitcnt lgkmcnt(3)
    v_mfma_f32_32x32x16_bf16 v[84:99], v[104:107], v[64:67], v[84:99]
    v_mfma_f32_32x32x16_bf16 v[28:43], v[48:51], v[64:67], v[28:43]
    ds_read_b128 v[72:75], v11 offset:49152
    ds_read_b64_tr_b16 v[56:57], v12 offset:55296
    ds_read_b64_tr_b16 v[58:59], v12 offset:55808
    ds_read_b64 v[130:131], v13 offset:49152
    ds_read_b64 v[16:17], v26 offset:80
    s_add_u32 m0, s89, 81920
    s_add_u32 s60, s60, s61
    s_sub_u32 s93, s60, 851968
    s_min_u32 s60, s60, s93
    buffer_load_dwordx4 v2, s[40:43], s60 offen lds
    s_waitcnt lgkmcnt(5)
    v_mfma_f32_32x32x16_bf16 v[84:99], v[108:111], v[68:71], v[84:99]
    v_mfma_f32_32x32x16_bf16 v[28:43], v[52:55], v[68:71], v[28:43]
    s_add_u32 m0, s89, 90112
    s_add_u32 s60, s60, s61
    s_sub_u32 s93, s60, 851968
    s_min_u32 s60, s60, s93
    buffer_load_dwordx4 v2, s[40:43], s60 offen lds
    s_waitcnt lgkmcnt(0)
    v_lshl_add_u32 v16, v16, 7, v3
    v_lshl_add_u32 v17, v17, 7, v3
    s_waitcnt vmcnt(4)
    s_barrier
    ds_read_b128 v[60:63], v8 offset:0
    ds_read_b64_tr_b16 v[44:45], v12 offset:0
    ds_read_b64_tr_b16 v[46:47], v12 offset:512
    v_mfma_f32_32x32x16_bf16 v[84:99], v[112:115], v[72:75], v[84:99]
    v_mfma_f32_32x32x16_bf16 v[28:43], v[56:59], v[72:75], v[28:43]
    ds_read_b128 v[64:67], v9 offset:0
    ds_read_b64_tr_b16 v[48:49], v12 offset:2048
    ds_read_b64_tr_b16 v[50:51], v12 offset:2560
    s_add_u32 m0, s89, 32768
    s_nop 0
    buffer_load_dwordx4 v16, s[32:35], 0 offen  lds
    s_waitcnt lgkmcnt(3)
    v_mfma_f32_32x32x16_bf16 v[28:43], v[44:47], v[60:63], v[28:43]
    ds_read_b128 v[68:71], v10 offset:0
    ds_read_b64_tr_b16 v[52:53], v12 offset:4096
    ds_read_b64_tr_b16 v[54:55], v12 offset:4608
    v_cvt_pk_bf16_f32 v209, v213, v92
    v_cvt_pk_bf16_f32 v177, v76, v84
    v_cvt_pk_bf16_f32 v181, v77, v85
    v_cvt_pk_bf16_f32 v185, v78, v86
    v_cvt_pk_bf16_f32 v189, v79, v87
    v_cvt_pk_bf16_f32 v193, v80, v88
    v_cvt_pk_bf16_f32 v197, v81, v89
    v_cvt_pk_bf16_f32 v201, v82, v90
    v_cvt_pk_bf16_f32 v205, v83, v91
    s_add_u32 m0, s89, 40960
    s_nop 0
    buffer_load_dwordx4 v17, s[32:35], 0 offen  lds
    s_waitcnt lgkmcnt(3)
    v_mfma_f32_32x32x16_bf16 v[28:43], v[48:51], v[64:67], v[28:43]
    ds_read_b128 v[72:75], v11 offset:0
    ds_read_b64_tr_b16 v[56:57], v12 offset:6144
    ds_read_b64_tr_b16 v[58:59], v12 offset:6656
    ds_read_b64 v[132:133], v13 offset:0
    ds_read_b64 v[18:19], v26 offset:88
    s_add_u32 m0, s89, 98304
    s_add_u32 s60, s60, s61
    s_sub_u32 s93, s60, 851968
    s_min_u32 s60, s60, s93
    buffer_load_dwordx4 v2, s[40:43], s60 offen lds
    s_waitcnt lgkmcnt(5)
    v_mfma_f32_32x32x16_bf16 v[28:43], v[52:55], v[68:71], v[28:43]
    s_add_u32 m0, s89, 106496
    s_add_u32 s60, s60, s61
    s_sub_u32 s93, s60, 851968
    s_min_u32 s60, s60, s93
    buffer_load_dwordx4 v2, s[40:43], s60 offen lds
    s_waitcnt lgkmcnt(0)
    v_lshl_add_u32 v18, v18, 7, v3
    v_lshl_add_u32 v19, v19, 7, v3
    s_waitcnt vmcnt(4)
    s_barrier
    ds_read_b128 v[60:63], v8 offset:16384
    ds_read_b64_tr_b16 v[44:45], v12 offset:16384
    ds_read_b64_tr_b16 v[46:47], v12 offset:16896
    v_mfma_f32_32x32x16_bf16 v[28:43], v[56:59], v[72:75], v[28:43]
    ds_read_b128 v[64:67], v9 offset:16384
    ds_read_b64_tr_b16 v[48:49], v12 offset:18432
    ds_read_b64_tr_b16 v[50:51], v12 offset:18944
    s_add_u32 m0, s89, 49152
    s_nop 0
    buffer_load_dwordx4 v18, s[32:35], 0 offen  lds
    s_waitcnt lgkmcnt(3)
    v_mfma_f32_32x32x16_bf16 v[76:91], v[100:103], v[60:63], 0
    v_mfma_f32_32x32x16_bf16 v[28:43], v[44:47], v[60:63], v[28:43]
    ds_read_b128 v[68:71], v10 offset:16384
    ds_read_b64_tr_b16 v[52:53], v12 offset:20480
    ds_read_b64_tr_b16 v[54:55], v12 offset:20992
    s_add_u32 m0, s89, 57344
    s_nop 0
    buffer_load_dwordx4 v19, s[32:35], 0 offen  lds
    s_waitcnt lgkmcnt(3)
    v_mfma_f32_32x32x16_bf16 v[76:91], v[104:107], v[64:67], v[76:91]
    v_mfma_f32_32x32x16_bf16 v[28:43], v[48:51], v[64:67], v[28:43]
    ds_read_b128 v[72:75], v11 offset:16384
    ds_read_b64_tr_b16 v[56:57], v12 offset:22528
    ds_read_b64_tr_b16 v[58:59], v12 offset:23040
    ds_read_b64 v[134:135], v13 offset:16384
    ds_read_b64 v[16:17], v26 offset:96
    s_add_u32 m0, s89, 114688
    s_add_u32 s60, s60, s61
    s_sub_u32 s93, s60, 851968
    s_min_u32 s60, s60, s93
    buffer_load_dwordx4 v2, s[40:43], s60 offen lds
    s_waitcnt lgkmcnt(5)
    v_mfma_f32_32x32x16_bf16 v[76:91], v[108:111], v[68:71], v[76:91]
    v_mfma_f32_32x32x16_bf16 v[28:43], v[52:55], v[68:71], v[28:43]
    s_add_u32 m0, s89, 122880
    s_add_u32 s60, s60, s61
    s_sub_u32 s93, s60, 851968
    s_min_u32 s60, s60, s93
    buffer_load_dwordx4 v2, s[40:43], s60 offen lds
    s_waitcnt lgkmcnt(0)
    v_lshl_add_u32 v16, v16, 7, v3
    v_lshl_add_u32 v17, v17, 7, v3
    s_waitcnt vmcnt(4)
    s_barrier
    ds_read_b128 v[60:63], v8 offset:32768
    ds_read_b64_tr_b16 v[44:45], v12 offset:32768
    ds_read_b64_tr_b16 v[46:47], v12 offset:33280
    v_mfma_f32_32x32x16_bf16 v[76:91], v[112:115], v[72:75], v[76:91]
    v_mfma_f32_32x32x16_bf16 v[28:43], v[56:59], v[72:75], v[28:43]
    ds_read_b128 v[64:67], v9 offset:32768
    ds_read_b64_tr_b16 v[48:49], v12 offset:34816
    ds_read_b64_tr_b16 v[50:51], v12 offset:35328
    s_add_u32 m0, s89, 0
    s_nop 0
    buffer_load_dwordx4 v16, s[32:35], 0 offen  lds
    s_waitcnt lgkmcnt(3)
    v_mfma_f32_32x32x16_bf16 v[28:43], v[44:47], v[60:63], v[28:43]
    ds_read_b128 v[68:71], v10 offset:32768
    ds_read_b64_tr_b16 v[52:53], v12 offset:36864
    ds_read_b64_tr_b16 v[54:55], v12 offset:37376
    v_mov_b32 v213, v84
    s_add_u32 m0, s89, 8192
    s_nop 0
    buffer_load_dwordx4 v17, s[32:35], 0 offen  lds
    s_waitcnt lgkmcnt(3)
    v_mfma_f32_32x32x16_bf16 v[28:43], v[48:51], v[64:67], v[28:43]
    ds_read_b128 v[72:75], v11 offset:32768
    ds_read_b64_tr_b16 v[56:57], v12 offset:38912
    ds_read_b64_tr_b16 v[58:59], v12 offset:39424
    ds_read_b64 v[136:137], v13 offset:32768
    s_add_u32 m0, s89, 65536
    s_add_u32 s60, s60, s61
    s_sub_u32 s93, s60, 851968
    s_min_u32 s60, s60, s93
    buffer_load_dwordx4 v2, s[40:43], s60 offen lds
    s_waitcnt lgkmcnt(4)
    v_mfma_f32_32x32x16_bf16 v[28:43], v[52:55], v[68:71], v[28:43]
    s_add_u32 m0, s89, 73728
    s_add_u32 s60, s60, s61
    s_sub_u32 s93, s60, 851968
    s_min_u32 s60, s60, s93
    buffer_load_dwordx4 v2, s[40:43], s60 offen lds
    s_waitcnt vmcnt(4)
    s_barrier
    ds_read_b128 v[60:63], v8 offset:49152
    ds_read_b64_tr_b16 v[44:45], v12 offset:49152
    ds_read_b64_tr_b16 v[46:47], v12 offset:49664
    s_waitcnt lgkmcnt(4)
    v_mfma_f32_32x32x16_bf16 v[28:43], v[56:59], v[72:75], v[28:43]
    ds_read_b128 v[64:67], v9 offset:49152
    ds_read_b64_tr_b16 v[48:49], v12 offset:51200
    ds_read_b64_tr_b16 v[50:51], v12 offset:51712
    s_add_u32 m0, s89, 16384
    s_nop 0
    buffer_load_dwordx4 v7, s[36:39], s28 offen lds
    s_waitcnt lgkmcnt(3)
    v_mfma_f32_32x32x16_bf16 v[84:99], v[100:103], v[60:63], 0
    v_mfma_f32_32x32x16_bf16 v[28:43], v[44:47], v[60:63], v[28:43]
    ds_read_b128 v[68:71], v10 offset:49152
    ds_read_b64_tr_b16 v[52:53], v12 offset:53248
    ds_read_b64_tr_b16 v[54:55], v12 offset:53760
    s_lshl_b32 s91, s86, 11
    s_add_u32 s91, s91, 81920
    v_lshl_add_u32 v16, v1, 4, s91
    v_xor_b32 v17, 8192, v16
    v_lshrrev_b32 v250, 4, v1
    s_and_b32 s92, s86, 3
    s_lshl_b32 s92, s92, 8
    v_lshl_add_u32 v250, v250, 10, s92
    v_and_b32 v251, 15, v1
    v_lshl_add_u32 v18, v251, 4, v250
    s_and_b32 s91, s86, 2
    s_lshl_b32 s91, s91, 6
    s_lshr_b32 s92, s86, 2
    s_lshl_b32 s93, s92, 6
    s_add_u32 s91, s91, s93
    s_add_u32 s91, s91, 47104
    v_lshrrev_b32 v250, 5, v1
    v_lshl_add_u32 v19, v250, 4, s91
    s_lshl_b32 s91, s92, 12
    s_add_u32 s91, s91, 98304
    v_add_u32 v26, s91, v18
    s_waitcnt lgkmcnt(3)
    v_mfma_f32_32x32x16_bf16 v[84:99], v[104:107], v[64:67], v[84:99]
    v_mfma_f32_32x32x16_bf16 v[28:43], v[48:51], v[64:67], v[28:43]
    ds_read_b128 v[72:75], v11 offset:49152
    ds_read_b64_tr_b16 v[56:57], v12 offset:55296
    ds_read_b64_tr_b16 v[58:59], v12 offset:55808
    ds_read_b64 v[138:139], v13 offset:49152
    v_lshrrev_b32 v250, 5, v1
    v_and_b32 v251, 31, v1
    s_and_b32 s91, s86, 1
    s_lshl_b32 s92, s91, 9
    s_add_u32 s92, s92, 98304
    v_lshl_add_u32 v252, v250, 12, s92
    v_lshl_add_u32 v3, v251, 4, v252
    s_lshl_b32 s91, s91, 10
    s_lshr_b32 s92, s86, 1
    s_lshl_b32 s92, s92, 3
    s_add_u32 s91, s91, s92
    s_add_u32 s91, s91, 131072
    v_lshl_add_u32 v252, v250, 2, s91
    v_lshl_add_u32 v2, v251, 5, v252
    v_lshlrev_b32 v253, 2, v1
    v_add_u32 v253, 47104, v253
    s_waitcnt lgkmcnt(4)
    v_mfma_f32_32x32x16_bf16 v[84:99], v[108:111], v[68:71], v[84:99]
    v_mfma_f32_32x32x16_bf16 v[28:43], v[52:55], v[68:71], v[28:43]
    s_add_u32 m0, s89, 24576
    s_nop 0
    buffer_load_dwordx4 v7, s[36:39], s29 offen lds
    s_waitcnt vmcnt(2) lgkmcnt(0)
    s_barrier
    ds_read_b128 v[60:63], v8 offset:0
    ds_read_b64_tr_b16 v[44:45], v12 offset:0
    ds_read_b64_tr_b16 v[46:47], v12 offset:512
    v_mfma_f32_32x32x16_bf16 v[84:99], v[112:115], v[72:75], v[84:99]
    v_mfma_f32_32x32x16_bf16 v[28:43], v[56:59], v[72:75], v[28:43]
    ds_read_b128 v[64:67], v9 offset:0
    ds_read_b64_tr_b16 v[48:49], v12 offset:2048
    ds_read_b64_tr_b16 v[50:51], v12 offset:2560
    s_add_u32 m0, s89, 32768
    s_nop 0
    buffer_load_dwordx4 v7, s[36:39], s30 offen lds
    s_waitcnt lgkmcnt(3)
    v_mfma_f32_32x32x16_bf16 v[28:43], v[44:47], v[60:63], v[28:43]
    ds_read_b128 v[68:71], v10 offset:0
    ds_read_b64_tr_b16 v[52:53], v12 offset:4096
    ds_read_b64_tr_b16 v[54:55], v12 offset:4608
    s_lshr_b32 s91, s86, 1
    s_cmp_lg_u32 s91, 0
    s_cbranch_scc1 L_wc6
    s_add_u32 m0, s89, 40960
    buffer_load_dwordx4 v7, s[36:39], s31 offen lds
L_wc6:
    ds_read_b128 v[72:75], v11 offset:0
    ds_read_b64_tr_b16 v[56:57], v12 offset:6144
    ds_read_b64_tr_b16 v[58:59], v12 offset:6656
    ds_read_b64 v[140:141], v13 offset:0
    v_cvt_pk_bf16_f32 v210, v213, v92
    v_cvt_pk_bf16_f32 v178, v76, v84
    v_cvt_pk_bf16_f32 v182, v77, v85
    v_cvt_pk_bf16_f32 v186, v78, v86
    v_cvt_pk_bf16_f32 v190, v79, v87
    v_cvt_pk_bf16_f32 v194, v80, v88
    v_cvt_pk_bf16_f32 v198, v81, v89
    v_cvt_pk_bf16_f32 v202, v82, v90
    v_cvt_pk_bf16_f32 v206, v83, v91
    ds_write_b128 v27, v[208:211]
    ds_write_b32 v253, v212
    s_waitcnt lgkmcnt(9)
    v_mfma_f32_32x32x16_bf16 v[28:43], v[48:51], v[64:67], v[28:43]
    ds_write_b128 v14, v[176:179] offset:0
    ds_write_b128 v14, v[180:183] offset:4096
    s_waitcnt lgkmcnt(8)
    v_mfma_f32_32x32x16_bf16 v[28:43], v[52:55], v[68:71], v[28:43]
    ds_write_b128 v14, v[184:187] offset:8192
    ds_write_b128 v14, v[188:191] offset:12288
    s_waitcnt lgkmcnt(7)
    v_mfma_f32_32x32x16_bf16 v[28:43], v[56:59], v[72:75], v[28:43]
    ds_write_b128 v15, v[192:195] offset:0
    ds_write_b128 v15, v[196:199] offset:4096
    ds_write_b128 v15, v[200:203] offset:8192
    ds_write_b128 v15, v[204:207] offset:12288
    s_nop 7
    ds_write_b128 v16, v[36:39] offset:0
    ds_write_b128 v16, v[40:43] offset:1024
    s_waitcnt lgkmcnt(0)
    s_barrier
    ds_read_b128 v[240:243], v18 offset:43008
    ds_read_b128 v[36:39], v17 offset:0
    ds_read_b128 v[40:43], v17 offset:1024
    s_add_u32 m0, s89, 0
    s_add_u32 s91, s28, 86528
    buffer_load_dwordx4 v7, s[36:39], s91 offen lds
    s_waitcnt lgkmcnt(2)
    v_mfma_f32_16x16x32_bf16 v[244:247], v[20:23], v[240:243], 0
    ds_read_b128 v[108:111], v19 offset:0
    ds_read_b128 v[112:115], v19 offset:32
    s_add_u32 m0, s89, 8192
    s_add_u32 s91, s29, 86528
    buffer_load_dwordx4 v7, s[36:39], s91 offen lds
    s_nop 2
    v_pk_mul_f32 v[248:249], v[244:245], v[244:245]
    v_pk_mul_f32 v[250:251], v[246:247], v[246:247]
    ds_read_b128 v[148:151], v4 offset:1024
    v_pk_fma_f32 v[248:249], v[248:249], v[142:143], v[142:143] op_sel:[0,0,1] op_sel_hi:[1,0,1]
    v_pk_fma_f32 v[250:251], v[250:251], v[142:143], v[142:143] op_sel:[0,0,1] op_sel_hi:[1,0,1]
    v_pk_mul_f32 v[248:249], v[248:249], v[244:245]
    v_pk_mul_f32 v[250:251], v[250:251], v[246:247]
    v_exp_f32 v248, v248
    v_exp_f32 v249, v249
    ds_read_b128 v[156:159], v4 offset:5120
    v_exp_f32 v250, v250
    v_exp_f32 v251, v251
    v_pk_add_f32 v[248:249], v[248:249], 1.0 op_sel_hi:[1,0]
    v_pk_add_f32 v[250:251], v[250:251], 1.0 op_sel_hi:[1,0]
    v_rcp_f32 v248, v248
    v_rcp_f32 v249, v249
    v_rcp_f32 v250, v250
    v_rcp_f32 v251, v251
    v_pk_mul_f32 v[248:249], v[248:249], v[244:245]
    v_pk_mul_f32 v[250:251], v[250:251], v[246:247]
    v_cvt_pk_bf16_f32 v240, v248, v249
    v_cvt_pk_bf16_f32 v241, v250, v251
    s_add_u32 m0, s89, 65536
    s_add_u32 s91, s30, 86528
    buffer_load_dwordx4 v7, s[36:39], s91 offen lds
    v_mfma_f32_16x16x16_bf16 v[244:247], v[24:25], v[240:241], 0
    s_lshr_b32 s91, s86, 1
    s_cmp_lg_u32 s91, 1
    s_cbranch_scc1 L_wc7
    s_add_u32 m0, s89, 71680
    s_add_u32 s91, s31, 86528
    buffer_load_dwordx4 v7, s[36:39], s91 offen lds
L_wc7:
    s_mov_b32 s92, 0xbfb8aa3b
    s_mov_b32 s93, 0xbfb8aa3b
    s_waitcnt lgkmcnt(2)
    v_pk_add_f32 v[28:29], v[28:29], v[36:37]
    ds_read_b128 v[164:167], v4 offset:9216
    v_pk_add_f32 v[30:31], v[30:31], v[38:39]
    v_pk_add_f32 v[32:33], v[32:33], v[40:41]
    v_pk_add_f32 v[34:35], v[34:35], v[42:43]
    v_pk_mul_f32 v[248:249], v[244:245], s[92:93]
    v_pk_mul_f32 v[250:251], v[246:247], s[92:93]
    v_exp_f32 v248, v248
    ds_read_b128 v[172:175], v4 offset:13312
    v_exp_f32 v249, v249
    v_exp_f32 v250, v250
    v_exp_f32 v251, v251
    v_pk_add_f32 v[248:249], v[248:249], 1.0 op_sel_hi:[1,0]
    v_pk_add_f32 v[250:251], v[250:251], 1.0 op_sel_hi:[1,0]
    v_rcp_f32 v248, v248
    v_rcp_f32 v249, v249
    v_rcp_f32 v250, v250
    v_rcp_f32 v251, v251
    v_cvt_pk_bf16_f32 v240, v248, v249
    v_cvt_pk_bf16_f32 v241, v250, v251
    v_and_b32 v242, 0xffff, v240
    v_lshrrev_b32 v243, 16, v240
    v_lshlrev_b32 v248, 16, v240
    v_and_b32 v249, 0xffff0000, v240
    v_lshlrev_b32 v250, 16, v241
    v_and_b32 v251, 0xffff0000, v241
    ds_write_b64 v26, v[242:243] offset:8192
    ds_write_b128 v26, v[248:251]
    v_pk_mul_f32 v[36:37], v[28:29], v[28:29]
    v_pk_mul_f32 v[38:39], v[30:31], v[30:31]
    v_pk_mul_f32 v[40:41], v[32:33], v[32:33]
    v_pk_mul_f32 v[42:43], v[34:35], v[34:35]
    v_pk_fma_f32 v[36:37], v[36:37], v[142:143], v[142:143] op_sel:[0,0,1] op_sel_hi:[1,0,1]
    v_pk_fma_f32 v[38:39], v[38:39], v[142:143], v[142:143] op_sel:[0,0,1] op_sel_hi:[1,0,1]
    v_pk_fma_f32 v[40:41], v[40:41], v[142:143], v[142:143] op_sel:[0,0,1] op_sel_hi:[1,0,1]
    v_pk_fma_f32 v[42:43], v[42:43], v[142:143], v[142:143] op_sel:[0,0,1] op_sel_hi:[1,0,1]
    v_pk_mul_f32 v[36:37], v[36:37], v[28:29]
    v_pk_mul_f32 v[38:39], v[38:39], v[30:31]
    v_pk_mul_f32 v[40:41], v[40:41], v[32:33]
    v_pk_mul_f32 v[42:43], v[42:43], v[34:35]
    v_pk_mul_f32 v[108:109], v[108:109], v[28:29]
    v_pk_mul_f32 v[110:111], v[110:111], v[30:31]
    v_pk_mul_f32 v[112:113], v[112:113], v[32:33]
    v_pk_mul_f32 v[114:115], v[114:115], v[34:35]
L_tail:
    s_waitcnt vmcnt(3) lgkmcnt(0)
    s_barrier
    ds_read_b64 v[28:29], v3 offset:8192
    ds_read_b128 v[8:11], v3 offset:0
    ds_read_b64 v[30:31], v3 offset:9216
    v_exp_f32 v36, v36
    v_exp_f32 v37, v37
    ds_read_b128 v[12:15], v3 offset:1024
    v_exp_f32 v38, v38
    v_exp_f32 v39, v39
    ds_read_b64 v[32:33], v3 offset:10240
    v_exp_f32 v40, v40
    v_exp_f32 v41, v41
    ds_read_b128 v[16:19], v3 offset:2048
    v_exp_f32 v42, v42
    v_exp_f32 v43, v43
    ds_read_b64 v[34:35], v3 offset:11264
    v_mov_b32 v215, 0
    v_mov_b32 v223, 0
    ds_read_b128 v[20:23], v3 offset:3072
    v_mov_b32 v231, 0
    v_mov_b32 v239, 0
    v_add_u32 v7, 65536, v5
    ds_read_b128 v[144:147], v4 offset:0
    s_waitcnt lgkmcnt(7)
    v_dot2_f32_bf16 v62, v148, v29, 0
    v_dot2_f32_bf16 v63, v148, v11, 0
    s_waitcnt lgkmcnt(5)
    ds_read_b128 v[152:155], v4 offset:4096
    v_dot2_f32_bf16 v66, v149, v31, 0
    v_dot2_f32_bf16 v67, v149, v15, 0
    s_waitcnt lgkmcnt(4)
    v_dot2_f32_bf16 v70, v150, v33, 0
    ds_read_b128 v[160:163], v4 offset:8192
    v_dot2_f32_bf16 v71, v150, v19, 0
    v_dot2_f32_bf16 v78, v156, v29, 0
    v_dot2_f32_bf16 v79, v156, v11, 0
    ds_read_b128 v[168:171], v4 offset:12288
    v_dot2_f32_bf16 v82, v157, v31, 0
    v_dot2_f32_bf16 v83, v157, v15, 0
    ds_read_b64 v[44:45], v5 offset:16384
    v_dot2_f32_bf16 v86, v158, v33, 0
    v_dot2_f32_bf16 v87, v158, v19, 0
    s_waitcnt lgkmcnt(4)
    ds_read_b64 v[46:47], v5 offset:20480
    v_dot2_f32_bf16 v60, v144, v28, 0
    v_dot2_f32_bf16 v61, v144, v10, 0
    v_dot2_f32_bf16 v64, v145, v30, 0
    ds_read_b64 v[48:49], v5 offset:24576
    v_dot2_f32_bf16 v65, v145, v14, 0
    v_dot2_f32_bf16 v68, v146, v32, 0
    v_dot2_f32_bf16 v69, v146, v18, 0
    ds_read_b64 v[50:51], v5 offset:28672
    v_dot2_f32_bf16 v72, v147, v34, 0
    s_waitcnt lgkmcnt(6)
    ds_read_b64 v[52:53], v5 offset:32768
    v_dot2_f32_bf16 v76, v152, v28, 0
    v_dot2_f32_bf16 v77, v152, v10, 0
    v_dot2_f32_bf16 v80, v153, v30, 0
    ds_read_b64 v[54:55], v5 offset:36864
    v_dot2_f32_bf16 v81, v153, v14, 0
    v_dot2_f32_bf16 v84, v154, v32, 0
    v_dot2_f32_bf16 v85, v154, v18, 0
    ds_read_b64 v[56:57], v5 offset:40960
    v_dot2_f32_bf16 v88, v155, v34, 0
    v_cvt_pk_bf16_f32 v212, v62, v63
    v_cvt_pk_bf16_f32 v213, v66, v67
    ds_read_b64 v[240:241], v5 offset:18432
    v_cvt_pk_bf16_f32 v214, v70, v71
    v_cvt_pk_bf16_f32 v208, v60, v61
    v_cvt_pk_bf16_f32 v209, v64, v65
    v_cvt_pk_bf16_f32 v210, v68, v69
    ds_read_b64 v[242:243], v5 offset:22528
    v_cvt_pk_bf16_f32 v211, v72, 0
    v_cvt_pk_bf16_f32 v220, v78, v79
    v_cvt_pk_bf16_f32 v221, v82, v83
    v_cvt_pk_bf16_f32 v222, v86, v87
    ds_read_b64 v[244:245], v5 offset:26624
    v_cvt_pk_bf16_f32 v216, v76, v77
    v_cvt_pk_bf16_f32 v217, v80, v81
    v_cvt_pk_bf16_f32 v218, v84, v85
    v_cvt_pk_bf16_f32 v219, v88, 0
    ds_read_b64 v[246:247], v5 offset:30720
    v_dot2_f32_bf16 v62, v164, v29, 0
    v_dot2_f32_bf16 v63, v164, v11, 0
    ds_read_b64 v[248:249], v5 offset:34816
    v_dot2_f32_bf16 v66, v165, v31, 0
    v_dot2_f32_bf16 v67, v165, v15, 0
    v_dot2_f32_bf16 v70, v166, v33, 0
    ds_read_b64 v[250:251], v5 offset:38912
    v_dot2_f32_bf16 v71, v166, v19, 0
    v_dot2_f32_bf16 v78, v172, v29, 0
    v_dot2_f32_bf16 v79, v172, v11, 0
    v_dot2_f32_bf16 v82, v173, v31, 0
    v_dot2_f32_bf16 v83, v173, v15, 0
    v_dot2_f32_bf16 v86, v174, v33, 0
    v_dot2_f32_bf16 v87, v174, v19, 0
    s_waitcnt lgkmcnt(14)
    v_dot2_f32_bf16 v60, v160, v28, 0
    v_dot2_f32_bf16 v61, v160, v10, 0
    v_dot2_f32_bf16 v64, v161, v30, 0
    v_dot2_f32_bf16 v65, v161, v14, 0
    v_dot2_f32_bf16 v68, v162, v32, 0
    v_dot2_f32_bf16 v69, v162, v18, 0
    v_dot2_f32_bf16 v72, v163, v34, 0
    s_waitcnt lgkmcnt(13)
    v_dot2_f32_bf16 v76, v168, v28, 0
    v_dot2_f32_bf16 v77, v168, v10, 0
    v_dot2_f32_bf16 v80, v169, v30, 0
    v_dot2_f32_bf16 v81, v169, v14, 0
    v_dot2_f32_bf16 v84, v170, v32, 0
    v_dot2_f32_bf16 v85, v170, v18, 0
    v_dot2_f32_bf16 v88, v171, v34, 0
    v_cvt_pk_bf16_f32 v228, v62, v63
    v_cvt_pk_bf16_f32 v229, v66, v67
    v_cvt_pk_bf16_f32 v230, v70, v71
    v_cvt_pk_bf16_f32 v224, v60, v61
    v_cvt_pk_bf16_f32 v225, v64, v65
    v_cvt_pk_bf16_f32 v226, v68, v69
    v_cvt_pk_bf16_f32 v227, v72, 0
    v_cvt_pk_bf16_f32 v236, v78, v79
    v_cvt_pk_bf16_f32 v237, v82, v83
    v_cvt_pk_bf16_f32 v238, v86, v87
    v_cvt_pk_bf16_f32 v232, v76, v77
    v_cvt_pk_bf16_f32 v233, v80, v81
    v_cvt_pk_bf16_f32 v234, v84, v85
    v_cvt_pk_bf16_f32 v235, v88, 0
    s_waitcnt vmcnt(0)
    s_barrier
    ds_read_b64 v[28:29], v5 offset:0
    s_waitcnt lgkmcnt(12)
    v_perm_b32 v176, v46, v44, s94
    v_perm_b32 v184, v46, v44, s95
    ds_read_b64 v[30:31], v5 offset:4096
    v_perm_b32 v192, v47, v45, s94
    v_perm_b32 v200, v47, v45, s95
    s_waitcnt lgkmcnt(11)
    ds_read_b64 v[32:33], v5 offset:8192
    v_perm_b32 v177, v50, v48, s94
    v_perm_b32 v185, v50, v48, s95
    v_perm_b32 v193, v51, v49, s94
    ds_read_b64 v[34:35], v5 offset:12288
    v_perm_b32 v201, v51, v49, s95
    s_waitcnt lgkmcnt(11)
    v_perm_b32 v178, v54, v52, s94
    ds_read_b64 v[252:253], v7 offset:0
    v_perm_b32 v186, v54, v52, s95
    v_perm_b32 v194, v55, v53, s94
    v_perm_b32 v202, v55, v53, s95
    ds_read_b64 v[254:255], v7 offset:4096
    s_waitcnt lgkmcnt(12)
    v_and_b32 v179, 0xffff, v56
    v_lshrrev_b32 v187, 16, v56
    ds_read_b64 v[142:143], v7 offset:8192
    v_and_b32 v195, 0xffff, v57
    v_lshrrev_b32 v203, 16, v57
    v_mfma_f32_32x32x16_bf16 v[44:59], v[176:179], v[144:147], 0
    s_waitcnt lgkmcnt(11)
    v_perm_b32 v180, v242, v240, s94
    v_perm_b32 v188, v242, v240, s95
    v_perm_b32 v196, v243, v241, s94
    v_perm_b32 v204, v243, v241, s95
    s_waitcnt lgkmcnt(9)
    v_perm_b32 v181, v246, v244, s94
    v_mfma_f32_32x32x16_bf16 v[60:75], v[184:187], v[152:155], 0
    v_perm_b32 v189, v246, v244, s95
    v_perm_b32 v197, v247, v245, s94
    v_perm_b32 v205, v247, v245, s95
    s_waitcnt lgkmcnt(7)
    v_perm_b32 v182, v250, v248, s94
    v_perm_b32 v190, v250, v248, s95
    v_perm_b32 v198, v251, v249, s94
    v_perm_b32 v206, v251, v249, s95
    v_mfma_f32_32x32x16_bf16 v[76:91], v[192:195], v[160:163], 0
    v_mov_b32 v183, 0
    v_mov_b32 v191, 0
    v_mov_b32 v199, 0
    v_mov_b32 v207, 0
    ds_read_b64 v[240:241], v5 offset:2048
    v_add_f32 v36, 1.0, v36
    v_add_f32 v37, 1.0, v37
    v_mfma_f32_32x32x16_bf16 v[92:107], v[200:203], v[168:171], 0
    v_add_f32 v38, 1.0, v38
    ds_read_b64 v[242:243], v5 offset:6144
    v_add_f32 v39, 1.0, v39
    v_add_f32 v40, 1.0, v40
    v_add_f32 v41, 1.0, v41
    ds_read_b64 v[244:245], v5 offset:10240
    v_add_f32 v42, 1.0, v42
    v_add_f32 v43, 1.0, v43
    v_mfma_f32_32x32x16_bf16 v[44:59], v[180:183], v[148:151], v[44:59]
    s_waitcnt lgkmcnt(8)
    ds_read_b64 v[246:247], v5 offset:14336
    v_perm_b32 v176, v30, v28, s94
    v_perm_b32 v184, v30, v28, s95
    v_perm_b32 v192, v31, v29, s94
    v_perm_b32 v200, v31, v29, s95
    v_mfma_f32_32x32x16_bf16 v[60:75], v[188:191], v[156:159], v[60:75]
    ds_read_b64 v[248:249], v7 offset:2048
    s_waitcnt lgkmcnt(8)
    v_perm_b32 v177, v34, v32, s94
    v_perm_b32 v185, v34, v32, s95
    v_perm_b32 v193, v35, v33, s94
    ds_read_b64 v[250:251], v7 offset:6144
    v_perm_b32 v201, v35, v33, s95
    v_mfma_f32_32x32x16_bf16 v[76:91], v[196:199], v[164:167], v[76:91]
    s_waitcnt lgkmcnt(7)
    v_perm_b32 v178, v254, v252, s94
    v_perm_b32 v186, v254, v252, s95
    v_perm_b32 v194, v255, v253, s94
    v_perm_b32 v202, v255, v253, s95
    s_waitcnt lgkmcnt(6)
    v_and_b32 v179, 0xffff, v142
    v_mfma_f32_32x32x16_bf16 v[92:107], v[204:207], v[172:175], v[92:107]
    v_lshrrev_b32 v187, 16, v142
    v_and_b32 v195, 0xffff, v143
    v_lshrrev_b32 v203, 16, v143
    v_rcp_f32 v36, v36
    v_rcp_f32 v37, v37
    v_rcp_f32 v38, v38
    v_rcp_f32 v39, v39
    v_mfma_f32_32x32x16_bf16 v[144:159], v[176:179], v[208:211], 0
    s_waitcnt lgkmcnt(4)
    v_perm_b32 v180, v242, v240, s94
    v_perm_b32 v188, v242, v240, s95
    v_perm_b32 v196, v243, v241, s94
    v_perm_b32 v204, v243, v241, s95
    s_waitcnt lgkmcnt(2)
    v_perm_b32 v181, v246, v244, s94
    v_mfma_f32_32x32x16_bf16 v[160:175], v[184:187], v[216:219], 0
    v_perm_b32 v189, v246, v244, s95
    v_perm_b32 v197, v247, v245, s94
    v_perm_b32 v205, v247, v245, s95
    s_waitcnt lgkmcnt(0)
    v_perm_b32 v182, v250, v248, s94
    v_perm_b32 v190, v250, v248, s95
    v_perm_b32 v198, v251, v249, s94
    v_perm_b32 v206, v251, v249, s95
    v_mfma_f32_32x32x16_bf16 v[144:159], v[180:183], v[212:215], v[144:159]
    v_rcp_f32 v40, v40
    v_rcp_f32 v41, v41
    v_rcp_f32 v42, v42
    v_rcp_f32 v43, v43
    v_mul_f32 v24, v108, v36
    v_mul_f32 v25, v109, v37
    v_fmac_f32 v24, v110, v38
    v_fmac_f32 v25, v111, v39
    v_fmac_f32 v24, v112, v40
    v_fmac_f32 v25, v113, v41
    v_fmac_f32 v24, v114, v42
    v_mfma_f32_32x32x16_bf16 v[160:175], v[188:191], v[220:223], v[160:175]
    v_fmac_f32 v25, v115, v43
    v_lshlrev_b32 v27, 4, v1
    v_lshlrev_b32 v26, 5, v1
    v_add_u32 v26, 131072, v26
    s_and_b32 s91, s88, 1
    s_lshl_b32 s91, s91, 4
    s_cmp_lt_u32 s88, 2
    s_cselect_b32 s92, -1, 0
    s_cselect_b32 s93, 0, -1
    s_lshl_b32 s90, s87, 10
    s_mov_b32 s3, 0x40000
    v_mfma_f32_32x32x16_bf16 v[208:223], v[192:195], v[224:227], 0
    v_fmac_f32 v44, v8, v144
    v_fmac_f32 v45, v9, v145
    v_fmac_f32 v46, v10, v146
    v_fmac_f32 v47, v11, v147
    v_fmac_f32 v48, v12, v148
    v_fmac_f32 v49, v13, v149
    v_mfma_f32_32x32x16_bf16 v[208:223], v[196:199], v[228:231], v[208:223]
    v_fmac_f32 v50, v14, v150
    v_fmac_f32 v51, v15, v151
    v_fmac_f32 v52, v16, v152
    v_fmac_f32 v53, v17, v153
    v_fmac_f32 v54, v18, v154
    v_fmac_f32 v55, v19, v155
    v_fmac_f32 v56, v20, v156
    v_mfma_f32_32x32x16_bf16 v[176:191], v[200:203], v[232:235], 0
    v_fmac_f32 v60, v8, v160
    v_fmac_f32 v61, v9, v161
    v_fmac_f32 v62, v10, v162
    v_fmac_f32 v63, v11, v163
    v_fmac_f32 v64, v12, v164
    v_fmac_f32 v65, v13, v165
    v_mfma_f32_32x32x16_bf16 v[176:191], v[204:207], v[236:239], v[176:191]
    v_fmac_f32 v66, v14, v166
    v_fmac_f32 v67, v15, v167
    v_fmac_f32 v68, v16, v168
    v_fmac_f32 v69, v17, v169
    v_fmac_f32 v70, v18, v170
    v_fmac_f32 v71, v19, v171
    v_fmac_f32 v72, v20, v172
    v_cvt_pk_bf16_f32 v44, v44, v60
    v_cvt_pk_bf16_f32 v45, v45, v61
    v_cvt_pk_bf16_f32 v46, v46, v62
    v_cvt_pk_bf16_f32 v47, v47, v63
    v_cvt_pk_bf16_f32 v48, v48, v64
    v_cvt_pk_bf16_f32 v49, v49, v65
    v_cvt_pk_bf16_f32 v50, v50, v66
    v_cvt_pk_bf16_f32 v51, v51, v67
    v_cvt_pk_bf16_f32 v52, v52, v68
    v_cvt_pk_bf16_f32 v53, v53, v69
    v_cvt_pk_bf16_f32 v54, v54, v70
    v_cvt_pk_bf16_f32 v55, v55, v71
    v_cvt_pk_bf16_f32 v56, v56, v72
    v_dot2c_f32_bf16 v24, v44, v116
    v_dot2c_f32_bf16 v25, v45, v118
    v_dot2c_f32_bf16 v24, v46, v120
    v_dot2c_f32_bf16 v25, v47, v122
    v_dot2c_f32_bf16 v24, v48, v124
    v_dot2c_f32_bf16 v25, v49, v126
    v_dot2c_f32_bf16 v24, v50, v128
    v_dot2c_f32_bf16 v25, v51, v130
    v_dot2c_f32_bf16 v24, v52, v132
    v_dot2c_f32_bf16 v25, v53, v134
    v_dot2c_f32_bf16 v24, v54, v136
    v_dot2c_f32_bf16 v25, v55, v138
    v_dot2c_f32_bf16 v24, v56, v140
    v_pk_fma_f32 v[76:77], v[8:9], v[208:209], v[76:77]
    v_pk_fma_f32 v[78:79], v[10:11], v[210:211], v[78:79]
    v_pk_fma_f32 v[80:81], v[12:13], v[212:213], v[80:81]
    v_pk_fma_f32 v[82:83], v[14:15], v[214:215], v[82:83]
    v_pk_fma_f32 v[84:85], v[16:17], v[216:217], v[84:85]
    v_pk_fma_f32 v[86:87], v[18:19], v[218:219], v[86:87]
    v_fmac_f32 v88, v20, v220
    v_pk_fma_f32 v[92:93], v[8:9], v[176:177], v[92:93]
    v_pk_fma_f32 v[94:95], v[10:11], v[178:179], v[94:95]
    v_pk_fma_f32 v[96:97], v[12:13], v[180:181], v[96:97]
    v_pk_fma_f32 v[98:99], v[14:15], v[182:183], v[98:99]
    v_pk_fma_f32 v[100:101], v[16:17], v[184:185], v[100:101]
    v_pk_fma_f32 v[102:103], v[18:19], v[186:187], v[102:103]
    v_fmac_f32 v104, v20, v188
    v_cvt_pk_bf16_f32 v76, v76, v92
    v_cvt_pk_bf16_f32 v77, v77, v93
    v_cvt_pk_bf16_f32 v78, v78, v94
    v_cvt_pk_bf16_f32 v79, v79, v95
    v_cvt_pk_bf16_f32 v80, v80, v96
    v_cvt_pk_bf16_f32 v81, v81, v97
    v_cvt_pk_bf16_f32 v82, v82, v98
    v_cvt_pk_bf16_f32 v83, v83, v99
    v_cvt_pk_bf16_f32 v84, v84, v100
    v_cvt_pk_bf16_f32 v85, v85, v101
    v_cvt_pk_bf16_f32 v86, v86, v102
    v_cvt_pk_bf16_f32 v87, v87, v103
    v_cvt_pk_bf16_f32 v88, v88, v104
    v_dot2c_f32_bf16 v24, v76, v117
    v_dot2c_f32_bf16 v25, v77, v119
    v_dot2c_f32_bf16 v24, v78, v121
    v_dot2c_f32_bf16 v25, v79, v123
    v_dot2c_f32_bf16 v24, v80, v125
    v_dot2c_f32_bf16 v25, v81, v127
    v_dot2c_f32_bf16 v24, v82, v129
    v_dot2c_f32_bf16 v25, v83, v131
    v_dot2c_f32_bf16 v24, v84, v133
    v_dot2c_f32_bf16 v25, v85, v135
    v_dot2c_f32_bf16 v24, v86, v137
    v_dot2c_f32_bf16 v25, v87, v139
    v_dot2c_f32_bf16 v24, v88, v141
    s_nop 2
    v_add_f32 v24, v24, v25
    ds_write_b32 v2, v24
    s_waitcnt lgkmcnt(0)
    s_barrier
    s_cmp_lg_u32 s86, 0
    s_cbranch_scc1 L_end
    ds_read_b128 v[240:243], v26 offset:0
    ds_read_b128 v[244:247], v26 offset:16
L_spin:
    v_readfirstlane_b32 s89, v6
    s_nop 0
    s_cmp_eq_u32 s89, 1
    s_cbranch_scc1 L_go
    s_sleep 2
    s_lshl_b32 s89, s87, 2
    buffer_load_dword v6, v0, s[52:55], s89 offen sc0 sc1
    s_waitcnt vmcnt(0)
    s_sub_u32 s3, s3, 1
    s_cbranch_scc0 L_spin
L_go:
    s_waitcnt lgkmcnt(0)
    v_pk_add_f32 v[240:241], v[240:241], v[244:245]
    v_pk_add_f32 v[242:243], v[242:243], v[246:247]
    v_pk_add_f32 v[240:241], v[240:241], v[242:243]
    v_add_f32 v240, v240, v241
    v_bfe_u32 v242, v240, 1, 16
    v_lshrrev_b32 v241, 16, v240
    v_or_b32 v242, 1, v242
    v_or_b32 v241, 1, v241
    v_lshlrev_b32 v242, s91, v242
    v_lshlrev_b32 v241, s91, v241
    v_and_b32 v250, s92, v242
    v_and_b32 v251, s93, v242
    buffer_atomic_or_x2 v[250:251], v27, s[56:59], s90 offen offset:8 sc0 sc1
    v_and_b32 v248, s92, v241
    v_and_b32 v249, s93, v241
    buffer_atomic_or_x2 v[248:249], v27, s[56:59], s90 offen sc0 sc1
    v_and_b32 v246, s92, v242
    v_and_b32 v247, s93, v242
    v_and_b32 v244, s92, v241
    v_and_b32 v245, s93, v241
    s_mov_b32 s91, 0x00010001
    v_lshlrev_b32 v4, 1, v1
    s_lshl_b32 s92, s87, 7
    s_waitcnt vmcnt(0)
    v_or_b32 v248, v248, v244
    v_or_b32 v249, v249, v245
    v_and_b32 v240, v248, v249
    v_and_b32 v240, s91, v240
    v_cmp_eq_u32 vcc, s91, v240
    v_or_b32 v250, v250, v246
    v_or_b32 v251, v251, v247
    s_and_b64 exec, exec, vcc
    s_cbranch_execz L_end
L_lchk:
    v_and_b32 v240, v250, v251
    v_and_b32 v240, s91, v240
    v_cmp_ne_u32 vcc, s91, v240
    v_lshlrev_b32 v240, 16, v248
    v_and_b32 v241, 0xfffe0000, v248
    v_and_b32 v240, 0xfffe0000, v240
    v_lshlrev_b32 v242, 16, v249
    v_and_b32 v243, 0xfffe0000, v249
    v_and_b32 v242, 0xfffe0000, v242
    s_cbranch_vccz L_sum
    buffer_load_dwordx2 v[250:251], v27, s[56:59], s90 offen offset:8 sc0 sc1
    s_waitcnt vmcnt(0)
    s_sub_u32 s3, s3, 1
    s_cbranch_scc0 L_lchk
L_sum:
    v_and_b32 v244, 0xfffe, v250
    v_lshrrev_b32 v245, 17, v250
    v_and_b32 v246, 0xfffe, v251
    v_lshrrev_b32 v247, 17, v251
    v_lshl_or_b32 v240, v244, 1, v240
    v_lshl_or_b32 v241, v245, 2, v241
    v_lshl_or_b32 v242, v246, 1, v242
    v_lshl_or_b32 v243, v247, 2, v243
    v_pk_add_f32 v[240:241], v[240:241], v[242:243]
    v_add_f32 v240, v240, v241
    v_cvt_pk_bf16_f32 v240, v240, v240
    buffer_store_short v240, v4, s[48:51], s92 offen
L_end:
    s_endpgm
.section .rodata,"a"
.p2align 6
.amdhsa_kernel standalone__deep_cross_fibinet__recsys_kernel
  .amdhsa_next_free_vgpr 256
  .amdhsa_next_free_sgpr 102
  .amdhsa_accum_offset 256
  .amdhsa_group_segment_fixed_size 0
  .amdhsa_kernarg_size 88
  .amdhsa_user_sgpr_count 2
  .amdhsa_user_sgpr_kernarg_segment_ptr 1
  .amdhsa_system_sgpr_workgroup_id_x 1
.end_amdhsa_kernel
```

```asm
; @launch grid=(256,1,1) block=(512,1,1) lds=163840
.amdgcn_target "amdgcn-amd-amdhsa--gfx950"
.text
.globl standalone__deep_cross_fibinet__recsys_kernel
.p2align 8
.type standalone__deep_cross_fibinet__recsys_kernel,@function
standalone__deep_cross_fibinet__recsys_kernel:
    s_cmp_ge_u32 s2, 256
    s_cbranch_scc1 L_end
    v_lshrrev_b32 v242, 6, v0
    s_load_dwordx4 s[4:7], s[0:1], 0
    s_load_dwordx4 s[12:15], s[0:1], 40
    v_readfirstlane_b32 s86, v242
    s_load_dwordx4 s[20:23], s[0:1], 64
    s_load_dwordx2 s[24:25], s[0:1], 80
    s_getpc_b64 s[92:93]
    s_bfe_u32 s88, s2, 0x20003
    s_lshl_b32 s91, s86, 2
    s_lshr_b32 s91, 0x77773244, s91
    s_and_b32 s91, s91, 15
    s_lshl_b32 s91, s91, 3
    s_load_dwordx2 s[44:45], s[0:1], s91
    s_mul_i32 s91, s88, 3840
    v_lshl_add_u32 v240, v0, 7, s91
    v_min_u32 v240, 14892, v240
    v_mov_b32 v241, s93
    v_add_co_u32 v240, vcc, s92, v240
    v_and_b32 v1, 63, v0
    s_lshl_b32 s89, s86, 10
    v_addc_co_u32 v241, vcc, 0, v241, vcc
    v_cmp_gt_u32 vcc, 30, v0
    v_and_b32 v244, 31, v0
    s_and_saveexec_b64 s[92:93], vcc
    s_cbranch_execz L_cpf
    global_load_dword v6, v[240:241], off
L_cpf:
    s_mov_b64 exec, -1
    s_lshl_b32 s91, s88, 3
    s_lshr_b32 s91, 336398080, s91
    s_bitcmp1_b32 s91, 6
    s_cselect_b32 s96, -1, 1
    s_cselect_b32 s61, 25, 1
    s_cselect_b32 s92, 52, 0
    s_and_b32 s91, s91, 31
    s_add_u32 s97, s91, s92
    s_lshl_b32 s60, s91, 15
    s_lshl_b32 s61, s61, 15
    v_mul_i32_i24 v245, s96, v244
    s_lshr_b32 s91, s2, 5
    v_add_u32 v245, s97, v245
    s_lshl_b32 s91, s91, 3
    v_subrev_u32 v246, 26, v245
    s_and_b32 s92, s2, 7
    s_add_u32 s87, s91, s92
    v_min_u32 v245, v245, v246
    s_lshl_b32 s91, s87, 3
    v_subrev_u32 v246, 26, v245
    s_add_u32 s91, s91, s86
    v_min_u32 v245, v245, v246
    s_mul_i32 s90, s91, 832
    s_mov_b32 s30, 425984
    v_lshrrev_b32 v246, 5, v1
    s_mov_b32 s31, 0x00020000
    v_mul_u32_u24 v246, 104, v246
    s_add_u32 m0, s89, 155648
    v_lshl_add_u32 v246, v245, 2, v246
    s_waitcnt lgkmcnt(0)
    s_mov_b32 s28, s4
    s_and_b32 s29, s5, 0xffff
    buffer_load_dword v246, s[28:31], s90 offen offset:0  lds
    s_add_u32 m0, m0, 48
    s_nop 0
    buffer_load_dword v246, s[28:31], s90 offen offset:208  lds
    s_add_u32 m0, m0, 48
    s_nop 0
    buffer_load_dword v246, s[28:31], s90 offen offset:416  lds
    s_add_u32 m0, m0, 48
    s_nop 0
    buffer_load_dword v246, s[28:31], s90 offen offset:624  lds
    s_mov_b32 s40, s14
    s_and_b32 s41, s15, 0xffff
    s_mov_b32 s42, 851968
    s_mov_b32 s43, 0x00020000
    s_mov_b32 s36, s12
    s_and_b32 s37, s13, 0xffff
    s_mov_b32 s38, 173056
    s_mov_b32 s39, 0x00020000
    v_min_u32 v247, 3, v1
    v_lshlrev_b32 v247, 7, v247
    s_mul_i32 s91, s2, 3328
    s_lshl_b32 s92, s86, 9
    s_add_u32 s91, s91, s92
    buffer_load_dword v6, v247, s[40:43], s91 offen
    s_mul_i32 s91, s2, 768
    s_lshl_b32 s92, s86, 7
    s_add_u32 s91, s91, s92
    buffer_load_dword v6, off, s[36:39], s91
    s_and_b32 s45, s45, 0xffff
    s_mov_b32 s47, 0x00020000
    s_lshl_b32 s91, s88, 7
    v_lshlrev_b32 v246, 4, v1
    s_movk_i32 s46, 676
    s_cmp_ge_u32 s86, 4
    s_cselect_b32 s46, 512, s46
    s_cselect_b32 s91, s91, 0
    v_and_b32 v248, 16, v246
    s_lshl_b32 s92, s86, 12
    s_lshl_b32 s93, s88, 5
    s_add_u32 s92, s92, s93
    v_lshrrev_b32 v247, 1, v1
    s_cmp_lt_u32 s86, 2
    s_cselect_b32 s46, 8192, s46
    s_cselect_b32 s91, s92, s91
    s_cselect_b32 s92, 7, 5
    s_add_u32 m0, s89, 131072
    v_lshl_add_u32 v247, v247, s92, v248
    buffer_load_dwordx4 v247, s[44:47], s91 offen lds
    v_and_b32 v245, 7, v1
    v_lshrrev_b32 v247, 2, v1
    s_mov_b32 s32, s6
    v_and_b32 v247, 4, v247
    v_xor_b32 v247, v247, v245
    v_lshrrev_b32 v248, 3, v0
    s_and_b32 s33, s7, 0xffff
    v_lshlrev_b32 v248, 9, v248
    v_lshl_add_u32 v247, v247, 4, v248
    s_mov_b32 s34, 12800000
    v_mov_b32 v248, s88
    v_lshl_add_u32 v2, v248, 7, v247
    v_bfe_u32 v247, v0, 4, 3
    s_mov_b32 s35, 0x00020000
    v_xor_b32 v247, v247, v245
    v_lshlrev_b32 v3, 4, v247
    s_add_u32 s91, s89, 155648
    v_lshrrev_b32 v244, 3, v1
    v_lshl_add_u32 v26, v244, 7, s91
    v_and_b32 v247, 5, v0
    v_cmp_eq_u32 s[92:93], 0, v247
    v_mov_b32 v247, 0x3c80
    v_lshlrev_b32 v248, 2, v0
    v_cndmask_b32 v247, 0, v247, s[92:93]
    v_add_u32 v248, 139264, v248
    ds_write_b32 v248, v247
    s_lshr_b32 s91, s86, 1
    s_lshr_b32 s92, s86, 2
    s_add_u32 s90, s91, s92
    s_and_b32 s90, s90, 1
    v_and_b32 v100, 31, v1
    v_lshrrev_b32 v101, 5, v1
    v_bfe_u32 v102, v1, 1, 3
    s_and_b32 s91, s86, 1
    s_lshl_b32 s91, s91, 5
    v_add_u32 v103, s91, v100
    s_lshl_b32 s92, s92, 13
    v_lshl_add_u32 v104, v103, 7, s92
    v_xor_b32 v105, v101, v102
    v_lshl_add_u32 v8, v105, 4, v104
    v_xor_b32 v9, 32, v8
    v_xor_b32 v10, 64, v8
    v_xor_b32 v11, 96, v8
    v_bfe_u32 v104, v1, 2, 2
    v_lshl_add_u32 v105, v101, 3, v104
    s_add_u32 s92, s92, 65536
    v_lshl_add_u32 v105, v105, 7, s92
    v_bfe_u32 v106, v1, 4, 1
    s_lshr_b32 s91, s86, 2
    v_xor_b32 v106, s91, v106
    v_bfe_u32 v107, v1, 1, 1
    v_lshl_add_u32 v106, v106, 1, v107
    s_and_b32 s91, s86, 2
    s_lshl_b32 s91, s91, 1
    v_or_b32 v106, s91, v106
    v_lshrrev_b32 v107, 1, v1
    v_and_b32 v107, 4, v107
    v_xor_b32 v106, v106, v107
    v_lshl_add_u32 v105, v106, 4, v105
    v_and_b32 v107, 1, v1
    v_lshl_add_u32 v12, v107, 3, v105
    s_lshl_b32 s91, s88, 1
    s_lshr_b32 s92, s86, 2
    s_add_u32 s91, s91, s92
    v_xor_b32 v104, s91, v102
    v_lshlrev_b32 v105, 13, v101
    v_lshl_add_u32 v105, v103, 7, v105
    v_lshl_add_u32 v105, v104, 4, v105
    s_and_b32 s91, s86, 2
    s_lshl_b32 s91, s91, 2
    v_add_u32 v13, s91, v105
    v_and_b32 v104, 15, v1
    v_lshlrev_b32 v104, 3, v104
    v_lshl_add_u32 v104, v101, 8, v104
    v_and_b32 v105, 16, v1
    v_lshl_add_u32 v104, v105, 9, v104
    v_add_u32 v76, 131072, v104
    s_waitcnt vmcnt(3)
    ds_read_b128 v[44:47], v26
    ds_read_b128 v[16:19], v26 offset:16
    s_add_u32 m0, s89, 0
    s_waitcnt lgkmcnt(1)
    v_lshl_add_u32 v44, v44, 7, v3
    buffer_load_dwordx4 v44, s[32:35], 0 offen  lds
    s_add_u32 m0, s89, 8192
    v_lshl_add_u32 v45, v45, 7, v3
    buffer_load_dwordx4 v45, s[32:35], 0 offen  lds
    s_add_u32 m0, s89, 65536
    s_nop 0
    buffer_load_dwordx4 v2, s[40:43], s60 offen lds
    s_add_u32 m0, s89, 73728
    s_add_u32 s60, s60, s61
    s_sub_u32 s93, s60, 851968
    s_min_u32 s60, s60, s93
    buffer_load_dwordx4 v2, s[40:43], s60 offen lds
    s_add_u32 m0, s89, 16384
    v_lshl_add_u32 v46, v46, 7, v3
    buffer_load_dwordx4 v46, s[32:35], 0 offen  lds
    s_add_u32 m0, s89, 24576
    v_lshl_add_u32 v47, v47, 7, v3
    buffer_load_dwordx4 v47, s[32:35], 0 offen  lds
    s_waitcnt vmcnt(6) lgkmcnt(0)
    v_lshl_add_u32 v16, v16, 7, v3
    v_lshl_add_u32 v17, v17, 7, v3
    v_lshl_add_u32 v18, v18, 7, v3
    v_lshl_add_u32 v19, v19, 7, v3
    s_barrier
    ds_read_b64_tr_b16 v[100:101], v76 offset:0
    ds_read_b64_tr_b16 v[102:103], v76 offset:128
    ds_read_b64_tr_b16 v[104:105], v76 offset:512
    ds_read_b64_tr_b16 v[106:107], v76 offset:640
    ds_read_b64_tr_b16 v[108:109], v76 offset:1024
    ds_read_b64_tr_b16 v[110:111], v76 offset:1152
    ds_read_b64_tr_b16 v[112:113], v76 offset:1536
    ds_read_b64_tr_b16 v[114:115], v76 offset:1664
    s_mov_b32 s48, s20
    s_and_b32 s49, s21, 0xffff
    s_mov_b32 s50, 8192
    s_mov_b32 s51, 0x00020000
    s_mov_b32 s52, s22
    s_and_b32 s53, s23, 0xffff
    s_mov_b32 s54, 256
    s_mov_b32 s55, 0x00020000
    s_mov_b32 s56, s24
    s_and_b32 s57, s25, 0xffff
    s_mov_b32 s58, 268435456
    s_mov_b32 s59, 0x00020000
    s_mov_b32 s94, 0x05040100
    s_mov_b32 s95, 0x07060302
    v_and_b32 v144, 31, v1
    v_lshrrev_b32 v145, 5, v1
    s_and_b32 s8, s86, 1
    s_lshl_b32 s8, s8, 5
    v_add_u32 v147, s8, v144
    s_and_b32 s8, s86, 2
    s_lshl_b32 s8, s8, 2
    s_lshr_b32 s9, s86, 2
    v_bfe_u32 v148, v1, 3, 1
    v_xor_b32 v148, s9, v148
    v_lshl_add_u32 v149, v1, 5, s8
    v_lshl_add_u32 v5, v148, 4, v149
    s_lshl_b32 s8, s90, 1
    s_add_u32 s8, s8, s9
    s_lshl_b32 s9, s8, 10
    s_add_u32 s9, s9, 157696
    v_lshl_add_u32 v14, v147, 4, s9
    s_and_b32 s9, s86, 1
    s_lshl_b32 s9, s9, 10
    s_lshr_b32 s10, s86, 2
    s_lshl_b32 s10, s10, 9
    s_add_u32 s10, s10, s9
    s_mul_i32 s8, s90, 81920
    s_add_u32 s10, s10, s8
    s_add_u32 s10, s10, 16384
    v_lshl_add_u32 v149, v144, 4, s10
    v_lshl_add_u32 v15, v145, 13, v149
    s_lshr_b32 s8, s86, 1
    s_lshl_b32 s8, s8, 13
    s_add_u32 s8, s8, s9
    v_lshl_add_u32 v4, v1, 4, s8
    v_add_u32 v27, 98304, v4
    v_mov_b32 v142, 0xbdd2d3e8
    v_mov_b32 v143, 0xc0135761
    v_mov_b32 v211, 0
    s_and_b32 s8, s86, 2
    s_lshl_b32 s8, s8, 5
    s_lshr_b32 s9, s86, 2
    s_lshl_b32 s9, s9, 5
    s_add_u32 s8, s8, s9
    s_add_u32 s8, s8, 135168
    v_lshrrev_b32 v151, 5, v1
    v_lshl_add_u32 v151, v151, 3, s8
    ds_read_b64 v[172:173], v151 offset:0
    ds_read_b64 v[174:175], v151 offset:16
    v_and_b32 v145, 15, v1
    v_lshrrev_b32 v147, 4, v1
    v_min_u32 v145, 12, v145
    v_lshlrev_b32 v148, 1, v145
    v_mul_i32_i24 v149, s96, v148
    v_add_u32 v149, s97, v149
    v_subrev_u32 v150, 26, v149
    v_min_u32 v149, v149, v150
    v_subrev_u32 v150, 26, v149
    v_min_u32 v149, v149, v150
    v_add_u32 v148, 1, v148
    v_mul_i32_i24 v152, s96, v148
    v_add_u32 v152, s97, v152
    v_subrev_u32 v150, 26, v152
    v_min_u32 v152, v152, v150
    v_subrev_u32 v150, 26, v152
    v_min_u32 v152, v152, v150
    v_mul_u32_u24 v150, 208, v147
    v_add_u32 v150, 134144, v150
    v_lshl_add_u32 v149, v149, 1, v150
    v_lshl_add_u32 v152, v152, 1, v150
    ds_read_u16 v168, v149 offset:0
    ds_read_u16 v169, v149 offset:52
    ds_read_u16 v170, v149 offset:104
    ds_read_u16 v171, v149 offset:156
    ds_read_u16 v156, v152 offset:0
    s_waitcnt lgkmcnt(9)
    ds_read_u16 v157, v152 offset:52
    ds_read_u16 v158, v152 offset:104
    ds_read_u16 v159, v152 offset:156
    v_mul_i32_i24 v146, s96, v147
    v_add_u32 v146, s97, v146
    v_subrev_u32 v150, 26, v146
    v_min_u32 v146, v146, v150
    v_subrev_u32 v150, 26, v146
    v_min_u32 v146, v146, v150
    v_lshlrev_b32 v145, 1, v145
    v_mad_u32_u24 v149, v146, 26, v145
    s_cmp_eq_u32 s96, 1
    s_cselect_b32 s8, 4, 22
    s_mul_i32 s8, s8, 26
    s_waitcnt lgkmcnt(8)
    v_lshlrev_b32 v216, 16, v172
    v_and_b32 v217, 0xffff0000, v172
    v_lshlrev_b32 v218, 16, v173
    v_and_b32 v219, 0xffff0000, v173
    v_lshlrev_b32 v220, 16, v174
    v_and_b32 v221, 0xffff0000, v174
    v_lshlrev_b32 v222, 16, v175
    v_and_b32 v223, 0xffff0000, v175
    v_add_u32 v153, 133120, v149
    ds_read_u16 v160, v153
    v_add_u32 v149, s8, v149
    v_subrev_u32 v150, 676, v149
    v_min_u32 v149, v149, v150
    v_add_u32 v154, 133120, v149
    ds_read_u16 v161, v154
    v_add_u32 v149, s8, v149
    v_subrev_u32 v150, 676, v149
    v_min_u32 v149, v149, v150
    v_add_u32 v153, 133120, v149
    ds_read_u16 v162, v153
    v_add_u32 v149, s8, v149
    v_subrev_u32 v150, 676, v149
    v_min_u32 v149, v149, v150
    v_add_u32 v154, 133120, v149
    ds_read_u16 v163, v154
    v_add_u32 v149, s8, v149
    v_subrev_u32 v150, 676, v149
    v_min_u32 v149, v149, v150
    v_add_u32 v153, 133120, v149
    ds_read_u16 v164, v153
    v_add_u32 v149, s8, v149
    v_subrev_u32 v150, 676, v149
    v_min_u32 v149, v149, v150
    v_add_u32 v154, 133120, v149
    ds_read_u16 v165, v154
    v_add_u32 v149, s8, v149
    v_subrev_u32 v150, 676, v149
    v_min_u32 v149, v149, v150
    v_add_u32 v153, 133120, v149
    ds_read_u16 v23, v153
    s_mul_i32 s28, s86, s96
    s_add_u32 s28, s28, s97
    v_lshrrev_b32 v144, 4, v1
    s_sub_u32 s10, s28, 26
    s_min_u32 s28, s28, s10
    s_sub_u32 s10, s28, 26
    s_min_u32 s28, s28, s10
    v_bfe_u32 v145, v1, 1, 2
    s_mul_i32 s28, s28, 3328
    v_lshl_add_u32 v145, v144, 2, v145
    s_cmp_eq_u32 s96, 1
    s_cselect_b32 s9, 8, 18
    s_mul_i32 s9, s9, 3328
    v_bfe_u32 v146, v1, 3, 1
    v_lshl_add_u32 v146, v145, 1, v146
    s_add_u32 s29, s28, s9
    s_sub_u32 s10, s29, 86528
    s_min_u32 s29, s29, s10
    s_add_u32 s30, s29, s9
    s_sub_u32 s10, s30, 86528
    s_min_u32 s30, s30, s10
    v_mul_i32_i24 v147, s96, v146
    v_add_u32 v147, s97, v147
    v_subrev_u32 v148, 26, v147
    v_min_u32 v147, v147, v148
    v_subrev_u32 v148, 26, v147
    v_min_u32 v147, v147, v148
    s_and_b32 s9, s86, 1
    s_add_u32 s9, s9, 24
    s_mul_i32 s31, s9, s96
    s_add_u32 s31, s31, s97
    v_xor_b32 v144, v144, v1
    s_sub_u32 s10, s31, 26
    s_min_u32 s31, s31, s10
    s_sub_u32 s10, s31, 26
    s_min_u32 s31, s31, s10
    v_and_b32 v144, 1, v144
    s_lshl_b32 s9, s88, 5
    v_lshl_add_u32 v144, v144, 4, s9
    s_mul_i32 s31, s31, 3328
    v_lshl_add_u32 v144, v147, 7, v144
    v_add_u32 v145, 3, v145
    v_lshrrev_b32 v145, 4, v145
    v_lshl_add_u32 v7, v145, 30, v144
    s_waitcnt lgkmcnt(0)
    v_lshl_or_b32 v24, v169, 16, v168
    v_lshl_or_b32 v25, v171, 16, v170
    v_lshl_or_b32 v214, v157, 16, v156
    v_lshl_or_b32 v215, v159, 16, v158
    v_lshl_or_b32 v20, v161, 16, v160
    v_lshl_or_b32 v21, v163, 16, v162
    v_lshl_or_b32 v22, v165, 16, v164
    s_add_u32 m0, s89, 81920
    s_add_u32 s60, s60, s61
    s_sub_u32 s93, s60, 851968
    s_min_u32 s60, s60, s93
    buffer_load_dwordx4 v2, s[40:43], s60 offen lds
    s_add_u32 m0, s89, 90112
    s_add_u32 s60, s60, s61
    s_sub_u32 s93, s60, 851968
    s_min_u32 s60, s60, s93
    buffer_load_dwordx4 v2, s[40:43], s60 offen lds
    s_add_u32 m0, s89, 32768
    s_nop 0
    buffer_load_dwordx4 v16, s[32:35], 0 offen  lds
    s_add_u32 m0, s89, 40960
    s_nop 0
    buffer_load_dwordx4 v17, s[32:35], 0 offen  lds
    s_cmp_eq_u32 s90, 1
    s_cbranch_scc1 L_k1
    s_waitcnt vmcnt(6)
    s_barrier
    ds_read_b128 v[60:63], v8 offset:0
    ds_read_b64_tr_b16 v[44:45], v12 offset:0
    ds_read_b64_tr_b16 v[46:47], v12 offset:512
    ds_read_b128 v[64:67], v9 offset:0
    ds_read_b64_tr_b16 v[48:49], v12 offset:2048
    ds_read_b64_tr_b16 v[50:51], v12 offset:2560
    s_add_u32 m0, s89, 98304
    s_add_u32 s60, s60, s61
    s_sub_u32 s93, s60, 851968
    s_min_u32 s60, s60, s93
    buffer_load_dwordx4 v2, s[40:43], s60 offen lds
    s_waitcnt lgkmcnt(3)
    v_mfma_f32_32x32x16_bf16 v[76:91], v[100:103], v[60:63], 0
    v_mfma_f32_32x32x16_bf16 v[28:43], v[44:47], v[60:63], 0
    ds_read_b128 v[68:71], v10 offset:0
    ds_read_b64_tr_b16 v[52:53], v12 offset:4096
    ds_read_b64_tr_b16 v[54:55], v12 offset:4608
    s_add_u32 m0, s89, 106496
    s_add_u32 s60, s60, s61
    s_sub_u32 s93, s60, 851968
    s_min_u32 s60, s60, s93
    buffer_load_dwordx4 v2, s[40:43], s60 offen lds
    s_waitcnt lgkmcnt(3)
    v_mfma_f32_32x32x16_bf16 v[76:91], v[104:107], v[64:67], v[76:91]
    v_mfma_f32_32x32x16_bf16 v[28:43], v[48:51], v[64:67], v[28:43]
    ds_read_b128 v[72:75], v11 offset:0
    ds_read_b64_tr_b16 v[56:57], v12 offset:6144
    ds_read_b64_tr_b16 v[58:59], v12 offset:6656
    ds_read_b64 v[116:117], v13 offset:0
    s_add_u32 m0, s89, 49152
    s_nop 0
    buffer_load_dwordx4 v18, s[32:35], 0 offen  lds
    s_waitcnt lgkmcnt(4)
    v_mfma_f32_32x32x16_bf16 v[76:91], v[108:111], v[68:71], v[76:91]
    v_mfma_f32_32x32x16_bf16 v[28:43], v[52:55], v[68:71], v[28:43]
    s_add_u32 m0, s89, 57344
    s_nop 0
    buffer_load_dwordx4 v19, s[32:35], 0 offen  lds
    s_waitcnt vmcnt(6)
    s_barrier
    ds_read_b128 v[60:63], v8 offset:16384
    ds_read_b64_tr_b16 v[44:45], v12 offset:16384
    ds_read_b64_tr_b16 v[46:47], v12 offset:16896
    s_waitcnt lgkmcnt(4)
    v_mfma_f32_32x32x16_bf16 v[76:91], v[112:115], v[72:75], v[76:91]
    v_mfma_f32_32x32x16_bf16 v[28:43], v[56:59], v[72:75], v[28:43]
    ds_read_b128 v[64:67], v9 offset:16384
    ds_read_b64_tr_b16 v[48:49], v12 offset:18432
    ds_read_b64_tr_b16 v[50:51], v12 offset:18944
    s_waitcnt lgkmcnt(3)
    v_mfma_f32_32x32x16_bf16 v[28:43], v[44:47], v[60:63], v[28:43]
    ds_read_b128 v[68:71], v10 offset:16384
    ds_read_b64_tr_b16 v[52:53], v12 offset:20480
    ds_read_b64_tr_b16 v[54:55], v12 offset:20992
    s_nop 2
    v_mov_b32 v213, v84
    s_waitcnt lgkmcnt(3)
    v_mfma_f32_32x32x16_bf16 v[28:43], v[48:51], v[64:67], v[28:43]
    ds_read_b128 v[72:75], v11 offset:16384
    ds_read_b64_tr_b16 v[56:57], v12 offset:22528
    ds_read_b64_tr_b16 v[58:59], v12 offset:23040
    ds_read_b64 v[118:119], v13 offset:16384
    ds_read_b64 v[16:17], v26 offset:32
    s_add_u32 m0, s89, 114688
    s_add_u32 s60, s60, s61
    s_sub_u32 s93, s60, 851968
    s_min_u32 s60, s60, s93
    buffer_load_dwordx4 v2, s[40:43], s60 offen lds
    s_waitcnt lgkmcnt(5)
    v_mfma_f32_32x32x16_bf16 v[28:43], v[52:55], v[68:71], v[28:43]
    s_add_u32 m0, s89, 122880
    s_add_u32 s60, s60, s61
    s_sub_u32 s93, s60, 851968
    s_min_u32 s60, s60, s93
    buffer_load_dwordx4 v2, s[40:43], s60 offen lds
    s_waitcnt lgkmcnt(0)
    v_lshl_add_u32 v16, v16, 7, v3
    v_lshl_add_u32 v17, v17, 7, v3
    s_waitcnt vmcnt(4)
    s_barrier
    ds_read_b128 v[60:63], v8 offset:32768
    ds_read_b64_tr_b16 v[44:45], v12 offset:32768
    ds_read_b64_tr_b16 v[46:47], v12 offset:33280
    v_mfma_f32_32x32x16_bf16 v[28:43], v[56:59], v[72:75], v[28:43]
    ds_read_b128 v[64:67], v9 offset:32768
    ds_read_b64_tr_b16 v[48:49], v12 offset:34816
    ds_read_b64_tr_b16 v[50:51], v12 offset:35328
    s_add_u32 m0, s89, 0
    s_nop 0
    buffer_load_dwordx4 v16, s[32:35], 0 offen  lds
    s_waitcnt lgkmcnt(3)
    v_mfma_f32_32x32x16_bf16 v[84:99], v[100:103], v[60:63], 0
    v_mfma_f32_32x32x16_bf16 v[28:43], v[44:47], v[60:63], v[28:43]
    ds_read_b128 v[68:71], v10 offset:32768
    ds_read_b64_tr_b16 v[52:53], v12 offset:36864
    ds_read_b64_tr_b16 v[54:55], v12 offset:37376
    s_add_u32 m0, s89, 8192
    s_nop 0
    buffer_load_dwordx4 v17, s[32:35], 0 offen  lds
    s_waitcnt lgkmcnt(3)
    v_mfma_f32_32x32x16_bf16 v[84:99], v[104:107], v[64:67], v[84:99]
    v_mfma_f32_32x32x16_bf16 v[28:43], v[48:51], v[64:67], v[28:43]
    ds_read_b128 v[72:75], v11 offset:32768
    ds_read_b64_tr_b16 v[56:57], v12 offset:38912
    ds_read_b64_tr_b16 v[58:59], v12 offset:39424
    ds_read_b64 v[120:121], v13 offset:32768
    ds_read_b64 v[18:19], v26 offset:40
    s_add_u32 m0, s89, 65536
    s_add_u32 s60, s60, s61
    s_sub_u32 s93, s60, 851968
    s_min_u32 s60, s60, s93
    buffer_load_dwordx4 v2, s[40:43], s60 offen lds
    s_waitcnt lgkmcnt(5)
    v_mfma_f32_32x32x16_bf16 v[84:99], v[108:111], v[68:71], v[84:99]
    v_mfma_f32_32x32x16_bf16 v[28:43], v[52:55], v[68:71], v[28:43]
    s_add_u32 m0, s89, 73728
    s_add_u32 s60, s60, s61
    s_sub_u32 s93, s60, 851968
    s_min_u32 s60, s60, s93
    buffer_load_dwordx4 v2, s[40:43], s60 offen lds
    s_waitcnt lgkmcnt(0)
    v_lshl_add_u32 v18, v18, 7, v3
    v_lshl_add_u32 v19, v19, 7, v3
    s_lshl_b32 s91, s88, 3
    s_add_u32 s91, s91, s86
    s_cmp_lg_u32 s91, 23
    s_cbranch_scc1 L_z1
    v_mov_b32 v240, 0
    v_mov_b32 v241, 0
    v_mov_b32 v242, 0
    v_mov_b32 v243, 0
    v_lshlrev_b32 v244, 4, v1
    s_lshl_b32 s91, s87, 10
    buffer_store_dwordx4 v[240:243], v244, s[56:59], s91 offen sc0 sc1
L_z1:
    s_waitcnt vmcnt(4)
    s_barrier
    ds_read_b128 v[60:63], v8 offset:49152
    ds_read_b64_tr_b16 v[44:45], v12 offset:49152
    ds_read_b64_tr_b16 v[46:47], v12 offset:49664
    v_mfma_f32_32x32x16_bf16 v[84:99], v[112:115], v[72:75], v[84:99]
    v_mfma_f32_32x32x16_bf16 v[28:43], v[56:59], v[72:75], v[28:43]
    ds_read_b128 v[64:67], v9 offset:49152
    ds_read_b64_tr_b16 v[48:49], v12 offset:51200
    ds_read_b64_tr_b16 v[50:51], v12 offset:51712
    s_add_u32 m0, s89, 16384
    s_nop 0
    buffer_load_dwordx4 v18, s[32:35], 0 offen  lds
    s_waitcnt lgkmcnt(3)
    v_mfma_f32_32x32x16_bf16 v[28:43], v[44:47], v[60:63], v[28:43]
    ds_read_b128 v[68:71], v10 offset:49152
    ds_read_b64_tr_b16 v[52:53], v12 offset:53248
    ds_read_b64_tr_b16 v[54:55], v12 offset:53760
    v_cvt_pk_bf16_f32 v208, v213, v92
    v_cvt_pk_bf16_f32 v176, v76, v84
    v_cvt_pk_bf16_f32 v180, v77, v85
    v_cvt_pk_bf16_f32 v184, v78, v86
    v_cvt_pk_bf16_f32 v188, v79, v87
    v_cvt_pk_bf16_f32 v192, v80, v88
    v_cvt_pk_bf16_f32 v196, v81, v89
    v_cvt_pk_bf16_f32 v200, v82, v90
    v_cvt_pk_bf16_f32 v204, v83, v91
    s_add_u32 m0, s89, 24576
    s_nop 0
    buffer_load_dwordx4 v19, s[32:35], 0 offen  lds
    s_waitcnt lgkmcnt(3)
    v_mfma_f32_32x32x16_bf16 v[28:43], v[48:51], v[64:67], v[28:43]
    ds_read_b128 v[72:75], v11 offset:49152
    ds_read_b64_tr_b16 v[56:57], v12 offset:55296
    ds_read_b64_tr_b16 v[58:59], v12 offset:55808
    ds_read_b64 v[122:123], v13 offset:49152
    ds_read_b64 v[16:17], v26 offset:48
    s_add_u32 m0, s89, 81920
    s_add_u32 s60, s60, s61
    s_sub_u32 s93, s60, 851968
    s_min_u32 s60, s60, s93
    buffer_load_dwordx4 v2, s[40:43], s60 offen lds
    s_waitcnt lgkmcnt(5)
    v_mfma_f32_32x32x16_bf16 v[28:43], v[52:55], v[68:71], v[28:43]
    s_add_u32 m0, s89, 90112
    s_add_u32 s60, s60, s61
    s_sub_u32 s93, s60, 851968
    s_min_u32 s60, s60, s93
    buffer_load_dwordx4 v2, s[40:43], s60 offen lds
    s_waitcnt lgkmcnt(0)
    v_lshl_add_u32 v16, v16, 7, v3
    v_lshl_add_u32 v17, v17, 7, v3
    s_waitcnt vmcnt(4)
    s_barrier
    ds_read_b128 v[60:63], v8 offset:0
    ds_read_b64_tr_b16 v[44:45], v12 offset:0
    ds_read_b64_tr_b16 v[46:47], v12 offset:512
    v_mfma_f32_32x32x16_bf16 v[28:43], v[56:59], v[72:75], v[28:43]
    ds_read_b128 v[64:67], v9 offset:0
    ds_read_b64_tr_b16 v[48:49], v12 offset:2048
    ds_read_b64_tr_b16 v[50:51], v12 offset:2560
    s_add_u32 m0, s89, 32768
    s_nop 0
    buffer_load_dwordx4 v16, s[32:35], 0 offen  lds
    s_waitcnt lgkmcnt(3)
    v_mfma_f32_32x32x16_bf16 v[76:91], v[100:103], v[60:63], 0
    v_mfma_f32_32x32x16_bf16 v[28:43], v[44:47], v[60:63], v[28:43]
    ds_read_b128 v[68:71], v10 offset:0
    ds_read_b64_tr_b16 v[52:53], v12 offset:4096
    ds_read_b64_tr_b16 v[54:55], v12 offset:4608
    s_add_u32 m0, s89, 40960
    s_nop 0
    buffer_load_dwordx4 v17, s[32:35], 0 offen  lds
    s_waitcnt lgkmcnt(3)
    v_mfma_f32_32x32x16_bf16 v[76:91], v[104:107], v[64:67], v[76:91]
    v_mfma_f32_32x32x16_bf16 v[28:43], v[48:51], v[64:67], v[28:43]
    ds_read_b128 v[72:75], v11 offset:0
    ds_read_b64_tr_b16 v[56:57], v12 offset:6144
    ds_read_b64_tr_b16 v[58:59], v12 offset:6656
    ds_read_b64 v[124:125], v13 offset:0
    ds_read_b64 v[18:19], v26 offset:56
    s_add_u32 m0, s89, 98304
    s_add_u32 s60, s60, s61
    s_sub_u32 s93, s60, 851968
    s_min_u32 s60, s60, s93
    buffer_load_dwordx4 v2, s[40:43], s60 offen lds
    s_waitcnt lgkmcnt(5)
    v_mfma_f32_32x32x16_bf16 v[76:91], v[108:111], v[68:71], v[76:91]
    v_mfma_f32_32x32x16_bf16 v[28:43], v[52:55], v[68:71], v[28:43]
    s_add_u32 m0, s89, 106496
    s_add_u32 s60, s60, s61
    s_sub_u32 s93, s60, 851968
    s_min_u32 s60, s60, s93
    buffer_load_dwordx4 v2, s[40:43], s60 offen lds
    s_waitcnt lgkmcnt(0)
    v_lshl_add_u32 v18, v18, 7, v3
    v_lshl_add_u32 v19, v19, 7, v3
    s_waitcnt vmcnt(4)
    s_barrier
    ds_read_b128 v[60:63], v8 offset:16384
    ds_read_b64_tr_b16 v[44:45], v12 offset:16384
    ds_read_b64_tr_b16 v[46:47], v12 offset:16896
    v_mfma_f32_32x32x16_bf16 v[76:91], v[112:115], v[72:75], v[76:91]
    v_mfma_f32_32x32x16_bf16 v[28:43], v[56:59], v[72:75], v[28:43]
    ds_read_b128 v[64:67], v9 offset:16384
    ds_read_b64_tr_b16 v[48:49], v12 offset:18432
    ds_read_b64_tr_b16 v[50:51], v12 offset:18944
    s_add_u32 m0, s89, 49152
    s_nop 0
    buffer_load_dwordx4 v18, s[32:35], 0 offen  lds
    s_waitcnt lgkmcnt(3)
    v_mfma_f32_32x32x16_bf16 v[28:43], v[44:47], v[60:63], v[28:43]
    ds_read_b128 v[68:71], v10 offset:16384
    ds_read_b64_tr_b16 v[52:53], v12 offset:20480
    ds_read_b64_tr_b16 v[54:55], v12 offset:20992
    v_mov_b32 v213, v84
    s_add_u32 m0, s89, 57344
    s_nop 0
    buffer_load_dwordx4 v19, s[32:35], 0 offen  lds
    s_waitcnt lgkmcnt(3)
    v_mfma_f32_32x32x16_bf16 v[28:43], v[48:51], v[64:67], v[28:43]
    ds_read_b128 v[72:75], v11 offset:16384
    ds_read_b64_tr_b16 v[56:57], v12 offset:22528
    ds_read_b64_tr_b16 v[58:59], v12 offset:23040
    ds_read_b64 v[126:127], v13 offset:16384
    ds_read_b64 v[16:17], v26 offset:64
    s_add_u32 m0, s89, 114688
    s_add_u32 s60, s60, s61
    s_sub_u32 s93, s60, 851968
    s_min_u32 s60, s60, s93
    buffer_load_dwordx4 v2, s[40:43], s60 offen lds
    s_waitcnt lgkmcnt(5)
    v_mfma_f32_32x32x16_bf16 v[28:43], v[52:55], v[68:71], v[28:43]
    s_add_u32 m0, s89, 122880
    s_add_u32 s60, s60, s61
    s_sub_u32 s93, s60, 851968
    s_min_u32 s60, s60, s93
    buffer_load_dwordx4 v2, s[40:43], s60 offen lds
    s_waitcnt lgkmcnt(0)
    v_lshl_add_u32 v16, v16, 7, v3
    v_lshl_add_u32 v17, v17, 7, v3
    s_lshl_b32 s91, s88, 3
    s_add_u32 s91, s91, s86
    s_cmp_lg_u32 s91, 23
    s_cbranch_scc1 L_z2
    v_mov_b32 v240, 1
    v_mov_b32 v241, 0
    s_lshl_b32 s91, s87, 2
    s_mov_b64 exec, 1
    buffer_store_dword v240, v241, s[52:55], s91 offen sc0 sc1
    s_mov_b64 exec, -1
L_z2:
    s_waitcnt vmcnt(4)
    s_barrier
    ds_read_b128 v[60:63], v8 offset:32768
    ds_read_b64_tr_b16 v[44:45], v12 offset:32768
    ds_read_b64_tr_b16 v[46:47], v12 offset:33280
    v_mfma_f32_32x32x16_bf16 v[28:43], v[56:59], v[72:75], v[28:43]
    ds_read_b128 v[64:67], v9 offset:32768
    ds_read_b64_tr_b16 v[48:49], v12 offset:34816
    ds_read_b64_tr_b16 v[50:51], v12 offset:35328
    s_add_u32 m0, s89, 0
    s_nop 0
    buffer_load_dwordx4 v16, s[32:35], 0 offen  lds
    s_waitcnt lgkmcnt(3)
    v_mfma_f32_32x32x16_bf16 v[84:99], v[100:103], v[60:63], 0
    v_mfma_f32_32x32x16_bf16 v[28:43], v[44:47], v[60:63], v[28:43]
    ds_read_b128 v[68:71], v10 offset:32768
    ds_read_b64_tr_b16 v[52:53], v12 offset:36864
    ds_read_b64_tr_b16 v[54:55], v12 offset:37376
    s_add_u32 m0, s89, 8192
    s_nop 0
    buffer_load_dwordx4 v17, s[32:35], 0 offen  lds
    s_waitcnt lgkmcnt(3)
    v_mfma_f32_32x32x16_bf16 v[84:99], v[104:107], v[64:67], v[84:99]
    v_mfma_f32_32x32x16_bf16 v[28:43], v[48:51], v[64:67], v[28:43]
    ds_read_b128 v[72:75], v11 offset:32768
    ds_read_b64_tr_b16 v[56:57], v12 offset:38912
    ds_read_b64_tr_b16 v[58:59], v12 offset:39424
    ds_read_b64 v[128:129], v13 offset:32768
    ds_read_b64 v[18:19], v26 offset:72
    s_add_u32 m0, s89, 65536
    s_add_u32 s60, s60, s61
    s_sub_u32 s93, s60, 851968
    s_min_u32 s60, s60, s93
    buffer_load_dwordx4 v2, s[40:43], s60 offen lds
    s_waitcnt lgkmcnt(5)
    v_mfma_f32_32x32x16_bf16 v[84:99], v[108:111], v[68:71], v[84:99]
    v_mfma_f32_32x32x16_bf16 v[28:43], v[52:55], v[68:71], v[28:43]
    s_add_u32 m0, s89, 73728
    s_add_u32 s60, s60, s61
    s_sub_u32 s93, s60, 851968
    s_min_u32 s60, s60, s93
    buffer_load_dwordx4 v2, s[40:43], s60 offen lds
    s_waitcnt lgkmcnt(0)
    v_lshl_add_u32 v18, v18, 7, v3
    v_lshl_add_u32 v19, v19, 7, v3
    s_waitcnt vmcnt(4)
    s_barrier
    ds_read_b128 v[60:63], v8 offset:49152
    ds_read_b64_tr_b16 v[44:45], v12 offset:49152
    ds_read_b64_tr_b16 v[46:47], v12 offset:49664
    v_mfma_f32_32x32x16_bf16 v[84:99], v[112:115], v[72:75], v[84:99]
    v_mfma_f32_32x32x16_bf16 v[28:43], v[56:59], v[72:75], v[28:43]
    ds_read_b128 v[64:67], v9 offset:49152
    ds_read_b64_tr_b16 v[48:49], v12 offset:51200
    ds_read_b64_tr_b16 v[50:51], v12 offset:51712
    s_add_u32 m0, s89, 16384
    s_nop 0
    buffer_load_dwordx4 v18, s[32:35], 0 offen  lds
    s_waitcnt lgkmcnt(3)
    v_mfma_f32_32x32x16_bf16 v[28:43], v[44:47], v[60:63], v[28:43]
    ds_read_b128 v[68:71], v10 offset:49152
    ds_read_b64_tr_b16 v[52:53], v12 offset:53248
    ds_read_b64_tr_b16 v[54:55], v12 offset:53760
    v_cvt_pk_bf16_f32 v209, v213, v92
    v_cvt_pk_bf16_f32 v177, v76, v84
    v_cvt_pk_bf16_f32 v181, v77, v85
    v_cvt_pk_bf16_f32 v185, v78, v86
    v_cvt_pk_bf16_f32 v189, v79, v87
    v_cvt_pk_bf16_f32 v193, v80, v88
    v_cvt_pk_bf16_f32 v197, v81, v89
    v_cvt_pk_bf16_f32 v201, v82, v90
    v_cvt_pk_bf16_f32 v205, v83, v91
    s_add_u32 m0, s89, 24576
    s_nop 0
    buffer_load_dwordx4 v19, s[32:35], 0 offen  lds
    s_waitcnt lgkmcnt(3)
    v_mfma_f32_32x32x16_bf16 v[28:43], v[48:51], v[64:67], v[28:43]
    ds_read_b128 v[72:75], v11 offset:49152
    ds_read_b64_tr_b16 v[56:57], v12 offset:55296
    ds_read_b64_tr_b16 v[58:59], v12 offset:55808
    ds_read_b64 v[130:131], v13 offset:49152
    ds_read_b64 v[16:17], v26 offset:80
    s_add_u32 m0, s89, 81920
    s_add_u32 s60, s60, s61
    s_sub_u32 s93, s60, 851968
    s_min_u32 s60, s60, s93
    buffer_load_dwordx4 v2, s[40:43], s60 offen lds
    s_waitcnt lgkmcnt(5)
    v_mfma_f32_32x32x16_bf16 v[28:43], v[52:55], v[68:71], v[28:43]
    s_add_u32 m0, s89, 90112
    s_add_u32 s60, s60, s61
    s_sub_u32 s93, s60, 851968
    s_min_u32 s60, s60, s93
    buffer_load_dwordx4 v2, s[40:43], s60 offen lds
    s_waitcnt lgkmcnt(0)
    v_lshl_add_u32 v16, v16, 7, v3
    v_lshl_add_u32 v17, v17, 7, v3
    s_waitcnt vmcnt(4)
    s_barrier
    ds_read_b128 v[60:63], v8 offset:0
    ds_read_b64_tr_b16 v[44:45], v12 offset:0
    ds_read_b64_tr_b16 v[46:47], v12 offset:512
    v_mfma_f32_32x32x16_bf16 v[28:43], v[56:59], v[72:75], v[28:43]
    ds_read_b128 v[64:67], v9 offset:0
    ds_read_b64_tr_b16 v[48:49], v12 offset:2048
    ds_read_b64_tr_b16 v[50:51], v12 offset:2560
    s_add_u32 m0, s89, 32768
    s_nop 0
    buffer_load_dwordx4 v16, s[32:35], 0 offen  lds
    s_waitcnt lgkmcnt(3)
    v_mfma_f32_32x32x16_bf16 v[76:91], v[100:103], v[60:63], 0
    v_mfma_f32_32x32x16_bf16 v[28:43], v[44:47], v[60:63], v[28:43]
    ds_read_b128 v[68:71], v10 offset:0
    ds_read_b64_tr_b16 v[52:53], v12 offset:4096
    ds_read_b64_tr_b16 v[54:55], v12 offset:4608
    s_add_u32 m0, s89, 40960
    s_nop 0
    buffer_load_dwordx4 v17, s[32:35], 0 offen  lds
    s_waitcnt lgkmcnt(3)
    v_mfma_f32_32x32x16_bf16 v[76:91], v[104:107], v[64:67], v[76:91]
    v_mfma_f32_32x32x16_bf16 v[28:43], v[48:51], v[64:67], v[28:43]
    ds_read_b128 v[72:75], v11 offset:0
    ds_read_b64_tr_b16 v[56:57], v12 offset:6144
    ds_read_b64_tr_b16 v[58:59], v12 offset:6656
    ds_read_b64 v[132:133], v13 offset:0
    ds_read_b64 v[18:19], v26 offset:88
    s_add_u32 m0, s89, 98304
    s_add_u32 s60, s60, s61
    s_sub_u32 s93, s60, 851968
    s_min_u32 s60, s60, s93
    buffer_load_dwordx4 v2, s[40:43], s60 offen lds
    s_waitcnt lgkmcnt(5)
    v_mfma_f32_32x32x16_bf16 v[76:91], v[108:111], v[68:71], v[76:91]
    v_mfma_f32_32x32x16_bf16 v[28:43], v[52:55], v[68:71], v[28:43]
    s_add_u32 m0, s89, 106496
    s_add_u32 s60, s60, s61
    s_sub_u32 s93, s60, 851968
    s_min_u32 s60, s60, s93
    buffer_load_dwordx4 v2, s[40:43], s60 offen lds
    s_waitcnt lgkmcnt(0)
    v_lshl_add_u32 v18, v18, 7, v3
    v_lshl_add_u32 v19, v19, 7, v3
    s_waitcnt vmcnt(4)
    s_barrier
    ds_read_b128 v[60:63], v8 offset:16384
    ds_read_b64_tr_b16 v[44:45], v12 offset:16384
    ds_read_b64_tr_b16 v[46:47], v12 offset:16896
    v_mfma_f32_32x32x16_bf16 v[76:91], v[112:115], v[72:75], v[76:91]
    v_mfma_f32_32x32x16_bf16 v[28:43], v[56:59], v[72:75], v[28:43]
    ds_read_b128 v[64:67], v9 offset:16384
    ds_read_b64_tr_b16 v[48:49], v12 offset:18432
    ds_read_b64_tr_b16 v[50:51], v12 offset:18944
    s_add_u32 m0, s89, 49152
    s_nop 0
    buffer_load_dwordx4 v18, s[32:35], 0 offen  lds
    s_waitcnt lgkmcnt(3)
    v_mfma_f32_32x32x16_bf16 v[28:43], v[44:47], v[60:63], v[28:43]
    ds_read_b128 v[68:71], v10 offset:16384
    ds_read_b64_tr_b16 v[52:53], v12 offset:20480
    ds_read_b64_tr_b16 v[54:55], v12 offset:20992
    v_mov_b32 v213, v84
    s_add_u32 m0, s89, 57344
    s_nop 0
    buffer_load_dwordx4 v19, s[32:35], 0 offen  lds
    s_waitcnt lgkmcnt(3)
    v_mfma_f32_32x32x16_bf16 v[28:43], v[48:51], v[64:67], v[28:43]
    ds_read_b128 v[72:75], v11 offset:16384
    ds_read_b64_tr_b16 v[56:57], v12 offset:22528
    ds_read_b64_tr_b16 v[58:59], v12 offset:23040
    ds_read_b64 v[134:135], v13 offset:16384
    ds_read_b64 v[16:17], v26 offset:96
    s_add_u32 m0, s89, 114688
    s_add_u32 s60, s60, s61
    s_sub_u32 s93, s60, 851968
    s_min_u32 s60, s60, s93
    buffer_load_dwordx4 v2, s[40:43], s60 offen lds
    s_waitcnt lgkmcnt(5)
    v_mfma_f32_32x32x16_bf16 v[28:43], v[52:55], v[68:71], v[28:43]
    s_add_u32 m0, s89, 122880
    s_add_u32 s60, s60, s61
    s_sub_u32 s93, s60, 851968
    s_min_u32 s60, s60, s93
    buffer_load_dwordx4 v2, s[40:43], s60 offen lds
    s_waitcnt lgkmcnt(0)
    v_lshl_add_u32 v16, v16, 7, v3
    v_lshl_add_u32 v17, v17, 7, v3
    s_waitcnt vmcnt(4)
    s_barrier
    ds_read_b128 v[60:63], v8 offset:32768
    ds_read_b64_tr_b16 v[44:45], v12 offset:32768
    ds_read_b64_tr_b16 v[46:47], v12 offset:33280
    v_mfma_f32_32x32x16_bf16 v[28:43], v[56:59], v[72:75], v[28:43]
    ds_read_b128 v[64:67], v9 offset:32768
    ds_read_b64_tr_b16 v[48:49], v12 offset:34816
    ds_read_b64_tr_b16 v[50:51], v12 offset:35328
    s_add_u32 m0, s89, 0
    s_nop 0
    buffer_load_dwordx4 v16, s[32:35], 0 offen  lds
    s_waitcnt lgkmcnt(3)
    v_mfma_f32_32x32x16_bf16 v[84:99], v[100:103], v[60:63], 0
    v_mfma_f32_32x32x16_bf16 v[28:43], v[44:47], v[60:63], v[28:43]
    ds_read_b128 v[68:71], v10 offset:32768
    ds_read_b64_tr_b16 v[52:53], v12 offset:36864
    ds_read_b64_tr_b16 v[54:55], v12 offset:37376
    s_add_u32 m0, s89, 8192
    s_nop 0
    buffer_load_dwordx4 v17, s[32:35], 0 offen  lds
    s_waitcnt lgkmcnt(3)
    v_mfma_f32_32x32x16_bf16 v[84:99], v[104:107], v[64:67], v[84:99]
    v_mfma_f32_32x32x16_bf16 v[28:43], v[48:51], v[64:67], v[28:43]
    ds_read_b128 v[72:75], v11 offset:32768
    ds_read_b64_tr_b16 v[56:57], v12 offset:38912
    ds_read_b64_tr_b16 v[58:59], v12 offset:39424
    ds_read_b64 v[136:137], v13 offset:32768
    s_add_u32 m0, s89, 65536
    s_add_u32 s60, s60, s61
    s_sub_u32 s93, s60, 851968
    s_min_u32 s60, s60, s93
    buffer_load_dwordx4 v2, s[40:43], s60 offen lds
    s_waitcnt lgkmcnt(4)
    v_mfma_f32_32x32x16_bf16 v[84:99], v[108:111], v[68:71], v[84:99]
    v_mfma_f32_32x32x16_bf16 v[28:43], v[52:55], v[68:71], v[28:43]
    s_add_u32 m0, s89, 73728
    s_add_u32 s60, s60, s61
    s_sub_u32 s93, s60, 851968
    s_min_u32 s60, s60, s93
    buffer_load_dwordx4 v2, s[40:43], s60 offen lds
    s_waitcnt vmcnt(4)
    s_barrier
    ds_read_b128 v[60:63], v8 offset:49152
    ds_read_b64_tr_b16 v[44:45], v12 offset:49152
    ds_read_b64_tr_b16 v[46:47], v12 offset:49664
    s_waitcnt lgkmcnt(4)
    v_mfma_f32_32x32x16_bf16 v[84:99], v[112:115], v[72:75], v[84:99]
    v_mfma_f32_32x32x16_bf16 v[28:43], v[56:59], v[72:75], v[28:43]
    ds_read_b128 v[64:67], v9 offset:49152
    ds_read_b64_tr_b16 v[48:49], v12 offset:51200
    ds_read_b64_tr_b16 v[50:51], v12 offset:51712
    s_add_u32 m0, s89, 131072
    s_nop 0
    buffer_load_dwordx4 v7, s[36:39], s28 offen lds
    s_waitcnt lgkmcnt(3)
    v_mfma_f32_32x32x16_bf16 v[28:43], v[44:47], v[60:63], v[28:43]
    ds_read_b128 v[68:71], v10 offset:49152
    ds_read_b64_tr_b16 v[52:53], v12 offset:53248
    ds_read_b64_tr_b16 v[54:55], v12 offset:53760
    v_cvt_pk_bf16_f32 v210, v213, v92
    v_cvt_pk_bf16_f32 v178, v76, v84
    v_cvt_pk_bf16_f32 v182, v77, v85
    v_cvt_pk_bf16_f32 v186, v78, v86
    v_cvt_pk_bf16_f32 v190, v79, v87
    v_cvt_pk_bf16_f32 v194, v80, v88
    v_cvt_pk_bf16_f32 v198, v81, v89
    v_cvt_pk_bf16_f32 v202, v82, v90
    v_cvt_pk_bf16_f32 v206, v83, v91
    s_add_u32 m0, s89, 139264
    s_nop 0
    buffer_load_dwordx4 v7, s[36:39], s29 offen lds
    s_lshl_b32 s91, s86, 11
    v_lshl_add_u32 v16, v1, 4, s91
    v_xor_b32 v17, 8192, v16
    v_lshrrev_b32 v250, 4, v1
    s_and_b32 s92, s86, 3
    s_lshl_b32 s92, s92, 8
    v_lshl_add_u32 v250, v250, 10, s92
    v_and_b32 v251, 15, v1
    v_lshl_add_u32 v18, v251, 4, v250
    v_add_u32 v26, 81920, v18
    v_add_u32 v18, 157696, v18
    s_waitcnt lgkmcnt(3)
    v_mfma_f32_32x32x16_bf16 v[28:43], v[48:51], v[64:67], v[28:43]
    ds_read_b128 v[72:75], v11 offset:49152
    ds_read_b64_tr_b16 v[56:57], v12 offset:55296
    ds_read_b64_tr_b16 v[58:59], v12 offset:55808
    ds_read_b64 v[138:139], v13 offset:49152
    s_add_u32 m0, s89, 147456
    s_nop 0
    buffer_load_dwordx4 v7, s[36:39], s30 offen lds
    v_lshrrev_b32 v250, 5, v1
    v_and_b32 v251, 31, v1
    s_and_b32 s91, s86, 1
    s_lshl_b32 s92, s91, 9
    s_add_u32 s92, s92, 81920
    v_lshl_add_u32 v252, v250, 12, s92
    v_lshl_add_u32 v3, v251, 4, v252
    s_lshl_b32 s91, s91, 10
    s_lshr_b32 s92, s86, 1
    s_lshl_b32 s92, s92, 3
    s_add_u32 s91, s91, s92
    s_add_u32 s91, s91, 16384
    v_lshl_add_u32 v252, v250, 2, s91
    v_lshl_add_u32 v2, v251, 5, v252
    s_waitcnt lgkmcnt(4)
    v_mfma_f32_32x32x16_bf16 v[28:43], v[52:55], v[68:71], v[28:43]
    s_waitcnt vmcnt(3) lgkmcnt(0)
    s_barrier
    s_setprio 3
    ds_read_b128 v[60:63], v8 offset:0
    ds_read_b64_tr_b16 v[44:45], v12 offset:0
    ds_read_b64_tr_b16 v[46:47], v12 offset:512
    v_mfma_f32_32x32x16_bf16 v[28:43], v[56:59], v[72:75], v[28:43]
    ds_read_b128 v[64:67], v9 offset:0
    ds_read_b64_tr_b16 v[48:49], v12 offset:2048
    ds_read_b64_tr_b16 v[50:51], v12 offset:2560
    s_lshr_b32 s91, s86, 1
    s_cmp_lg_u32 s91, 0
    s_cbranch_scc1 L_wc3
    s_add_u32 m0, s89, 155648
    s_nop 0
    buffer_load_dwordx4 v7, s[36:39], s31 offen lds
L_wc3:
    s_waitcnt lgkmcnt(3)
    v_mfma_f32_32x32x16_bf16 v[76:91], v[100:103], v[60:63], 0
    v_mfma_f32_32x32x16_bf16 v[28:43], v[44:47], v[60:63], v[28:43]
    ds_read_b128 v[68:71], v10 offset:0
    ds_read_b64_tr_b16 v[52:53], v12 offset:4096
    ds_read_b64_tr_b16 v[54:55], v12 offset:4608
    s_waitcnt lgkmcnt(3)
    v_mfma_f32_32x32x16_bf16 v[76:91], v[104:107], v[64:67], v[76:91]
    v_mfma_f32_32x32x16_bf16 v[28:43], v[48:51], v[64:67], v[28:43]
    ds_read_b128 v[72:75], v11 offset:0
    ds_read_b64_tr_b16 v[56:57], v12 offset:6144
    ds_read_b64_tr_b16 v[58:59], v12 offset:6656
    ds_read_b64 v[140:141], v13 offset:0
    s_waitcnt lgkmcnt(4)
    v_mfma_f32_32x32x16_bf16 v[76:91], v[108:111], v[68:71], v[76:91]
    s_waitcnt lgkmcnt(1)
    v_mfma_f32_32x32x16_bf16 v[76:91], v[112:115], v[72:75], v[76:91]
    v_mfma_f32_32x32x16_bf16 v[28:43], v[52:55], v[68:71], v[28:43]
    v_mfma_f32_32x32x16_bf16 v[28:43], v[56:59], v[72:75], v[28:43]
    s_cmp_lg_u32 s86, 0
    s_cbranch_scc1 L_f4
    v_mov_b32 v0, 0
    s_lshl_b32 s91, s87, 2
    buffer_load_dword v6, v0, s[52:55], s91 offen sc0 sc1
L_f4:
    s_nop 7
    v_cvt_pk_bf16_f32 v211, v84, 0
    ds_write_b128 v14, v[208:211]
    v_cvt_pk_bf16_f32 v179, v76, 0
    ds_write_b128 v16, v[36:39] offset:49152
    v_cvt_pk_bf16_f32 v183, v77, 0
    v_cvt_pk_bf16_f32 v187, v78, 0
    v_cvt_pk_bf16_f32 v191, v79, 0
    ds_write_b128 v16, v[40:43] offset:50176
    v_cvt_pk_bf16_f32 v195, v80, 0
    v_cvt_pk_bf16_f32 v199, v81, 0
    v_cvt_pk_bf16_f32 v203, v82, 0
    v_cvt_pk_bf16_f32 v207, v83, 0
    s_waitcnt lgkmcnt(0)
    s_barrier
    s_setprio 0
    s_add_u32 m0, s89, 0
    s_add_u32 s91, s28, 86528
    buffer_load_dwordx4 v7, s[36:39], s91 offen lds
    ds_write_b128 v15, v[176:179] offset:0
    ds_write_b128 v15, v[180:183] offset:2048
    ds_write_b128 v15, v[184:187] offset:4096
    s_add_u32 m0, s89, 8192
    s_add_u32 s91, s29, 86528
    buffer_load_dwordx4 v7, s[36:39], s91 offen lds
    ds_write_b128 v15, v[188:191] offset:6144
    ds_write_b128 v15, v[192:195] offset:16384
    ds_write_b128 v15, v[196:199] offset:18432
    s_add_u32 m0, s89, 65536
    s_add_u32 s91, s30, 86528
    buffer_load_dwordx4 v7, s[36:39], s91 offen lds
    ds_write_b128 v15, v[200:203] offset:20480
    ds_write_b128 v15, v[204:207] offset:22528
    s_lshr_b32 s91, s86, 1
    s_cmp_lg_u32 s91, 1
    s_cbranch_scc1 L_wc5
    s_add_u32 m0, s89, 71680
    s_add_u32 s91, s31, 86528
    buffer_load_dwordx4 v7, s[36:39], s91 offen lds
L_wc5:
    ds_read_b128 v[36:39], v17 offset:49152
    ds_read_b128 v[40:43], v17 offset:50176
    ds_read_b128 v[148:151], v27 offset:0
    ds_read_b128 v[156:159], v27 offset:2048
    s_waitcnt lgkmcnt(2)
    v_pk_add_f32 v[28:29], v[28:29], v[36:37]
    v_pk_add_f32 v[30:31], v[30:31], v[38:39]
    ds_read_b128 v[164:167], v27 offset:4096
    v_pk_add_f32 v[32:33], v[32:33], v[40:41]
    v_pk_add_f32 v[34:35], v[34:35], v[42:43]
    v_pk_mul_f32 v[36:37], v[28:29], v[28:29]
    ds_read_b128 v[172:175], v27 offset:6144
    v_pk_mul_f32 v[38:39], v[30:31], v[30:31]
    v_pk_mul_f32 v[40:41], v[32:33], v[32:33]
    v_pk_mul_f32 v[42:43], v[34:35], v[34:35]
    v_pk_fma_f32 v[36:37], v[36:37], v[142:143], v[142:143] op_sel:[0,0,1] op_sel_hi:[1,0,1]
    v_pk_fma_f32 v[38:39], v[38:39], v[142:143], v[142:143] op_sel:[0,0,1] op_sel_hi:[1,0,1]
    v_pk_fma_f32 v[40:41], v[40:41], v[142:143], v[142:143] op_sel:[0,0,1] op_sel_hi:[1,0,1]
    v_pk_fma_f32 v[42:43], v[42:43], v[142:143], v[142:143] op_sel:[0,0,1] op_sel_hi:[1,0,1]
    v_pk_mul_f32 v[36:37], v[36:37], v[28:29]
    v_pk_mul_f32 v[38:39], v[38:39], v[30:31]
    v_pk_mul_f32 v[40:41], v[40:41], v[32:33]
    v_pk_mul_f32 v[42:43], v[42:43], v[34:35]
    v_pk_mul_f32 v[108:109], v[216:217], v[28:29]
    v_pk_mul_f32 v[110:111], v[218:219], v[30:31]
    v_pk_mul_f32 v[112:113], v[220:221], v[32:33]
    v_pk_mul_f32 v[114:115], v[222:223], v[34:35]
    s_branch L_tail
L_k1:
    s_waitcnt vmcnt(6)
    s_barrier
    ds_read_b128 v[60:63], v8 offset:0
    ds_read_b64_tr_b16 v[44:45], v12 offset:0
    ds_read_b64_tr_b16 v[46:47], v12 offset:512
    ds_read_b128 v[64:67], v9 offset:0
    ds_read_b64_tr_b16 v[48:49], v12 offset:2048
    ds_read_b64_tr_b16 v[50:51], v12 offset:2560
    s_add_u32 m0, s89, 98304
    s_add_u32 s60, s60, s61
    s_sub_u32 s93, s60, 851968
    s_min_u32 s60, s60, s93
    buffer_load_dwordx4 v2, s[40:43], s60 offen lds
    s_waitcnt lgkmcnt(3)
    v_mfma_f32_32x32x16_bf16 v[28:43], v[44:47], v[60:63], 0
    ds_read_b128 v[68:71], v10 offset:0
    ds_read_b64_tr_b16 v[52:53], v12 offset:4096
    ds_read_b64_tr_b16 v[54:55], v12 offset:4608
    s_add_u32 m0, s89, 106496
    s_add_u32 s60, s60, s61
    s_sub_u32 s93, s60, 851968
    s_min_u32 s60, s60, s93
    buffer_load_dwordx4 v2, s[40:43], s60 offen lds
    s_waitcnt lgkmcnt(3)
    v_mfma_f32_32x32x16_bf16 v[28:43], v[48:51], v[64:67], v[28:43]
    ds_read_b128 v[72:75], v11 offset:0
    ds_read_b64_tr_b16 v[56:57], v12 offset:6144
    ds_read_b64_tr_b16 v[58:59], v12 offset:6656
    ds_read_b64 v[116:117], v13 offset:0
    s_add_u32 m0, s89, 49152
    s_nop 0
    buffer_load_dwordx4 v18, s[32:35], 0 offen  lds
    s_waitcnt lgkmcnt(4)
    v_mfma_f32_32x32x16_bf16 v[28:43], v[52:55], v[68:71], v[28:43]
    s_add_u32 m0, s89, 57344
    s_nop 0
    buffer_load_dwordx4 v19, s[32:35], 0 offen  lds
    s_waitcnt vmcnt(6)
    s_barrier
    ds_read_b128 v[60:63], v8 offset:16384
    ds_read_b64_tr_b16 v[44:45], v12 offset:16384
    ds_read_b64_tr_b16 v[46:47], v12 offset:16896
    s_waitcnt lgkmcnt(4)
    v_mfma_f32_32x32x16_bf16 v[28:43], v[56:59], v[72:75], v[28:43]
    ds_read_b128 v[64:67], v9 offset:16384
    ds_read_b64_tr_b16 v[48:49], v12 offset:18432
    ds_read_b64_tr_b16 v[50:51], v12 offset:18944
    s_waitcnt lgkmcnt(3)
    v_mfma_f32_32x32x16_bf16 v[76:91], v[100:103], v[60:63], 0
    v_mfma_f32_32x32x16_bf16 v[28:43], v[44:47], v[60:63], v[28:43]
    ds_read_b128 v[68:71], v10 offset:16384
    ds_read_b64_tr_b16 v[52:53], v12 offset:20480
    ds_read_b64_tr_b16 v[54:55], v12 offset:20992
    s_waitcnt lgkmcnt(3)
    v_mfma_f32_32x32x16_bf16 v[76:91], v[104:107], v[64:67], v[76:91]
    v_mfma_f32_32x32x16_bf16 v[28:43], v[48:51], v[64:67], v[28:43]
    ds_read_b128 v[72:75], v11 offset:16384
    ds_read_b64_tr_b16 v[56:57], v12 offset:22528
    ds_read_b64_tr_b16 v[58:59], v12 offset:23040
    ds_read_b64 v[118:119], v13 offset:16384
    ds_read_b64 v[16:17], v26 offset:32
    s_add_u32 m0, s89, 114688
    s_add_u32 s60, s60, s61
    s_sub_u32 s93, s60, 851968
    s_min_u32 s60, s60, s93
    buffer_load_dwordx4 v2, s[40:43], s60 offen lds
    s_waitcnt lgkmcnt(5)
    v_mfma_f32_32x32x16_bf16 v[76:91], v[108:111], v[68:71], v[76:91]
    v_mfma_f32_32x32x16_bf16 v[28:43], v[52:55], v[68:71], v[28:43]
    s_add_u32 m0, s89, 122880
    s_add_u32 s60, s60, s61
    s_sub_u32 s93, s60, 851968
    s_min_u32 s60, s60, s93
    buffer_load_dwordx4 v2, s[40:43], s60 offen lds
    s_waitcnt lgkmcnt(0)
    v_lshl_add_u32 v16, v16, 7, v3
    v_lshl_add_u32 v17, v17, 7, v3
    s_waitcnt vmcnt(4)
    s_barrier
    ds_read_b128 v[60:63], v8 offset:32768
    ds_read_b64_tr_b16 v[44:45], v12 offset:32768
    ds_read_b64_tr_b16 v[46:47], v12 offset:33280
    v_mfma_f32_32x32x16_bf16 v[76:91], v[112:115], v[72:75], v[76:91]
    v_mfma_f32_32x32x16_bf16 v[28:43], v[56:59], v[72:75], v[28:43]
    ds_read_b128 v[64:67], v9 offset:32768
    ds_read_b64_tr_b16 v[48:49], v12 offset:34816
    ds_read_b64_tr_b16 v[50:51], v12 offset:35328
    s_add_u32 m0, s89, 0
    s_nop 0
    buffer_load_dwordx4 v16, s[32:35], 0 offen  lds
    s_waitcnt lgkmcnt(3)
    v_mfma_f32_32x32x16_bf16 v[28:43], v[44:47], v[60:63], v[28:43]
    ds_read_b128 v[68:71], v10 offset:32768
    ds_read_b64_tr_b16 v[52:53], v12 offset:36864
    ds_read_b64_tr_b16 v[54:55], v12 offset:37376
    v_mov_b32 v213, v84
    s_add_u32 m0, s89, 8192
    s_nop 0
    buffer_load_dwordx4 v17, s[32:35], 0 offen  lds
    s_waitcnt lgkmcnt(3)
    v_mfma_f32_32x32x16_bf16 v[28:43], v[48:51], v[64:67], v[28:43]
    ds_read_b128 v[72:75], v11 offset:32768
    ds_read_b64_tr_b16 v[56:57], v12 offset:38912
    ds_read_b64_tr_b16 v[58:59], v12 offset:39424
    ds_read_b64 v[120:121], v13 offset:32768
    ds_read_b64 v[18:19], v26 offset:40
    s_add_u32 m0, s89, 65536
    s_add_u32 s60, s60, s61
    s_sub_u32 s93, s60, 851968
    s_min_u32 s60, s60, s93
    buffer_load_dwordx4 v2, s[40:43], s60 offen lds
    s_waitcnt lgkmcnt(5)
    v_mfma_f32_32x32x16_bf16 v[28:43], v[52:55], v[68:71], v[28:43]
    s_add_u32 m0, s89, 73728
    s_add_u32 s60, s60, s61
    s_sub_u32 s93, s60, 851968
    s_min_u32 s60, s60, s93
    buffer_load_dwordx4 v2, s[40:43], s60 offen lds
    s_waitcnt lgkmcnt(0)
    v_lshl_add_u32 v18, v18, 7, v3
    v_lshl_add_u32 v19, v19, 7, v3
    s_waitcnt vmcnt(4)
    s_barrier
    ds_read_b128 v[60:63], v8 offset:49152
    ds_read_b64_tr_b16 v[44:45], v12 offset:49152
    ds_read_b64_tr_b16 v[46:47], v12 offset:49664
    v_mfma_f32_32x32x16_bf16 v[28:43], v[56:59], v[72:75], v[28:43]
    ds_read_b128 v[64:67], v9 offset:49152
    ds_read_b64_tr_b16 v[48:49], v12 offset:51200
    ds_read_b64_tr_b16 v[50:51], v12 offset:51712
    s_add_u32 m0, s89, 16384
    s_nop 0
    buffer_load_dwordx4 v18, s[32:35], 0 offen  lds
    s_waitcnt lgkmcnt(3)
    v_mfma_f32_32x32x16_bf16 v[84:99], v[100:103], v[60:63], 0
    v_mfma_f32_32x32x16_bf16 v[28:43], v[44:47], v[60:63], v[28:43]
    ds_read_b128 v[68:71], v10 offset:49152
    ds_read_b64_tr_b16 v[52:53], v12 offset:53248
    ds_read_b64_tr_b16 v[54:55], v12 offset:53760
    s_add_u32 m0, s89, 24576
    s_nop 0
    buffer_load_dwordx4 v19, s[32:35], 0 offen  lds
    s_waitcnt lgkmcnt(3)
    v_mfma_f32_32x32x16_bf16 v[84:99], v[104:107], v[64:67], v[84:99]
    v_mfma_f32_32x32x16_bf16 v[28:43], v[48:51], v[64:67], v[28:43]
    ds_read_b128 v[72:75], v11 offset:49152
    ds_read_b64_tr_b16 v[56:57], v12 offset:55296
    ds_read_b64_tr_b16 v[58:59], v12 offset:55808
    ds_read_b64 v[122:123], v13 offset:49152
    ds_read_b64 v[16:17], v26 offset:48
    s_add_u32 m0, s89, 81920
    s_add_u32 s60, s60, s61
    s_sub_u32 s93, s60, 851968
    s_min_u32 s60, s60, s93
    buffer_load_dwordx4 v2, s[40:43], s60 offen lds
    s_waitcnt lgkmcnt(5)
    v_mfma_f32_32x32x16_bf16 v[84:99], v[108:111], v[68:71], v[84:99]
    v_mfma_f32_32x32x16_bf16 v[28:43], v[52:55], v[68:71], v[28:43]
    s_add_u32 m0, s89, 90112
    s_add_u32 s60, s60, s61
    s_sub_u32 s93, s60, 851968
    s_min_u32 s60, s60, s93
    buffer_load_dwordx4 v2, s[40:43], s60 offen lds
    s_waitcnt lgkmcnt(0)
    v_lshl_add_u32 v16, v16, 7, v3
    v_lshl_add_u32 v17, v17, 7, v3
    s_waitcnt vmcnt(4)
    s_barrier
    ds_read_b128 v[60:63], v8 offset:0
    ds_read_b64_tr_b16 v[44:45], v12 offset:0
    ds_read_b64_tr_b16 v[46:47], v12 offset:512
    v_mfma_f32_32x32x16_bf16 v[84:99], v[112:115], v[72:75], v[84:99]
    v_mfma_f32_32x32x16_bf16 v[28:43], v[56:59], v[72:75], v[28:43]
    ds_read_b128 v[64:67], v9 offset:0
    ds_read_b64_tr_b16 v[48:49], v12 offset:2048
    ds_read_b64_tr_b16 v[50:51], v12 offset:2560
    s_add_u32 m0, s89, 32768
    s_nop 0
    buffer_load_dwordx4 v16, s[32:35], 0 offen  lds
    s_waitcnt lgkmcnt(3)
    v_mfma_f32_32x32x16_bf16 v[28:43], v[44:47], v[60:63], v[28:43]
    ds_read_b128 v[68:71], v10 offset:0
    ds_read_b64_tr_b16 v[52:53], v12 offset:4096
    ds_read_b64_tr_b16 v[54:55], v12 offset:4608
    v_cvt_pk_bf16_f32 v208, v213, v92
    v_cvt_pk_bf16_f32 v176, v76, v84
    v_cvt_pk_bf16_f32 v180, v77, v85
    v_cvt_pk_bf16_f32 v184, v78, v86
    v_cvt_pk_bf16_f32 v188, v79, v87
    v_cvt_pk_bf16_f32 v192, v80, v88
    v_cvt_pk_bf16_f32 v196, v81, v89
    v_cvt_pk_bf16_f32 v200, v82, v90
    v_cvt_pk_bf16_f32 v204, v83, v91
    s_add_u32 m0, s89, 40960
    s_nop 0
    buffer_load_dwordx4 v17, s[32:35], 0 offen  lds
    s_waitcnt lgkmcnt(3)
    v_mfma_f32_32x32x16_bf16 v[28:43], v[48:51], v[64:67], v[28:43]
    ds_read_b128 v[72:75], v11 offset:0
    ds_read_b64_tr_b16 v[56:57], v12 offset:6144
    ds_read_b64_tr_b16 v[58:59], v12 offset:6656
    ds_read_b64 v[124:125], v13 offset:0
    ds_read_b64 v[18:19], v26 offset:56
    s_add_u32 m0, s89, 98304
    s_add_u32 s60, s60, s61
    s_sub_u32 s93, s60, 851968
    s_min_u32 s60, s60, s93
    buffer_load_dwordx4 v2, s[40:43], s60 offen lds
    s_waitcnt lgkmcnt(5)
    v_mfma_f32_32x32x16_bf16 v[28:43], v[52:55], v[68:71], v[28:43]
    s_add_u32 m0, s89, 106496
    s_add_u32 s60, s60, s61
    s_sub_u32 s93, s60, 851968
    s_min_u32 s60, s60, s93
    buffer_load_dwordx4 v2, s[40:43], s60 offen lds
    s_waitcnt lgkmcnt(0)
    v_lshl_add_u32 v18, v18, 7, v3
    v_lshl_add_u32 v19, v19, 7, v3
    s_waitcnt vmcnt(4)
    s_barrier
    ds_read_b128 v[60:63], v8 offset:16384
    ds_read_b64_tr_b16 v[44:45], v12 offset:16384
    ds_read_b64_tr_b16 v[46:47], v12 offset:16896
    v_mfma_f32_32x32x16_bf16 v[28:43], v[56:59], v[72:75], v[28:43]
    ds_read_b128 v[64:67], v9 offset:16384
    ds_read_b64_tr_b16 v[48:49], v12 offset:18432
    ds_read_b64_tr_b16 v[50:51], v12 offset:18944
    s_add_u32 m0, s89, 49152
    s_nop 0
    buffer_load_dwordx4 v18, s[32:35], 0 offen  lds
    s_waitcnt lgkmcnt(3)
    v_mfma_f32_32x32x16_bf16 v[76:91], v[100:103], v[60:63], 0
    v_mfma_f32_32x32x16_bf16 v[28:43], v[44:47], v[60:63], v[28:43]
    ds_read_b128 v[68:71], v10 offset:16384
    ds_read_b64_tr_b16 v[52:53], v12 offset:20480
    ds_read_b64_tr_b16 v[54:55], v12 offset:20992
    s_add_u32 m0, s89, 57344
    s_nop 0
    buffer_load_dwordx4 v19, s[32:35], 0 offen  lds
    s_waitcnt lgkmcnt(3)
    v_mfma_f32_32x32x16_bf16 v[76:91], v[104:107], v[64:67], v[76:91]
    v_mfma_f32_32x32x16_bf16 v[28:43], v[48:51], v[64:67], v[28:43]
    ds_read_b128 v[72:75], v11 offset:16384
    ds_read_b64_tr_b16 v[56:57], v12 offset:22528
    ds_read_b64_tr_b16 v[58:59], v12 offset:23040
    ds_read_b64 v[126:127], v13 offset:16384
    ds_read_b64 v[16:17], v26 offset:64
    s_add_u32 m0, s89, 114688
    s_add_u32 s60, s60, s61
    s_sub_u32 s93, s60, 851968
    s_min_u32 s60, s60, s93
    buffer_load_dwordx4 v2, s[40:43], s60 offen lds
    s_waitcnt lgkmcnt(5)
    v_mfma_f32_32x32x16_bf16 v[76:91], v[108:111], v[68:71], v[76:91]
    v_mfma_f32_32x32x16_bf16 v[28:43], v[52:55], v[68:71], v[28:43]
    s_add_u32 m0, s89, 122880
    s_add_u32 s60, s60, s61
    s_sub_u32 s93, s60, 851968
    s_min_u32 s60, s60, s93
    buffer_load_dwordx4 v2, s[40:43], s60 offen lds
    s_waitcnt lgkmcnt(0)
    v_lshl_add_u32 v16, v16, 7, v3
    v_lshl_add_u32 v17, v17, 7, v3
    s_waitcnt vmcnt(4)
    s_barrier
    ds_read_b128 v[60:63], v8 offset:32768
    ds_read_b64_tr_b16 v[44:45], v12 offset:32768
    ds_read_b64_tr_b16 v[46:47], v12 offset:33280
    v_mfma_f32_32x32x16_bf16 v[76:91], v[112:115], v[72:75], v[76:91]
    v_mfma_f32_32x32x16_bf16 v[28:43], v[56:59], v[72:75], v[28:43]
    ds_read_b128 v[64:67], v9 offset:32768
    ds_read_b64_tr_b16 v[48:49], v12 offset:34816
    ds_read_b64_tr_b16 v[50:51], v12 offset:35328
    s_add_u32 m0, s89, 0
    s_nop 0
    buffer_load_dwordx4 v16, s[32:35], 0 offen  lds
    s_waitcnt lgkmcnt(3)
    v_mfma_f32_32x32x16_bf16 v[28:43], v[44:47], v[60:63], v[28:43]
    ds_read_b128 v[68:71], v10 offset:32768
    ds_read_b64_tr_b16 v[52:53], v12 offset:36864
    ds_read_b64_tr_b16 v[54:55], v12 offset:37376
    v_mov_b32 v213, v84
    s_add_u32 m0, s89, 8192
    s_nop 0
    buffer_load_dwordx4 v17, s[32:35], 0 offen  lds
    s_waitcnt lgkmcnt(3)
    v_mfma_f32_32x32x16_bf16 v[28:43], v[48:51], v[64:67], v[28:43]
    ds_read_b128 v[72:75], v11 offset:32768
    ds_read_b64_tr_b16 v[56:57], v12 offset:38912
    ds_read_b64_tr_b16 v[58:59], v12 offset:39424
    ds_read_b64 v[128:129], v13 offset:32768
    ds_read_b64 v[18:19], v26 offset:72
    s_add_u32 m0, s89, 65536
    s_add_u32 s60, s60, s61
    s_sub_u32 s93, s60, 851968
    s_min_u32 s60, s60, s93
    buffer_load_dwordx4 v2, s[40:43], s60 offen lds
    s_waitcnt lgkmcnt(5)
    v_mfma_f32_32x32x16_bf16 v[28:43], v[52:55], v[68:71], v[28:43]
    s_add_u32 m0, s89, 73728
    s_add_u32 s60, s60, s61
    s_sub_u32 s93, s60, 851968
    s_min_u32 s60, s60, s93
    buffer_load_dwordx4 v2, s[40:43], s60 offen lds
    s_waitcnt lgkmcnt(0)
    v_lshl_add_u32 v18, v18, 7, v3
    v_lshl_add_u32 v19, v19, 7, v3
    s_waitcnt vmcnt(4)
    s_barrier
    ds_read_b128 v[60:63], v8 offset:49152
    ds_read_b64_tr_b16 v[44:45], v12 offset:49152
    ds_read_b64_tr_b16 v[46:47], v12 offset:49664
    v_mfma_f32_32x32x16_bf16 v[28:43], v[56:59], v[72:75], v[28:43]
    ds_read_b128 v[64:67], v9 offset:49152
    ds_read_b64_tr_b16 v[48:49], v12 offset:51200
    ds_read_b64_tr_b16 v[50:51], v12 offset:51712
    s_add_u32 m0, s89, 16384
    s_nop 0
    buffer_load_dwordx4 v18, s[32:35], 0 offen  lds
    s_waitcnt lgkmcnt(3)
    v_mfma_f32_32x32x16_bf16 v[84:99], v[100:103], v[60:63], 0
    v_mfma_f32_32x32x16_bf16 v[28:43], v[44:47], v[60:63], v[28:43]
    ds_read_b128 v[68:71], v10 offset:49152
    ds_read_b64_tr_b16 v[52:53], v12 offset:53248
    ds_read_b64_tr_b16 v[54:55], v12 offset:53760
    s_add_u32 m0, s89, 24576
    s_nop 0
    buffer_load_dwordx4 v19, s[32:35], 0 offen  lds
    s_waitcnt lgkmcnt(3)
    v_mfma_f32_32x32x16_bf16 v[84:99], v[104:107], v[64:67], v[84:99]
    v_mfma_f32_32x32x16_bf16 v[28:43], v[48:51], v[64:67], v[28:43]
    ds_read_b128 v[72:75], v11 offset:49152
    ds_read_b64_tr_b16 v[56:57], v12 offset:55296
    ds_read_b64_tr_b16 v[58:59], v12 offset:55808
    ds_read_b64 v[130:131], v13 offset:49152
    ds_read_b64 v[16:17], v26 offset:80
    s_add_u32 m0, s89, 81920
    s_add_u32 s60, s60, s61
    s_sub_u32 s93, s60, 851968
    s_min_u32 s60, s60, s93
    buffer_load_dwordx4 v2, s[40:43], s60 offen lds
    s_waitcnt lgkmcnt(5)
    v_mfma_f32_32x32x16_bf16 v[84:99], v[108:111], v[68:71], v[84:99]
    v_mfma_f32_32x32x16_bf16 v[28:43], v[52:55], v[68:71], v[28:43]
    s_add_u32 m0, s89, 90112
    s_add_u32 s60, s60, s61
    s_sub_u32 s93, s60, 851968
    s_min_u32 s60, s60, s93
    buffer_load_dwordx4 v2, s[40:43], s60 offen lds
    s_waitcnt lgkmcnt(0)
    v_lshl_add_u32 v16, v16, 7, v3
    v_lshl_add_u32 v17, v17, 7, v3
    s_waitcnt vmcnt(4)
    s_barrier
    ds_read_b128 v[60:63], v8 offset:0
    ds_read_b64_tr_b16 v[44:45], v12 offset:0
    ds_read_b64_tr_b16 v[46:47], v12 offset:512
    v_mfma_f32_32x32x16_bf16 v[84:99], v[112:115], v[72:75], v[84:99]
    v_mfma_f32_32x32x16_bf16 v[28:43], v[56:59], v[72:75], v[28:43]
    ds_read_b128 v[64:67], v9 offset:0
    ds_read_b64_tr_b16 v[48:49], v12 offset:2048
    ds_read_b64_tr_b16 v[50:51], v12 offset:2560
    s_add_u32 m0, s89, 32768
    s_nop 0
    buffer_load_dwordx4 v16, s[32:35], 0 offen  lds
    s_waitcnt lgkmcnt(3)
    v_mfma_f32_32x32x16_bf16 v[28:43], v[44:47], v[60:63], v[28:43]
    ds_read_b128 v[68:71], v10 offset:0
    ds_read_b64_tr_b16 v[52:53], v12 offset:4096
    ds_read_b64_tr_b16 v[54:55], v12 offset:4608
    v_cvt_pk_bf16_f32 v209, v213, v92
    v_cvt_pk_bf16_f32 v177, v76, v84
    v_cvt_pk_bf16_f32 v181, v77, v85
    v_cvt_pk_bf16_f32 v185, v78, v86
    v_cvt_pk_bf16_f32 v189, v79, v87
    v_cvt_pk_bf16_f32 v193, v80, v88
    v_cvt_pk_bf16_f32 v197, v81, v89
    v_cvt_pk_bf16_f32 v201, v82, v90
    v_cvt_pk_bf16_f32 v205, v83, v91
    s_add_u32 m0, s89, 40960
    s_nop 0
    buffer_load_dwordx4 v17, s[32:35], 0 offen  lds
    s_waitcnt lgkmcnt(3)
    v_mfma_f32_32x32x16_bf16 v[28:43], v[48:51], v[64:67], v[28:43]
    ds_read_b128 v[72:75], v11 offset:0
    ds_read_b64_tr_b16 v[56:57], v12 offset:6144
    ds_read_b64_tr_b16 v[58:59], v12 offset:6656
    ds_read_b64 v[132:133], v13 offset:0
    ds_read_b64 v[18:19], v26 offset:88
    s_add_u32 m0, s89, 98304
    s_add_u32 s60, s60, s61
    s_sub_u32 s93, s60, 851968
    s_min_u32 s60, s60, s93
    buffer_load_dwordx4 v2, s[40:43], s60 offen lds
    s_waitcnt lgkmcnt(5)
    v_mfma_f32_32x32x16_bf16 v[28:43], v[52:55], v[68:71], v[28:43]
    s_add_u32 m0, s89, 106496
    s_add_u32 s60, s60, s61
    s_sub_u32 s93, s60, 851968
    s_min_u32 s60, s60, s93
    buffer_load_dwordx4 v2, s[40:43], s60 offen lds
    s_waitcnt lgkmcnt(0)
    v_lshl_add_u32 v18, v18, 7, v3
    v_lshl_add_u32 v19, v19, 7, v3
    s_waitcnt vmcnt(4)
    s_barrier
    ds_read_b128 v[60:63], v8 offset:16384
    ds_read_b64_tr_b16 v[44:45], v12 offset:16384
    ds_read_b64_tr_b16 v[46:47], v12 offset:16896
    v_mfma_f32_32x32x16_bf16 v[28:43], v[56:59], v[72:75], v[28:43]
    ds_read_b128 v[64:67], v9 offset:16384
    ds_read_b64_tr_b16 v[48:49], v12 offset:18432
    ds_read_b64_tr_b16 v[50:51], v12 offset:18944
    s_add_u32 m0, s89, 49152
    s_nop 0
    buffer_load_dwordx4 v18, s[32:35], 0 offen  lds
    s_waitcnt lgkmcnt(3)
    v_mfma_f32_32x32x16_bf16 v[76:91], v[100:103], v[60:63], 0
    v_mfma_f32_32x32x16_bf16 v[28:43], v[44:47], v[60:63], v[28:43]
    ds_read_b128 v[68:71], v10 offset:16384
    ds_read_b64_tr_b16 v[52:53], v12 offset:20480
    ds_read_b64_tr_b16 v[54:55], v12 offset:20992
    s_add_u32 m0, s89, 57344
    s_nop 0
    buffer_load_dwordx4 v19, s[32:35], 0 offen  lds
    s_waitcnt lgkmcnt(3)
    v_mfma_f32_32x32x16_bf16 v[76:91], v[104:107], v[64:67], v[76:91]
    v_mfma_f32_32x32x16_bf16 v[28:43], v[48:51], v[64:67], v[28:43]
    ds_read_b128 v[72:75], v11 offset:16384
    ds_read_b64_tr_b16 v[56:57], v12 offset:22528
    ds_read_b64_tr_b16 v[58:59], v12 offset:23040
    ds_read_b64 v[134:135], v13 offset:16384
    ds_read_b64 v[16:17], v26 offset:96
    s_add_u32 m0, s89, 114688
    s_add_u32 s60, s60, s61
    s_sub_u32 s93, s60, 851968
    s_min_u32 s60, s60, s93
    buffer_load_dwordx4 v2, s[40:43], s60 offen lds
    s_waitcnt lgkmcnt(5)
    v_mfma_f32_32x32x16_bf16 v[76:91], v[108:111], v[68:71], v[76:91]
    v_mfma_f32_32x32x16_bf16 v[28:43], v[52:55], v[68:71], v[28:43]
    s_add_u32 m0, s89, 122880
    s_add_u32 s60, s60, s61
    s_sub_u32 s93, s60, 851968
    s_min_u32 s60, s60, s93
    buffer_load_dwordx4 v2, s[40:43], s60 offen lds
    s_waitcnt lgkmcnt(0)
    v_lshl_add_u32 v16, v16, 7, v3
    v_lshl_add_u32 v17, v17, 7, v3
    s_waitcnt vmcnt(4)
    s_barrier
    ds_read_b128 v[60:63], v8 offset:32768
    ds_read_b64_tr_b16 v[44:45], v12 offset:32768
    ds_read_b64_tr_b16 v[46:47], v12 offset:33280
    v_mfma_f32_32x32x16_bf16 v[76:91], v[112:115], v[72:75], v[76:91]
    v_mfma_f32_32x32x16_bf16 v[28:43], v[56:59], v[72:75], v[28:43]
    ds_read_b128 v[64:67], v9 offset:32768
    ds_read_b64_tr_b16 v[48:49], v12 offset:34816
    ds_read_b64_tr_b16 v[50:51], v12 offset:35328
    s_add_u32 m0, s89, 0
    s_nop 0
    buffer_load_dwordx4 v16, s[32:35], 0 offen  lds
    s_waitcnt lgkmcnt(3)
    v_mfma_f32_32x32x16_bf16 v[28:43], v[44:47], v[60:63], v[28:43]
    ds_read_b128 v[68:71], v10 offset:32768
    ds_read_b64_tr_b16 v[52:53], v12 offset:36864
    ds_read_b64_tr_b16 v[54:55], v12 offset:37376
    v_mov_b32 v213, v84
    s_add_u32 m0, s89, 8192
    s_nop 0
    buffer_load_dwordx4 v17, s[32:35], 0 offen  lds
    s_waitcnt lgkmcnt(3)
    v_mfma_f32_32x32x16_bf16 v[28:43], v[48:51], v[64:67], v[28:43]
    ds_read_b128 v[72:75], v11 offset:32768
    ds_read_b64_tr_b16 v[56:57], v12 offset:38912
    ds_read_b64_tr_b16 v[58:59], v12 offset:39424
    ds_read_b64 v[136:137], v13 offset:32768
    s_add_u32 m0, s89, 65536
    s_add_u32 s60, s60, s61
    s_sub_u32 s93, s60, 851968
    s_min_u32 s60, s60, s93
    buffer_load_dwordx4 v2, s[40:43], s60 offen lds
    s_waitcnt lgkmcnt(4)
    v_mfma_f32_32x32x16_bf16 v[28:43], v[52:55], v[68:71], v[28:43]
    s_add_u32 m0, s89, 73728
    s_add_u32 s60, s60, s61
    s_sub_u32 s93, s60, 851968
    s_min_u32 s60, s60, s93
    buffer_load_dwordx4 v2, s[40:43], s60 offen lds
    s_waitcnt vmcnt(4)
    s_barrier
    ds_read_b128 v[60:63], v8 offset:49152
    ds_read_b64_tr_b16 v[44:45], v12 offset:49152
    ds_read_b64_tr_b16 v[46:47], v12 offset:49664
    s_waitcnt lgkmcnt(4)
    v_mfma_f32_32x32x16_bf16 v[28:43], v[56:59], v[72:75], v[28:43]
    ds_read_b128 v[64:67], v9 offset:49152
    ds_read_b64_tr_b16 v[48:49], v12 offset:51200
    ds_read_b64_tr_b16 v[50:51], v12 offset:51712
    s_add_u32 m0, s89, 131072
    s_nop 0
    buffer_load_dwordx4 v7, s[36:39], s28 offen lds
    s_waitcnt lgkmcnt(3)
    v_mfma_f32_32x32x16_bf16 v[84:99], v[100:103], v[60:63], 0
    v_mfma_f32_32x32x16_bf16 v[28:43], v[44:47], v[60:63], v[28:43]
    ds_read_b128 v[68:71], v10 offset:49152
    ds_read_b64_tr_b16 v[52:53], v12 offset:53248
    ds_read_b64_tr_b16 v[54:55], v12 offset:53760
    s_add_u32 m0, s89, 139264
    s_nop 0
    buffer_load_dwordx4 v7, s[36:39], s29 offen lds
    s_lshl_b32 s91, s86, 11
    v_lshl_add_u32 v16, v1, 4, s91
    v_xor_b32 v17, 8192, v16
    v_lshrrev_b32 v250, 4, v1
    s_and_b32 s92, s86, 3
    s_lshl_b32 s92, s92, 8
    v_lshl_add_u32 v250, v250, 10, s92
    v_and_b32 v251, 15, v1
    v_lshl_add_u32 v18, v251, 4, v250
    v_add_u32 v26, 81920, v18
    v_add_u32 v18, 157696, v18
    s_waitcnt lgkmcnt(3)
    v_mfma_f32_32x32x16_bf16 v[84:99], v[104:107], v[64:67], v[84:99]
    v_mfma_f32_32x32x16_bf16 v[28:43], v[48:51], v[64:67], v[28:43]
    ds_read_b128 v[72:75], v11 offset:49152
    ds_read_b64_tr_b16 v[56:57], v12 offset:55296
    ds_read_b64_tr_b16 v[58:59], v12 offset:55808
    ds_read_b64 v[138:139], v13 offset:49152
    s_add_u32 m0, s89, 147456
    s_nop 0
    buffer_load_dwordx4 v7, s[36:39], s30 offen lds
    v_lshrrev_b32 v250, 5, v1
    v_and_b32 v251, 31, v1
    s_and_b32 s91, s86, 1
    s_lshl_b32 s92, s91, 9
    s_add_u32 s92, s92, 81920
    v_lshl_add_u32 v252, v250, 12, s92
    v_lshl_add_u32 v3, v251, 4, v252
    s_lshl_b32 s91, s91, 10
    s_lshr_b32 s92, s86, 1
    s_lshl_b32 s92, s92, 3
    s_add_u32 s91, s91, s92
    s_add_u32 s91, s91, 16384
    v_lshl_add_u32 v252, v250, 2, s91
    v_lshl_add_u32 v2, v251, 5, v252
    s_waitcnt lgkmcnt(4)
    v_mfma_f32_32x32x16_bf16 v[84:99], v[108:111], v[68:71], v[84:99]
    v_mfma_f32_32x32x16_bf16 v[28:43], v[52:55], v[68:71], v[28:43]
    s_waitcnt vmcnt(3) lgkmcnt(0)
    s_barrier
    s_setprio 3
    ds_read_b128 v[60:63], v8 offset:0
    ds_read_b64_tr_b16 v[44:45], v12 offset:0
    ds_read_b64_tr_b16 v[46:47], v12 offset:512
    v_mfma_f32_32x32x16_bf16 v[84:99], v[112:115], v[72:75], v[84:99]
    v_mfma_f32_32x32x16_bf16 v[28:43], v[56:59], v[72:75], v[28:43]
    ds_read_b128 v[64:67], v9 offset:0
    ds_read_b64_tr_b16 v[48:49], v12 offset:2048
    ds_read_b64_tr_b16 v[50:51], v12 offset:2560
    s_lshr_b32 s91, s86, 1
    s_cmp_lg_u32 s91, 0
    s_cbranch_scc1 L_wc6
    s_add_u32 m0, s89, 155648
    buffer_load_dwordx4 v7, s[36:39], s31 offen lds
L_wc6:
    s_waitcnt lgkmcnt(3)
    v_mfma_f32_32x32x16_bf16 v[28:43], v[44:47], v[60:63], v[28:43]
    ds_read_b128 v[68:71], v10 offset:0
    ds_read_b64_tr_b16 v[52:53], v12 offset:4096
    ds_read_b64_tr_b16 v[54:55], v12 offset:4608
    ds_read_b128 v[72:75], v11 offset:0
    ds_read_b64_tr_b16 v[56:57], v12 offset:6144
    ds_read_b64_tr_b16 v[58:59], v12 offset:6656
    ds_read_b64 v[140:141], v13 offset:0
    v_cvt_pk_bf16_f32 v210, v213, v92
    v_cvt_pk_bf16_f32 v178, v76, v84
    v_cvt_pk_bf16_f32 v182, v77, v85
    v_cvt_pk_bf16_f32 v186, v78, v86
    v_cvt_pk_bf16_f32 v190, v79, v87
    v_cvt_pk_bf16_f32 v194, v80, v88
    v_cvt_pk_bf16_f32 v198, v81, v89
    v_cvt_pk_bf16_f32 v202, v82, v90
    v_cvt_pk_bf16_f32 v206, v83, v91
    s_waitcnt lgkmcnt(7)
    v_mfma_f32_32x32x16_bf16 v[28:43], v[48:51], v[64:67], v[28:43]
    s_setprio 1
    ds_write_b128 v14, v[208:211]
    ds_write_b96 v15, v[176:178] offset:0
    s_waitcnt lgkmcnt(6)
    v_mfma_f32_32x32x16_bf16 v[28:43], v[52:55], v[68:71], v[28:43]
    ds_write_b96 v15, v[180:182] offset:2048
    ds_write_b96 v15, v[184:186] offset:4096
    s_waitcnt lgkmcnt(5)
    v_mfma_f32_32x32x16_bf16 v[28:43], v[56:59], v[72:75], v[28:43]
    ds_write_b96 v15, v[188:190] offset:6144
    ds_write_b96 v15, v[192:194] offset:16384
    ds_write_b96 v15, v[196:198] offset:18432
    ds_write_b96 v15, v[200:202] offset:20480
    ds_write_b96 v15, v[204:206] offset:22528
    s_nop 6
    ds_write_b128 v16, v[36:39] offset:49152
    ds_write_b128 v16, v[40:43] offset:50176
    s_waitcnt lgkmcnt(0)
    s_barrier
    s_setprio 3
    ds_read_b128 v[240:243], v18
    s_add_u32 m0, s89, 0
    s_add_u32 s91, s28, 86528
    buffer_load_dwordx4 v7, s[36:39], s91 offen lds
    s_mov_b32 s10, 0xbfb8aa3b
    s_mov_b32 s11, 0xbfb8aa3b
    s_waitcnt lgkmcnt(0)
    v_mfma_f32_16x16x32_bf16 v[44:47], v[20:23], v[240:243], 0
    ds_read_b128 v[36:39], v17 offset:49152
    ds_read_b128 v[40:43], v17 offset:50176
    s_add_u32 m0, s89, 8192
    s_add_u32 s91, s29, 86528
    buffer_load_dwordx4 v7, s[36:39], s91 offen lds
    s_nop 2
    v_pk_mul_f32 v[52:53], v[44:45], v[44:45]
    v_pk_mul_f32 v[54:55], v[46:47], v[46:47]
    v_pk_fma_f32 v[52:53], v[52:53], v[142:143], v[142:143] op_sel:[0,0,1] op_sel_hi:[1,0,1]
    v_pk_fma_f32 v[54:55], v[54:55], v[142:143], v[142:143] op_sel:[0,0,1] op_sel_hi:[1,0,1]
    v_pk_mul_f32 v[52:53], v[52:53], v[44:45]
    v_pk_mul_f32 v[54:55], v[54:55], v[46:47]
    v_exp_f32 v52, v52
    v_exp_f32 v53, v53
    v_exp_f32 v54, v54
    v_exp_f32 v55, v55
    v_pk_add_f32 v[52:53], v[52:53], 1.0 op_sel_hi:[1,0]
    v_pk_add_f32 v[54:55], v[54:55], 1.0 op_sel_hi:[1,0]
    v_rcp_f32 v52, v52
    v_rcp_f32 v53, v53
    v_rcp_f32 v54, v54
    v_rcp_f32 v55, v55
    v_pk_mul_f32 v[52:53], v[52:53], v[44:45]
    v_pk_mul_f32 v[54:55], v[54:55], v[46:47]
    v_cvt_pk_bf16_f32 v240, v52, v53
    v_cvt_pk_bf16_f32 v241, v54, v55
    s_add_u32 m0, s89, 65536
    s_add_u32 s91, s30, 86528
    buffer_load_dwordx4 v7, s[36:39], s91 offen lds
    v_mfma_f32_16x16x16_bf16 v[44:47], v[24:25], v[240:241], 0
    v_mfma_f32_16x16x16_bf16 v[48:51], v[214:215], v[240:241], 0
    s_lshr_b32 s91, s86, 1
    s_cmp_lg_u32 s91, 1
    s_cbranch_scc1 L_wc7
    s_add_u32 m0, s89, 71680
    s_add_u32 s91, s31, 86528
    buffer_load_dwordx4 v7, s[36:39], s91 offen lds
L_wc7:
    s_waitcnt lgkmcnt(0)
    v_pk_add_f32 v[28:29], v[28:29], v[36:37]
    v_pk_add_f32 v[30:31], v[30:31], v[38:39]
    v_pk_add_f32 v[32:33], v[32:33], v[40:41]
    v_pk_add_f32 v[34:35], v[34:35], v[42:43]
    v_pk_mul_f32 v[52:53], v[44:45], s[10:11]
    v_pk_mul_f32 v[54:55], v[46:47], s[10:11]
    v_pk_mul_f32 v[56:57], v[48:49], s[10:11]
    v_pk_mul_f32 v[58:59], v[50:51], s[10:11]
    v_exp_f32 v52, v52
    v_exp_f32 v53, v53
    v_exp_f32 v54, v54
    v_exp_f32 v55, v55
    v_exp_f32 v56, v56
    v_exp_f32 v57, v57
    v_exp_f32 v58, v58
    v_exp_f32 v59, v59
    v_pk_add_f32 v[52:53], v[52:53], 1.0 op_sel_hi:[1,0]
    v_pk_add_f32 v[54:55], v[54:55], 1.0 op_sel_hi:[1,0]
    v_pk_add_f32 v[56:57], v[56:57], 1.0 op_sel_hi:[1,0]
    v_pk_add_f32 v[58:59], v[58:59], 1.0 op_sel_hi:[1,0]
    v_rcp_f32 v52, v52
    v_rcp_f32 v53, v53
    v_rcp_f32 v54, v54
    v_rcp_f32 v55, v55
    v_rcp_f32 v56, v56
    v_rcp_f32 v57, v57
    v_rcp_f32 v58, v58
    v_rcp_f32 v59, v59
    v_cvt_pk_bf16_f32 v240, v52, v53
    v_cvt_pk_bf16_f32 v241, v54, v55
    v_and_b32 v242, 0xffff, v240
    v_lshrrev_b32 v243, 16, v240
    ds_write_b64 v26, v[242:243] offset:8192
    v_lshlrev_b32 v52, 16, v240
    v_and_b32 v53, 0xffff0000, v240
    v_lshlrev_b32 v54, 16, v241
    v_and_b32 v55, 0xffff0000, v241
    ds_write_b128 v26, v[52:55] offset:0
    v_cvt_pk_bf16_f32 v244, v56, v57
    v_cvt_pk_bf16_f32 v245, v58, v59
    v_and_b32 v246, 0xffff, v244
    v_lshrrev_b32 v247, 16, v244
    ds_write_b64 v26, v[246:247] offset:12288
    v_lshlrev_b32 v56, 16, v244
    v_and_b32 v57, 0xffff0000, v244
    v_lshlrev_b32 v58, 16, v245
    v_and_b32 v59, 0xffff0000, v245
    ds_write_b128 v26, v[56:59] offset:4096
    v_pk_mul_f32 v[36:37], v[28:29], v[28:29]
    ds_read_b128 v[148:151], v27 offset:0
    v_pk_mul_f32 v[38:39], v[30:31], v[30:31]
    v_pk_mul_f32 v[40:41], v[32:33], v[32:33]
    v_pk_mul_f32 v[42:43], v[34:35], v[34:35]
    v_pk_fma_f32 v[36:37], v[36:37], v[142:143], v[142:143] op_sel:[0,0,1] op_sel_hi:[1,0,1]
    ds_read_b128 v[156:159], v27 offset:2048
    v_pk_fma_f32 v[38:39], v[38:39], v[142:143], v[142:143] op_sel:[0,0,1] op_sel_hi:[1,0,1]
    v_pk_fma_f32 v[40:41], v[40:41], v[142:143], v[142:143] op_sel:[0,0,1] op_sel_hi:[1,0,1]
    v_pk_fma_f32 v[42:43], v[42:43], v[142:143], v[142:143] op_sel:[0,0,1] op_sel_hi:[1,0,1]
    v_pk_mul_f32 v[36:37], v[36:37], v[28:29]
    ds_read_b128 v[164:167], v27 offset:4096
    v_pk_mul_f32 v[38:39], v[38:39], v[30:31]
    v_pk_mul_f32 v[40:41], v[40:41], v[32:33]
    v_pk_mul_f32 v[42:43], v[42:43], v[34:35]
    v_pk_mul_f32 v[108:109], v[216:217], v[28:29]
    ds_read_b128 v[172:175], v27 offset:6144
    v_pk_mul_f32 v[110:111], v[218:219], v[30:31]
    v_pk_mul_f32 v[112:113], v[220:221], v[32:33]
    v_pk_mul_f32 v[114:115], v[222:223], v[34:35]
L_tail:
    s_setprio 2
    s_waitcnt vmcnt(3)
    s_setprio 1
    s_waitcnt lgkmcnt(4)
    s_setprio 0
    s_barrier
    s_setprio 3
    ds_read_b64 v[28:29], v3 offset:8192
    ds_read_b128 v[8:11], v3 offset:0
    ds_read_b64 v[30:31], v3 offset:9216
    v_exp_f32 v36, v36
    v_exp_f32 v37, v37
    ds_read_b128 v[12:15], v3 offset:1024
    v_exp_f32 v38, v38
    v_exp_f32 v39, v39
    ds_read_b64 v[32:33], v3 offset:10240
    v_exp_f32 v40, v40
    v_exp_f32 v41, v41
    ds_read_b128 v[16:19], v3 offset:2048
    v_exp_f32 v42, v42
    v_exp_f32 v43, v43
    ds_read_b64 v[34:35], v3 offset:11264
    v_mov_b32 v215, 0
    v_mov_b32 v223, 0
    ds_read_b128 v[20:23], v3 offset:3072
    v_mov_b32 v231, 0
    v_mov_b32 v239, 0
    v_add_u32 v7, 131072, v5
    ds_read_b128 v[144:147], v4 offset:16384
    s_waitcnt lgkmcnt(9)
    s_waitcnt lgkmcnt(7)
    v_dot2_f32_bf16 v62, v148, v29, 0
    v_dot2_f32_bf16 v63, v148, v11, 0
    ds_read_b128 v[152:155], v4 offset:18432
    s_waitcnt lgkmcnt(6)
    v_dot2_f32_bf16 v66, v149, v31, 0
    v_dot2_f32_bf16 v67, v149, v15, 0
    s_waitcnt lgkmcnt(4)
    ds_read_b128 v[160:163], v4 offset:20480
    v_dot2_f32_bf16 v70, v150, v33, 0
    v_dot2_f32_bf16 v71, v150, v19, 0
    ds_read_b128 v[168:171], v4 offset:22528
    v_dot2_f32_bf16 v78, v156, v29, 0
    v_dot2_f32_bf16 v79, v156, v11, 0
    s_setprio 2
    v_dot2_f32_bf16 v82, v157, v31, 0
    ds_read_b64 v[44:45], v7 offset:0
    v_dot2_f32_bf16 v83, v157, v15, 0
    v_dot2_f32_bf16 v86, v158, v33, 0
    v_dot2_f32_bf16 v87, v158, v19, 0
    ds_read_b64 v[46:47], v7 offset:4096
    s_waitcnt lgkmcnt(5)
    v_dot2_f32_bf16 v60, v144, v28, 0
    v_dot2_f32_bf16 v61, v144, v10, 0
    ds_read_b64 v[48:49], v7 offset:8192
    v_dot2_f32_bf16 v64, v145, v30, 0
    v_dot2_f32_bf16 v65, v145, v14, 0
    ds_read_b64 v[50:51], v7 offset:12288
    v_dot2_f32_bf16 v68, v146, v32, 0
    v_dot2_f32_bf16 v69, v146, v18, 0
    v_dot2_f32_bf16 v72, v147, v34, 0
    ds_read_b64 v[52:53], v7 offset:16384
    s_waitcnt lgkmcnt(7)
    v_dot2_f32_bf16 v76, v152, v28, 0
    v_dot2_f32_bf16 v77, v152, v10, 0
    ds_read_b64 v[54:55], v7 offset:20480
    v_dot2_f32_bf16 v80, v153, v30, 0
    v_dot2_f32_bf16 v81, v153, v14, 0
    ds_read_b64 v[56:57], v7 offset:24576
    v_dot2_f32_bf16 v84, v154, v32, 0
    v_dot2_f32_bf16 v85, v154, v18, 0
    v_dot2_f32_bf16 v88, v155, v34, 0
    ds_read_b64 v[240:241], v7 offset:2048
    v_cvt_pk_bf16_f32 v212, v62, v63
    s_setprio 1
    v_cvt_pk_bf16_f32 v213, v66, v67
    v_cvt_pk_bf16_f32 v214, v70, v71
    v_cvt_pk_bf16_f32 v208, v60, v61
    ds_read_b64 v[242:243], v7 offset:6144
    v_cvt_pk_bf16_f32 v209, v64, v65
    v_cvt_pk_bf16_f32 v210, v68, v69
    v_cvt_pk_bf16_f32 v211, v72, 0
    v_cvt_pk_bf16_f32 v220, v78, v79
    ds_read_b64 v[244:245], v7 offset:10240
    v_cvt_pk_bf16_f32 v221, v82, v83
    v_cvt_pk_bf16_f32 v222, v86, v87
    v_cvt_pk_bf16_f32 v216, v76, v77
    v_cvt_pk_bf16_f32 v217, v80, v81
    ds_read_b64 v[246:247], v7 offset:14336
    v_cvt_pk_bf16_f32 v218, v84, v85
    v_cvt_pk_bf16_f32 v219, v88, 0
    ds_read_b64 v[248:249], v7 offset:18432
    v_dot2_f32_bf16 v62, v164, v29, 0
    v_dot2_f32_bf16 v63, v164, v11, 0
    v_dot2_f32_bf16 v66, v165, v31, 0
    ds_read_b64 v[250:251], v7 offset:22528
    v_dot2_f32_bf16 v67, v165, v15, 0
    v_dot2_f32_bf16 v70, v166, v33, 0
    v_dot2_f32_bf16 v71, v166, v19, 0
    v_dot2_f32_bf16 v78, v172, v29, 0
    v_dot2_f32_bf16 v79, v172, v11, 0
    v_dot2_f32_bf16 v82, v173, v31, 0
    v_dot2_f32_bf16 v83, v173, v15, 0
    v_dot2_f32_bf16 v86, v174, v33, 0
    v_dot2_f32_bf16 v87, v174, v19, 0
    s_waitcnt lgkmcnt(14)
    s_setprio 0
    v_dot2_f32_bf16 v60, v160, v28, 0
    v_dot2_f32_bf16 v61, v160, v10, 0
    v_dot2_f32_bf16 v64, v161, v30, 0
    v_dot2_f32_bf16 v65, v161, v14, 0
    v_dot2_f32_bf16 v68, v162, v32, 0
    v_dot2_f32_bf16 v69, v162, v18, 0
    v_dot2_f32_bf16 v72, v163, v34, 0
    s_waitcnt lgkmcnt(13)
    v_dot2_f32_bf16 v76, v168, v28, 0
    v_dot2_f32_bf16 v77, v168, v10, 0
    v_dot2_f32_bf16 v80, v169, v30, 0
    v_dot2_f32_bf16 v81, v169, v14, 0
    v_dot2_f32_bf16 v84, v170, v32, 0
    v_dot2_f32_bf16 v85, v170, v18, 0
    v_dot2_f32_bf16 v88, v171, v34, 0
    v_cvt_pk_bf16_f32 v228, v62, v63
    v_cvt_pk_bf16_f32 v229, v66, v67
    v_cvt_pk_bf16_f32 v230, v70, v71
    v_cvt_pk_bf16_f32 v224, v60, v61
    v_cvt_pk_bf16_f32 v225, v64, v65
    v_cvt_pk_bf16_f32 v226, v68, v69
    v_cvt_pk_bf16_f32 v227, v72, 0
    v_cvt_pk_bf16_f32 v236, v78, v79
    v_cvt_pk_bf16_f32 v237, v82, v83
    v_cvt_pk_bf16_f32 v238, v86, v87
    v_cvt_pk_bf16_f32 v232, v76, v77
    v_cvt_pk_bf16_f32 v233, v80, v81
    v_cvt_pk_bf16_f32 v234, v84, v85
    v_cvt_pk_bf16_f32 v235, v88, 0
    v_add_u32 v7, 65536, v5
    s_waitcnt vmcnt(0)
    s_barrier
    s_setprio 3
    ds_read_b64 v[28:29], v5 offset:0
    s_waitcnt lgkmcnt(12)
    v_perm_b32 v176, v46, v44, s94
    v_perm_b32 v184, v46, v44, s95
    ds_read_b64 v[30:31], v5 offset:4096
    v_perm_b32 v192, v47, v45, s94
    v_perm_b32 v200, v47, v45, s95
    s_waitcnt lgkmcnt(11)
    ds_read_b64 v[32:33], v5 offset:8192
    v_perm_b32 v177, v50, v48, s94
    v_perm_b32 v185, v50, v48, s95
    v_perm_b32 v193, v51, v49, s94
    ds_read_b64 v[34:35], v5 offset:12288
    v_perm_b32 v201, v51, v49, s95
    s_waitcnt lgkmcnt(11)
    v_perm_b32 v178, v54, v52, s94
    ds_read_b64 v[252:253], v7 offset:0
    v_perm_b32 v186, v54, v52, s95
    v_perm_b32 v194, v55, v53, s94
    v_perm_b32 v202, v55, v53, s95
    ds_read_b64 v[254:255], v7 offset:4096
    s_waitcnt lgkmcnt(12)
    v_and_b32 v179, 0xffff, v56
    v_lshrrev_b32 v187, 16, v56
    ds_read_b64 v[142:143], v7 offset:8192
    v_and_b32 v195, 0xffff, v57
    v_lshrrev_b32 v203, 16, v57
    v_mfma_f32_32x32x16_bf16 v[44:59], v[176:179], v[144:147], 0
    s_waitcnt lgkmcnt(11)
    v_perm_b32 v180, v242, v240, s94
    v_perm_b32 v188, v242, v240, s95
    v_perm_b32 v196, v243, v241, s94
    v_perm_b32 v204, v243, v241, s95
    s_waitcnt lgkmcnt(9)
    v_perm_b32 v181, v246, v244, s94
    v_mfma_f32_32x32x16_bf16 v[60:75], v[184:187], v[152:155], 0
    v_perm_b32 v189, v246, v244, s95
    v_perm_b32 v197, v247, v245, s94
    v_perm_b32 v205, v247, v245, s95
    s_waitcnt lgkmcnt(7)
    v_perm_b32 v182, v250, v248, s94
    v_perm_b32 v190, v250, v248, s95
    v_perm_b32 v198, v251, v249, s94
    v_perm_b32 v206, v251, v249, s95
    v_mfma_f32_32x32x16_bf16 v[76:91], v[192:195], v[160:163], 0
    v_mov_b32 v183, 0
    v_mov_b32 v191, 0
    v_mov_b32 v199, 0
    v_mov_b32 v207, 0
    ds_read_b64 v[240:241], v5 offset:2048
    v_add_f32 v36, 1.0, v36
    v_add_f32 v37, 1.0, v37
    v_mfma_f32_32x32x16_bf16 v[92:107], v[200:203], v[168:171], 0
    v_add_f32 v38, 1.0, v38
    ds_read_b64 v[242:243], v5 offset:6144
    v_add_f32 v39, 1.0, v39
    v_add_f32 v40, 1.0, v40
    s_setprio 2
    v_add_f32 v41, 1.0, v41
    ds_read_b64 v[244:245], v5 offset:10240
    v_add_f32 v42, 1.0, v42
    v_add_f32 v43, 1.0, v43
    v_mfma_f32_32x32x16_bf16 v[44:59], v[180:183], v[148:151], v[44:59]
    s_waitcnt lgkmcnt(8)
    ds_read_b64 v[246:247], v5 offset:14336
    v_perm_b32 v176, v30, v28, s94
    v_perm_b32 v184, v30, v28, s95
    v_perm_b32 v192, v31, v29, s94
    v_perm_b32 v200, v31, v29, s95
    v_mfma_f32_32x32x16_bf16 v[60:75], v[188:191], v[156:159], v[60:75]
    ds_read_b64 v[248:249], v7 offset:2048
    s_waitcnt lgkmcnt(8)
    v_perm_b32 v177, v34, v32, s94
    v_perm_b32 v185, v34, v32, s95
    v_perm_b32 v193, v35, v33, s94
    ds_read_b64 v[250:251], v7 offset:6144
    v_perm_b32 v201, v35, v33, s95
    v_mfma_f32_32x32x16_bf16 v[76:91], v[196:199], v[164:167], v[76:91]
    s_waitcnt lgkmcnt(7)
    v_perm_b32 v178, v254, v252, s94
    v_perm_b32 v186, v254, v252, s95
    v_perm_b32 v194, v255, v253, s94
    v_perm_b32 v202, v255, v253, s95
    s_waitcnt lgkmcnt(6)
    v_and_b32 v179, 0xffff, v142
    v_mfma_f32_32x32x16_bf16 v[92:107], v[204:207], v[172:175], v[92:107]
    v_lshrrev_b32 v187, 16, v142
    v_and_b32 v195, 0xffff, v143
    v_lshrrev_b32 v203, 16, v143
    v_rcp_f32 v36, v36
    v_rcp_f32 v37, v37
    v_rcp_f32 v38, v38
    v_rcp_f32 v39, v39
    v_mfma_f32_32x32x16_bf16 v[144:159], v[176:179], v[208:211], 0
    s_waitcnt lgkmcnt(4)
    v_perm_b32 v180, v242, v240, s94
    v_perm_b32 v188, v242, v240, s95
    v_perm_b32 v196, v243, v241, s94
    v_perm_b32 v204, v243, v241, s95
    s_waitcnt lgkmcnt(2)
    v_perm_b32 v181, v246, v244, s94
    v_mfma_f32_32x32x16_bf16 v[160:175], v[184:187], v[216:219], 0
    v_perm_b32 v189, v246, v244, s95
    v_perm_b32 v197, v247, v245, s94
    v_perm_b32 v205, v247, v245, s95
    s_waitcnt lgkmcnt(0)
    v_perm_b32 v182, v250, v248, s94
    v_perm_b32 v190, v250, v248, s95
    v_perm_b32 v198, v251, v249, s94
    v_perm_b32 v206, v251, v249, s95
    v_mfma_f32_32x32x16_bf16 v[144:159], v[180:183], v[212:215], v[144:159]
    v_rcp_f32 v40, v40
    v_rcp_f32 v41, v41
    v_rcp_f32 v42, v42
    v_rcp_f32 v43, v43
    v_mul_f32 v24, v108, v36
    s_setprio 1
    v_mul_f32 v25, v109, v37
    v_fmac_f32 v24, v110, v38
    v_fmac_f32 v25, v111, v39
    v_fmac_f32 v24, v112, v40
    v_fmac_f32 v25, v113, v41
    v_fmac_f32 v24, v114, v42
    v_mfma_f32_32x32x16_bf16 v[160:175], v[188:191], v[220:223], v[160:175]
    v_fmac_f32 v25, v115, v43
    v_lshlrev_b32 v27, 4, v1
    v_lshlrev_b32 v26, 5, v1
    v_add_u32 v26, 16384, v26
    s_and_b32 s91, s88, 1
    s_lshl_b32 s91, s91, 4
    s_cmp_lt_u32 s88, 2
    s_cselect_b32 s92, -1, 0
    s_cselect_b32 s93, 0, -1
    s_lshl_b32 s90, s87, 10
    s_mov_b32 s3, 0x40000
    v_mfma_f32_32x32x16_bf16 v[208:223], v[192:195], v[224:227], 0
    v_fmac_f32 v44, v8, v144
    v_fmac_f32 v45, v9, v145
    v_fmac_f32 v46, v10, v146
    v_fmac_f32 v47, v11, v147
    v_fmac_f32 v48, v12, v148
    v_fmac_f32 v49, v13, v149
    v_mfma_f32_32x32x16_bf16 v[208:223], v[196:199], v[228:231], v[208:223]
    v_fmac_f32 v50, v14, v150
    v_fmac_f32 v51, v15, v151
    v_fmac_f32 v52, v16, v152
    v_fmac_f32 v53, v17, v153
    v_fmac_f32 v54, v18, v154
    v_fmac_f32 v55, v19, v155
    v_fmac_f32 v56, v20, v156
    v_mfma_f32_32x32x16_bf16 v[176:191], v[200:203], v[232:235], 0
    v_fmac_f32 v60, v8, v160
    v_fmac_f32 v61, v9, v161
    v_fmac_f32 v62, v10, v162
    v_fmac_f32 v63, v11, v163
    v_fmac_f32 v64, v12, v164
    v_fmac_f32 v65, v13, v165
    v_mfma_f32_32x32x16_bf16 v[176:191], v[204:207], v[236:239], v[176:191]
    v_fmac_f32 v66, v14, v166
    v_fmac_f32 v67, v15, v167
    v_fmac_f32 v68, v16, v168
    v_fmac_f32 v69, v17, v169
    v_fmac_f32 v70, v18, v170
    v_fmac_f32 v71, v19, v171
    v_fmac_f32 v72, v20, v172
    v_cvt_pk_bf16_f32 v44, v44, v60
    v_cvt_pk_bf16_f32 v45, v45, v61
    v_cvt_pk_bf16_f32 v46, v46, v62
    v_cvt_pk_bf16_f32 v47, v47, v63
    v_cvt_pk_bf16_f32 v48, v48, v64
    v_cvt_pk_bf16_f32 v49, v49, v65
    v_cvt_pk_bf16_f32 v50, v50, v66
    v_cvt_pk_bf16_f32 v51, v51, v67
    v_cvt_pk_bf16_f32 v52, v52, v68
    v_cvt_pk_bf16_f32 v53, v53, v69
    s_setprio 0
    v_cvt_pk_bf16_f32 v54, v54, v70
    v_cvt_pk_bf16_f32 v55, v55, v71
    v_cvt_pk_bf16_f32 v56, v56, v72
    v_dot2c_f32_bf16 v24, v44, v116
    v_dot2c_f32_bf16 v25, v45, v118
    v_dot2c_f32_bf16 v24, v46, v120
    v_dot2c_f32_bf16 v25, v47, v122
    v_dot2c_f32_bf16 v24, v48, v124
    v_dot2c_f32_bf16 v25, v49, v126
    v_dot2c_f32_bf16 v24, v50, v128
    v_dot2c_f32_bf16 v25, v51, v130
    v_dot2c_f32_bf16 v24, v52, v132
    v_dot2c_f32_bf16 v25, v53, v134
    v_dot2c_f32_bf16 v24, v54, v136
    v_dot2c_f32_bf16 v25, v55, v138
    v_dot2c_f32_bf16 v24, v56, v140
    v_pk_fma_f32 v[76:77], v[8:9], v[208:209], v[76:77]
    v_pk_fma_f32 v[78:79], v[10:11], v[210:211], v[78:79]
    v_pk_fma_f32 v[80:81], v[12:13], v[212:213], v[80:81]
    v_pk_fma_f32 v[82:83], v[14:15], v[214:215], v[82:83]
    v_pk_fma_f32 v[84:85], v[16:17], v[216:217], v[84:85]
    v_pk_fma_f32 v[86:87], v[18:19], v[218:219], v[86:87]
    v_fmac_f32 v88, v20, v220
    v_pk_fma_f32 v[92:93], v[8:9], v[176:177], v[92:93]
    v_pk_fma_f32 v[94:95], v[10:11], v[178:179], v[94:95]
    v_pk_fma_f32 v[96:97], v[12:13], v[180:181], v[96:97]
    v_pk_fma_f32 v[98:99], v[14:15], v[182:183], v[98:99]
    v_pk_fma_f32 v[100:101], v[16:17], v[184:185], v[100:101]
    v_pk_fma_f32 v[102:103], v[18:19], v[186:187], v[102:103]
    v_fmac_f32 v104, v20, v188
    v_cvt_pk_bf16_f32 v76, v76, v92
    v_cvt_pk_bf16_f32 v77, v77, v93
    v_cvt_pk_bf16_f32 v78, v78, v94
    v_cvt_pk_bf16_f32 v79, v79, v95
    v_cvt_pk_bf16_f32 v80, v80, v96
    v_cvt_pk_bf16_f32 v81, v81, v97
    v_cvt_pk_bf16_f32 v82, v82, v98
    v_cvt_pk_bf16_f32 v83, v83, v99
    v_cvt_pk_bf16_f32 v84, v84, v100
    v_cvt_pk_bf16_f32 v85, v85, v101
    v_cvt_pk_bf16_f32 v86, v86, v102
    v_cvt_pk_bf16_f32 v87, v87, v103
    v_cvt_pk_bf16_f32 v88, v88, v104
    v_dot2c_f32_bf16 v24, v76, v117
    v_dot2c_f32_bf16 v25, v77, v119
    v_dot2c_f32_bf16 v24, v78, v121
    v_dot2c_f32_bf16 v25, v79, v123
    v_dot2c_f32_bf16 v24, v80, v125
    v_dot2c_f32_bf16 v25, v81, v127
    v_dot2c_f32_bf16 v24, v82, v129
    v_dot2c_f32_bf16 v25, v83, v131
    v_dot2c_f32_bf16 v24, v84, v133
    v_dot2c_f32_bf16 v25, v85, v135
    v_dot2c_f32_bf16 v24, v86, v137
    v_dot2c_f32_bf16 v25, v87, v139
    v_dot2c_f32_bf16 v24, v88, v141
    s_nop 2
    v_add_f32 v24, v24, v25
    ds_write_b32 v2, v24
    s_waitcnt lgkmcnt(0)
    s_barrier
    s_cmp_lg_u32 s86, 0
    s_cbranch_scc1 L_end
    ds_read_b128 v[240:243], v26 offset:0
    ds_read_b128 v[244:247], v26 offset:16
L_spin:
    v_readfirstlane_b32 s89, v6
    s_nop 0
    s_cmp_eq_u32 s89, 1
    s_cbranch_scc1 L_go
    s_sleep 2
    s_lshl_b32 s89, s87, 2
    buffer_load_dword v6, v0, s[52:55], s89 offen sc0 sc1
    s_waitcnt vmcnt(0)
    s_sub_u32 s3, s3, 1
    s_cbranch_scc0 L_spin
L_go:
    s_waitcnt lgkmcnt(0)
    v_pk_add_f32 v[240:241], v[240:241], v[244:245]
    v_pk_add_f32 v[242:243], v[242:243], v[246:247]
    v_pk_add_f32 v[240:241], v[240:241], v[242:243]
    v_add_f32 v240, v240, v241
    v_bfe_u32 v242, v240, 1, 16
    v_lshrrev_b32 v241, 16, v240
    v_or_b32 v242, 1, v242
    v_or_b32 v241, 1, v241
    v_lshlrev_b32 v242, s91, v242
    v_lshlrev_b32 v241, s91, v241
    v_and_b32 v250, s92, v242
    v_and_b32 v251, s93, v242
    buffer_atomic_or_x2 v[250:251], v27, s[56:59], s90 offen offset:8 sc0 sc1
    v_and_b32 v248, s92, v241
    v_and_b32 v249, s93, v241
    buffer_atomic_or_x2 v[248:249], v27, s[56:59], s90 offen sc0 sc1
    v_and_b32 v246, s92, v242
    v_and_b32 v247, s93, v242
    v_and_b32 v244, s92, v241
    v_and_b32 v245, s93, v241
    s_mov_b32 s91, 0x00010001
    v_lshlrev_b32 v4, 1, v1
    s_lshl_b32 s92, s87, 7
    s_waitcnt vmcnt(0)
    v_or_b32 v248, v248, v244
    v_or_b32 v249, v249, v245
    v_and_b32 v240, v248, v249
    v_and_b32 v240, s91, v240
    v_cmp_eq_u32 vcc, s91, v240
    v_or_b32 v250, v250, v246
    v_or_b32 v251, v251, v247
    s_and_b64 exec, exec, vcc
    s_cbranch_execz L_end
L_lchk:
    v_and_b32 v240, v250, v251
    v_and_b32 v240, s91, v240
    v_cmp_ne_u32 vcc, s91, v240
    v_lshlrev_b32 v240, 16, v248
    v_and_b32 v241, 0xfffe0000, v248
    v_and_b32 v240, 0xfffe0000, v240
    v_lshlrev_b32 v242, 16, v249
    v_and_b32 v243, 0xfffe0000, v249
    v_and_b32 v242, 0xfffe0000, v242
    s_cbranch_vccz L_sum
    buffer_load_dwordx2 v[250:251], v27, s[56:59], s90 offen offset:8 sc0 sc1
    s_waitcnt vmcnt(0)
    s_sub_u32 s3, s3, 1
    s_cbranch_scc0 L_lchk
L_sum:
    v_and_b32 v244, 0xfffe, v250
    v_lshrrev_b32 v245, 17, v250
    v_and_b32 v246, 0xfffe, v251
    v_lshrrev_b32 v247, 17, v251
    v_lshl_or_b32 v240, v244, 1, v240
    v_lshl_or_b32 v241, v245, 2, v241
    v_lshl_or_b32 v242, v246, 1, v242
    v_lshl_or_b32 v243, v247, 2, v243
    v_pk_add_f32 v[240:241], v[240:241], v[242:243]
    v_add_f32 v240, v240, v241
    v_cvt_pk_bf16_f32 v240, v240, v240
    buffer_store_short v240, v4, s[48:51], s92 offen
L_end:
    s_endpgm
.section .rodata,"a"
.p2align 6
.amdhsa_kernel standalone__deep_cross_fibinet__recsys_kernel
  .amdhsa_next_free_vgpr 256
  .amdhsa_next_free_sgpr 102
  .amdhsa_accum_offset 256
  .amdhsa_group_segment_fixed_size 0
  .amdhsa_kernarg_size 88
  .amdhsa_user_sgpr_count 2
  .amdhsa_user_sgpr_kernarg_segment_ptr 1
  .amdhsa_system_sgpr_workgroup_id_x 1
.end_amdhsa_kernel
```

```asm
; @launch grid=(256,1,1) block=(512,1,1) lds=163840
.amdgcn_target "amdgcn-amd-amdhsa--gfx950"
.text
.globl standalone__deep_cross_fibinet__recsys_kernel
.p2align 8
.type standalone__deep_cross_fibinet__recsys_kernel,@function
standalone__deep_cross_fibinet__recsys_kernel:
    s_cmp_ge_u32 s2, 256
    s_cbranch_scc1 L_end
    v_lshrrev_b32 v242, 6, v0
    s_load_dwordx4 s[4:7], s[0:1], 0
    s_load_dwordx4 s[12:15], s[0:1], 40
    v_readfirstlane_b32 s86, v242
    s_load_dwordx4 s[20:23], s[0:1], 64
    s_load_dwordx2 s[24:25], s[0:1], 80
    s_getpc_b64 s[92:93]
    s_bfe_u32 s88, s2, 0x20003
    s_lshl_b32 s91, s86, 2
    s_lshr_b32 s91, 0x77773244, s91
    s_and_b32 s91, s91, 15
    s_lshl_b32 s91, s91, 3
    s_load_dwordx2 s[44:45], s[0:1], s91
    s_mul_i32 s91, s88, 3840
    v_lshl_add_u32 v240, v0, 7, s91
    v_min_u32 v240, 14876, v240
    v_mov_b32 v241, s93
    v_add_co_u32 v240, vcc, s92, v240
    v_and_b32 v1, 63, v0
    s_lshl_b32 s89, s86, 10
    v_addc_co_u32 v241, vcc, 0, v241, vcc
    v_cmp_gt_u32 vcc, 30, v0
    v_and_b32 v244, 31, v0
    s_and_saveexec_b64 s[92:93], vcc
    s_cbranch_execz L_cpf
    global_load_dword v6, v[240:241], off
L_cpf:
    s_mov_b64 exec, -1
    s_lshl_b32 s91, s88, 3
    s_lshr_b32 s91, 386926592, s91
    s_bitcmp1_b32 s91, 6
    s_cselect_b32 s96, -1, 1
    s_cselect_b32 s61, 25, 1
    s_cselect_b32 s92, 52, 0
    s_and_b32 s91, s91, 31
    s_add_u32 s97, s91, s92
    s_lshl_b32 s60, s91, 15
    s_lshl_b32 s61, s61, 15
    v_mul_i32_i24 v245, s96, v244
    s_lshr_b32 s91, s2, 5
    v_add_u32 v245, s97, v245
    s_lshl_b32 s91, s91, 3
    v_subrev_u32 v246, 26, v245
    s_and_b32 s92, s2, 7
    s_add_u32 s87, s91, s92
    v_min_u32 v245, v245, v246
    s_lshl_b32 s91, s87, 3
    v_subrev_u32 v246, 26, v245
    s_add_u32 s91, s91, s86
    v_min_u32 v245, v245, v246
    s_mul_i32 s90, s91, 832
    s_mov_b32 s30, 425984
    v_lshrrev_b32 v246, 5, v1
    s_mov_b32 s31, 0x00020000
    v_mul_u32_u24 v246, 104, v246
    s_add_u32 m0, s89, 155648
    v_lshl_add_u32 v246, v245, 2, v246
    s_waitcnt lgkmcnt(0)
    s_mov_b32 s28, s4
    s_and_b32 s29, s5, 0xffff
    buffer_load_dword v246, s[28:31], s90 offen offset:0  lds
    s_add_u32 m0, m0, 48
    s_nop 0
    buffer_load_dword v246, s[28:31], s90 offen offset:208  lds
    s_add_u32 m0, m0, 48
    s_nop 0
    buffer_load_dword v246, s[28:31], s90 offen offset:416  lds
    s_add_u32 m0, m0, 48
    s_nop 0
    buffer_load_dword v246, s[28:31], s90 offen offset:624  lds
    s_mov_b32 s40, s14
    s_and_b32 s41, s15, 0xffff
    s_mov_b32 s42, 851968
    s_mov_b32 s43, 0x00020000
    s_mov_b32 s36, s12
    s_and_b32 s37, s13, 0xffff
    s_mov_b32 s38, 173056
    s_mov_b32 s39, 0x00020000
    v_min_u32 v247, 3, v1
    v_lshlrev_b32 v247, 7, v247
    s_mul_i32 s91, s2, 3328
    s_lshl_b32 s92, s86, 9
    s_add_u32 s91, s91, s92
    buffer_load_dword v6, v247, s[40:43], s91 offen
    s_mul_i32 s91, s2, 768
    s_lshl_b32 s92, s86, 7
    s_add_u32 s91, s91, s92
    buffer_load_dword v6, off, s[36:39], s91
    s_lshl_b32 s91, s88, 3
    s_add_u32 s91, s91, s86
    s_cmp_lg_u32 s91, 23
    s_cbranch_scc1 L_z1
    s_mov_b32 s56, s24
    s_and_b32 s57, s25, 0xffff
    s_mov_b32 s58, 268435456
    s_mov_b32 s59, 0x00020000
    v_mov_b32 v144, 0
    v_mov_b32 v145, 0
    v_mov_b32 v146, 0
    v_mov_b32 v147, 0
    v_lshlrev_b32 v148, 4, v1
    s_lshl_b32 s91, s87, 10
    buffer_store_dwordx4 v[144:147], v148, s[56:59], s91 offen sc0 sc1
L_z1:
    s_and_b32 s45, s45, 0xffff
    s_mov_b32 s47, 0x00020000
    s_lshl_b32 s91, s88, 7
    v_lshlrev_b32 v246, 4, v1
    s_movk_i32 s46, 676
    s_cmp_ge_u32 s86, 4
    s_cselect_b32 s46, 512, s46
    s_cselect_b32 s91, s91, 0
    v_and_b32 v248, 16, v246
    s_lshl_b32 s92, s86, 12
    s_lshl_b32 s93, s88, 5
    s_add_u32 s92, s92, s93
    v_lshrrev_b32 v247, 1, v1
    s_cmp_lt_u32 s86, 2
    s_cselect_b32 s46, 8192, s46
    s_cselect_b32 s91, s92, s91
    s_cselect_b32 s92, 7, 5
    s_add_u32 m0, s89, 131072
    v_lshl_add_u32 v247, v247, s92, v248
    buffer_load_dwordx4 v247, s[44:47], s91 offen lds
    v_and_b32 v245, 7, v1
    v_lshrrev_b32 v247, 2, v1
    s_mov_b32 s32, s6
    v_and_b32 v247, 4, v247
    v_xor_b32 v247, v247, v245
    v_lshrrev_b32 v248, 3, v0
    s_and_b32 s33, s7, 0xffff
    v_lshlrev_b32 v248, 9, v248
    v_lshl_add_u32 v247, v247, 4, v248
    s_mov_b32 s34, 12800000
    v_mov_b32 v248, s88
    v_lshl_add_u32 v2, v248, 7, v247
    v_bfe_u32 v247, v0, 4, 3
    s_mov_b32 s35, 0x00020000
    v_xor_b32 v247, v247, v245
    v_lshlrev_b32 v3, 4, v247
    s_add_u32 s91, s89, 155648
    v_lshrrev_b32 v244, 3, v1
    v_lshl_add_u32 v26, v244, 7, s91
    v_and_b32 v247, 5, v0
    v_cmp_eq_u32 s[92:93], 0, v247
    v_mov_b32 v247, 0x3c80
    v_lshlrev_b32 v248, 2, v0
    v_cndmask_b32 v247, 0, v247, s[92:93]
    v_add_u32 v248, 139264, v248
    ds_write_b32 v248, v247
    s_lshr_b32 s91, s86, 1
    s_lshr_b32 s92, s86, 2
    s_add_u32 s90, s91, s92
    s_and_b32 s90, s90, 1
    v_and_b32 v100, 31, v1
    v_lshrrev_b32 v101, 5, v1
    v_bfe_u32 v102, v1, 1, 3
    s_and_b32 s91, s86, 1
    s_lshl_b32 s91, s91, 5
    v_add_u32 v103, s91, v100
    s_lshl_b32 s92, s92, 13
    v_lshl_add_u32 v104, v103, 7, s92
    v_xor_b32 v105, v101, v102
    v_lshl_add_u32 v8, v105, 4, v104
    v_xor_b32 v9, 32, v8
    v_xor_b32 v10, 64, v8
    v_xor_b32 v11, 96, v8
    v_bfe_u32 v104, v1, 2, 2
    v_lshl_add_u32 v105, v101, 3, v104
    s_add_u32 s92, s92, 65536
    v_lshl_add_u32 v105, v105, 7, s92
    v_bfe_u32 v106, v1, 4, 1
    s_lshr_b32 s91, s86, 2
    v_xor_b32 v106, s91, v106
    v_bfe_u32 v107, v1, 1, 1
    v_lshl_add_u32 v106, v106, 1, v107
    s_and_b32 s91, s86, 2
    s_lshl_b32 s91, s91, 1
    v_or_b32 v106, s91, v106
    v_lshrrev_b32 v107, 1, v1
    v_and_b32 v107, 4, v107
    v_xor_b32 v106, v106, v107
    v_lshl_add_u32 v105, v106, 4, v105
    v_and_b32 v107, 1, v1
    v_lshl_add_u32 v12, v107, 3, v105
    s_lshl_b32 s91, s88, 1
    s_lshr_b32 s92, s86, 2
    s_add_u32 s91, s91, s92
    v_xor_b32 v104, s91, v102
    v_lshlrev_b32 v105, 13, v101
    v_lshl_add_u32 v105, v103, 7, v105
    v_lshl_add_u32 v105, v104, 4, v105
    s_and_b32 s91, s86, 2
    s_lshl_b32 s91, s91, 2
    v_add_u32 v13, s91, v105
    v_and_b32 v104, 15, v1
    v_lshlrev_b32 v104, 3, v104
    v_lshl_add_u32 v104, v101, 8, v104
    v_and_b32 v105, 16, v1
    v_lshl_add_u32 v104, v105, 9, v104
    v_add_u32 v76, 131072, v104
    s_waitcnt vmcnt(3)
    ds_read_b128 v[44:47], v26
    ds_read_b128 v[16:19], v26 offset:16
    s_add_u32 m0, s89, 0
    s_waitcnt lgkmcnt(1)
    v_lshl_add_u32 v44, v44, 7, v3
    buffer_load_dwordx4 v44, s[32:35], 0 offen  lds
    s_add_u32 m0, s89, 8192
    v_lshl_add_u32 v45, v45, 7, v3
    buffer_load_dwordx4 v45, s[32:35], 0 offen  lds
    s_add_u32 m0, s89, 65536
    s_nop 0
    buffer_load_dwordx4 v2, s[40:43], s60 offen lds
    s_add_u32 m0, s89, 73728
    s_add_u32 s60, s60, s61
    s_sub_u32 s93, s60, 851968
    s_min_u32 s60, s60, s93
    buffer_load_dwordx4 v2, s[40:43], s60 offen lds
    s_add_u32 m0, s89, 16384
    v_lshl_add_u32 v46, v46, 7, v3
    buffer_load_dwordx4 v46, s[32:35], 0 offen  lds
    s_add_u32 m0, s89, 24576
    v_lshl_add_u32 v47, v47, 7, v3
    buffer_load_dwordx4 v47, s[32:35], 0 offen  lds
    s_waitcnt vmcnt(6) lgkmcnt(0)
    v_lshl_add_u32 v16, v16, 7, v3
    v_lshl_add_u32 v17, v17, 7, v3
    v_lshl_add_u32 v18, v18, 7, v3
    v_lshl_add_u32 v19, v19, 7, v3
    s_barrier
    ds_read_b64_tr_b16 v[100:101], v76 offset:0
    ds_read_b64_tr_b16 v[102:103], v76 offset:128
    ds_read_b64_tr_b16 v[104:105], v76 offset:512
    ds_read_b64_tr_b16 v[106:107], v76 offset:640
    ds_read_b64_tr_b16 v[108:109], v76 offset:1024
    ds_read_b64_tr_b16 v[110:111], v76 offset:1152
    ds_read_b64_tr_b16 v[112:113], v76 offset:1536
    ds_read_b64_tr_b16 v[114:115], v76 offset:1664
    s_mov_b32 s48, s20
    s_and_b32 s49, s21, 0xffff
    s_mov_b32 s50, 8192
    s_mov_b32 s51, 0x00020000
    s_mov_b32 s52, s22
    s_and_b32 s53, s23, 0xffff
    s_mov_b32 s54, 256
    s_mov_b32 s55, 0x00020000
    s_mov_b32 s56, s24
    s_and_b32 s57, s25, 0xffff
    s_mov_b32 s58, 268435456
    s_mov_b32 s59, 0x00020000
    s_mov_b32 s94, 0x05040100
    s_mov_b32 s95, 0x07060302
    v_and_b32 v144, 31, v1
    v_lshrrev_b32 v145, 5, v1
    s_and_b32 s8, s86, 1
    s_lshl_b32 s8, s8, 5
    v_add_u32 v147, s8, v144
    s_and_b32 s8, s86, 2
    s_lshl_b32 s8, s8, 2
    s_lshr_b32 s9, s86, 2
    v_bfe_u32 v148, v1, 3, 1
    v_xor_b32 v148, s9, v148
    v_lshl_add_u32 v149, v1, 5, s8
    v_lshl_add_u32 v5, v148, 4, v149
    s_lshl_b32 s8, s90, 1
    s_add_u32 s8, s8, s9
    s_lshl_b32 s9, s8, 10
    s_add_u32 s9, s9, 157696
    v_lshl_add_u32 v14, v147, 4, s9
    s_and_b32 s9, s86, 1
    s_lshl_b32 s9, s9, 10
    s_lshr_b32 s10, s86, 2
    s_lshl_b32 s10, s10, 9
    s_add_u32 s10, s10, s9
    s_mul_i32 s8, s90, 81920
    s_add_u32 s10, s10, s8
    s_add_u32 s10, s10, 16384
    v_lshl_add_u32 v149, v144, 4, s10
    v_lshl_add_u32 v15, v145, 13, v149
    s_lshr_b32 s8, s86, 1
    s_lshl_b32 s8, s8, 13
    s_add_u32 s8, s8, s9
    v_lshl_add_u32 v4, v1, 4, s8
    v_add_u32 v27, 98304, v4
    v_mov_b32 v142, 0xbdd2d3e8
    v_mov_b32 v143, 0xc0135761
    v_mov_b32 v211, 0
    v_mov_b32 v183, 0
    v_mov_b32 v191, 0
    v_mov_b32 v199, 0
    v_mov_b32 v207, 0
    v_mov_b32 v231, 0
    v_mov_b32 v239, 0
    s_and_b32 s8, s86, 2
    s_lshl_b32 s8, s8, 5
    s_lshr_b32 s9, s86, 2
    s_lshl_b32 s9, s9, 5
    s_add_u32 s8, s8, s9
    s_add_u32 s8, s8, 135168
    v_lshrrev_b32 v151, 5, v1
    v_lshl_add_u32 v151, v151, 3, s8
    ds_read_b64 v[172:173], v151 offset:0
    ds_read_b64 v[174:175], v151 offset:16
    v_and_b32 v145, 15, v1
    v_lshrrev_b32 v147, 4, v1
    v_min_u32 v145, 12, v145
    v_lshlrev_b32 v148, 1, v145
    v_mul_i32_i24 v149, s96, v148
    v_add_u32 v149, s97, v149
    v_subrev_u32 v150, 26, v149
    v_min_u32 v149, v149, v150
    v_subrev_u32 v150, 26, v149
    v_min_u32 v149, v149, v150
    v_add_u32 v148, 1, v148
    v_mul_i32_i24 v152, s96, v148
    v_add_u32 v152, s97, v152
    v_subrev_u32 v150, 26, v152
    v_min_u32 v152, v152, v150
    v_subrev_u32 v150, 26, v152
    v_min_u32 v152, v152, v150
    v_mul_u32_u24 v150, 208, v147
    v_add_u32 v150, 134144, v150
    v_lshl_add_u32 v149, v149, 1, v150
    v_lshl_add_u32 v152, v152, 1, v150
    ds_read_u16 v168, v149 offset:0
    ds_read_u16 v169, v149 offset:52
    ds_read_u16 v170, v149 offset:104
    ds_read_u16 v171, v149 offset:156
    ds_read_u16 v156, v152 offset:0
    s_waitcnt lgkmcnt(9)
    ds_read_u16 v157, v152 offset:52
    ds_read_u16 v158, v152 offset:104
    ds_read_u16 v159, v152 offset:156
    v_mul_i32_i24 v146, s96, v147
    v_add_u32 v146, s97, v146
    v_subrev_u32 v150, 26, v146
    v_min_u32 v146, v146, v150
    v_subrev_u32 v150, 26, v146
    v_min_u32 v146, v146, v150
    v_lshlrev_b32 v145, 1, v145
    v_mad_u32_u24 v149, v146, 26, v145
    s_cmp_eq_u32 s96, 1
    s_cselect_b32 s8, 4, 22
    s_mul_i32 s8, s8, 26
    s_waitcnt lgkmcnt(8)
    v_lshlrev_b32 v216, 16, v172
    v_and_b32 v217, 0xffff0000, v172
    v_lshlrev_b32 v218, 16, v173
    v_and_b32 v219, 0xffff0000, v173
    v_lshlrev_b32 v220, 16, v174
    v_and_b32 v221, 0xffff0000, v174
    v_lshlrev_b32 v222, 16, v175
    v_and_b32 v223, 0xffff0000, v175
    v_add_u32 v153, 133120, v149
    ds_read_u16 v160, v153
    v_add_u32 v149, s8, v149
    v_subrev_u32 v150, 676, v149
    v_min_u32 v149, v149, v150
    v_add_u32 v154, 133120, v149
    ds_read_u16 v161, v154
    v_add_u32 v149, s8, v149
    v_subrev_u32 v150, 676, v149
    v_min_u32 v149, v149, v150
    v_add_u32 v153, 133120, v149
    ds_read_u16 v162, v153
    v_add_u32 v149, s8, v149
    v_subrev_u32 v150, 676, v149
    v_min_u32 v149, v149, v150
    v_add_u32 v154, 133120, v149
    ds_read_u16 v163, v154
    v_add_u32 v149, s8, v149
    v_subrev_u32 v150, 676, v149
    v_min_u32 v149, v149, v150
    v_add_u32 v153, 133120, v149
    ds_read_u16 v164, v153
    v_add_u32 v149, s8, v149
    v_subrev_u32 v150, 676, v149
    v_min_u32 v149, v149, v150
    v_add_u32 v154, 133120, v149
    ds_read_u16 v165, v154
    v_add_u32 v149, s8, v149
    v_subrev_u32 v150, 676, v149
    v_min_u32 v149, v149, v150
    v_add_u32 v153, 133120, v149
    ds_read_u16 v23, v153
    s_mul_i32 s28, s86, s96
    s_add_u32 s28, s28, s97
    v_lshrrev_b32 v144, 4, v1
    s_sub_u32 s10, s28, 26
    s_min_u32 s28, s28, s10
    s_sub_u32 s10, s28, 26
    s_min_u32 s28, s28, s10
    v_bfe_u32 v145, v1, 1, 2
    s_mul_i32 s28, s28, 3328
    v_lshl_add_u32 v145, v144, 2, v145
    s_cmp_eq_u32 s96, 1
    s_cselect_b32 s9, 8, 18
    s_mul_i32 s9, s9, 3328
    v_bfe_u32 v146, v1, 3, 1
    v_lshl_add_u32 v146, v145, 1, v146
    s_add_u32 s29, s28, s9
    s_sub_u32 s10, s29, 86528
    s_min_u32 s29, s29, s10
    s_add_u32 s30, s29, s9
    s_sub_u32 s10, s30, 86528
    s_min_u32 s30, s30, s10
    v_mul_i32_i24 v147, s96, v146
    v_add_u32 v147, s97, v147
    v_subrev_u32 v148, 26, v147
    v_min_u32 v147, v147, v148
    v_subrev_u32 v148, 26, v147
    v_min_u32 v147, v147, v148
    s_and_b32 s9, s86, 1
    s_add_u32 s9, s9, 24
    s_mul_i32 s31, s9, s96
    s_add_u32 s31, s31, s97
    v_xor_b32 v144, v144, v1
    s_sub_u32 s10, s31, 26
    s_min_u32 s31, s31, s10
    s_sub_u32 s10, s31, 26
    s_min_u32 s31, s31, s10
    v_and_b32 v144, 1, v144
    s_lshl_b32 s9, s88, 5
    v_lshl_add_u32 v144, v144, 4, s9
    s_mul_i32 s31, s31, 3328
    v_lshl_add_u32 v144, v147, 7, v144
    v_add_u32 v145, 3, v145
    v_lshrrev_b32 v145, 4, v145
    v_lshl_add_u32 v7, v145, 30, v144
    s_waitcnt lgkmcnt(0)
    v_lshl_or_b32 v24, v169, 16, v168
    v_lshl_or_b32 v25, v171, 16, v170
    v_lshl_or_b32 v214, v157, 16, v156
    v_lshl_or_b32 v215, v159, 16, v158
    v_lshl_or_b32 v20, v161, 16, v160
    v_lshl_or_b32 v21, v163, 16, v162
    v_lshl_or_b32 v22, v165, 16, v164
    s_lshl_b32 s91, s88, 3
    s_add_u32 s91, s91, s86
    s_cmp_lg_u32 s91, 23
    s_cbranch_scc1 L_z2
    v_mov_b32 v240, 1
    v_mov_b32 v241, 0
    s_lshl_b32 s91, s87, 2
    s_mov_b64 exec, 1
    buffer_store_dword v240, v241, s[52:55], s91 offen sc0 sc1
    s_mov_b64 exec, -1
L_z2:
    s_add_u32 m0, s89, 81920
    s_add_u32 s60, s60, s61
    s_sub_u32 s93, s60, 851968
    s_min_u32 s60, s60, s93
    buffer_load_dwordx4 v2, s[40:43], s60 offen lds
    s_add_u32 m0, s89, 90112
    s_add_u32 s60, s60, s61
    s_sub_u32 s93, s60, 851968
    s_min_u32 s60, s60, s93
    buffer_load_dwordx4 v2, s[40:43], s60 offen lds
    s_add_u32 m0, s89, 32768
    s_nop 0
    buffer_load_dwordx4 v16, s[32:35], 0 offen  lds
    s_add_u32 m0, s89, 40960
    s_nop 0
    buffer_load_dwordx4 v17, s[32:35], 0 offen  lds
    s_cmp_eq_u32 s90, 1
    s_cbranch_scc1 L_k1
    s_waitcnt vmcnt(6)
    s_barrier
    ds_read_b128 v[60:63], v8 offset:0
    ds_read_b64_tr_b16 v[44:45], v12 offset:0
    ds_read_b64_tr_b16 v[46:47], v12 offset:512
    ds_read_b128 v[64:67], v9 offset:0
    ds_read_b64_tr_b16 v[48:49], v12 offset:2048
    ds_read_b64_tr_b16 v[50:51], v12 offset:2560
    s_add_u32 m0, s89, 98304
    s_add_u32 s60, s60, s61
    s_sub_u32 s93, s60, 851968
    s_min_u32 s60, s60, s93
    buffer_load_dwordx4 v2, s[40:43], s60 offen lds
    s_waitcnt lgkmcnt(3)
    v_mfma_f32_32x32x16_bf16 v[76:91], v[100:103], v[60:63], 0
    v_mfma_f32_32x32x16_bf16 v[28:43], v[44:47], v[60:63], 0
    ds_read_b128 v[68:71], v10 offset:0
    ds_read_b64_tr_b16 v[52:53], v12 offset:4096
    ds_read_b64_tr_b16 v[54:55], v12 offset:4608
    s_add_u32 m0, s89, 106496
    s_add_u32 s60, s60, s61
    s_sub_u32 s93, s60, 851968
    s_min_u32 s60, s60, s93
    buffer_load_dwordx4 v2, s[40:43], s60 offen lds
    s_waitcnt lgkmcnt(3)
    v_mfma_f32_32x32x16_bf16 v[76:91], v[104:107], v[64:67], v[76:91]
    v_mfma_f32_32x32x16_bf16 v[28:43], v[48:51], v[64:67], v[28:43]
    ds_read_b128 v[72:75], v11 offset:0
    ds_read_b64_tr_b16 v[56:57], v12 offset:6144
    ds_read_b64_tr_b16 v[58:59], v12 offset:6656
    ds_read_b64 v[116:117], v13 offset:0
    s_add_u32 m0, s89, 49152
    s_nop 0
    buffer_load_dwordx4 v18, s[32:35], 0 offen  lds
    s_waitcnt lgkmcnt(4)
    v_mfma_f32_32x32x16_bf16 v[76:91], v[108:111], v[68:71], v[76:91]
    v_mfma_f32_32x32x16_bf16 v[28:43], v[52:55], v[68:71], v[28:43]
    s_add_u32 m0, s89, 57344
    s_nop 0
    buffer_load_dwordx4 v19, s[32:35], 0 offen  lds
    s_waitcnt vmcnt(6)
    s_barrier
    ds_read_b128 v[60:63], v8 offset:16384
    ds_read_b64_tr_b16 v[44:45], v12 offset:16384
    ds_read_b64_tr_b16 v[46:47], v12 offset:16896
    s_waitcnt lgkmcnt(4)
    v_mfma_f32_32x32x16_bf16 v[76:91], v[112:115], v[72:75], v[76:91]
    v_mfma_f32_32x32x16_bf16 v[28:43], v[56:59], v[72:75], v[28:43]
    ds_read_b128 v[64:67], v9 offset:16384
    ds_read_b64_tr_b16 v[48:49], v12 offset:18432
    ds_read_b64_tr_b16 v[50:51], v12 offset:18944
    s_waitcnt lgkmcnt(3)
    v_mfma_f32_32x32x16_bf16 v[28:43], v[44:47], v[60:63], v[28:43]
    ds_read_b128 v[68:71], v10 offset:16384
    ds_read_b64_tr_b16 v[52:53], v12 offset:20480
    ds_read_b64_tr_b16 v[54:55], v12 offset:20992
    s_nop 2
    v_mov_b32 v213, v84
    s_waitcnt lgkmcnt(3)
    v_mfma_f32_32x32x16_bf16 v[28:43], v[48:51], v[64:67], v[28:43]
    ds_read_b128 v[72:75], v11 offset:16384
    ds_read_b64_tr_b16 v[56:57], v12 offset:22528
    ds_read_b64_tr_b16 v[58:59], v12 offset:23040
    ds_read_b64 v[118:119], v13 offset:16384
    ds_read_b64 v[16:17], v26 offset:32
    s_add_u32 m0, s89, 114688
    s_add_u32 s60, s60, s61
    s_sub_u32 s93, s60, 851968
    s_min_u32 s60, s60, s93
    buffer_load_dwordx4 v2, s[40:43], s60 offen lds
    s_waitcnt lgkmcnt(5)
    v_mfma_f32_32x32x16_bf16 v[28:43], v[52:55], v[68:71], v[28:43]
    s_add_u32 m0, s89, 122880
    s_add_u32 s60, s60, s61
    s_sub_u32 s93, s60, 851968
    s_min_u32 s60, s60, s93
    buffer_load_dwordx4 v2, s[40:43], s60 offen lds
    s_waitcnt lgkmcnt(0)
    v_lshl_add_u32 v16, v16, 7, v3
    v_lshl_add_u32 v17, v17, 7, v3
    s_waitcnt vmcnt(4)
    s_barrier
    ds_read_b128 v[60:63], v8 offset:32768
    ds_read_b64_tr_b16 v[44:45], v12 offset:32768
    ds_read_b64_tr_b16 v[46:47], v12 offset:33280
    v_mfma_f32_32x32x16_bf16 v[28:43], v[56:59], v[72:75], v[28:43]
    ds_read_b128 v[64:67], v9 offset:32768
    ds_read_b64_tr_b16 v[48:49], v12 offset:34816
    ds_read_b64_tr_b16 v[50:51], v12 offset:35328
    s_add_u32 m0, s89, 0
    s_nop 0
    buffer_load_dwordx4 v16, s[32:35], 0 offen  lds
    s_waitcnt lgkmcnt(3)
    v_mfma_f32_32x32x16_bf16 v[84:99], v[100:103], v[60:63], 0
    v_mfma_f32_32x32x16_bf16 v[28:43], v[44:47], v[60:63], v[28:43]
    ds_read_b128 v[68:71], v10 offset:32768
    ds_read_b64_tr_b16 v[52:53], v12 offset:36864
    ds_read_b64_tr_b16 v[54:55], v12 offset:37376
    s_add_u32 m0, s89, 8192
    s_nop 0
    buffer_load_dwordx4 v17, s[32:35], 0 offen  lds
    s_waitcnt lgkmcnt(3)
    v_mfma_f32_32x32x16_bf16 v[84:99], v[104:107], v[64:67], v[84:99]
    v_mfma_f32_32x32x16_bf16 v[28:43], v[48:51], v[64:67], v[28:43]
    ds_read_b128 v[72:75], v11 offset:32768
    ds_read_b64_tr_b16 v[56:57], v12 offset:38912
    ds_read_b64_tr_b16 v[58:59], v12 offset:39424
    ds_read_b64 v[120:121], v13 offset:32768
    ds_read_b64 v[18:19], v26 offset:40
    s_add_u32 m0, s89, 65536
    s_add_u32 s60, s60, s61
    s_sub_u32 s93, s60, 851968
    s_min_u32 s60, s60, s93
    buffer_load_dwordx4 v2, s[40:43], s60 offen lds
    s_waitcnt lgkmcnt(5)
    v_mfma_f32_32x32x16_bf16 v[84:99], v[108:111], v[68:71], v[84:99]
    v_mfma_f32_32x32x16_bf16 v[28:43], v[52:55], v[68:71], v[28:43]
    s_add_u32 m0, s89, 73728
    s_add_u32 s60, s60, s61
    s_sub_u32 s93, s60, 851968
    s_min_u32 s60, s60, s93
    buffer_load_dwordx4 v2, s[40:43], s60 offen lds
    s_waitcnt lgkmcnt(0)
    v_lshl_add_u32 v18, v18, 7, v3
    v_lshl_add_u32 v19, v19, 7, v3
    s_waitcnt vmcnt(4)
    s_barrier
    ds_read_b128 v[60:63], v8 offset:49152
    ds_read_b64_tr_b16 v[44:45], v12 offset:49152
    ds_read_b64_tr_b16 v[46:47], v12 offset:49664
    v_mfma_f32_32x32x16_bf16 v[84:99], v[112:115], v[72:75], v[84:99]
    v_mfma_f32_32x32x16_bf16 v[28:43], v[56:59], v[72:75], v[28:43]
    ds_read_b128 v[64:67], v9 offset:49152
    ds_read_b64_tr_b16 v[48:49], v12 offset:51200
    ds_read_b64_tr_b16 v[50:51], v12 offset:51712
    s_add_u32 m0, s89, 16384
    s_nop 0
    buffer_load_dwordx4 v18, s[32:35], 0 offen  lds
    s_waitcnt lgkmcnt(3)
    v_mfma_f32_32x32x16_bf16 v[28:43], v[44:47], v[60:63], v[28:43]
    ds_read_b128 v[68:71], v10 offset:49152
    ds_read_b64_tr_b16 v[52:53], v12 offset:53248
    ds_read_b64_tr_b16 v[54:55], v12 offset:53760
    v_cvt_pk_bf16_f32 v208, v213, v92
    v_cvt_pk_bf16_f32 v144, v76, v84
    v_cvt_pk_bf16_f32 v148, v77, v85
    v_cvt_pk_bf16_f32 v152, v78, v86
    v_cvt_pk_bf16_f32 v156, v79, v87
    v_cvt_pk_bf16_f32 v160, v80, v88
    v_cvt_pk_bf16_f32 v164, v81, v89
    v_cvt_pk_bf16_f32 v168, v82, v90
    v_cvt_pk_bf16_f32 v172, v83, v91
    s_add_u32 m0, s89, 24576
    s_nop 0
    buffer_load_dwordx4 v19, s[32:35], 0 offen  lds
    s_waitcnt lgkmcnt(3)
    v_mfma_f32_32x32x16_bf16 v[28:43], v[48:51], v[64:67], v[28:43]
    ds_read_b128 v[72:75], v11 offset:49152
    ds_read_b64_tr_b16 v[56:57], v12 offset:55296
    ds_read_b64_tr_b16 v[58:59], v12 offset:55808
    ds_read_b64 v[122:123], v13 offset:49152
    ds_read_b64 v[16:17], v26 offset:48
    s_add_u32 m0, s89, 81920
    s_add_u32 s60, s60, s61
    s_sub_u32 s93, s60, 851968
    s_min_u32 s60, s60, s93
    buffer_load_dwordx4 v2, s[40:43], s60 offen lds
    s_waitcnt lgkmcnt(5)
    v_mfma_f32_32x32x16_bf16 v[28:43], v[52:55], v[68:71], v[28:43]
    s_add_u32 m0, s89, 90112
    s_add_u32 s60, s60, s61
    s_sub_u32 s93, s60, 851968
    s_min_u32 s60, s60, s93
    buffer_load_dwordx4 v2, s[40:43], s60 offen lds
    s_waitcnt lgkmcnt(0)
    v_lshl_add_u32 v16, v16, 7, v3
    v_lshl_add_u32 v17, v17, 7, v3
    s_waitcnt vmcnt(4)
    s_barrier
    ds_read_b128 v[60:63], v8 offset:0
    ds_read_b64_tr_b16 v[44:45], v12 offset:0
    ds_read_b64_tr_b16 v[46:47], v12 offset:512
    v_mfma_f32_32x32x16_bf16 v[28:43], v[56:59], v[72:75], v[28:43]
    ds_read_b128 v[64:67], v9 offset:0
    ds_read_b64_tr_b16 v[48:49], v12 offset:2048
    ds_read_b64_tr_b16 v[50:51], v12 offset:2560
    s_add_u32 m0, s89, 32768
    s_nop 0
    buffer_load_dwordx4 v16, s[32:35], 0 offen  lds
    s_waitcnt lgkmcnt(3)
    v_mfma_f32_32x32x16_bf16 v[76:91], v[100:103], v[60:63], 0
    v_mfma_f32_32x32x16_bf16 v[28:43], v[44:47], v[60:63], v[28:43]
    ds_read_b128 v[68:71], v10 offset:0
    ds_read_b64_tr_b16 v[52:53], v12 offset:4096
    ds_read_b64_tr_b16 v[54:55], v12 offset:4608
    s_add_u32 m0, s89, 40960
    s_nop 0
    buffer_load_dwordx4 v17, s[32:35], 0 offen  lds
    s_waitcnt lgkmcnt(3)
    v_mfma_f32_32x32x16_bf16 v[76:91], v[104:107], v[64:67], v[76:91]
    v_mfma_f32_32x32x16_bf16 v[28:43], v[48:51], v[64:67], v[28:43]
    ds_read_b128 v[72:75], v11 offset:0
    ds_read_b64_tr_b16 v[56:57], v12 offset:6144
    ds_read_b64_tr_b16 v[58:59], v12 offset:6656
    ds_read_b64 v[124:125], v13 offset:0
    ds_read_b64 v[18:19], v26 offset:56
    s_add_u32 m0, s89, 98304
    s_add_u32 s60, s60, s61
    s_sub_u32 s93, s60, 851968
    s_min_u32 s60, s60, s93
    buffer_load_dwordx4 v2, s[40:43], s60 offen lds
    s_waitcnt lgkmcnt(5)
    v_mfma_f32_32x32x16_bf16 v[76:91], v[108:111], v[68:71], v[76:91]
    v_mfma_f32_32x32x16_bf16 v[28:43], v[52:55], v[68:71], v[28:43]
    s_add_u32 m0, s89, 106496
    s_add_u32 s60, s60, s61
    s_sub_u32 s93, s60, 851968
    s_min_u32 s60, s60, s93
    buffer_load_dwordx4 v2, s[40:43], s60 offen lds
    s_waitcnt lgkmcnt(0)
    v_lshl_add_u32 v18, v18, 7, v3
    v_lshl_add_u32 v19, v19, 7, v3
    s_waitcnt vmcnt(4)
    s_barrier
    ds_read_b128 v[60:63], v8 offset:16384
    ds_read_b64_tr_b16 v[44:45], v12 offset:16384
    ds_read_b64_tr_b16 v[46:47], v12 offset:16896
    v_mfma_f32_32x32x16_bf16 v[76:91], v[112:115], v[72:75], v[76:91]
    v_mfma_f32_32x32x16_bf16 v[28:43], v[56:59], v[72:75], v[28:43]
    ds_read_b128 v[64:67], v9 offset:16384
    ds_read_b64_tr_b16 v[48:49], v12 offset:18432
    ds_read_b64_tr_b16 v[50:51], v12 offset:18944
    s_add_u32 m0, s89, 49152
    s_nop 0
    buffer_load_dwordx4 v18, s[32:35], 0 offen  lds
    s_waitcnt lgkmcnt(3)
    v_mfma_f32_32x32x16_bf16 v[28:43], v[44:47], v[60:63], v[28:43]
    ds_read_b128 v[68:71], v10 offset:16384
    ds_read_b64_tr_b16 v[52:53], v12 offset:20480
    ds_read_b64_tr_b16 v[54:55], v12 offset:20992
    v_mov_b32 v213, v84
    s_add_u32 m0, s89, 57344
    s_nop 0
    buffer_load_dwordx4 v19, s[32:35], 0 offen  lds
    s_waitcnt lgkmcnt(3)
    v_mfma_f32_32x32x16_bf16 v[28:43], v[48:51], v[64:67], v[28:43]
    ds_read_b128 v[72:75], v11 offset:16384
    ds_read_b64_tr_b16 v[56:57], v12 offset:22528
    ds_read_b64_tr_b16 v[58:59], v12 offset:23040
    ds_read_b64 v[126:127], v13 offset:16384
    ds_read_b64 v[16:17], v26 offset:64
    s_add_u32 m0, s89, 114688
    s_add_u32 s60, s60, s61
    s_sub_u32 s93, s60, 851968
    s_min_u32 s60, s60, s93
    buffer_load_dwordx4 v2, s[40:43], s60 offen lds
    s_waitcnt lgkmcnt(5)
    v_mfma_f32_32x32x16_bf16 v[28:43], v[52:55], v[68:71], v[28:43]
    s_add_u32 m0, s89, 122880
    s_add_u32 s60, s60, s61
    s_sub_u32 s93, s60, 851968
    s_min_u32 s60, s60, s93
    buffer_load_dwordx4 v2, s[40:43], s60 offen lds
    s_waitcnt lgkmcnt(0)
    v_lshl_add_u32 v16, v16, 7, v3
    v_lshl_add_u32 v17, v17, 7, v3
    s_waitcnt vmcnt(4)
    s_barrier
    ds_read_b128 v[60:63], v8 offset:32768
    ds_read_b64_tr_b16 v[44:45], v12 offset:32768
    ds_read_b64_tr_b16 v[46:47], v12 offset:33280
    v_mfma_f32_32x32x16_bf16 v[28:43], v[56:59], v[72:75], v[28:43]
    ds_read_b128 v[64:67], v9 offset:32768
    ds_read_b64_tr_b16 v[48:49], v12 offset:34816
    ds_read_b64_tr_b16 v[50:51], v12 offset:35328
    s_add_u32 m0, s89, 0
    s_nop 0
    buffer_load_dwordx4 v16, s[32:35], 0 offen  lds
    s_waitcnt lgkmcnt(3)
    v_mfma_f32_32x32x16_bf16 v[84:99], v[100:103], v[60:63], 0
    v_mfma_f32_32x32x16_bf16 v[28:43], v[44:47], v[60:63], v[28:43]
    ds_read_b128 v[68:71], v10 offset:32768
    ds_read_b64_tr_b16 v[52:53], v12 offset:36864
    ds_read_b64_tr_b16 v[54:55], v12 offset:37376
    s_add_u32 m0, s89, 8192
    s_nop 0
    buffer_load_dwordx4 v17, s[32:35], 0 offen  lds
    s_waitcnt lgkmcnt(3)
    v_mfma_f32_32x32x16_bf16 v[84:99], v[104:107], v[64:67], v[84:99]
    v_mfma_f32_32x32x16_bf16 v[28:43], v[48:51], v[64:67], v[28:43]
    ds_read_b128 v[72:75], v11 offset:32768
    ds_read_b64_tr_b16 v[56:57], v12 offset:38912
    ds_read_b64_tr_b16 v[58:59], v12 offset:39424
    ds_read_b64 v[128:129], v13 offset:32768
    ds_read_b64 v[18:19], v26 offset:72
    s_add_u32 m0, s89, 65536
    s_add_u32 s60, s60, s61
    s_sub_u32 s93, s60, 851968
    s_min_u32 s60, s60, s93
    buffer_load_dwordx4 v2, s[40:43], s60 offen lds
    s_waitcnt lgkmcnt(5)
    v_mfma_f32_32x32x16_bf16 v[84:99], v[108:111], v[68:71], v[84:99]
    v_mfma_f32_32x32x16_bf16 v[28:43], v[52:55], v[68:71], v[28:43]
    s_add_u32 m0, s89, 73728
    s_add_u32 s60, s60, s61
    s_sub_u32 s93, s60, 851968
    s_min_u32 s60, s60, s93
    buffer_load_dwordx4 v2, s[40:43], s60 offen lds
    s_waitcnt lgkmcnt(0)
    v_lshl_add_u32 v18, v18, 7, v3
    v_lshl_add_u32 v19, v19, 7, v3
    s_waitcnt vmcnt(4)
    s_barrier
    ds_read_b128 v[60:63], v8 offset:49152
    ds_read_b64_tr_b16 v[44:45], v12 offset:49152
    ds_read_b64_tr_b16 v[46:47], v12 offset:49664
    v_mfma_f32_32x32x16_bf16 v[84:99], v[112:115], v[72:75], v[84:99]
    v_mfma_f32_32x32x16_bf16 v[28:43], v[56:59], v[72:75], v[28:43]
    ds_read_b128 v[64:67], v9 offset:49152
    ds_read_b64_tr_b16 v[48:49], v12 offset:51200
    ds_read_b64_tr_b16 v[50:51], v12 offset:51712
    s_add_u32 m0, s89, 16384
    s_nop 0
    buffer_load_dwordx4 v18, s[32:35], 0 offen  lds
    s_waitcnt lgkmcnt(3)
    v_mfma_f32_32x32x16_bf16 v[28:43], v[44:47], v[60:63], v[28:43]
    ds_read_b128 v[68:71], v10 offset:49152
    ds_read_b64_tr_b16 v[52:53], v12 offset:53248
    ds_read_b64_tr_b16 v[54:55], v12 offset:53760
    v_cvt_pk_bf16_f32 v209, v213, v92
    v_cvt_pk_bf16_f32 v145, v76, v84
    v_cvt_pk_bf16_f32 v149, v77, v85
    v_cvt_pk_bf16_f32 v153, v78, v86
    v_cvt_pk_bf16_f32 v157, v79, v87
    v_cvt_pk_bf16_f32 v161, v80, v88
    v_cvt_pk_bf16_f32 v165, v81, v89
    v_cvt_pk_bf16_f32 v169, v82, v90
    v_cvt_pk_bf16_f32 v173, v83, v91
    s_add_u32 m0, s89, 24576
    s_nop 0
    buffer_load_dwordx4 v19, s[32:35], 0 offen  lds
    s_waitcnt lgkmcnt(3)
    v_mfma_f32_32x32x16_bf16 v[28:43], v[48:51], v[64:67], v[28:43]
    ds_read_b128 v[72:75], v11 offset:49152
    ds_read_b64_tr_b16 v[56:57], v12 offset:55296
    ds_read_b64_tr_b16 v[58:59], v12 offset:55808
    ds_read_b64 v[130:131], v13 offset:49152
    ds_read_b64 v[16:17], v26 offset:80
    s_add_u32 m0, s89, 81920
    s_add_u32 s60, s60, s61
    s_sub_u32 s93, s60, 851968
    s_min_u32 s60, s60, s93
    buffer_load_dwordx4 v2, s[40:43], s60 offen lds
    s_waitcnt lgkmcnt(5)
    v_mfma_f32_32x32x16_bf16 v[28:43], v[52:55], v[68:71], v[28:43]
    s_add_u32 m0, s89, 90112
    s_add_u32 s60, s60, s61
    s_sub_u32 s93, s60, 851968
    s_min_u32 s60, s60, s93
    buffer_load_dwordx4 v2, s[40:43], s60 offen lds
    s_waitcnt lgkmcnt(0)
    v_lshl_add_u32 v16, v16, 7, v3
    v_lshl_add_u32 v17, v17, 7, v3
    s_waitcnt vmcnt(4)
    s_barrier
    ds_read_b128 v[60:63], v8 offset:0
    ds_read_b64_tr_b16 v[44:45], v12 offset:0
    ds_read_b64_tr_b16 v[46:47], v12 offset:512
    v_mfma_f32_32x32x16_bf16 v[28:43], v[56:59], v[72:75], v[28:43]
    ds_read_b128 v[64:67], v9 offset:0
    ds_read_b64_tr_b16 v[48:49], v12 offset:2048
    ds_read_b64_tr_b16 v[50:51], v12 offset:2560
    s_add_u32 m0, s89, 32768
    s_nop 0
    buffer_load_dwordx4 v16, s[32:35], 0 offen  lds
    s_waitcnt lgkmcnt(3)
    v_mfma_f32_32x32x16_bf16 v[76:91], v[100:103], v[60:63], 0
    v_mfma_f32_32x32x16_bf16 v[28:43], v[44:47], v[60:63], v[28:43]
    ds_read_b128 v[68:71], v10 offset:0
    ds_read_b64_tr_b16 v[52:53], v12 offset:4096
    ds_read_b64_tr_b16 v[54:55], v12 offset:4608
    s_add_u32 m0, s89, 40960
    s_nop 0
    buffer_load_dwordx4 v17, s[32:35], 0 offen  lds
    s_waitcnt lgkmcnt(3)
    v_mfma_f32_32x32x16_bf16 v[76:91], v[104:107], v[64:67], v[76:91]
    v_mfma_f32_32x32x16_bf16 v[28:43], v[48:51], v[64:67], v[28:43]
    ds_read_b128 v[72:75], v11 offset:0
    ds_read_b64_tr_b16 v[56:57], v12 offset:6144
    ds_read_b64_tr_b16 v[58:59], v12 offset:6656
    ds_read_b64 v[132:133], v13 offset:0
    ds_read_b64 v[18:19], v26 offset:88
    s_add_u32 m0, s89, 98304
    s_add_u32 s60, s60, s61
    s_sub_u32 s93, s60, 851968
    s_min_u32 s60, s60, s93
    buffer_load_dwordx4 v2, s[40:43], s60 offen lds
    s_waitcnt lgkmcnt(5)
    v_mfma_f32_32x32x16_bf16 v[76:91], v[108:111], v[68:71], v[76:91]
    v_mfma_f32_32x32x16_bf16 v[28:43], v[52:55], v[68:71], v[28:43]
    s_add_u32 m0, s89, 106496
    s_add_u32 s60, s60, s61
    s_sub_u32 s93, s60, 851968
    s_min_u32 s60, s60, s93
    buffer_load_dwordx4 v2, s[40:43], s60 offen lds
    s_waitcnt lgkmcnt(0)
    v_lshl_add_u32 v18, v18, 7, v3
    v_lshl_add_u32 v19, v19, 7, v3
    s_waitcnt vmcnt(4)
    s_barrier
    ds_read_b128 v[60:63], v8 offset:16384
    ds_read_b64_tr_b16 v[44:45], v12 offset:16384
    ds_read_b64_tr_b16 v[46:47], v12 offset:16896
    v_mfma_f32_32x32x16_bf16 v[76:91], v[112:115], v[72:75], v[76:91]
    v_mfma_f32_32x32x16_bf16 v[28:43], v[56:59], v[72:75], v[28:43]
    ds_read_b128 v[64:67], v9 offset:16384
    ds_read_b64_tr_b16 v[48:49], v12 offset:18432
    ds_read_b64_tr_b16 v[50:51], v12 offset:18944
    s_add_u32 m0, s89, 49152
    s_nop 0
    buffer_load_dwordx4 v18, s[32:35], 0 offen  lds
    s_waitcnt lgkmcnt(3)
    v_mfma_f32_32x32x16_bf16 v[28:43], v[44:47], v[60:63], v[28:43]
    ds_read_b128 v[68:71], v10 offset:16384
    ds_read_b64_tr_b16 v[52:53], v12 offset:20480
    ds_read_b64_tr_b16 v[54:55], v12 offset:20992
    v_mov_b32 v213, v84
    s_add_u32 m0, s89, 57344
    s_nop 0
    buffer_load_dwordx4 v19, s[32:35], 0 offen  lds
    s_waitcnt lgkmcnt(3)
    v_mfma_f32_32x32x16_bf16 v[28:43], v[48:51], v[64:67], v[28:43]
    ds_read_b128 v[72:75], v11 offset:16384
    ds_read_b64_tr_b16 v[56:57], v12 offset:22528
    ds_read_b64_tr_b16 v[58:59], v12 offset:23040
    ds_read_b64 v[134:135], v13 offset:16384
    ds_read_b64 v[16:17], v26 offset:96
    s_add_u32 m0, s89, 114688
    s_add_u32 s60, s60, s61
    s_sub_u32 s93, s60, 851968
    s_min_u32 s60, s60, s93
    buffer_load_dwordx4 v2, s[40:43], s60 offen lds
    s_waitcnt lgkmcnt(5)
    v_mfma_f32_32x32x16_bf16 v[28:43], v[52:55], v[68:71], v[28:43]
    s_add_u32 m0, s89, 122880
    s_add_u32 s60, s60, s61
    s_sub_u32 s93, s60, 851968
    s_min_u32 s60, s60, s93
    buffer_load_dwordx4 v2, s[40:43], s60 offen lds
    s_waitcnt lgkmcnt(0)
    v_lshl_add_u32 v16, v16, 7, v3
    v_lshl_add_u32 v17, v17, 7, v3
    s_waitcnt vmcnt(4)
    s_barrier
    ds_read_b128 v[60:63], v8 offset:32768
    ds_read_b64_tr_b16 v[44:45], v12 offset:32768
    ds_read_b64_tr_b16 v[46:47], v12 offset:33280
    v_mfma_f32_32x32x16_bf16 v[28:43], v[56:59], v[72:75], v[28:43]
    ds_read_b128 v[64:67], v9 offset:32768
    ds_read_b64_tr_b16 v[48:49], v12 offset:34816
    ds_read_b64_tr_b16 v[50:51], v12 offset:35328
    s_add_u32 m0, s89, 0
    s_nop 0
    buffer_load_dwordx4 v16, s[32:35], 0 offen  lds
    s_waitcnt lgkmcnt(3)
    v_mfma_f32_32x32x16_bf16 v[84:99], v[100:103], v[60:63], 0
    v_mfma_f32_32x32x16_bf16 v[28:43], v[44:47], v[60:63], v[28:43]
    ds_read_b128 v[68:71], v10 offset:32768
    ds_read_b64_tr_b16 v[52:53], v12 offset:36864
    ds_read_b64_tr_b16 v[54:55], v12 offset:37376
    s_add_u32 m0, s89, 8192
    s_nop 0
    buffer_load_dwordx4 v17, s[32:35], 0 offen  lds
    s_waitcnt lgkmcnt(3)
    v_mfma_f32_32x32x16_bf16 v[84:99], v[104:107], v[64:67], v[84:99]
    v_mfma_f32_32x32x16_bf16 v[28:43], v[48:51], v[64:67], v[28:43]
    ds_read_b128 v[72:75], v11 offset:32768
    ds_read_b64_tr_b16 v[56:57], v12 offset:38912
    ds_read_b64_tr_b16 v[58:59], v12 offset:39424
    ds_read_b64 v[136:137], v13 offset:32768
    s_add_u32 m0, s89, 65536
    s_add_u32 s60, s60, s61
    s_sub_u32 s93, s60, 851968
    s_min_u32 s60, s60, s93
    buffer_load_dwordx4 v2, s[40:43], s60 offen lds
    s_waitcnt lgkmcnt(4)
    v_mfma_f32_32x32x16_bf16 v[84:99], v[108:111], v[68:71], v[84:99]
    v_mfma_f32_32x32x16_bf16 v[28:43], v[52:55], v[68:71], v[28:43]
    s_add_u32 m0, s89, 73728
    s_add_u32 s60, s60, s61
    s_sub_u32 s93, s60, 851968
    s_min_u32 s60, s60, s93
    buffer_load_dwordx4 v2, s[40:43], s60 offen lds
    s_waitcnt vmcnt(4)
    s_barrier
    ds_read_b128 v[60:63], v8 offset:49152
    ds_read_b64_tr_b16 v[44:45], v12 offset:49152
    ds_read_b64_tr_b16 v[46:47], v12 offset:49664
    s_waitcnt lgkmcnt(4)
    v_mfma_f32_32x32x16_bf16 v[84:99], v[112:115], v[72:75], v[84:99]
    v_mfma_f32_32x32x16_bf16 v[28:43], v[56:59], v[72:75], v[28:43]
    ds_read_b128 v[64:67], v9 offset:49152
    ds_read_b64_tr_b16 v[48:49], v12 offset:51200
    ds_read_b64_tr_b16 v[50:51], v12 offset:51712
    s_add_u32 m0, s89, 131072
    s_nop 0
    buffer_load_dwordx4 v7, s[36:39], s28 offen lds
    s_waitcnt lgkmcnt(3)
    v_mfma_f32_32x32x16_bf16 v[28:43], v[44:47], v[60:63], v[28:43]
    ds_read_b128 v[68:71], v10 offset:49152
    ds_read_b64_tr_b16 v[52:53], v12 offset:53248
    ds_read_b64_tr_b16 v[54:55], v12 offset:53760
    v_cvt_pk_bf16_f32 v210, v213, v92
    v_cvt_pk_bf16_f32 v146, v76, v84
    v_cvt_pk_bf16_f32 v150, v77, v85
    v_cvt_pk_bf16_f32 v154, v78, v86
    v_cvt_pk_bf16_f32 v158, v79, v87
    v_cvt_pk_bf16_f32 v162, v80, v88
    v_cvt_pk_bf16_f32 v166, v81, v89
    v_cvt_pk_bf16_f32 v170, v82, v90
    v_cvt_pk_bf16_f32 v174, v83, v91
    s_add_u32 m0, s89, 139264
    s_nop 0
    buffer_load_dwordx4 v7, s[36:39], s29 offen lds
    s_lshl_b32 s91, s86, 11
    v_lshl_add_u32 v16, v1, 4, s91
    v_xor_b32 v17, 8192, v16
    v_lshrrev_b32 v250, 4, v1
    s_and_b32 s92, s86, 3
    s_lshl_b32 s92, s92, 8
    v_lshl_add_u32 v250, v250, 10, s92
    v_and_b32 v251, 15, v1
    v_lshl_add_u32 v18, v251, 4, v250
    v_add_u32 v26, 81920, v18
    v_add_u32 v18, 157696, v18
    s_waitcnt lgkmcnt(3)
    v_mfma_f32_32x32x16_bf16 v[28:43], v[48:51], v[64:67], v[28:43]
    ds_read_b128 v[72:75], v11 offset:49152
    ds_read_b64_tr_b16 v[56:57], v12 offset:55296
    ds_read_b64_tr_b16 v[58:59], v12 offset:55808
    ds_read_b64 v[138:139], v13 offset:49152
    s_add_u32 m0, s89, 147456
    s_nop 0
    buffer_load_dwordx4 v7, s[36:39], s30 offen lds
    v_lshrrev_b32 v250, 5, v1
    v_and_b32 v251, 31, v1
    s_and_b32 s91, s86, 1
    s_lshl_b32 s92, s91, 9
    s_add_u32 s92, s92, 81920
    v_lshl_add_u32 v252, v250, 12, s92
    v_lshl_add_u32 v3, v251, 4, v252
    s_lshl_b32 s91, s91, 10
    s_lshr_b32 s92, s86, 1
    s_lshl_b32 s92, s92, 3
    s_add_u32 s91, s91, s92
    s_add_u32 s91, s91, 16384
    v_lshl_add_u32 v252, v250, 2, s91
    v_lshl_add_u32 v2, v251, 5, v252
    s_waitcnt lgkmcnt(4)
    v_mfma_f32_32x32x16_bf16 v[28:43], v[52:55], v[68:71], v[28:43]
    s_waitcnt vmcnt(3) lgkmcnt(0)
    s_barrier
    s_setprio 3
    ds_read_b128 v[60:63], v8 offset:0
    ds_read_b64_tr_b16 v[44:45], v12 offset:0
    ds_read_b64_tr_b16 v[46:47], v12 offset:512
    v_mfma_f32_32x32x16_bf16 v[28:43], v[56:59], v[72:75], v[28:43]
    ds_read_b128 v[64:67], v9 offset:0
    ds_read_b64_tr_b16 v[48:49], v12 offset:2048
    ds_read_b64_tr_b16 v[50:51], v12 offset:2560
    s_lshr_b32 s91, s86, 1
    s_cmp_lg_u32 s91, 0
    s_cbranch_scc1 L_wc3
    s_add_u32 m0, s89, 155648
    s_nop 0
    buffer_load_dwordx4 v7, s[36:39], s31 offen lds
L_wc3:
    s_waitcnt lgkmcnt(3)
    v_mfma_f32_32x32x16_bf16 v[76:91], v[100:103], v[60:63], 0
    v_mfma_f32_32x32x16_bf16 v[28:43], v[44:47], v[60:63], v[28:43]
    ds_read_b128 v[68:71], v10 offset:0
    ds_read_b64_tr_b16 v[52:53], v12 offset:4096
    ds_read_b64_tr_b16 v[54:55], v12 offset:4608
    s_waitcnt lgkmcnt(3)
    v_mfma_f32_32x32x16_bf16 v[76:91], v[104:107], v[64:67], v[76:91]
    v_mfma_f32_32x32x16_bf16 v[28:43], v[48:51], v[64:67], v[28:43]
    ds_read_b128 v[72:75], v11 offset:0
    ds_read_b64_tr_b16 v[56:57], v12 offset:6144
    ds_read_b64_tr_b16 v[58:59], v12 offset:6656
    ds_read_b64 v[140:141], v13 offset:0
    s_waitcnt lgkmcnt(4)
    v_mfma_f32_32x32x16_bf16 v[76:91], v[108:111], v[68:71], v[76:91]
    s_waitcnt lgkmcnt(1)
    v_mfma_f32_32x32x16_bf16 v[76:91], v[112:115], v[72:75], v[76:91]
    v_mfma_f32_32x32x16_bf16 v[28:43], v[52:55], v[68:71], v[28:43]
    v_mfma_f32_32x32x16_bf16 v[28:43], v[56:59], v[72:75], v[28:43]
    s_cmp_lg_u32 s86, 0
    s_cbranch_scc1 L_f4
    v_mov_b32 v0, 0
    s_lshl_b32 s91, s87, 2
    buffer_load_dword v6, v0, s[52:55], s91 offen sc0 sc1
L_f4:
    s_nop 7
    v_cvt_pk_bf16_f32 v211, v84, 0
    ds_write_b128 v14, v[208:211]
    v_cvt_pk_bf16_f32 v147, v76, 0
    ds_write_b128 v16, v[36:39] offset:49152
    v_cvt_pk_bf16_f32 v151, v77, 0
    v_cvt_pk_bf16_f32 v155, v78, 0
    v_cvt_pk_bf16_f32 v159, v79, 0
    ds_write_b128 v16, v[40:43] offset:50176
    v_cvt_pk_bf16_f32 v163, v80, 0
    v_cvt_pk_bf16_f32 v167, v81, 0
    v_cvt_pk_bf16_f32 v171, v82, 0
    v_cvt_pk_bf16_f32 v175, v83, 0
    s_waitcnt lgkmcnt(0)
    s_barrier
    s_setprio 0
    s_add_u32 m0, s89, 0
    s_add_u32 s91, s28, 86528
    buffer_load_dwordx4 v7, s[36:39], s91 offen lds
    ds_write_b128 v15, v[144:147] offset:0
    ds_write_b128 v15, v[148:151] offset:2048
    ds_write_b128 v15, v[152:155] offset:4096
    s_add_u32 m0, s89, 8192
    s_add_u32 s91, s29, 86528
    buffer_load_dwordx4 v7, s[36:39], s91 offen lds
    ds_write_b128 v15, v[156:159] offset:6144
    ds_write_b128 v15, v[160:163] offset:16384
    ds_write_b128 v15, v[164:167] offset:18432
    s_add_u32 m0, s89, 65536
    s_add_u32 s91, s30, 86528
    buffer_load_dwordx4 v7, s[36:39], s91 offen lds
    ds_write_b128 v15, v[168:171] offset:20480
    ds_write_b128 v15, v[172:175] offset:22528
    s_lshr_b32 s91, s86, 1
    s_cmp_lg_u32 s91, 1
    s_cbranch_scc1 L_wc5
    s_add_u32 m0, s89, 71680
    s_add_u32 s91, s31, 86528
    buffer_load_dwordx4 v7, s[36:39], s91 offen lds
L_wc5:
    ds_read_b128 v[36:39], v17 offset:49152
    ds_read_b128 v[40:43], v17 offset:50176
    ds_read_b128 v[148:151], v27 offset:0
    ds_read_b128 v[156:159], v27 offset:2048
    s_waitcnt lgkmcnt(2)
    v_pk_add_f32 v[28:29], v[28:29], v[36:37]
    v_pk_add_f32 v[30:31], v[30:31], v[38:39]
    ds_read_b128 v[164:167], v27 offset:4096
    v_pk_add_f32 v[32:33], v[32:33], v[40:41]
    v_pk_add_f32 v[34:35], v[34:35], v[42:43]
    v_pk_mul_f32 v[36:37], v[28:29], v[28:29]
    ds_read_b128 v[172:175], v27 offset:6144
    v_pk_mul_f32 v[38:39], v[30:31], v[30:31]
    v_pk_mul_f32 v[40:41], v[32:33], v[32:33]
    v_pk_mul_f32 v[42:43], v[34:35], v[34:35]
    v_pk_fma_f32 v[36:37], v[36:37], v[142:143], v[142:143] op_sel:[0,0,1] op_sel_hi:[1,0,1]
    v_pk_fma_f32 v[38:39], v[38:39], v[142:143], v[142:143] op_sel:[0,0,1] op_sel_hi:[1,0,1]
    v_pk_fma_f32 v[40:41], v[40:41], v[142:143], v[142:143] op_sel:[0,0,1] op_sel_hi:[1,0,1]
    v_pk_fma_f32 v[42:43], v[42:43], v[142:143], v[142:143] op_sel:[0,0,1] op_sel_hi:[1,0,1]
    v_pk_mul_f32 v[36:37], v[36:37], v[28:29]
    v_pk_mul_f32 v[38:39], v[38:39], v[30:31]
    v_pk_mul_f32 v[40:41], v[40:41], v[32:33]
    v_pk_mul_f32 v[42:43], v[42:43], v[34:35]
    v_pk_mul_f32 v[28:29], v[216:217], v[28:29]
    v_pk_mul_f32 v[30:31], v[218:219], v[30:31]
    v_pk_mul_f32 v[32:33], v[220:221], v[32:33]
    v_pk_mul_f32 v[34:35], v[222:223], v[34:35]
    v_exp_f32 v36, v36
    v_exp_f32 v37, v37
    v_exp_f32 v38, v38
    v_exp_f32 v39, v39
    v_exp_f32 v40, v40
    v_exp_f32 v41, v41
    v_exp_f32 v42, v42
    v_exp_f32 v43, v43
    s_waitcnt vmcnt(3)
    s_barrier
    s_setprio 3
    ds_read_b64 v[108:109], v3 offset:8192
    v_add_u32 v7, 131072, v5
    ds_read_b128 v[8:11], v3 offset:0
    ds_read_b64 v[110:111], v3 offset:9216
    ds_read_b128 v[12:15], v3 offset:1024
    ds_read_b64 v[112:113], v3 offset:10240
    ds_read_b128 v[16:19], v3 offset:2048
    ds_read_b64 v[114:115], v3 offset:11264
    ds_read_b128 v[20:23], v3 offset:3072
    s_branch L_tail
L_k1:
    s_waitcnt vmcnt(6)
    s_barrier
    ds_read_b128 v[60:63], v8 offset:0
    ds_read_b64_tr_b16 v[44:45], v12 offset:0
    ds_read_b64_tr_b16 v[46:47], v12 offset:512
    ds_read_b128 v[64:67], v9 offset:0
    ds_read_b64_tr_b16 v[48:49], v12 offset:2048
    ds_read_b64_tr_b16 v[50:51], v12 offset:2560
    s_add_u32 m0, s89, 98304
    s_add_u32 s60, s60, s61
    s_sub_u32 s93, s60, 851968
    s_min_u32 s60, s60, s93
    buffer_load_dwordx4 v2, s[40:43], s60 offen lds
    s_waitcnt lgkmcnt(3)
    v_mfma_f32_32x32x16_bf16 v[28:43], v[44:47], v[60:63], 0
    ds_read_b128 v[68:71], v10 offset:0
    ds_read_b64_tr_b16 v[52:53], v12 offset:4096
    ds_read_b64_tr_b16 v[54:55], v12 offset:4608
    s_add_u32 m0, s89, 106496
    s_add_u32 s60, s60, s61
    s_sub_u32 s93, s60, 851968
    s_min_u32 s60, s60, s93
    buffer_load_dwordx4 v2, s[40:43], s60 offen lds
    s_waitcnt lgkmcnt(3)
    v_mfma_f32_32x32x16_bf16 v[28:43], v[48:51], v[64:67], v[28:43]
    ds_read_b128 v[72:75], v11 offset:0
    ds_read_b64_tr_b16 v[56:57], v12 offset:6144
    ds_read_b64_tr_b16 v[58:59], v12 offset:6656
    ds_read_b64 v[116:117], v13 offset:0
    s_add_u32 m0, s89, 49152
    s_nop 0
    buffer_load_dwordx4 v18, s[32:35], 0 offen  lds
    s_waitcnt lgkmcnt(4)
    v_mfma_f32_32x32x16_bf16 v[28:43], v[52:55], v[68:71], v[28:43]
    s_add_u32 m0, s89, 57344
    s_nop 0
    buffer_load_dwordx4 v19, s[32:35], 0 offen  lds
    s_waitcnt vmcnt(6)
    s_barrier
    ds_read_b128 v[60:63], v8 offset:16384
    ds_read_b64_tr_b16 v[44:45], v12 offset:16384
    ds_read_b64_tr_b16 v[46:47], v12 offset:16896
    s_waitcnt lgkmcnt(4)
    v_mfma_f32_32x32x16_bf16 v[28:43], v[56:59], v[72:75], v[28:43]
    ds_read_b128 v[64:67], v9 offset:16384
    ds_read_b64_tr_b16 v[48:49], v12 offset:18432
    ds_read_b64_tr_b16 v[50:51], v12 offset:18944
    s_waitcnt lgkmcnt(3)
    v_mfma_f32_32x32x16_bf16 v[76:91], v[100:103], v[60:63], 0
    v_mfma_f32_32x32x16_bf16 v[28:43], v[44:47], v[60:63], v[28:43]
    ds_read_b128 v[68:71], v10 offset:16384
    ds_read_b64_tr_b16 v[52:53], v12 offset:20480
    ds_read_b64_tr_b16 v[54:55], v12 offset:20992
    s_waitcnt lgkmcnt(3)
    v_mfma_f32_32x32x16_bf16 v[76:91], v[104:107], v[64:67], v[76:91]
    v_mfma_f32_32x32x16_bf16 v[28:43], v[48:51], v[64:67], v[28:43]
    ds_read_b128 v[72:75], v11 offset:16384
    ds_read_b64_tr_b16 v[56:57], v12 offset:22528
    ds_read_b64_tr_b16 v[58:59], v12 offset:23040
    ds_read_b64 v[118:119], v13 offset:16384
    ds_read_b64 v[16:17], v26 offset:32
    s_add_u32 m0, s89, 114688
    s_add_u32 s60, s60, s61
    s_sub_u32 s93, s60, 851968
    s_min_u32 s60, s60, s93
    buffer_load_dwordx4 v2, s[40:43], s60 offen lds
    s_waitcnt lgkmcnt(5)
    v_mfma_f32_32x32x16_bf16 v[76:91], v[108:111], v[68:71], v[76:91]
    v_mfma_f32_32x32x16_bf16 v[28:43], v[52:55], v[68:71], v[28:43]
    s_add_u32 m0, s89, 122880
    s_add_u32 s60, s60, s61
    s_sub_u32 s93, s60, 851968
    s_min_u32 s60, s60, s93
    buffer_load_dwordx4 v2, s[40:43], s60 offen lds
    s_waitcnt lgkmcnt(0)
    v_lshl_add_u32 v16, v16, 7, v3
    v_lshl_add_u32 v17, v17, 7, v3
    s_waitcnt vmcnt(4)
    s_barrier
    ds_read_b128 v[60:63], v8 offset:32768
    ds_read_b64_tr_b16 v[44:45], v12 offset:32768
    ds_read_b64_tr_b16 v[46:47], v12 offset:33280
    v_mfma_f32_32x32x16_bf16 v[76:91], v[112:115], v[72:75], v[76:91]
    v_mfma_f32_32x32x16_bf16 v[28:43], v[56:59], v[72:75], v[28:43]
    ds_read_b128 v[64:67], v9 offset:32768
    ds_read_b64_tr_b16 v[48:49], v12 offset:34816
    ds_read_b64_tr_b16 v[50:51], v12 offset:35328
    s_add_u32 m0, s89, 0
    s_nop 0
    buffer_load_dwordx4 v16, s[32:35], 0 offen  lds
    s_waitcnt lgkmcnt(3)
    v_mfma_f32_32x32x16_bf16 v[28:43], v[44:47], v[60:63], v[28:43]
    ds_read_b128 v[68:71], v10 offset:32768
    ds_read_b64_tr_b16 v[52:53], v12 offset:36864
    ds_read_b64_tr_b16 v[54:55], v12 offset:37376
    v_mov_b32 v213, v84
    s_add_u32 m0, s89, 8192
    s_nop 0
    buffer_load_dwordx4 v17, s[32:35], 0 offen  lds
    s_waitcnt lgkmcnt(3)
    v_mfma_f32_32x32x16_bf16 v[28:43], v[48:51], v[64:67], v[28:43]
    ds_read_b128 v[72:75], v11 offset:32768
    ds_read_b64_tr_b16 v[56:57], v12 offset:38912
    ds_read_b64_tr_b16 v[58:59], v12 offset:39424
    ds_read_b64 v[120:121], v13 offset:32768
    ds_read_b64 v[18:19], v26 offset:40
    s_add_u32 m0, s89, 65536
    s_add_u32 s60, s60, s61
    s_sub_u32 s93, s60, 851968
    s_min_u32 s60, s60, s93
    buffer_load_dwordx4 v2, s[40:43], s60 offen lds
    s_waitcnt lgkmcnt(5)
    v_mfma_f32_32x32x16_bf16 v[28:43], v[52:55], v[68:71], v[28:43]
    s_add_u32 m0, s89, 73728
    s_add_u32 s60, s60, s61
    s_sub_u32 s93, s60, 851968
    s_min_u32 s60, s60, s93
    buffer_load_dwordx4 v2, s[40:43], s60 offen lds
    s_waitcnt lgkmcnt(0)
    v_lshl_add_u32 v18, v18, 7, v3
    v_lshl_add_u32 v19, v19, 7, v3
    s_waitcnt vmcnt(4)
    s_barrier
    ds_read_b128 v[60:63], v8 offset:49152
    ds_read_b64_tr_b16 v[44:45], v12 offset:49152
    ds_read_b64_tr_b16 v[46:47], v12 offset:49664
    v_mfma_f32_32x32x16_bf16 v[28:43], v[56:59], v[72:75], v[28:43]
    ds_read_b128 v[64:67], v9 offset:49152
    ds_read_b64_tr_b16 v[48:49], v12 offset:51200
    ds_read_b64_tr_b16 v[50:51], v12 offset:51712
    s_add_u32 m0, s89, 16384
    s_nop 0
    buffer_load_dwordx4 v18, s[32:35], 0 offen  lds
    s_waitcnt lgkmcnt(3)
    v_mfma_f32_32x32x16_bf16 v[84:99], v[100:103], v[60:63], 0
    v_mfma_f32_32x32x16_bf16 v[28:43], v[44:47], v[60:63], v[28:43]
    ds_read_b128 v[68:71], v10 offset:49152
    ds_read_b64_tr_b16 v[52:53], v12 offset:53248
    ds_read_b64_tr_b16 v[54:55], v12 offset:53760
    s_add_u32 m0, s89, 24576
    s_nop 0
    buffer_load_dwordx4 v19, s[32:35], 0 offen  lds
    s_waitcnt lgkmcnt(3)
    v_mfma_f32_32x32x16_bf16 v[84:99], v[104:107], v[64:67], v[84:99]
    v_mfma_f32_32x32x16_bf16 v[28:43], v[48:51], v[64:67], v[28:43]
    ds_read_b128 v[72:75], v11 offset:49152
    ds_read_b64_tr_b16 v[56:57], v12 offset:55296
    ds_read_b64_tr_b16 v[58:59], v12 offset:55808
    ds_read_b64 v[122:123], v13 offset:49152
    ds_read_b64 v[16:17], v26 offset:48
    s_add_u32 m0, s89, 81920
    s_add_u32 s60, s60, s61
    s_sub_u32 s93, s60, 851968
    s_min_u32 s60, s60, s93
    buffer_load_dwordx4 v2, s[40:43], s60 offen lds
    s_waitcnt lgkmcnt(5)
    v_mfma_f32_32x32x16_bf16 v[84:99], v[108:111], v[68:71], v[84:99]
    v_mfma_f32_32x32x16_bf16 v[28:43], v[52:55], v[68:71], v[28:43]
    s_add_u32 m0, s89, 90112
    s_add_u32 s60, s60, s61
    s_sub_u32 s93, s60, 851968
    s_min_u32 s60, s60, s93
    buffer_load_dwordx4 v2, s[40:43], s60 offen lds
    s_waitcnt lgkmcnt(0)
    v_lshl_add_u32 v16, v16, 7, v3
    v_lshl_add_u32 v17, v17, 7, v3
    s_waitcnt vmcnt(4)
    s_barrier
    ds_read_b128 v[60:63], v8 offset:0
    ds_read_b64_tr_b16 v[44:45], v12 offset:0
    ds_read_b64_tr_b16 v[46:47], v12 offset:512
    v_mfma_f32_32x32x16_bf16 v[84:99], v[112:115], v[72:75], v[84:99]
    v_mfma_f32_32x32x16_bf16 v[28:43], v[56:59], v[72:75], v[28:43]
    ds_read_b128 v[64:67], v9 offset:0
    ds_read_b64_tr_b16 v[48:49], v12 offset:2048
    ds_read_b64_tr_b16 v[50:51], v12 offset:2560
    s_add_u32 m0, s89, 32768
    s_nop 0
    buffer_load_dwordx4 v16, s[32:35], 0 offen  lds
    s_waitcnt lgkmcnt(3)
    v_mfma_f32_32x32x16_bf16 v[28:43], v[44:47], v[60:63], v[28:43]
    ds_read_b128 v[68:71], v10 offset:0
    ds_read_b64_tr_b16 v[52:53], v12 offset:4096
    ds_read_b64_tr_b16 v[54:55], v12 offset:4608
    v_cvt_pk_bf16_f32 v208, v213, v92
    v_cvt_pk_bf16_f32 v144, v76, v84
    v_cvt_pk_bf16_f32 v148, v77, v85
    v_cvt_pk_bf16_f32 v152, v78, v86
    v_cvt_pk_bf16_f32 v156, v79, v87
    v_cvt_pk_bf16_f32 v160, v80, v88
    v_cvt_pk_bf16_f32 v164, v81, v89
    v_cvt_pk_bf16_f32 v168, v82, v90
    v_cvt_pk_bf16_f32 v172, v83, v91
    s_add_u32 m0, s89, 40960
    s_nop 0
    buffer_load_dwordx4 v17, s[32:35], 0 offen  lds
    s_waitcnt lgkmcnt(3)
    v_mfma_f32_32x32x16_bf16 v[28:43], v[48:51], v[64:67], v[28:43]
    ds_read_b128 v[72:75], v11 offset:0
    ds_read_b64_tr_b16 v[56:57], v12 offset:6144
    ds_read_b64_tr_b16 v[58:59], v12 offset:6656
    ds_read_b64 v[124:125], v13 offset:0
    ds_read_b64 v[18:19], v26 offset:56
    s_add_u32 m0, s89, 98304
    s_add_u32 s60, s60, s61
    s_sub_u32 s93, s60, 851968
    s_min_u32 s60, s60, s93
    buffer_load_dwordx4 v2, s[40:43], s60 offen lds
    s_waitcnt lgkmcnt(5)
    v_mfma_f32_32x32x16_bf16 v[28:43], v[52:55], v[68:71], v[28:43]
    s_add_u32 m0, s89, 106496
    s_add_u32 s60, s60, s61
    s_sub_u32 s93, s60, 851968
    s_min_u32 s60, s60, s93
    buffer_load_dwordx4 v2, s[40:43], s60 offen lds
    s_waitcnt lgkmcnt(0)
    v_lshl_add_u32 v18, v18, 7, v3
    v_lshl_add_u32 v19, v19, 7, v3
    s_waitcnt vmcnt(4)
    s_barrier
    ds_read_b128 v[60:63], v8 offset:16384
    ds_read_b64_tr_b16 v[44:45], v12 offset:16384
    ds_read_b64_tr_b16 v[46:47], v12 offset:16896
    v_mfma_f32_32x32x16_bf16 v[28:43], v[56:59], v[72:75], v[28:43]
    ds_read_b128 v[64:67], v9 offset:16384
    ds_read_b64_tr_b16 v[48:49], v12 offset:18432
    ds_read_b64_tr_b16 v[50:51], v12 offset:18944
    s_add_u32 m0, s89, 49152
    s_nop 0
    buffer_load_dwordx4 v18, s[32:35], 0 offen  lds
    s_waitcnt lgkmcnt(3)
    v_mfma_f32_32x32x16_bf16 v[76:91], v[100:103], v[60:63], 0
    v_mfma_f32_32x32x16_bf16 v[28:43], v[44:47], v[60:63], v[28:43]
    ds_read_b128 v[68:71], v10 offset:16384
    ds_read_b64_tr_b16 v[52:53], v12 offset:20480
    ds_read_b64_tr_b16 v[54:55], v12 offset:20992
    s_add_u32 m0, s89, 57344
    s_nop 0
    buffer_load_dwordx4 v19, s[32:35], 0 offen  lds
    s_waitcnt lgkmcnt(3)
    v_mfma_f32_32x32x16_bf16 v[76:91], v[104:107], v[64:67], v[76:91]
    v_mfma_f32_32x32x16_bf16 v[28:43], v[48:51], v[64:67], v[28:43]
    ds_read_b128 v[72:75], v11 offset:16384
    ds_read_b64_tr_b16 v[56:57], v12 offset:22528
    ds_read_b64_tr_b16 v[58:59], v12 offset:23040
    ds_read_b64 v[126:127], v13 offset:16384
    ds_read_b64 v[16:17], v26 offset:64
    s_add_u32 m0, s89, 114688
    s_add_u32 s60, s60, s61
    s_sub_u32 s93, s60, 851968
    s_min_u32 s60, s60, s93
    buffer_load_dwordx4 v2, s[40:43], s60 offen lds
    s_waitcnt lgkmcnt(5)
    v_mfma_f32_32x32x16_bf16 v[76:91], v[108:111], v[68:71], v[76:91]
    v_mfma_f32_32x32x16_bf16 v[28:43], v[52:55], v[68:71], v[28:43]
    s_add_u32 m0, s89, 122880
    s_add_u32 s60, s60, s61
    s_sub_u32 s93, s60, 851968
    s_min_u32 s60, s60, s93
    buffer_load_dwordx4 v2, s[40:43], s60 offen lds
    s_waitcnt lgkmcnt(0)
    v_lshl_add_u32 v16, v16, 7, v3
    v_lshl_add_u32 v17, v17, 7, v3
    s_waitcnt vmcnt(4)
    s_barrier
    ds_read_b128 v[60:63], v8 offset:32768
    ds_read_b64_tr_b16 v[44:45], v12 offset:32768
    ds_read_b64_tr_b16 v[46:47], v12 offset:33280
    v_mfma_f32_32x32x16_bf16 v[76:91], v[112:115], v[72:75], v[76:91]
    v_mfma_f32_32x32x16_bf16 v[28:43], v[56:59], v[72:75], v[28:43]
    ds_read_b128 v[64:67], v9 offset:32768
    ds_read_b64_tr_b16 v[48:49], v12 offset:34816
    ds_read_b64_tr_b16 v[50:51], v12 offset:35328
    s_add_u32 m0, s89, 0
    s_nop 0
    buffer_load_dwordx4 v16, s[32:35], 0 offen  lds
    s_waitcnt lgkmcnt(3)
    v_mfma_f32_32x32x16_bf16 v[28:43], v[44:47], v[60:63], v[28:43]
    ds_read_b128 v[68:71], v10 offset:32768
    ds_read_b64_tr_b16 v[52:53], v12 offset:36864
    ds_read_b64_tr_b16 v[54:55], v12 offset:37376
    v_mov_b32 v213, v84
    s_add_u32 m0, s89, 8192
    s_nop 0
    buffer_load_dwordx4 v17, s[32:35], 0 offen  lds
    s_waitcnt lgkmcnt(3)
    v_mfma_f32_32x32x16_bf16 v[28:43], v[48:51], v[64:67], v[28:43]
    ds_read_b128 v[72:75], v11 offset:32768
    ds_read_b64_tr_b16 v[56:57], v12 offset:38912
    ds_read_b64_tr_b16 v[58:59], v12 offset:39424
    ds_read_b64 v[128:129], v13 offset:32768
    ds_read_b64 v[18:19], v26 offset:72
    s_add_u32 m0, s89, 65536
    s_add_u32 s60, s60, s61
    s_sub_u32 s93, s60, 851968
    s_min_u32 s60, s60, s93
    buffer_load_dwordx4 v2, s[40:43], s60 offen lds
    s_waitcnt lgkmcnt(5)
    v_mfma_f32_32x32x16_bf16 v[28:43], v[52:55], v[68:71], v[28:43]
    s_add_u32 m0, s89, 73728
    s_add_u32 s60, s60, s61
    s_sub_u32 s93, s60, 851968
    s_min_u32 s60, s60, s93
    buffer_load_dwordx4 v2, s[40:43], s60 offen lds
    s_waitcnt lgkmcnt(0)
    v_lshl_add_u32 v18, v18, 7, v3
    v_lshl_add_u32 v19, v19, 7, v3
    s_waitcnt vmcnt(4)
    s_barrier
    ds_read_b128 v[60:63], v8 offset:49152
    ds_read_b64_tr_b16 v[44:45], v12 offset:49152
    ds_read_b64_tr_b16 v[46:47], v12 offset:49664
    v_mfma_f32_32x32x16_bf16 v[28:43], v[56:59], v[72:75], v[28:43]
    ds_read_b128 v[64:67], v9 offset:49152
    ds_read_b64_tr_b16 v[48:49], v12 offset:51200
    ds_read_b64_tr_b16 v[50:51], v12 offset:51712
    s_add_u32 m0, s89, 16384
    s_nop 0
    buffer_load_dwordx4 v18, s[32:35], 0 offen  lds
    s_waitcnt lgkmcnt(3)
    v_mfma_f32_32x32x16_bf16 v[84:99], v[100:103], v[60:63], 0
    v_mfma_f32_32x32x16_bf16 v[28:43], v[44:47], v[60:63], v[28:43]
    ds_read_b128 v[68:71], v10 offset:49152
    ds_read_b64_tr_b16 v[52:53], v12 offset:53248
    ds_read_b64_tr_b16 v[54:55], v12 offset:53760
    s_add_u32 m0, s89, 24576
    s_nop 0
    buffer_load_dwordx4 v19, s[32:35], 0 offen  lds
    s_waitcnt lgkmcnt(3)
    v_mfma_f32_32x32x16_bf16 v[84:99], v[104:107], v[64:67], v[84:99]
    v_mfma_f32_32x32x16_bf16 v[28:43], v[48:51], v[64:67], v[28:43]
    ds_read_b128 v[72:75], v11 offset:49152
    ds_read_b64_tr_b16 v[56:57], v12 offset:55296
    ds_read_b64_tr_b16 v[58:59], v12 offset:55808
    ds_read_b64 v[130:131], v13 offset:49152
    ds_read_b64 v[16:17], v26 offset:80
    s_add_u32 m0, s89, 81920
    s_add_u32 s60, s60, s61
    s_sub_u32 s93, s60, 851968
    s_min_u32 s60, s60, s93
    buffer_load_dwordx4 v2, s[40:43], s60 offen lds
    s_waitcnt lgkmcnt(5)
    v_mfma_f32_32x32x16_bf16 v[84:99], v[108:111], v[68:71], v[84:99]
    v_mfma_f32_32x32x16_bf16 v[28:43], v[52:55], v[68:71], v[28:43]
    s_add_u32 m0, s89, 90112
    s_add_u32 s60, s60, s61
    s_sub_u32 s93, s60, 851968
    s_min_u32 s60, s60, s93
    buffer_load_dwordx4 v2, s[40:43], s60 offen lds
    s_waitcnt lgkmcnt(0)
    v_lshl_add_u32 v16, v16, 7, v3
    v_lshl_add_u32 v17, v17, 7, v3
    s_waitcnt vmcnt(4)
    s_barrier
    ds_read_b128 v[60:63], v8 offset:0
    ds_read_b64_tr_b16 v[44:45], v12 offset:0
    ds_read_b64_tr_b16 v[46:47], v12 offset:512
    v_mfma_f32_32x32x16_bf16 v[84:99], v[112:115], v[72:75], v[84:99]
    v_mfma_f32_32x32x16_bf16 v[28:43], v[56:59], v[72:75], v[28:43]
    ds_read_b128 v[64:67], v9 offset:0
    ds_read_b64_tr_b16 v[48:49], v12 offset:2048
    ds_read_b64_tr_b16 v[50:51], v12 offset:2560
    s_add_u32 m0, s89, 32768
    s_nop 0
    buffer_load_dwordx4 v16, s[32:35], 0 offen  lds
    s_waitcnt lgkmcnt(3)
    v_mfma_f32_32x32x16_bf16 v[28:43], v[44:47], v[60:63], v[28:43]
    ds_read_b128 v[68:71], v10 offset:0
    ds_read_b64_tr_b16 v[52:53], v12 offset:4096
    ds_read_b64_tr_b16 v[54:55], v12 offset:4608
    v_cvt_pk_bf16_f32 v209, v213, v92
    v_cvt_pk_bf16_f32 v145, v76, v84
    v_cvt_pk_bf16_f32 v149, v77, v85
    v_cvt_pk_bf16_f32 v153, v78, v86
    v_cvt_pk_bf16_f32 v157, v79, v87
    v_cvt_pk_bf16_f32 v161, v80, v88
    v_cvt_pk_bf16_f32 v165, v81, v89
    v_cvt_pk_bf16_f32 v169, v82, v90
    v_cvt_pk_bf16_f32 v173, v83, v91
    s_add_u32 m0, s89, 40960
    s_nop 0
    buffer_load_dwordx4 v17, s[32:35], 0 offen  lds
    s_waitcnt lgkmcnt(3)
    v_mfma_f32_32x32x16_bf16 v[28:43], v[48:51], v[64:67], v[28:43]
    ds_read_b128 v[72:75], v11 offset:0
    ds_read_b64_tr_b16 v[56:57], v12 offset:6144
    ds_read_b64_tr_b16 v[58:59], v12 offset:6656
    ds_read_b64 v[132:133], v13 offset:0
    ds_read_b64 v[18:19], v26 offset:88
    s_add_u32 m0, s89, 98304
    s_add_u32 s60, s60, s61
    s_sub_u32 s93, s60, 851968
    s_min_u32 s60, s60, s93
    buffer_load_dwordx4 v2, s[40:43], s60 offen lds
    s_waitcnt lgkmcnt(5)
    v_mfma_f32_32x32x16_bf16 v[28:43], v[52:55], v[68:71], v[28:43]
    s_add_u32 m0, s89, 106496
    s_add_u32 s60, s60, s61
    s_sub_u32 s93, s60, 851968
    s_min_u32 s60, s60, s93
    buffer_load_dwordx4 v2, s[40:43], s60 offen lds
    s_waitcnt lgkmcnt(0)
    v_lshl_add_u32 v18, v18, 7, v3
    v_lshl_add_u32 v19, v19, 7, v3
    s_waitcnt vmcnt(4)
    s_barrier
    ds_read_b128 v[60:63], v8 offset:16384
    ds_read_b64_tr_b16 v[44:45], v12 offset:16384
    ds_read_b64_tr_b16 v[46:47], v12 offset:16896
    v_mfma_f32_32x32x16_bf16 v[28:43], v[56:59], v[72:75], v[28:43]
    ds_read_b128 v[64:67], v9 offset:16384
    ds_read_b64_tr_b16 v[48:49], v12 offset:18432
    ds_read_b64_tr_b16 v[50:51], v12 offset:18944
    s_add_u32 m0, s89, 49152
    s_nop 0
    buffer_load_dwordx4 v18, s[32:35], 0 offen  lds
    s_waitcnt lgkmcnt(3)
    v_mfma_f32_32x32x16_bf16 v[76:91], v[100:103], v[60:63], 0
    v_mfma_f32_32x32x16_bf16 v[28:43], v[44:47], v[60:63], v[28:43]
    ds_read_b128 v[68:71], v10 offset:16384
    ds_read_b64_tr_b16 v[52:53], v12 offset:20480
    ds_read_b64_tr_b16 v[54:55], v12 offset:20992
    s_add_u32 m0, s89, 57344
    s_nop 0
    buffer_load_dwordx4 v19, s[32:35], 0 offen  lds
    s_waitcnt lgkmcnt(3)
    v_mfma_f32_32x32x16_bf16 v[76:91], v[104:107], v[64:67], v[76:91]
    v_mfma_f32_32x32x16_bf16 v[28:43], v[48:51], v[64:67], v[28:43]
    ds_read_b128 v[72:75], v11 offset:16384
    ds_read_b64_tr_b16 v[56:57], v12 offset:22528
    ds_read_b64_tr_b16 v[58:59], v12 offset:23040
    ds_read_b64 v[134:135], v13 offset:16384
    ds_read_b64 v[16:17], v26 offset:96
    s_add_u32 m0, s89, 114688
    s_add_u32 s60, s60, s61
    s_sub_u32 s93, s60, 851968
    s_min_u32 s60, s60, s93
    buffer_load_dwordx4 v2, s[40:43], s60 offen lds
    s_waitcnt lgkmcnt(5)
    v_mfma_f32_32x32x16_bf16 v[76:91], v[108:111], v[68:71], v[76:91]
    v_mfma_f32_32x32x16_bf16 v[28:43], v[52:55], v[68:71], v[28:43]
    s_add_u32 m0, s89, 122880
    s_add_u32 s60, s60, s61
    s_sub_u32 s93, s60, 851968
    s_min_u32 s60, s60, s93
    buffer_load_dwordx4 v2, s[40:43], s60 offen lds
    s_waitcnt lgkmcnt(0)
    v_lshl_add_u32 v16, v16, 7, v3
    v_lshl_add_u32 v17, v17, 7, v3
    s_waitcnt vmcnt(4)
    s_barrier
    ds_read_b128 v[60:63], v8 offset:32768
    ds_read_b64_tr_b16 v[44:45], v12 offset:32768
    ds_read_b64_tr_b16 v[46:47], v12 offset:33280
    v_mfma_f32_32x32x16_bf16 v[76:91], v[112:115], v[72:75], v[76:91]
    v_mfma_f32_32x32x16_bf16 v[28:43], v[56:59], v[72:75], v[28:43]
    ds_read_b128 v[64:67], v9 offset:32768
    ds_read_b64_tr_b16 v[48:49], v12 offset:34816
    ds_read_b64_tr_b16 v[50:51], v12 offset:35328
    s_add_u32 m0, s89, 0
    s_nop 0
    buffer_load_dwordx4 v16, s[32:35], 0 offen  lds
    s_waitcnt lgkmcnt(3)
    v_mfma_f32_32x32x16_bf16 v[28:43], v[44:47], v[60:63], v[28:43]
    ds_read_b128 v[68:71], v10 offset:32768
    ds_read_b64_tr_b16 v[52:53], v12 offset:36864
    ds_read_b64_tr_b16 v[54:55], v12 offset:37376
    v_mov_b32 v213, v84
    s_add_u32 m0, s89, 8192
    s_nop 0
    buffer_load_dwordx4 v17, s[32:35], 0 offen  lds
    s_waitcnt lgkmcnt(3)
    v_mfma_f32_32x32x16_bf16 v[28:43], v[48:51], v[64:67], v[28:43]
    ds_read_b128 v[72:75], v11 offset:32768
    ds_read_b64_tr_b16 v[56:57], v12 offset:38912
    ds_read_b64_tr_b16 v[58:59], v12 offset:39424
    ds_read_b64 v[136:137], v13 offset:32768
    s_add_u32 m0, s89, 65536
    s_add_u32 s60, s60, s61
    s_sub_u32 s93, s60, 851968
    s_min_u32 s60, s60, s93
    buffer_load_dwordx4 v2, s[40:43], s60 offen lds
    s_waitcnt lgkmcnt(4)
    v_mfma_f32_32x32x16_bf16 v[28:43], v[52:55], v[68:71], v[28:43]
    s_add_u32 m0, s89, 73728
    s_add_u32 s60, s60, s61
    s_sub_u32 s93, s60, 851968
    s_min_u32 s60, s60, s93
    buffer_load_dwordx4 v2, s[40:43], s60 offen lds
    s_waitcnt vmcnt(4)
    s_barrier
    ds_read_b128 v[60:63], v8 offset:49152
    ds_read_b64_tr_b16 v[44:45], v12 offset:49152
    ds_read_b64_tr_b16 v[46:47], v12 offset:49664
    s_waitcnt lgkmcnt(4)
    v_mfma_f32_32x32x16_bf16 v[28:43], v[56:59], v[72:75], v[28:43]
    ds_read_b128 v[64:67], v9 offset:49152
    ds_read_b64_tr_b16 v[48:49], v12 offset:51200
    ds_read_b64_tr_b16 v[50:51], v12 offset:51712
    s_add_u32 m0, s89, 131072
    s_nop 0
    buffer_load_dwordx4 v7, s[36:39], s28 offen lds
    s_waitcnt lgkmcnt(3)
    v_mfma_f32_32x32x16_bf16 v[84:99], v[100:103], v[60:63], 0
    v_mfma_f32_32x32x16_bf16 v[28:43], v[44:47], v[60:63], v[28:43]
    ds_read_b128 v[68:71], v10 offset:49152
    ds_read_b64_tr_b16 v[52:53], v12 offset:53248
    ds_read_b64_tr_b16 v[54:55], v12 offset:53760
    s_add_u32 m0, s89, 139264
    s_nop 0
    buffer_load_dwordx4 v7, s[36:39], s29 offen lds
    s_lshl_b32 s91, s86, 11
    v_lshl_add_u32 v16, v1, 4, s91
    v_xor_b32 v17, 8192, v16
    v_lshrrev_b32 v250, 4, v1
    s_and_b32 s92, s86, 3
    s_lshl_b32 s92, s92, 8
    v_lshl_add_u32 v250, v250, 10, s92
    v_and_b32 v251, 15, v1
    v_lshl_add_u32 v18, v251, 4, v250
    v_add_u32 v26, 81920, v18
    v_add_u32 v18, 157696, v18
    s_waitcnt lgkmcnt(3)
    v_mfma_f32_32x32x16_bf16 v[84:99], v[104:107], v[64:67], v[84:99]
    v_mfma_f32_32x32x16_bf16 v[28:43], v[48:51], v[64:67], v[28:43]
    ds_read_b128 v[72:75], v11 offset:49152
    ds_read_b64_tr_b16 v[56:57], v12 offset:55296
    ds_read_b64_tr_b16 v[58:59], v12 offset:55808
    ds_read_b64 v[138:139], v13 offset:49152
    s_add_u32 m0, s89, 147456
    s_nop 0
    buffer_load_dwordx4 v7, s[36:39], s30 offen lds
    v_lshrrev_b32 v250, 5, v1
    v_and_b32 v251, 31, v1
    s_and_b32 s91, s86, 1
    s_lshl_b32 s92, s91, 9
    s_add_u32 s92, s92, 81920
    v_lshl_add_u32 v252, v250, 12, s92
    v_lshl_add_u32 v3, v251, 4, v252
    s_lshl_b32 s91, s91, 10
    s_lshr_b32 s92, s86, 1
    s_lshl_b32 s92, s92, 3
    s_add_u32 s91, s91, s92
    s_add_u32 s91, s91, 16384
    v_lshl_add_u32 v252, v250, 2, s91
    v_lshl_add_u32 v2, v251, 5, v252
    s_waitcnt lgkmcnt(4)
    v_mfma_f32_32x32x16_bf16 v[84:99], v[108:111], v[68:71], v[84:99]
    v_mfma_f32_32x32x16_bf16 v[28:43], v[52:55], v[68:71], v[28:43]
    s_waitcnt vmcnt(3) lgkmcnt(0)
    s_barrier
    s_setprio 3
    ds_read_b128 v[60:63], v8 offset:0
    ds_read_b64_tr_b16 v[44:45], v12 offset:0
    ds_read_b64_tr_b16 v[46:47], v12 offset:512
    v_mfma_f32_32x32x16_bf16 v[84:99], v[112:115], v[72:75], v[84:99]
    v_mfma_f32_32x32x16_bf16 v[28:43], v[56:59], v[72:75], v[28:43]
    ds_read_b128 v[64:67], v9 offset:0
    ds_read_b64_tr_b16 v[48:49], v12 offset:2048
    ds_read_b64_tr_b16 v[50:51], v12 offset:2560
    s_lshr_b32 s91, s86, 1
    s_cmp_lg_u32 s91, 0
    s_cbranch_scc1 L_wc6
    s_add_u32 m0, s89, 155648
    buffer_load_dwordx4 v7, s[36:39], s31 offen lds
L_wc6:
    s_waitcnt lgkmcnt(3)
    v_mfma_f32_32x32x16_bf16 v[28:43], v[44:47], v[60:63], v[28:43]
    ds_read_b128 v[68:71], v10 offset:0
    ds_read_b64_tr_b16 v[52:53], v12 offset:4096
    ds_read_b64_tr_b16 v[54:55], v12 offset:4608
    ds_read_b128 v[72:75], v11 offset:0
    ds_read_b64_tr_b16 v[56:57], v12 offset:6144
    ds_read_b64_tr_b16 v[58:59], v12 offset:6656
    ds_read_b64 v[140:141], v13 offset:0
    v_cvt_pk_bf16_f32 v210, v213, v92
    v_cvt_pk_bf16_f32 v146, v76, v84
    v_cvt_pk_bf16_f32 v150, v77, v85
    v_cvt_pk_bf16_f32 v154, v78, v86
    v_cvt_pk_bf16_f32 v158, v79, v87
    v_cvt_pk_bf16_f32 v162, v80, v88
    v_cvt_pk_bf16_f32 v166, v81, v89
    v_cvt_pk_bf16_f32 v170, v82, v90
    v_cvt_pk_bf16_f32 v174, v83, v91
    s_waitcnt lgkmcnt(7)
    v_mfma_f32_32x32x16_bf16 v[28:43], v[48:51], v[64:67], v[28:43]
    s_setprio 1
    ds_write_b128 v14, v[208:211]
    ds_write_b96 v15, v[144:146] offset:0
    s_waitcnt lgkmcnt(6)
    v_mfma_f32_32x32x16_bf16 v[28:43], v[52:55], v[68:71], v[28:43]
    ds_write_b96 v15, v[148:150] offset:2048
    ds_write_b96 v15, v[152:154] offset:4096
    s_waitcnt lgkmcnt(5)
    v_mfma_f32_32x32x16_bf16 v[28:43], v[56:59], v[72:75], v[28:43]
    ds_write_b96 v15, v[156:158] offset:6144
    ds_write_b96 v15, v[160:162] offset:16384
    ds_write_b96 v15, v[164:166] offset:18432
    ds_write_b96 v15, v[168:170] offset:20480
    ds_write_b96 v15, v[172:174] offset:22528
    s_nop 6
    ds_write_b128 v16, v[36:39] offset:49152
    ds_write_b128 v16, v[40:43] offset:50176
    s_waitcnt lgkmcnt(0)
    s_barrier
    s_setprio 3
    ds_read_b128 v[240:243], v18
    s_add_u32 m0, s89, 0
    s_add_u32 s91, s28, 86528
    buffer_load_dwordx4 v7, s[36:39], s91 offen lds
    s_mov_b32 s10, 0xbfb8aa3b
    s_mov_b32 s11, 0xbfb8aa3b
    s_waitcnt lgkmcnt(0)
    v_mfma_f32_16x16x32_bf16 v[44:47], v[20:23], v[240:243], 0
    ds_read_b128 v[36:39], v17 offset:49152
    ds_read_b128 v[40:43], v17 offset:50176
    s_add_u32 m0, s89, 8192
    s_add_u32 s91, s29, 86528
    buffer_load_dwordx4 v7, s[36:39], s91 offen lds
    s_nop 2
    v_pk_mul_f32 v[52:53], v[44:45], v[44:45]
    v_pk_mul_f32 v[54:55], v[46:47], v[46:47]
    v_pk_fma_f32 v[52:53], v[52:53], v[142:143], v[142:143] op_sel:[0,0,1] op_sel_hi:[1,0,1]
    v_pk_fma_f32 v[54:55], v[54:55], v[142:143], v[142:143] op_sel:[0,0,1] op_sel_hi:[1,0,1]
    v_pk_mul_f32 v[52:53], v[52:53], v[44:45]
    v_pk_mul_f32 v[54:55], v[54:55], v[46:47]
    v_exp_f32 v52, v52
    v_exp_f32 v53, v53
    v_exp_f32 v54, v54
    v_exp_f32 v55, v55
    v_pk_add_f32 v[52:53], v[52:53], 1.0 op_sel_hi:[1,0]
    v_pk_add_f32 v[54:55], v[54:55], 1.0 op_sel_hi:[1,0]
    v_rcp_f32 v52, v52
    v_rcp_f32 v53, v53
    v_rcp_f32 v54, v54
    v_rcp_f32 v55, v55
    v_pk_mul_f32 v[52:53], v[52:53], v[44:45]
    v_pk_mul_f32 v[54:55], v[54:55], v[46:47]
    v_cvt_pk_bf16_f32 v240, v52, v53
    v_cvt_pk_bf16_f32 v241, v54, v55
    s_add_u32 m0, s89, 65536
    s_add_u32 s91, s30, 86528
    buffer_load_dwordx4 v7, s[36:39], s91 offen lds
    v_mfma_f32_16x16x16_bf16 v[44:47], v[24:25], v[240:241], 0
    v_mfma_f32_16x16x16_bf16 v[48:51], v[214:215], v[240:241], 0
    s_lshr_b32 s91, s86, 1
    s_cmp_lg_u32 s91, 1
    s_cbranch_scc1 L_wc7
    s_add_u32 m0, s89, 71680
    s_add_u32 s91, s31, 86528
    buffer_load_dwordx4 v7, s[36:39], s91 offen lds
L_wc7:
    s_waitcnt lgkmcnt(0)
    v_pk_add_f32 v[28:29], v[28:29], v[36:37]
    v_pk_add_f32 v[30:31], v[30:31], v[38:39]
    v_pk_add_f32 v[32:33], v[32:33], v[40:41]
    v_pk_add_f32 v[34:35], v[34:35], v[42:43]
    v_pk_mul_f32 v[52:53], v[44:45], s[10:11]
    v_pk_mul_f32 v[54:55], v[46:47], s[10:11]
    v_pk_mul_f32 v[56:57], v[48:49], s[10:11]
    v_pk_mul_f32 v[58:59], v[50:51], s[10:11]
    v_exp_f32 v52, v52
    v_exp_f32 v53, v53
    v_exp_f32 v54, v54
    v_exp_f32 v55, v55
    v_exp_f32 v56, v56
    v_exp_f32 v57, v57
    v_exp_f32 v58, v58
    v_exp_f32 v59, v59
    v_pk_add_f32 v[52:53], v[52:53], 1.0 op_sel_hi:[1,0]
    v_pk_add_f32 v[54:55], v[54:55], 1.0 op_sel_hi:[1,0]
    v_pk_add_f32 v[56:57], v[56:57], 1.0 op_sel_hi:[1,0]
    v_pk_add_f32 v[58:59], v[58:59], 1.0 op_sel_hi:[1,0]
    v_rcp_f32 v52, v52
    v_rcp_f32 v53, v53
    v_rcp_f32 v54, v54
    v_rcp_f32 v55, v55
    v_rcp_f32 v56, v56
    v_rcp_f32 v57, v57
    v_rcp_f32 v58, v58
    v_rcp_f32 v59, v59
    v_cvt_pk_bf16_f32 v240, v52, v53
    v_cvt_pk_bf16_f32 v241, v54, v55
    v_and_b32 v242, 0xffff, v240
    v_lshrrev_b32 v243, 16, v240
    ds_write_b64 v26, v[242:243] offset:8192
    v_lshlrev_b32 v52, 16, v240
    v_and_b32 v53, 0xffff0000, v240
    v_lshlrev_b32 v54, 16, v241
    v_and_b32 v55, 0xffff0000, v241
    ds_write_b128 v26, v[52:55] offset:0
    v_cvt_pk_bf16_f32 v244, v56, v57
    v_cvt_pk_bf16_f32 v245, v58, v59
    v_and_b32 v246, 0xffff, v244
    v_lshrrev_b32 v247, 16, v244
    ds_write_b64 v26, v[246:247] offset:12288
    v_lshlrev_b32 v56, 16, v244
    v_and_b32 v57, 0xffff0000, v244
    v_lshlrev_b32 v58, 16, v245
    v_and_b32 v59, 0xffff0000, v245
    ds_write_b128 v26, v[56:59] offset:4096
    ds_read_b128 v[148:151], v27 offset:0
    v_pk_mul_f32 v[36:37], v[28:29], v[28:29]
    ds_read_b128 v[156:159], v27 offset:2048
    v_pk_mul_f32 v[38:39], v[30:31], v[30:31]
    ds_read_b128 v[164:167], v27 offset:4096
    v_pk_mul_f32 v[40:41], v[32:33], v[32:33]
    ds_read_b128 v[172:175], v27 offset:6144
    v_pk_mul_f32 v[42:43], v[34:35], v[34:35]
    s_waitcnt vmcnt(3) lgkmcnt(4)
    s_barrier
    s_setprio 3
    ds_read_b64 v[108:109], v3 offset:8192
    v_pk_fma_f32 v[36:37], v[36:37], v[142:143], v[142:143] op_sel:[0,0,1] op_sel_hi:[1,0,1]
    v_pk_fma_f32 v[38:39], v[38:39], v[142:143], v[142:143] op_sel:[0,0,1] op_sel_hi:[1,0,1]
    v_pk_fma_f32 v[40:41], v[40:41], v[142:143], v[142:143] op_sel:[0,0,1] op_sel_hi:[1,0,1]
    ds_read_b128 v[8:11], v3 offset:0
    v_pk_fma_f32 v[42:43], v[42:43], v[142:143], v[142:143] op_sel:[0,0,1] op_sel_hi:[1,0,1]
    v_pk_mul_f32 v[36:37], v[36:37], v[28:29]
    v_pk_mul_f32 v[38:39], v[38:39], v[30:31]
    ds_read_b64 v[110:111], v3 offset:9216
    v_pk_mul_f32 v[40:41], v[40:41], v[32:33]
    v_pk_mul_f32 v[42:43], v[42:43], v[34:35]
    v_pk_mul_f32 v[28:29], v[216:217], v[28:29]
    ds_read_b128 v[12:15], v3 offset:1024
    v_pk_mul_f32 v[30:31], v[218:219], v[30:31]
    v_pk_mul_f32 v[32:33], v[220:221], v[32:33]
    v_pk_mul_f32 v[34:35], v[222:223], v[34:35]
    ds_read_b64 v[112:113], v3 offset:10240
    v_exp_f32 v36, v36
    v_exp_f32 v37, v37
    v_exp_f32 v38, v38
    ds_read_b128 v[16:19], v3 offset:2048
    v_exp_f32 v39, v39
    v_exp_f32 v40, v40
    v_exp_f32 v41, v41
    ds_read_b64 v[114:115], v3 offset:11264
    v_exp_f32 v42, v42
    v_exp_f32 v43, v43
    v_add_u32 v7, 131072, v5
    ds_read_b128 v[20:23], v3 offset:3072
L_tail:
    s_setprio 3
    ds_read_b128 v[144:147], v4 offset:16384
    s_waitcnt lgkmcnt(9)
    s_waitcnt lgkmcnt(7)
    v_dot2_f32_bf16 v62, v148, v109, 0
    v_dot2_f32_bf16 v63, v148, v11, 0
    ds_read_b128 v[152:155], v4 offset:18432
    s_waitcnt lgkmcnt(6)
    v_dot2_f32_bf16 v66, v149, v111, 0
    v_dot2_f32_bf16 v67, v149, v15, 0
    s_waitcnt lgkmcnt(4)
    ds_read_b128 v[160:163], v4 offset:20480
    v_dot2_f32_bf16 v70, v150, v113, 0
    v_dot2_f32_bf16 v71, v150, v19, 0
    ds_read_b128 v[168:171], v4 offset:22528
    v_dot2_f32_bf16 v78, v156, v109, 0
    v_dot2_f32_bf16 v79, v156, v11, 0
    v_dot2_f32_bf16 v82, v157, v111, 0
    ds_read_b64 v[44:45], v7 offset:0
    v_dot2_f32_bf16 v83, v157, v15, 0
    v_dot2_f32_bf16 v86, v158, v113, 0
    v_dot2_f32_bf16 v87, v158, v19, 0
    ds_read_b64 v[46:47], v7 offset:4096
    s_waitcnt lgkmcnt(5)
    v_dot2_f32_bf16 v60, v144, v108, 0
    v_dot2_f32_bf16 v61, v144, v10, 0
    ds_read_b64 v[48:49], v7 offset:8192
    v_dot2_f32_bf16 v64, v145, v110, 0
    v_dot2_f32_bf16 v65, v145, v14, 0
    s_setprio 2
    ds_read_b64 v[50:51], v7 offset:12288
    v_dot2_f32_bf16 v68, v146, v112, 0
    v_dot2_f32_bf16 v69, v146, v18, 0
    v_dot2_f32_bf16 v72, v147, v114, 0
    ds_read_b64 v[52:53], v7 offset:16384
    s_waitcnt lgkmcnt(7)
    v_dot2_f32_bf16 v76, v152, v108, 0
    v_dot2_f32_bf16 v77, v152, v10, 0
    ds_read_b64 v[54:55], v7 offset:20480
    v_dot2_f32_bf16 v80, v153, v110, 0
    v_dot2_f32_bf16 v81, v153, v14, 0
    ds_read_b64 v[56:57], v7 offset:24576
    v_dot2_f32_bf16 v84, v154, v112, 0
    v_dot2_f32_bf16 v85, v154, v18, 0
    v_dot2_f32_bf16 v88, v155, v114, 0
    ds_read_b64 v[240:241], v7 offset:2048
    v_cvt_pk_bf16_f32 v212, v62, v63
    v_cvt_pk_bf16_f32 v213, v66, v67
    v_cvt_pk_bf16_f32 v214, v70, v71
    v_cvt_pk_bf16_f32 v208, v60, v61
    ds_read_b64 v[242:243], v7 offset:6144
    v_cvt_pk_bf16_f32 v209, v64, v65
    v_cvt_pk_bf16_f32 v210, v68, v69
    v_cvt_pk_bf16_f32 v211, v72, 0
    v_cvt_pk_bf16_f32 v220, v78, v79
    ds_read_b64 v[244:245], v7 offset:10240
    v_cvt_pk_bf16_f32 v221, v82, v83
    v_cvt_pk_bf16_f32 v222, v86, v87
    s_setprio 1
    v_cvt_pk_bf16_f32 v216, v76, v77
    v_cvt_pk_bf16_f32 v217, v80, v81
    ds_read_b64 v[246:247], v7 offset:14336
    v_cvt_pk_bf16_f32 v218, v84, v85
    v_cvt_pk_bf16_f32 v219, v88, 0
    ds_read_b64 v[248:249], v7 offset:18432
    v_dot2_f32_bf16 v62, v164, v109, 0
    v_dot2_f32_bf16 v63, v164, v11, 0
    v_dot2_f32_bf16 v66, v165, v111, 0
    ds_read_b64 v[250:251], v7 offset:22528
    v_dot2_f32_bf16 v67, v165, v15, 0
    v_dot2_f32_bf16 v70, v166, v113, 0
    v_dot2_f32_bf16 v71, v166, v19, 0
    v_dot2_f32_bf16 v78, v172, v109, 0
    v_dot2_f32_bf16 v79, v172, v11, 0
    v_dot2_f32_bf16 v82, v173, v111, 0
    v_dot2_f32_bf16 v83, v173, v15, 0
    v_dot2_f32_bf16 v86, v174, v113, 0
    v_dot2_f32_bf16 v87, v174, v19, 0
    s_waitcnt lgkmcnt(14)
    v_dot2_f32_bf16 v60, v160, v108, 0
    v_dot2_f32_bf16 v61, v160, v10, 0
    v_dot2_f32_bf16 v64, v161, v110, 0
    v_dot2_f32_bf16 v65, v161, v14, 0
    s_setprio 0
    v_dot2_f32_bf16 v68, v162, v112, 0
    v_dot2_f32_bf16 v69, v162, v18, 0
    v_dot2_f32_bf16 v72, v163, v114, 0
    s_waitcnt lgkmcnt(13)
    v_dot2_f32_bf16 v76, v168, v108, 0
    v_dot2_f32_bf16 v77, v168, v10, 0
    v_dot2_f32_bf16 v80, v169, v110, 0
    v_dot2_f32_bf16 v81, v169, v14, 0
    v_dot2_f32_bf16 v84, v170, v112, 0
    v_dot2_f32_bf16 v85, v170, v18, 0
    v_dot2_f32_bf16 v88, v171, v114, 0
    v_cvt_pk_bf16_f32 v228, v62, v63
    v_cvt_pk_bf16_f32 v229, v66, v67
    v_cvt_pk_bf16_f32 v230, v70, v71
    v_cvt_pk_bf16_f32 v224, v60, v61
    v_cvt_pk_bf16_f32 v225, v64, v65
    v_cvt_pk_bf16_f32 v226, v68, v69
    v_cvt_pk_bf16_f32 v227, v72, 0
    v_cvt_pk_bf16_f32 v236, v78, v79
    v_cvt_pk_bf16_f32 v237, v82, v83
    v_cvt_pk_bf16_f32 v238, v86, v87
    v_cvt_pk_bf16_f32 v232, v76, v77
    v_cvt_pk_bf16_f32 v233, v80, v81
    v_cvt_pk_bf16_f32 v234, v84, v85
    v_cvt_pk_bf16_f32 v235, v88, 0
    v_add_u32 v7, 65536, v5
    s_waitcnt vmcnt(0)
    s_barrier
    s_setprio 3
    ds_read_b64 v[108:109], v5 offset:0
    s_waitcnt lgkmcnt(12)
    v_perm_b32 v176, v46, v44, s94
    v_perm_b32 v184, v46, v44, s95
    ds_read_b64 v[110:111], v5 offset:4096
    v_perm_b32 v192, v47, v45, s94
    v_perm_b32 v200, v47, v45, s95
    s_waitcnt lgkmcnt(11)
    ds_read_b64 v[112:113], v5 offset:8192
    v_perm_b32 v177, v50, v48, s94
    v_perm_b32 v185, v50, v48, s95
    v_perm_b32 v193, v51, v49, s94
    ds_read_b64 v[114:115], v5 offset:12288
    v_perm_b32 v201, v51, v49, s95
    s_waitcnt lgkmcnt(11)
    v_perm_b32 v178, v54, v52, s94
    ds_read_b64 v[252:253], v7 offset:0
    v_perm_b32 v186, v54, v52, s95
    v_perm_b32 v194, v55, v53, s94
    v_perm_b32 v202, v55, v53, s95
    ds_read_b64 v[254:255], v7 offset:4096
    s_waitcnt lgkmcnt(12)
    v_and_b32 v179, 0xffff, v56
    v_lshrrev_b32 v187, 16, v56
    ds_read_b64 v[142:143], v7 offset:8192
    v_and_b32 v195, 0xffff, v57
    v_lshrrev_b32 v203, 16, v57
    v_mfma_f32_32x32x16_bf16 v[44:59], v[176:179], v[144:147], 0
    s_waitcnt lgkmcnt(11)
    v_perm_b32 v180, v242, v240, s94
    v_perm_b32 v188, v242, v240, s95
    v_perm_b32 v196, v243, v241, s94
    v_perm_b32 v204, v243, v241, s95
    s_waitcnt lgkmcnt(9)
    v_mfma_f32_32x32x16_bf16 v[60:75], v[184:187], v[152:155], 0
    v_perm_b32 v181, v246, v244, s94
    v_perm_b32 v189, v246, v244, s95
    v_perm_b32 v197, v247, v245, s94
    v_perm_b32 v205, v247, v245, s95
    s_waitcnt lgkmcnt(7)
    v_perm_b32 v182, v250, v248, s94
    v_perm_b32 v190, v250, v248, s95
    v_mfma_f32_32x32x16_bf16 v[76:91], v[192:195], v[160:163], 0
    v_perm_b32 v198, v251, v249, s94
    v_perm_b32 v206, v251, v249, s95
    ds_read_b64 v[240:241], v5 offset:2048
    v_add_f32 v36, 1.0, v36
    v_add_f32 v37, 1.0, v37
    v_add_f32 v38, 1.0, v38
    v_mfma_f32_32x32x16_bf16 v[92:107], v[200:203], v[168:171], 0
    ds_read_b64 v[242:243], v5 offset:6144
    v_add_f32 v39, 1.0, v39
    v_add_f32 v40, 1.0, v40
    v_add_f32 v41, 1.0, v41
    ds_read_b64 v[244:245], v5 offset:10240
    v_add_f32 v42, 1.0, v42
    s_setprio 2
    v_add_f32 v43, 1.0, v43
    v_mfma_f32_32x32x16_bf16 v[44:59], v[180:183], v[148:151], v[44:59]
    s_waitcnt lgkmcnt(8)
    ds_read_b64 v[246:247], v5 offset:14336
    v_perm_b32 v176, v110, v108, s94
    v_perm_b32 v184, v110, v108, s95
    v_perm_b32 v192, v111, v109, s94
    v_perm_b32 v200, v111, v109, s95
    v_mfma_f32_32x32x16_bf16 v[60:75], v[188:191], v[156:159], v[60:75]
    ds_read_b64 v[248:249], v7 offset:2048
    s_waitcnt lgkmcnt(8)
    v_perm_b32 v177, v114, v112, s94
    v_perm_b32 v185, v114, v112, s95
    v_perm_b32 v193, v115, v113, s94
    ds_read_b64 v[250:251], v7 offset:6144
    v_perm_b32 v201, v115, v113, s95
    v_mfma_f32_32x32x16_bf16 v[76:91], v[196:199], v[164:167], v[76:91]
    s_waitcnt lgkmcnt(7)
    v_perm_b32 v178, v254, v252, s94
    v_perm_b32 v186, v254, v252, s95
    v_perm_b32 v194, v255, v253, s94
    v_perm_b32 v202, v255, v253, s95
    s_waitcnt lgkmcnt(6)
    v_and_b32 v179, 0xffff, v142
    v_mfma_f32_32x32x16_bf16 v[92:107], v[204:207], v[172:175], v[92:107]
    v_lshrrev_b32 v187, 16, v142
    v_and_b32 v195, 0xffff, v143
    v_lshrrev_b32 v203, 16, v143
    v_rcp_f32 v36, v36
    v_rcp_f32 v37, v37
    v_rcp_f32 v38, v38
    v_rcp_f32 v39, v39
    v_mfma_f32_32x32x16_bf16 v[144:159], v[176:179], v[208:211], 0
    s_waitcnt lgkmcnt(4)
    v_perm_b32 v180, v242, v240, s94
    v_perm_b32 v188, v242, v240, s95
    v_perm_b32 v196, v243, v241, s94
    v_perm_b32 v204, v243, v241, s95
    s_waitcnt lgkmcnt(2)
    v_perm_b32 v181, v246, v244, s94
    v_mfma_f32_32x32x16_bf16 v[160:175], v[184:187], v[216:219], 0
    v_perm_b32 v189, v246, v244, s95
    v_perm_b32 v197, v247, v245, s94
    v_perm_b32 v205, v247, v245, s95
    s_waitcnt lgkmcnt(0)
    v_perm_b32 v182, v250, v248, s94
    v_perm_b32 v190, v250, v248, s95
    v_perm_b32 v198, v251, v249, s94
    v_perm_b32 v206, v251, v249, s95
    v_mfma_f32_32x32x16_bf16 v[144:159], v[180:183], v[212:215], v[144:159]
    v_rcp_f32 v40, v40
    v_rcp_f32 v41, v41
    v_rcp_f32 v42, v42
    v_rcp_f32 v43, v43
    v_mul_f32 v24, v28, v36
    v_mul_f32 v25, v29, v37
    v_fmac_f32 v24, v30, v38
    s_setprio 1
    v_fmac_f32 v25, v31, v39
    v_fmac_f32 v24, v32, v40
    v_fmac_f32 v25, v33, v41
    v_fmac_f32 v24, v34, v42
    v_mfma_f32_32x32x16_bf16 v[160:175], v[188:191], v[220:223], v[160:175]
    v_fmac_f32 v25, v35, v43
    v_lshlrev_b32 v27, 3, v1
    v_lshlrev_b32 v26, 5, v1
    v_add_u32 v26, 16384, v26
    s_and_b32 s91, s88, 1
    s_lshl_b32 s91, s91, 4
    s_cmp_lt_u32 s88, 2
    s_cselect_b32 s92, -1, 0
    s_cselect_b32 s93, 0, -1
    s_lshl_b32 s90, s87, 10
    s_mov_b32 s3, 0x40000
    v_mfma_f32_32x32x16_bf16 v[208:223], v[192:195], v[224:227], 0
    v_fmac_f32 v44, v8, v144
    v_fmac_f32 v45, v9, v145
    v_fmac_f32 v46, v10, v146
    v_fmac_f32 v47, v11, v147
    v_fmac_f32 v48, v12, v148
    v_fmac_f32 v49, v13, v149
    v_mfma_f32_32x32x16_bf16 v[208:223], v[196:199], v[228:231], v[208:223]
    v_fmac_f32 v50, v14, v150
    v_fmac_f32 v51, v15, v151
    v_fmac_f32 v52, v16, v152
    v_fmac_f32 v53, v17, v153
    v_fmac_f32 v54, v18, v154
    v_fmac_f32 v55, v19, v155
    v_fmac_f32 v56, v20, v156
    v_mfma_f32_32x32x16_bf16 v[176:191], v[200:203], v[232:235], 0
    v_fmac_f32 v60, v8, v160
    v_fmac_f32 v61, v9, v161
    v_fmac_f32 v62, v10, v162
    v_fmac_f32 v63, v11, v163
    v_fmac_f32 v64, v12, v164
    v_fmac_f32 v65, v13, v165
    v_mfma_f32_32x32x16_bf16 v[176:191], v[204:207], v[236:239], v[176:191]
    v_fmac_f32 v66, v14, v166
    v_fmac_f32 v67, v15, v167
    v_fmac_f32 v68, v16, v168
    v_fmac_f32 v69, v17, v169
    v_fmac_f32 v70, v18, v170
    v_fmac_f32 v71, v19, v171
    v_fmac_f32 v72, v20, v172
    v_cvt_pk_bf16_f32 v44, v44, v60
    v_cvt_pk_bf16_f32 v45, v45, v61
    v_cvt_pk_bf16_f32 v46, v46, v62
    v_cvt_pk_bf16_f32 v47, v47, v63
    v_cvt_pk_bf16_f32 v48, v48, v64
    v_cvt_pk_bf16_f32 v49, v49, v65
    v_cvt_pk_bf16_f32 v50, v50, v66
    v_cvt_pk_bf16_f32 v51, v51, v67
    v_cvt_pk_bf16_f32 v52, v52, v68
    v_cvt_pk_bf16_f32 v53, v53, v69
    v_cvt_pk_bf16_f32 v54, v54, v70
    s_setprio 0
    v_cvt_pk_bf16_f32 v55, v55, v71
    v_cvt_pk_bf16_f32 v56, v56, v72
    v_dot2c_f32_bf16 v24, v44, v116
    v_dot2c_f32_bf16 v25, v45, v118
    v_dot2c_f32_bf16 v24, v46, v120
    v_dot2c_f32_bf16 v25, v47, v122
    v_dot2c_f32_bf16 v24, v48, v124
    v_dot2c_f32_bf16 v25, v49, v126
    v_dot2c_f32_bf16 v24, v50, v128
    v_dot2c_f32_bf16 v25, v51, v130
    v_dot2c_f32_bf16 v24, v52, v132
    v_dot2c_f32_bf16 v25, v53, v134
    v_dot2c_f32_bf16 v24, v54, v136
    v_dot2c_f32_bf16 v25, v55, v138
    v_dot2c_f32_bf16 v24, v56, v140
    v_pk_fma_f32 v[76:77], v[8:9], v[208:209], v[76:77]
    v_pk_fma_f32 v[78:79], v[10:11], v[210:211], v[78:79]
    v_pk_fma_f32 v[80:81], v[12:13], v[212:213], v[80:81]
    v_pk_fma_f32 v[82:83], v[14:15], v[214:215], v[82:83]
    v_pk_fma_f32 v[84:85], v[16:17], v[216:217], v[84:85]
    v_pk_fma_f32 v[86:87], v[18:19], v[218:219], v[86:87]
    v_fmac_f32 v88, v20, v220
    v_pk_fma_f32 v[92:93], v[8:9], v[176:177], v[92:93]
    v_pk_fma_f32 v[94:95], v[10:11], v[178:179], v[94:95]
    v_pk_fma_f32 v[96:97], v[12:13], v[180:181], v[96:97]
    v_pk_fma_f32 v[98:99], v[14:15], v[182:183], v[98:99]
    v_pk_fma_f32 v[100:101], v[16:17], v[184:185], v[100:101]
    v_pk_fma_f32 v[102:103], v[18:19], v[186:187], v[102:103]
    v_fmac_f32 v104, v20, v188
    v_cvt_pk_bf16_f32 v76, v76, v92
    v_cvt_pk_bf16_f32 v77, v77, v93
    v_cvt_pk_bf16_f32 v78, v78, v94
    v_cvt_pk_bf16_f32 v79, v79, v95
    v_cvt_pk_bf16_f32 v80, v80, v96
    v_cvt_pk_bf16_f32 v81, v81, v97
    v_cvt_pk_bf16_f32 v82, v82, v98
    v_cvt_pk_bf16_f32 v83, v83, v99
    v_cvt_pk_bf16_f32 v84, v84, v100
    v_cvt_pk_bf16_f32 v85, v85, v101
    v_cvt_pk_bf16_f32 v86, v86, v102
    v_cvt_pk_bf16_f32 v87, v87, v103
    v_cvt_pk_bf16_f32 v88, v88, v104
    v_dot2c_f32_bf16 v24, v76, v117
    v_dot2c_f32_bf16 v25, v77, v119
    v_dot2c_f32_bf16 v24, v78, v121
    v_dot2c_f32_bf16 v25, v79, v123
    v_dot2c_f32_bf16 v24, v80, v125
    v_dot2c_f32_bf16 v25, v81, v127
    v_dot2c_f32_bf16 v24, v82, v129
    v_dot2c_f32_bf16 v25, v83, v131
    v_dot2c_f32_bf16 v24, v84, v133
    v_dot2c_f32_bf16 v25, v85, v135
    v_dot2c_f32_bf16 v24, v86, v137
    v_dot2c_f32_bf16 v25, v87, v139
    v_dot2c_f32_bf16 v24, v88, v141
    s_nop 2
    v_add_f32 v24, v24, v25
    ds_write_b32 v2, v24
    s_waitcnt lgkmcnt(0)
    s_barrier
    s_cmp_lg_u32 s86, 0
    s_cbranch_scc1 L_end
    ds_read_b128 v[240:243], v26 offset:0
    ds_read_b128 v[244:247], v26 offset:16
L_spin:
    v_readfirstlane_b32 s89, v6
    s_nop 0
    s_cmp_eq_u32 s89, 1
    s_cbranch_scc1 L_go
    s_sleep 2
    s_lshl_b32 s89, s87, 2
    buffer_load_dword v6, v0, s[52:55], s89 offen sc0 sc1
    s_waitcnt vmcnt(0)
    s_sub_u32 s3, s3, 1
    s_cbranch_scc0 L_spin
L_go:
    s_waitcnt lgkmcnt(0)
    v_pk_add_f32 v[240:241], v[240:241], v[244:245]
    v_pk_add_f32 v[242:243], v[242:243], v[246:247]
    v_pk_add_f32 v[240:241], v[240:241], v[242:243]
    v_add_f32 v240, v240, v241
    v_cvt_pk_bf16_f32 v241, v240, 0
    v_cmp_eq_u32 vcc, 0, v241
    v_mov_b32 v242, 0x8000
    v_lshlrev_b32 v4, 1, v1
    v_cndmask_b32 v241, v241, v242, vcc
    v_lshlrev_b32 v241, s91, v241
    v_and_b32 v248, s92, v241
    v_and_b32 v249, s93, v241
    buffer_atomic_or_x2 v[248:249], v27, s[56:59], s90 offen sc0 sc1
    v_and_b32 v244, s92, v241
    v_and_b32 v245, s93, v241
    s_lshl_b32 s92, s87, 7
    s_waitcnt vmcnt(0)
    v_or_b32 v248, v248, v244
    v_or_b32 v249, v249, v245
    v_lshlrev_b32 v240, 16, v248
    v_and_b32 v241, 0xffff0000, v248
    v_lshlrev_b32 v242, 16, v249
    v_and_b32 v243, 0xffff0000, v249
    v_min3_u32 v244, v240, v241, v242
    v_min_u32 v244, v244, v243
    v_cmp_ne_u32 vcc, 0, v244
    s_nop 0
    s_and_b64 exec, exec, vcc
    s_cbranch_execz L_end
    v_pk_add_f32 v[240:241], v[240:241], v[242:243]
    v_add_f32 v240, v240, v241
    v_cvt_pk_bf16_f32 v240, v240, v240
    buffer_store_short v240, v4, s[48:51], s92 offen
L_end:
    s_endpgm
.section .rodata,"a"
.p2align 6
.amdhsa_kernel standalone__deep_cross_fibinet__recsys_kernel
  .amdhsa_next_free_vgpr 256
  .amdhsa_next_free_sgpr 102
  .amdhsa_accum_offset 256
  .amdhsa_group_segment_fixed_size 0
  .amdhsa_kernarg_size 88
  .amdhsa_user_sgpr_count 2
  .amdhsa_user_sgpr_kernarg_segment_ptr 1
  .amdhsa_system_sgpr_workgroup_id_x 1
.end_amdhsa_kernel
```

```asm
; @launch grid=(256,1,1) block=(512,1,1) lds=163840
.amdgcn_target "amdgcn-amd-amdhsa--gfx950"
.text
.globl standalone__deep_cross_fibinet__recsys_kernel
.p2align 8
.type standalone__deep_cross_fibinet__recsys_kernel,@function
standalone__deep_cross_fibinet__recsys_kernel:
    s_cmp_ge_u32 s2, 256
    s_cbranch_scc1 L_end
    v_lshrrev_b32 v242, 6, v0
    s_load_dwordx16 s[4:19], s[0:1], 0
    v_readfirstlane_b32 s86, v242
    s_load_dwordx4 s[20:23], s[0:1], 64
    s_load_dwordx2 s[24:25], s[0:1], 80
    s_getpc_b64 s[92:93]
    s_bfe_u32 s88, s2, 0x20003
    s_lshr_b32 s91, s2, 4
    s_and_b32 s91, s91, 2
    s_xor_b32 s88, s88, s91
    s_mul_i32 s91, s88, 5504
    v_lshl_add_u32 v240, v0, 7, s91
    v_min_u32 v240, 21884, v240
    v_mov_b32 v241, s93
    v_add_co_u32 v240, vcc, s92, v240
    v_and_b32 v1, 63, v0
    s_lshl_b32 s89, s86, 10
    v_addc_co_u32 v241, vcc, 0, v241, vcc
    v_cmp_gt_u32 vcc, 43, v0
    v_lshlrev_b32 v246, 4, v1
    s_and_saveexec_b64 s[92:93], vcc
    s_cbranch_execz L_cpf
    global_load_dword v6, v[240:241], off
L_cpf:
    s_mov_b64 exec, -1
    s_lshr_b32 s91, s2, 5
    s_lshl_b32 s91, s91, 3
    s_and_b32 s92, s2, 7
    s_add_u32 s87, s91, s92
    s_and_b32 s91, s88, 1
    s_lshl_b32 s91, s91, 2
    s_and_b32 s92, s86, 3
    s_add_u32 s91, s91, s92
    s_cmp_ge_u32 s88, 2
    s_cselect_b32 s91, s91, s86
    s_lshl_b32 s92, s87, 3
    s_add_u32 s91, s91, s92
    s_mul_i32 s90, s91, 832
    s_mov_b32 s30, 425984
    s_mov_b32 s31, 0x00020000
    s_mov_b32 s42, 851968
    s_mov_b32 s43, 0x00020000
    s_mov_b32 s38, 173056
    s_mov_b32 s39, 0x00020000
    s_lshr_b32 s91, s2, 5
    s_lshl_b32 s91, s91, 1
    s_and_b32 s92, s88, 1
    s_add_u32 s91, s91, s92
    s_lshl_b32 s91, s91, 3
    s_add_u32 s91, s91, s86
    s_mul_i32 s91, s91, 20
    s_cmp_ge_u32 s88, 2
    s_cselect_b32 s92, 14, 0
    s_cselect_b32 s93, 5, 13
    s_add_u32 s91, s91, s92
    s_lshl_b32 s91, s91, 7
    v_min_u32 v247, s93, v1
    s_mul_i32 s92, s2, 16
    s_mul_i32 s93, s86, 2
    s_add_u32 s92, s92, s93
    s_add_u32 s92, s92, 2560
    s_lshr_b32 s93, s91, 7
    s_sub_u32 s92, s92, s93
    s_sub_u32 s92, s92, 62
    v_add_u32 v248, s92, v1
    v_cmp_le_u32 s[44:45], 62, v1
    s_nop 1
    v_cndmask_b32 v247, v247, v248, s[44:45]
    v_lshlrev_b32 v247, 7, v247
    s_mul_i32 s92, s2, 768
    s_lshl_b32 s93, s86, 7
    s_add_u32 s92, s92, s93
    s_add_u32 m0, s89, 147456
    s_waitcnt lgkmcnt(0)
    s_mov_b32 s28, s4
    s_and_b32 s29, s5, 0xffff
    buffer_load_dwordx4 v246, s[28:31], s90 offen lds
    s_cmp_lt_u32 s88, 2
    s_cbranch_scc1 L_sm1
    s_mov_b32 s44, s12
    s_and_b32 s45, s13, 0xffff
    s_mov_b32 s46, 8192
    s_mov_b32 s47, 0x00020000
    s_mov_b32 m0, s89
    s_nop 0
    buffer_load_dwordx4 v246, s[44:47], s89 offen lds
    s_cmp_ge_u32 s86, 2
    s_cbranch_scc1 L_sm1
    s_cmp_eq_u32 s86, 0
    s_cselect_b32 s44, s8, s10
    s_cselect_b32 s45, s9, s11
    s_and_b32 s45, s45, 0xffff
    s_movk_i32 s46, 676
    s_add_u32 m0, s89, 114688
    s_nop 0
    buffer_load_dwordx4 v246, s[44:47], 0 offen lds
L_sm1:
    s_mov_b32 s40, s16
    s_and_b32 s41, s17, 0xffff
    buffer_load_dword v6, v247, s[40:43], s91 offen
    s_mov_b32 s36, s14
    s_and_b32 s37, s15, 0xffff
    buffer_load_dword v6, off, s[36:39], s92
    s_mov_b32 s32, s6
    s_and_b32 s33, s7, 0xffff
    s_mov_b32 s34, 12800000
    s_mov_b32 s35, 0x00020000
    v_and_b32 v245, 7, v1
    v_bfe_u32 v247, v0, 4, 3
    v_xor_b32 v247, v247, v245
    v_lshlrev_b32 v3, 4, v247
    s_mov_b32 s48, s20
    s_and_b32 s49, s21, 0xffff
    s_mov_b32 s50, 8192
    s_mov_b32 s51, 0x00020000
    s_mov_b32 s52, s22
    s_and_b32 s53, s23, 0xffff
    s_mov_b32 s54, 256
    s_mov_b32 s55, 0x00020000
    s_mov_b32 s56, s24
    s_and_b32 s57, s25, 0xffff
    s_mov_b32 s58, 268435456
    s_mov_b32 s59, 0x00020000
    s_cmp_ge_u32 s88, 2
    s_cbranch_scc1 L_cross
    s_lshl_b32 s91, s88, 3
    s_add_u32 s91, s91, s86
    s_cmp_lg_u32 s91, 7
    s_cbranch_scc1 L_z2
    v_mov_b32 v108, 0
    v_mov_b32 v109, 0
    v_lshlrev_b32 v110, 3, v1
    s_lshl_b32 s91, s87, 9
    buffer_store_dwordx2 v[108:109], v110, s[56:59], s91 offen sc0 sc1
L_z2:
    s_mov_b32 s44, s18
    s_and_b32 s45, s19, 0xffff
    s_mov_b32 s46, 512
    s_mov_b32 s47, 0x00020000
    v_lshrrev_b32 v241, 5, v1
    s_lshl_b32 s91, s88, 8
    s_lshr_b32 s92, s86, 1
    s_lshl_b32 s92, s92, 6
    s_add_u32 s91, s91, s92
    v_lshlrev_b32 v248, 3, v241
    buffer_load_dwordx2 v[112:113], v248, s[44:47], s91 offen offset:0
    buffer_load_dwordx2 v[114:115], v248, s[44:47], s91 offen offset:16
    buffer_load_dwordx2 v[116:117], v248, s[44:47], s91 offen offset:32
    buffer_load_dwordx2 v[118:119], v248, s[44:47], s91 offen offset:48
    v_lshrrev_b32 v247, 2, v1
    v_and_b32 v247, 4, v247
    v_xor_b32 v247, v247, v245
    v_lshrrev_b32 v248, 3, v0
    v_lshlrev_b32 v248, 9, v248
    v_lshl_add_u32 v247, v247, 4, v248
    s_lshl_b32 s91, s88, 8
    v_add_u32 v13, s91, v247
    v_lshrrev_b32 v244, 3, v1
    v_mul_u32_u24 v14, 104, v244
    s_add_u32 s91, s89, 147456
    v_add_u32 v14, s91, v14
    v_and_b32 v240, 31, v1
    v_bfe_u32 v242, v1, 1, 3
    s_and_b32 s91, s86, 1
    s_lshl_b32 s91, s91, 5
    v_add_u32 v243, s91, v240
    v_lshlrev_b32 v244, 7, v243
    v_xor_b32 v245, v241, v242
    v_lshl_add_u32 v8, v245, 4, v244
    v_xor_b32 v9, 32, v8
    v_xor_b32 v10, 64, v8
    v_xor_b32 v11, 96, v8
    v_bfe_u32 v244, v1, 2, 2
    v_lshl_add_u32 v245, v241, 3, v244
    s_lshr_b32 s92, s86, 2
    s_mul_i32 s92, s92, 49152
    s_add_u32 s92, s92, 49152
    v_lshl_add_u32 v245, v245, 7, s92
    v_bfe_u32 v246, v1, 4, 1
    v_bfe_u32 v247, v1, 1, 1
    v_lshl_add_u32 v246, v246, 1, v247
    s_and_b32 s91, s86, 2
    s_lshl_b32 s91, s91, 1
    v_or_b32 v246, s91, v246
    v_lshrrev_b32 v247, 1, v1
    v_and_b32 v247, 4, v247
    v_xor_b32 v246, v246, v247
    v_lshl_add_u32 v245, v246, 4, v245
    v_and_b32 v247, 1, v1
    v_lshl_add_u32 v12, v247, 3, v245
    s_lshr_b32 s92, s86, 1
    s_lshl_b32 s92, s92, 3
    s_add_u32 s92, s92, 161280
    v_lshl_add_u32 v244, v241, 2, s92
    v_lshl_add_u32 v2, v243, 5, v244
    v_mov_b32 v106, 0xbdd2d3e8
    v_mov_b32 v107, 0xc0135761
    s_waitcnt vmcnt(6)
    ds_read_b64 v[80:81], v14 offset:0
    ds_read_b64 v[82:83], v14 offset:8
    ds_read_b64 v[84:85], v14 offset:16
    ds_read_b64 v[86:87], v14 offset:24
    ds_read_b64 v[88:89], v14 offset:32
    ds_read_b64 v[90:91], v14 offset:40
    ds_read_b64 v[92:93], v14 offset:48
    ds_read_b64 v[94:95], v14 offset:56
    ds_read_b64 v[96:97], v14 offset:64
    ds_read_b64 v[98:99], v14 offset:72
    ds_read_b64 v[100:101], v14 offset:80
    ds_read_b64 v[102:103], v14 offset:88
    ds_read_b64 v[104:105], v14 offset:96
    s_barrier
    s_add_u32 m0, s89, 49152
    s_mov_b32 s91, 0
    buffer_load_dwordx4 v13, s[40:43], s91 offen lds
    s_add_u32 m0, s89, 98304
    s_mov_b32 s91, 128
    buffer_load_dwordx4 v13, s[40:43], s91 offen lds
    s_add_u32 m0, s89, 57344
    s_mov_b32 s91, 32768
    buffer_load_dwordx4 v13, s[40:43], s91 offen lds
    s_add_u32 m0, s89, 106496
    s_mov_b32 s91, 32896
    buffer_load_dwordx4 v13, s[40:43], s91 offen lds
    s_waitcnt lgkmcnt(0)
    v_lshl_add_u32 v80, v80, 7, v3
    v_lshl_add_u32 v81, v81, 7, v3
    v_lshl_add_u32 v82, v82, 7, v3
    v_lshl_add_u32 v83, v83, 7, v3
    v_lshl_add_u32 v84, v84, 7, v3
    v_lshl_add_u32 v85, v85, 7, v3
    v_lshl_add_u32 v86, v86, 7, v3
    v_lshl_add_u32 v87, v87, 7, v3
    v_lshl_add_u32 v88, v88, 7, v3
    v_lshl_add_u32 v89, v89, 7, v3
    v_lshl_add_u32 v90, v90, 7, v3
    v_lshl_add_u32 v91, v91, 7, v3
    v_lshl_add_u32 v92, v92, 7, v3
    v_lshl_add_u32 v93, v93, 7, v3
    v_lshl_add_u32 v94, v94, 7, v3
    v_lshl_add_u32 v95, v95, 7, v3
    v_lshl_add_u32 v96, v96, 7, v3
    v_lshl_add_u32 v97, v97, 7, v3
    v_lshl_add_u32 v98, v98, 7, v3
    v_lshl_add_u32 v99, v99, 7, v3
    v_lshl_add_u32 v100, v100, 7, v3
    v_lshl_add_u32 v101, v101, 7, v3
    v_lshl_add_u32 v102, v102, 7, v3
    v_lshl_add_u32 v103, v103, 7, v3
    v_lshl_add_u32 v104, v104, 7, v3
    v_lshl_add_u32 v105, v105, 7, v3
    s_waitcnt vmcnt(4)
    v_lshlrev_b32 v64, 16, v112
    v_and_b32 v65, 0xffff0000, v112
    v_lshlrev_b32 v66, 16, v113
    v_and_b32 v67, 0xffff0000, v113
    v_lshlrev_b32 v68, 16, v114
    v_and_b32 v69, 0xffff0000, v114
    v_lshlrev_b32 v70, 16, v115
    v_and_b32 v71, 0xffff0000, v115
    v_lshlrev_b32 v72, 16, v116
    v_and_b32 v73, 0xffff0000, v116
    v_lshlrev_b32 v74, 16, v117
    v_and_b32 v75, 0xffff0000, v117
    v_lshlrev_b32 v76, 16, v118
    v_and_b32 v77, 0xffff0000, v118
    v_lshlrev_b32 v78, 16, v119
    v_and_b32 v79, 0xffff0000, v119
    s_lshl_b32 s91, s88, 3
    s_add_u32 s91, s91, s86
    s_cmp_lg_u32 s91, 7
    s_cbranch_scc1 L_z3
    v_mov_b32 v240, 1
    v_mov_b32 v241, 0
    s_lshl_b32 s91, s87, 2
    s_mov_b64 exec, 1
    buffer_store_dword v240, v241, s[52:55], s91 offen sc0 sc1
    s_mov_b64 exec, -1
L_z3:
    s_add_u32 m0, s89, 65536
    s_mov_b32 s91, 65536
    buffer_load_dwordx4 v13, s[40:43], s91 offen lds
    s_add_u32 m0, s89, 114688
    s_mov_b32 s91, 65664
    buffer_load_dwordx4 v13, s[40:43], s91 offen lds
    s_barrier
    s_add_u32 m0, s89, 0
    s_nop 0
    buffer_load_dwordx4 v80, s[32:35], 0 offen lds
    s_add_u32 m0, s89, 8192
    s_nop 0
    buffer_load_dwordx4 v81, s[32:35], 0 offen lds
    s_add_u32 m0, s89, 16384
    s_nop 0
    buffer_load_dwordx4 v82, s[32:35], 0 offen lds
    s_waitcnt vmcnt(2)
    s_barrier
    ds_read_b128 v[48:51], v8 offset:0
    ds_read_b64_tr_b16 v[32:33], v12 offset:0
    ds_read_b64_tr_b16 v[34:35], v12 offset:512
    ds_read_b128 v[52:55], v9 offset:0
    ds_read_b64_tr_b16 v[36:37], v12 offset:2048
    ds_read_b64_tr_b16 v[38:39], v12 offset:2560
    ds_read_b128 v[56:59], v10 offset:0
    ds_read_b64_tr_b16 v[40:41], v12 offset:4096
    ds_read_b64_tr_b16 v[42:43], v12 offset:4608
    s_add_u32 m0, s89, 24576
    s_nop 0
    buffer_load_dwordx4 v83, s[32:35], 0 offen lds
    s_waitcnt lgkmcnt(6)
    v_mfma_f32_32x32x16_bf16 v[16:31], v[32:35], v[48:51], 0
    ds_read_b128 v[60:63], v11 offset:0
    ds_read_b64_tr_b16 v[44:45], v12 offset:6144
    ds_read_b64_tr_b16 v[46:47], v12 offset:6656
    s_add_u32 m0, s89, 73728
    s_mov_b32 s91, 98304
    buffer_load_dwordx4 v13, s[40:43], s91 offen lds
    s_waitcnt lgkmcnt(6)
    v_mfma_f32_32x32x16_bf16 v[16:31], v[36:39], v[52:55], v[16:31]
    s_add_u32 m0, s89, 122880
    s_mov_b32 s91, 98432
    buffer_load_dwordx4 v13, s[40:43], s91 offen lds
    s_waitcnt vmcnt(4)
    s_barrier
    ds_read_b128 v[48:51], v8 offset:8192
    ds_read_b64_tr_b16 v[32:33], v12 offset:8192
    ds_read_b64_tr_b16 v[34:35], v12 offset:8704
    s_waitcnt lgkmcnt(6)
    v_mfma_f32_32x32x16_bf16 v[16:31], v[40:43], v[56:59], v[16:31]
    ds_read_b128 v[52:55], v9 offset:8192
    ds_read_b64_tr_b16 v[36:37], v12 offset:10240
    ds_read_b64_tr_b16 v[38:39], v12 offset:10752
    s_waitcnt lgkmcnt(6)
    v_mfma_f32_32x32x16_bf16 v[16:31], v[44:47], v[60:63], v[16:31]
    ds_read_b128 v[56:59], v10 offset:8192
    ds_read_b64_tr_b16 v[40:41], v12 offset:12288
    ds_read_b64_tr_b16 v[42:43], v12 offset:12800
    s_add_u32 m0, s89, 32768
    s_nop 0
    buffer_load_dwordx4 v84, s[32:35], 0 offen lds
    s_waitcnt lgkmcnt(6)
    v_mfma_f32_32x32x16_bf16 v[16:31], v[32:35], v[48:51], v[16:31]
    ds_read_b128 v[60:63], v11 offset:8192
    ds_read_b64_tr_b16 v[44:45], v12 offset:14336
    ds_read_b64_tr_b16 v[46:47], v12 offset:14848
    s_add_u32 m0, s89, 81920
    s_mov_b32 s91, 131072
    buffer_load_dwordx4 v13, s[40:43], s91 offen lds
    s_waitcnt lgkmcnt(6)
    v_mfma_f32_32x32x16_bf16 v[16:31], v[36:39], v[52:55], v[16:31]
    s_add_u32 m0, s89, 131072
    s_mov_b32 s91, 131200
    buffer_load_dwordx4 v13, s[40:43], s91 offen lds
    s_waitcnt vmcnt(6)
    s_barrier
    ds_read_b128 v[48:51], v8 offset:16384
    ds_read_b64_tr_b16 v[32:33], v12 offset:16384
    ds_read_b64_tr_b16 v[34:35], v12 offset:16896
    s_waitcnt lgkmcnt(6)
    v_mfma_f32_32x32x16_bf16 v[16:31], v[40:43], v[56:59], v[16:31]
    ds_read_b128 v[52:55], v9 offset:16384
    ds_read_b64_tr_b16 v[36:37], v12 offset:18432
    ds_read_b64_tr_b16 v[38:39], v12 offset:18944
    s_waitcnt lgkmcnt(6)
    v_mfma_f32_32x32x16_bf16 v[16:31], v[44:47], v[60:63], v[16:31]
    ds_read_b128 v[56:59], v10 offset:16384
    ds_read_b64_tr_b16 v[40:41], v12 offset:20480
    ds_read_b64_tr_b16 v[42:43], v12 offset:20992
    s_add_u32 m0, s89, 40960
    s_nop 0
    buffer_load_dwordx4 v85, s[32:35], 0 offen lds
    s_waitcnt lgkmcnt(6)
    v_mfma_f32_32x32x16_bf16 v[16:31], v[32:35], v[48:51], v[16:31]
    ds_read_b128 v[60:63], v11 offset:16384
    ds_read_b64_tr_b16 v[44:45], v12 offset:22528
    ds_read_b64_tr_b16 v[46:47], v12 offset:23040
    s_add_u32 m0, s89, 90112
    s_mov_b32 s91, 163840
    buffer_load_dwordx4 v13, s[40:43], s91 offen lds
    s_waitcnt lgkmcnt(6)
    v_mfma_f32_32x32x16_bf16 v[16:31], v[36:39], v[52:55], v[16:31]
    s_add_u32 m0, s89, 139264
    s_mov_b32 s91, 163968
    buffer_load_dwordx4 v13, s[40:43], s91 offen lds
    s_waitcnt vmcnt(6)
    s_barrier
    ds_read_b128 v[48:51], v8 offset:24576
    ds_read_b64_tr_b16 v[32:33], v12 offset:24576
    ds_read_b64_tr_b16 v[34:35], v12 offset:25088
    s_waitcnt lgkmcnt(6)
    v_mfma_f32_32x32x16_bf16 v[16:31], v[40:43], v[56:59], v[16:31]
    ds_read_b128 v[52:55], v9 offset:24576
    ds_read_b64_tr_b16 v[36:37], v12 offset:26624
    ds_read_b64_tr_b16 v[38:39], v12 offset:27136
    s_waitcnt lgkmcnt(6)
    v_mfma_f32_32x32x16_bf16 v[16:31], v[44:47], v[60:63], v[16:31]
    ds_read_b128 v[56:59], v10 offset:24576
    ds_read_b64_tr_b16 v[40:41], v12 offset:28672
    ds_read_b64_tr_b16 v[42:43], v12 offset:29184
    s_add_u32 m0, s89, 0
    s_nop 0
    buffer_load_dwordx4 v86, s[32:35], 0 offen lds
    s_waitcnt lgkmcnt(6)
    v_mfma_f32_32x32x16_bf16 v[16:31], v[32:35], v[48:51], v[16:31]
    ds_read_b128 v[60:63], v11 offset:24576
    ds_read_b64_tr_b16 v[44:45], v12 offset:30720
    ds_read_b64_tr_b16 v[46:47], v12 offset:31232
    s_add_u32 m0, s89, 49152
    s_mov_b32 s91, 196608
    buffer_load_dwordx4 v13, s[40:43], s91 offen lds
    s_waitcnt lgkmcnt(6)
    v_mfma_f32_32x32x16_bf16 v[16:31], v[36:39], v[52:55], v[16:31]
    s_add_u32 m0, s89, 98304
    s_mov_b32 s91, 196736
    buffer_load_dwordx4 v13, s[40:43], s91 offen lds
    s_waitcnt vmcnt(6)
    s_barrier
    ds_read_b128 v[48:51], v8 offset:32768
    ds_read_b64_tr_b16 v[32:33], v12 offset:32768
    ds_read_b64_tr_b16 v[34:35], v12 offset:33280
    s_waitcnt lgkmcnt(6)
    v_mfma_f32_32x32x16_bf16 v[16:31], v[40:43], v[56:59], v[16:31]
    ds_read_b128 v[52:55], v9 offset:32768
    ds_read_b64_tr_b16 v[36:37], v12 offset:34816
    ds_read_b64_tr_b16 v[38:39], v12 offset:35328
    s_waitcnt lgkmcnt(6)
    v_mfma_f32_32x32x16_bf16 v[16:31], v[44:47], v[60:63], v[16:31]
    ds_read_b128 v[56:59], v10 offset:32768
    ds_read_b64_tr_b16 v[40:41], v12 offset:36864
    ds_read_b64_tr_b16 v[42:43], v12 offset:37376
    s_add_u32 m0, s89, 8192
    s_nop 0
    buffer_load_dwordx4 v87, s[32:35], 0 offen lds
    s_waitcnt lgkmcnt(6)
    v_mfma_f32_32x32x16_bf16 v[16:31], v[32:35], v[48:51], v[16:31]
    ds_read_b128 v[60:63], v11 offset:32768
    ds_read_b64_tr_b16 v[44:45], v12 offset:38912
    ds_read_b64_tr_b16 v[46:47], v12 offset:39424
    s_add_u32 m0, s89, 57344
    s_mov_b32 s91, 229376
    buffer_load_dwordx4 v13, s[40:43], s91 offen lds
    s_waitcnt lgkmcnt(6)
    v_mfma_f32_32x32x16_bf16 v[16:31], v[36:39], v[52:55], v[16:31]
    s_add_u32 m0, s89, 106496
    s_mov_b32 s91, 229504
    buffer_load_dwordx4 v13, s[40:43], s91 offen lds
    s_waitcnt vmcnt(6)
    s_barrier
    ds_read_b128 v[48:51], v8 offset:40960
    ds_read_b64_tr_b16 v[32:33], v12 offset:40960
    ds_read_b64_tr_b16 v[34:35], v12 offset:41472
    s_waitcnt lgkmcnt(6)
    v_mfma_f32_32x32x16_bf16 v[16:31], v[40:43], v[56:59], v[16:31]
    ds_read_b128 v[52:55], v9 offset:40960
    ds_read_b64_tr_b16 v[36:37], v12 offset:43008
    ds_read_b64_tr_b16 v[38:39], v12 offset:43520
    s_waitcnt lgkmcnt(6)
    v_mfma_f32_32x32x16_bf16 v[16:31], v[44:47], v[60:63], v[16:31]
    ds_read_b128 v[56:59], v10 offset:40960
    ds_read_b64_tr_b16 v[40:41], v12 offset:45056
    ds_read_b64_tr_b16 v[42:43], v12 offset:45568
    s_add_u32 m0, s89, 16384
    s_nop 0
    buffer_load_dwordx4 v88, s[32:35], 0 offen lds
    s_waitcnt lgkmcnt(6)
    v_mfma_f32_32x32x16_bf16 v[16:31], v[32:35], v[48:51], v[16:31]
    ds_read_b128 v[60:63], v11 offset:40960
    ds_read_b64_tr_b16 v[44:45], v12 offset:47104
    ds_read_b64_tr_b16 v[46:47], v12 offset:47616
    s_add_u32 m0, s89, 65536
    s_mov_b32 s91, 262144
    buffer_load_dwordx4 v13, s[40:43], s91 offen lds
    s_waitcnt lgkmcnt(6)
    v_mfma_f32_32x32x16_bf16 v[16:31], v[36:39], v[52:55], v[16:31]
    s_add_u32 m0, s89, 114688
    s_mov_b32 s91, 262272
    buffer_load_dwordx4 v13, s[40:43], s91 offen lds
    s_waitcnt vmcnt(6)
    s_barrier
    ds_read_b128 v[48:51], v8 offset:0
    ds_read_b64_tr_b16 v[32:33], v12 offset:0
    ds_read_b64_tr_b16 v[34:35], v12 offset:512
    s_waitcnt lgkmcnt(6)
    v_mfma_f32_32x32x16_bf16 v[16:31], v[40:43], v[56:59], v[16:31]
    ds_read_b128 v[52:55], v9 offset:0
    ds_read_b64_tr_b16 v[36:37], v12 offset:2048
    ds_read_b64_tr_b16 v[38:39], v12 offset:2560
    s_waitcnt lgkmcnt(6)
    v_mfma_f32_32x32x16_bf16 v[16:31], v[44:47], v[60:63], v[16:31]
    ds_read_b128 v[56:59], v10 offset:0
    ds_read_b64_tr_b16 v[40:41], v12 offset:4096
    ds_read_b64_tr_b16 v[42:43], v12 offset:4608
    s_add_u32 m0, s89, 24576
    s_nop 0
    buffer_load_dwordx4 v89, s[32:35], 0 offen lds
    s_waitcnt lgkmcnt(6)
    v_mfma_f32_32x32x16_bf16 v[16:31], v[32:35], v[48:51], v[16:31]
    ds_read_b128 v[60:63], v11 offset:0
    ds_read_b64_tr_b16 v[44:45], v12 offset:6144
    ds_read_b64_tr_b16 v[46:47], v12 offset:6656
    s_add_u32 m0, s89, 73728
    s_mov_b32 s91, 294912
    buffer_load_dwordx4 v13, s[40:43], s91 offen lds
    s_waitcnt lgkmcnt(6)
    v_mfma_f32_32x32x16_bf16 v[16:31], v[36:39], v[52:55], v[16:31]
    s_add_u32 m0, s89, 122880
    s_mov_b32 s91, 295040
    buffer_load_dwordx4 v13, s[40:43], s91 offen lds
    s_waitcnt vmcnt(6)
    s_barrier
    ds_read_b128 v[48:51], v8 offset:8192
    ds_read_b64_tr_b16 v[32:33], v12 offset:8192
    ds_read_b64_tr_b16 v[34:35], v12 offset:8704
    s_waitcnt lgkmcnt(6)
    v_mfma_f32_32x32x16_bf16 v[16:31], v[40:43], v[56:59], v[16:31]
    ds_read_b128 v[52:55], v9 offset:8192
    ds_read_b64_tr_b16 v[36:37], v12 offset:10240
    ds_read_b64_tr_b16 v[38:39], v12 offset:10752
    s_waitcnt lgkmcnt(6)
    v_mfma_f32_32x32x16_bf16 v[16:31], v[44:47], v[60:63], v[16:31]
    ds_read_b128 v[56:59], v10 offset:8192
    ds_read_b64_tr_b16 v[40:41], v12 offset:12288
    ds_read_b64_tr_b16 v[42:43], v12 offset:12800
    s_add_u32 m0, s89, 32768
    s_nop 0
    buffer_load_dwordx4 v90, s[32:35], 0 offen lds
    s_waitcnt lgkmcnt(6)
    v_mfma_f32_32x32x16_bf16 v[16:31], v[32:35], v[48:51], v[16:31]
    ds_read_b128 v[60:63], v11 offset:8192
    ds_read_b64_tr_b16 v[44:45], v12 offset:14336
    ds_read_b64_tr_b16 v[46:47], v12 offset:14848
    s_add_u32 m0, s89, 81920
    s_mov_b32 s91, 327680
    buffer_load_dwordx4 v13, s[40:43], s91 offen lds
    s_waitcnt lgkmcnt(6)
    v_mfma_f32_32x32x16_bf16 v[16:31], v[36:39], v[52:55], v[16:31]
    s_add_u32 m0, s89, 131072
    s_mov_b32 s91, 327808
    buffer_load_dwordx4 v13, s[40:43], s91 offen lds
    s_waitcnt vmcnt(6)
    s_barrier
    ds_read_b128 v[48:51], v8 offset:16384
    ds_read_b64_tr_b16 v[32:33], v12 offset:16384
    ds_read_b64_tr_b16 v[34:35], v12 offset:16896
    s_waitcnt lgkmcnt(6)
    v_mfma_f32_32x32x16_bf16 v[16:31], v[40:43], v[56:59], v[16:31]
    ds_read_b128 v[52:55], v9 offset:16384
    ds_read_b64_tr_b16 v[36:37], v12 offset:18432
    ds_read_b64_tr_b16 v[38:39], v12 offset:18944
    s_waitcnt lgkmcnt(6)
    v_mfma_f32_32x32x16_bf16 v[16:31], v[44:47], v[60:63], v[16:31]
    ds_read_b128 v[56:59], v10 offset:16384
    ds_read_b64_tr_b16 v[40:41], v12 offset:20480
    ds_read_b64_tr_b16 v[42:43], v12 offset:20992
    s_add_u32 m0, s89, 40960
    s_nop 0
    buffer_load_dwordx4 v91, s[32:35], 0 offen lds
    s_waitcnt lgkmcnt(6)
    v_mfma_f32_32x32x16_bf16 v[16:31], v[32:35], v[48:51], v[16:31]
    ds_read_b128 v[60:63], v11 offset:16384
    ds_read_b64_tr_b16 v[44:45], v12 offset:22528
    ds_read_b64_tr_b16 v[46:47], v12 offset:23040
    s_add_u32 m0, s89, 90112
    s_mov_b32 s91, 360448
    buffer_load_dwordx4 v13, s[40:43], s91 offen lds
    s_waitcnt lgkmcnt(6)
    v_mfma_f32_32x32x16_bf16 v[16:31], v[36:39], v[52:55], v[16:31]
    s_add_u32 m0, s89, 139264
    s_mov_b32 s91, 360576
    buffer_load_dwordx4 v13, s[40:43], s91 offen lds
    s_waitcnt vmcnt(6)
    s_barrier
    ds_read_b128 v[48:51], v8 offset:24576
    ds_read_b64_tr_b16 v[32:33], v12 offset:24576
    ds_read_b64_tr_b16 v[34:35], v12 offset:25088
    s_waitcnt lgkmcnt(6)
    v_mfma_f32_32x32x16_bf16 v[16:31], v[40:43], v[56:59], v[16:31]
    ds_read_b128 v[52:55], v9 offset:24576
    ds_read_b64_tr_b16 v[36:37], v12 offset:26624
    ds_read_b64_tr_b16 v[38:39], v12 offset:27136
    s_waitcnt lgkmcnt(6)
    v_mfma_f32_32x32x16_bf16 v[16:31], v[44:47], v[60:63], v[16:31]
    ds_read_b128 v[56:59], v10 offset:24576
    ds_read_b64_tr_b16 v[40:41], v12 offset:28672
    ds_read_b64_tr_b16 v[42:43], v12 offset:29184
    s_add_u32 m0, s89, 0
    s_nop 0
    buffer_load_dwordx4 v92, s[32:35], 0 offen lds
    s_waitcnt lgkmcnt(6)
    v_mfma_f32_32x32x16_bf16 v[16:31], v[32:35], v[48:51], v[16:31]
    ds_read_b128 v[60:63], v11 offset:24576
    ds_read_b64_tr_b16 v[44:45], v12 offset:30720
    ds_read_b64_tr_b16 v[46:47], v12 offset:31232
    s_add_u32 m0, s89, 49152
    s_mov_b32 s91, 393216
    buffer_load_dwordx4 v13, s[40:43], s91 offen lds
    s_waitcnt lgkmcnt(6)
    v_mfma_f32_32x32x16_bf16 v[16:31], v[36:39], v[52:55], v[16:31]
    s_add_u32 m0, s89, 98304
    s_mov_b32 s91, 393344
    buffer_load_dwordx4 v13, s[40:43], s91 offen lds
    s_waitcnt vmcnt(6)
    s_barrier
    ds_read_b128 v[48:51], v8 offset:32768
    ds_read_b64_tr_b16 v[32:33], v12 offset:32768
    ds_read_b64_tr_b16 v[34:35], v12 offset:33280
    s_waitcnt lgkmcnt(6)
    v_mfma_f32_32x32x16_bf16 v[16:31], v[40:43], v[56:59], v[16:31]
    ds_read_b128 v[52:55], v9 offset:32768
    ds_read_b64_tr_b16 v[36:37], v12 offset:34816
    ds_read_b64_tr_b16 v[38:39], v12 offset:35328
    s_waitcnt lgkmcnt(6)
    v_mfma_f32_32x32x16_bf16 v[16:31], v[44:47], v[60:63], v[16:31]
    ds_read_b128 v[56:59], v10 offset:32768
    ds_read_b64_tr_b16 v[40:41], v12 offset:36864
    ds_read_b64_tr_b16 v[42:43], v12 offset:37376
    s_add_u32 m0, s89, 8192
    s_nop 0
    buffer_load_dwordx4 v93, s[32:35], 0 offen lds
    s_waitcnt lgkmcnt(6)
    v_mfma_f32_32x32x16_bf16 v[16:31], v[32:35], v[48:51], v[16:31]
    ds_read_b128 v[60:63], v11 offset:32768
    ds_read_b64_tr_b16 v[44:45], v12 offset:38912
    ds_read_b64_tr_b16 v[46:47], v12 offset:39424
    s_add_u32 m0, s89, 57344
    s_mov_b32 s91, 425984
    buffer_load_dwordx4 v13, s[40:43], s91 offen lds
    s_waitcnt lgkmcnt(6)
    v_mfma_f32_32x32x16_bf16 v[16:31], v[36:39], v[52:55], v[16:31]
    s_add_u32 m0, s89, 106496
    s_mov_b32 s91, 426112
    buffer_load_dwordx4 v13, s[40:43], s91 offen lds
    s_waitcnt vmcnt(6)
    s_barrier
    ds_read_b128 v[48:51], v8 offset:40960
    ds_read_b64_tr_b16 v[32:33], v12 offset:40960
    ds_read_b64_tr_b16 v[34:35], v12 offset:41472
    s_waitcnt lgkmcnt(6)
    v_mfma_f32_32x32x16_bf16 v[16:31], v[40:43], v[56:59], v[16:31]
    ds_read_b128 v[52:55], v9 offset:40960
    ds_read_b64_tr_b16 v[36:37], v12 offset:43008
    ds_read_b64_tr_b16 v[38:39], v12 offset:43520
    s_waitcnt lgkmcnt(6)
    v_mfma_f32_32x32x16_bf16 v[16:31], v[44:47], v[60:63], v[16:31]
    ds_read_b128 v[56:59], v10 offset:40960
    ds_read_b64_tr_b16 v[40:41], v12 offset:45056
    ds_read_b64_tr_b16 v[42:43], v12 offset:45568
    s_add_u32 m0, s89, 16384
    s_nop 0
    buffer_load_dwordx4 v94, s[32:35], 0 offen lds
    s_waitcnt lgkmcnt(6)
    v_mfma_f32_32x32x16_bf16 v[16:31], v[32:35], v[48:51], v[16:31]
    ds_read_b128 v[60:63], v11 offset:40960
    ds_read_b64_tr_b16 v[44:45], v12 offset:47104
    ds_read_b64_tr_b16 v[46:47], v12 offset:47616
    s_add_u32 m0, s89, 65536
    s_mov_b32 s91, 458752
    buffer_load_dwordx4 v13, s[40:43], s91 offen lds
    s_waitcnt lgkmcnt(6)
    v_mfma_f32_32x32x16_bf16 v[16:31], v[36:39], v[52:55], v[16:31]
    s_add_u32 m0, s89, 114688
    s_mov_b32 s91, 458880
    buffer_load_dwordx4 v13, s[40:43], s91 offen lds
    s_waitcnt vmcnt(6)
    s_barrier
    ds_read_b128 v[48:51], v8 offset:0
    ds_read_b64_tr_b16 v[32:33], v12 offset:0
    ds_read_b64_tr_b16 v[34:35], v12 offset:512
    s_waitcnt lgkmcnt(6)
    v_mfma_f32_32x32x16_bf16 v[16:31], v[40:43], v[56:59], v[16:31]
    ds_read_b128 v[52:55], v9 offset:0
    ds_read_b64_tr_b16 v[36:37], v12 offset:2048
    ds_read_b64_tr_b16 v[38:39], v12 offset:2560
    s_waitcnt lgkmcnt(6)
    v_mfma_f32_32x32x16_bf16 v[16:31], v[44:47], v[60:63], v[16:31]
    ds_read_b128 v[56:59], v10 offset:0
    ds_read_b64_tr_b16 v[40:41], v12 offset:4096
    ds_read_b64_tr_b16 v[42:43], v12 offset:4608
    s_add_u32 m0, s89, 24576
    s_nop 0
    buffer_load_dwordx4 v95, s[32:35], 0 offen lds
    s_waitcnt lgkmcnt(6)
    v_mfma_f32_32x32x16_bf16 v[16:31], v[32:35], v[48:51], v[16:31]
    ds_read_b128 v[60:63], v11 offset:0
    ds_read_b64_tr_b16 v[44:45], v12 offset:6144
    ds_read_b64_tr_b16 v[46:47], v12 offset:6656
    s_add_u32 m0, s89, 73728
    s_mov_b32 s91, 491520
    buffer_load_dwordx4 v13, s[40:43], s91 offen lds
    s_waitcnt lgkmcnt(6)
    v_mfma_f32_32x32x16_bf16 v[16:31], v[36:39], v[52:55], v[16:31]
    s_add_u32 m0, s89, 122880
    s_mov_b32 s91, 491648
    buffer_load_dwordx4 v13, s[40:43], s91 offen lds
    s_waitcnt vmcnt(6)
    s_barrier
    ds_read_b128 v[48:51], v8 offset:8192
    ds_read_b64_tr_b16 v[32:33], v12 offset:8192
    ds_read_b64_tr_b16 v[34:35], v12 offset:8704
    s_waitcnt lgkmcnt(6)
    v_mfma_f32_32x32x16_bf16 v[16:31], v[40:43], v[56:59], v[16:31]
    ds_read_b128 v[52:55], v9 offset:8192
    ds_read_b64_tr_b16 v[36:37], v12 offset:10240
    ds_read_b64_tr_b16 v[38:39], v12 offset:10752
    s_waitcnt lgkmcnt(6)
    v_mfma_f32_32x32x16_bf16 v[16:31], v[44:47], v[60:63], v[16:31]
    ds_read_b128 v[56:59], v10 offset:8192
    ds_read_b64_tr_b16 v[40:41], v12 offset:12288
    ds_read_b64_tr_b16 v[42:43], v12 offset:12800
    s_add_u32 m0, s89, 32768
    s_nop 0
    buffer_load_dwordx4 v96, s[32:35], 0 offen lds
    s_waitcnt lgkmcnt(6)
    v_mfma_f32_32x32x16_bf16 v[16:31], v[32:35], v[48:51], v[16:31]
    ds_read_b128 v[60:63], v11 offset:8192
    ds_read_b64_tr_b16 v[44:45], v12 offset:14336
    ds_read_b64_tr_b16 v[46:47], v12 offset:14848
    s_add_u32 m0, s89, 81920
    s_mov_b32 s91, 524288
    buffer_load_dwordx4 v13, s[40:43], s91 offen lds
    s_waitcnt lgkmcnt(6)
    v_mfma_f32_32x32x16_bf16 v[16:31], v[36:39], v[52:55], v[16:31]
    s_add_u32 m0, s89, 131072
    s_mov_b32 s91, 524416
    buffer_load_dwordx4 v13, s[40:43], s91 offen lds
    s_waitcnt vmcnt(6)
    s_barrier
    ds_read_b128 v[48:51], v8 offset:16384
    ds_read_b64_tr_b16 v[32:33], v12 offset:16384
    ds_read_b64_tr_b16 v[34:35], v12 offset:16896
    s_waitcnt lgkmcnt(6)
    v_mfma_f32_32x32x16_bf16 v[16:31], v[40:43], v[56:59], v[16:31]
    ds_read_b128 v[52:55], v9 offset:16384
    ds_read_b64_tr_b16 v[36:37], v12 offset:18432
    ds_read_b64_tr_b16 v[38:39], v12 offset:18944
    s_waitcnt lgkmcnt(6)
    v_mfma_f32_32x32x16_bf16 v[16:31], v[44:47], v[60:63], v[16:31]
    ds_read_b128 v[56:59], v10 offset:16384
    ds_read_b64_tr_b16 v[40:41], v12 offset:20480
    ds_read_b64_tr_b16 v[42:43], v12 offset:20992
    s_add_u32 m0, s89, 40960
    s_nop 0
    buffer_load_dwordx4 v97, s[32:35], 0 offen lds
    s_waitcnt lgkmcnt(6)
    v_mfma_f32_32x32x16_bf16 v[16:31], v[32:35], v[48:51], v[16:31]
    ds_read_b128 v[60:63], v11 offset:16384
    ds_read_b64_tr_b16 v[44:45], v12 offset:22528
    ds_read_b64_tr_b16 v[46:47], v12 offset:23040
    s_add_u32 m0, s89, 90112
    s_mov_b32 s91, 557056
    buffer_load_dwordx4 v13, s[40:43], s91 offen lds
    s_waitcnt lgkmcnt(6)
    v_mfma_f32_32x32x16_bf16 v[16:31], v[36:39], v[52:55], v[16:31]
    s_add_u32 m0, s89, 139264
    s_mov_b32 s91, 557184
    buffer_load_dwordx4 v13, s[40:43], s91 offen lds
    s_waitcnt vmcnt(6)
    s_barrier
    ds_read_b128 v[48:51], v8 offset:24576
    ds_read_b64_tr_b16 v[32:33], v12 offset:24576
    ds_read_b64_tr_b16 v[34:35], v12 offset:25088
    s_waitcnt lgkmcnt(6)
    v_mfma_f32_32x32x16_bf16 v[16:31], v[40:43], v[56:59], v[16:31]
    ds_read_b128 v[52:55], v9 offset:24576
    ds_read_b64_tr_b16 v[36:37], v12 offset:26624
    ds_read_b64_tr_b16 v[38:39], v12 offset:27136
    s_waitcnt lgkmcnt(6)
    v_mfma_f32_32x32x16_bf16 v[16:31], v[44:47], v[60:63], v[16:31]
    ds_read_b128 v[56:59], v10 offset:24576
    ds_read_b64_tr_b16 v[40:41], v12 offset:28672
    ds_read_b64_tr_b16 v[42:43], v12 offset:29184
    s_add_u32 m0, s89, 0
    s_nop 0
    buffer_load_dwordx4 v98, s[32:35], 0 offen lds
    s_waitcnt lgkmcnt(6)
    v_mfma_f32_32x32x16_bf16 v[16:31], v[32:35], v[48:51], v[16:31]
    ds_read_b128 v[60:63], v11 offset:24576
    ds_read_b64_tr_b16 v[44:45], v12 offset:30720
    ds_read_b64_tr_b16 v[46:47], v12 offset:31232
    s_add_u32 m0, s89, 49152
    s_mov_b32 s91, 589824
    buffer_load_dwordx4 v13, s[40:43], s91 offen lds
    s_waitcnt lgkmcnt(6)
    v_mfma_f32_32x32x16_bf16 v[16:31], v[36:39], v[52:55], v[16:31]
    s_add_u32 m0, s89, 98304
    s_mov_b32 s91, 589952
    buffer_load_dwordx4 v13, s[40:43], s91 offen lds
    s_waitcnt vmcnt(6)
    s_barrier
    ds_read_b128 v[48:51], v8 offset:32768
    ds_read_b64_tr_b16 v[32:33], v12 offset:32768
    ds_read_b64_tr_b16 v[34:35], v12 offset:33280
    s_waitcnt lgkmcnt(6)
    v_mfma_f32_32x32x16_bf16 v[16:31], v[40:43], v[56:59], v[16:31]
    ds_read_b128 v[52:55], v9 offset:32768
    ds_read_b64_tr_b16 v[36:37], v12 offset:34816
    ds_read_b64_tr_b16 v[38:39], v12 offset:35328
    s_waitcnt lgkmcnt(6)
    v_mfma_f32_32x32x16_bf16 v[16:31], v[44:47], v[60:63], v[16:31]
    ds_read_b128 v[56:59], v10 offset:32768
    ds_read_b64_tr_b16 v[40:41], v12 offset:36864
    ds_read_b64_tr_b16 v[42:43], v12 offset:37376
    s_add_u32 m0, s89, 8192
    s_nop 0
    buffer_load_dwordx4 v99, s[32:35], 0 offen lds
    s_waitcnt lgkmcnt(6)
    v_mfma_f32_32x32x16_bf16 v[16:31], v[32:35], v[48:51], v[16:31]
    ds_read_b128 v[60:63], v11 offset:32768
    ds_read_b64_tr_b16 v[44:45], v12 offset:38912
    ds_read_b64_tr_b16 v[46:47], v12 offset:39424
    s_add_u32 m0, s89, 57344
    s_mov_b32 s91, 622592
    buffer_load_dwordx4 v13, s[40:43], s91 offen lds
    s_waitcnt lgkmcnt(6)
    v_mfma_f32_32x32x16_bf16 v[16:31], v[36:39], v[52:55], v[16:31]
    s_add_u32 m0, s89, 106496
    s_mov_b32 s91, 622720
    buffer_load_dwordx4 v13, s[40:43], s91 offen lds
    s_waitcnt vmcnt(6)
    s_barrier
    ds_read_b128 v[48:51], v8 offset:40960
    ds_read_b64_tr_b16 v[32:33], v12 offset:40960
    ds_read_b64_tr_b16 v[34:35], v12 offset:41472
    s_waitcnt lgkmcnt(6)
    v_mfma_f32_32x32x16_bf16 v[16:31], v[40:43], v[56:59], v[16:31]
    ds_read_b128 v[52:55], v9 offset:40960
    ds_read_b64_tr_b16 v[36:37], v12 offset:43008
    ds_read_b64_tr_b16 v[38:39], v12 offset:43520
    s_waitcnt lgkmcnt(6)
    v_mfma_f32_32x32x16_bf16 v[16:31], v[44:47], v[60:63], v[16:31]
    ds_read_b128 v[56:59], v10 offset:40960
    ds_read_b64_tr_b16 v[40:41], v12 offset:45056
    ds_read_b64_tr_b16 v[42:43], v12 offset:45568
    s_add_u32 m0, s89, 16384
    s_nop 0
    buffer_load_dwordx4 v100, s[32:35], 0 offen lds
    s_waitcnt lgkmcnt(6)
    v_mfma_f32_32x32x16_bf16 v[16:31], v[32:35], v[48:51], v[16:31]
    ds_read_b128 v[60:63], v11 offset:40960
    ds_read_b64_tr_b16 v[44:45], v12 offset:47104
    ds_read_b64_tr_b16 v[46:47], v12 offset:47616
    s_add_u32 m0, s89, 65536
    s_mov_b32 s91, 655360
    buffer_load_dwordx4 v13, s[40:43], s91 offen lds
    s_waitcnt lgkmcnt(6)
    v_mfma_f32_32x32x16_bf16 v[16:31], v[36:39], v[52:55], v[16:31]
    s_add_u32 m0, s89, 114688
    s_mov_b32 s91, 655488
    buffer_load_dwordx4 v13, s[40:43], s91 offen lds
    s_waitcnt vmcnt(6)
    s_barrier
    ds_read_b128 v[48:51], v8 offset:0
    ds_read_b64_tr_b16 v[32:33], v12 offset:0
    ds_read_b64_tr_b16 v[34:35], v12 offset:512
    s_waitcnt lgkmcnt(6)
    v_mfma_f32_32x32x16_bf16 v[16:31], v[40:43], v[56:59], v[16:31]
    ds_read_b128 v[52:55], v9 offset:0
    ds_read_b64_tr_b16 v[36:37], v12 offset:2048
    ds_read_b64_tr_b16 v[38:39], v12 offset:2560
    s_waitcnt lgkmcnt(6)
    v_mfma_f32_32x32x16_bf16 v[16:31], v[44:47], v[60:63], v[16:31]
    ds_read_b128 v[56:59], v10 offset:0
    ds_read_b64_tr_b16 v[40:41], v12 offset:4096
    ds_read_b64_tr_b16 v[42:43], v12 offset:4608
    s_add_u32 m0, s89, 24576
    s_nop 0
    buffer_load_dwordx4 v101, s[32:35], 0 offen lds
    s_waitcnt lgkmcnt(6)
    v_mfma_f32_32x32x16_bf16 v[16:31], v[32:35], v[48:51], v[16:31]
    ds_read_b128 v[60:63], v11 offset:0
    ds_read_b64_tr_b16 v[44:45], v12 offset:6144
    ds_read_b64_tr_b16 v[46:47], v12 offset:6656
    s_add_u32 m0, s89, 73728
    s_mov_b32 s91, 688128
    buffer_load_dwordx4 v13, s[40:43], s91 offen lds
    s_waitcnt lgkmcnt(6)
    v_mfma_f32_32x32x16_bf16 v[16:31], v[36:39], v[52:55], v[16:31]
    s_add_u32 m0, s89, 122880
    s_mov_b32 s91, 688256
    buffer_load_dwordx4 v13, s[40:43], s91 offen lds
    s_waitcnt vmcnt(6)
    s_barrier
    ds_read_b128 v[48:51], v8 offset:8192
    ds_read_b64_tr_b16 v[32:33], v12 offset:8192
    ds_read_b64_tr_b16 v[34:35], v12 offset:8704
    s_waitcnt lgkmcnt(6)
    v_mfma_f32_32x32x16_bf16 v[16:31], v[40:43], v[56:59], v[16:31]
    ds_read_b128 v[52:55], v9 offset:8192
    ds_read_b64_tr_b16 v[36:37], v12 offset:10240
    ds_read_b64_tr_b16 v[38:39], v12 offset:10752
    s_waitcnt lgkmcnt(6)
    v_mfma_f32_32x32x16_bf16 v[16:31], v[44:47], v[60:63], v[16:31]
    ds_read_b128 v[56:59], v10 offset:8192
    ds_read_b64_tr_b16 v[40:41], v12 offset:12288
    ds_read_b64_tr_b16 v[42:43], v12 offset:12800
    s_add_u32 m0, s89, 32768
    s_nop 0
    buffer_load_dwordx4 v102, s[32:35], 0 offen lds
    s_waitcnt lgkmcnt(6)
    v_mfma_f32_32x32x16_bf16 v[16:31], v[32:35], v[48:51], v[16:31]
    ds_read_b128 v[60:63], v11 offset:8192
    ds_read_b64_tr_b16 v[44:45], v12 offset:14336
    ds_read_b64_tr_b16 v[46:47], v12 offset:14848
    s_add_u32 m0, s89, 81920
    s_mov_b32 s91, 720896
    buffer_load_dwordx4 v13, s[40:43], s91 offen lds
    s_waitcnt lgkmcnt(6)
    v_mfma_f32_32x32x16_bf16 v[16:31], v[36:39], v[52:55], v[16:31]
    s_add_u32 m0, s89, 131072
    s_mov_b32 s91, 721024
    buffer_load_dwordx4 v13, s[40:43], s91 offen lds
    s_waitcnt vmcnt(6)
    s_barrier
    ds_read_b128 v[48:51], v8 offset:16384
    ds_read_b64_tr_b16 v[32:33], v12 offset:16384
    ds_read_b64_tr_b16 v[34:35], v12 offset:16896
    s_waitcnt lgkmcnt(6)
    v_mfma_f32_32x32x16_bf16 v[16:31], v[40:43], v[56:59], v[16:31]
    ds_read_b128 v[52:55], v9 offset:16384
    ds_read_b64_tr_b16 v[36:37], v12 offset:18432
    ds_read_b64_tr_b16 v[38:39], v12 offset:18944
    s_waitcnt lgkmcnt(6)
    v_mfma_f32_32x32x16_bf16 v[16:31], v[44:47], v[60:63], v[16:31]
    ds_read_b128 v[56:59], v10 offset:16384
    ds_read_b64_tr_b16 v[40:41], v12 offset:20480
    ds_read_b64_tr_b16 v[42:43], v12 offset:20992
    s_add_u32 m0, s89, 40960
    s_nop 0
    buffer_load_dwordx4 v103, s[32:35], 0 offen lds
    s_waitcnt lgkmcnt(6)
    v_mfma_f32_32x32x16_bf16 v[16:31], v[32:35], v[48:51], v[16:31]
    ds_read_b128 v[60:63], v11 offset:16384
    ds_read_b64_tr_b16 v[44:45], v12 offset:22528
    ds_read_b64_tr_b16 v[46:47], v12 offset:23040
    s_add_u32 m0, s89, 90112
    s_mov_b32 s91, 753664
    buffer_load_dwordx4 v13, s[40:43], s91 offen lds
    s_waitcnt lgkmcnt(6)
    v_mfma_f32_32x32x16_bf16 v[16:31], v[36:39], v[52:55], v[16:31]
    s_add_u32 m0, s89, 139264
    s_mov_b32 s91, 753792
    buffer_load_dwordx4 v13, s[40:43], s91 offen lds
    s_waitcnt vmcnt(6)
    s_barrier
    ds_read_b128 v[48:51], v8 offset:24576
    ds_read_b64_tr_b16 v[32:33], v12 offset:24576
    ds_read_b64_tr_b16 v[34:35], v12 offset:25088
    s_waitcnt lgkmcnt(6)
    v_mfma_f32_32x32x16_bf16 v[16:31], v[40:43], v[56:59], v[16:31]
    ds_read_b128 v[52:55], v9 offset:24576
    ds_read_b64_tr_b16 v[36:37], v12 offset:26624
    ds_read_b64_tr_b16 v[38:39], v12 offset:27136
    s_waitcnt lgkmcnt(6)
    v_mfma_f32_32x32x16_bf16 v[16:31], v[44:47], v[60:63], v[16:31]
    ds_read_b128 v[56:59], v10 offset:24576
    ds_read_b64_tr_b16 v[40:41], v12 offset:28672
    ds_read_b64_tr_b16 v[42:43], v12 offset:29184
    s_add_u32 m0, s89, 0
    s_nop 0
    buffer_load_dwordx4 v104, s[32:35], 0 offen lds
    s_waitcnt lgkmcnt(6)
    v_mfma_f32_32x32x16_bf16 v[16:31], v[32:35], v[48:51], v[16:31]
    ds_read_b128 v[60:63], v11 offset:24576
    ds_read_b64_tr_b16 v[44:45], v12 offset:30720
    ds_read_b64_tr_b16 v[46:47], v12 offset:31232
    s_add_u32 m0, s89, 49152
    s_mov_b32 s91, 786432
    buffer_load_dwordx4 v13, s[40:43], s91 offen lds
    s_waitcnt lgkmcnt(6)
    v_mfma_f32_32x32x16_bf16 v[16:31], v[36:39], v[52:55], v[16:31]
    s_add_u32 m0, s89, 98304
    s_mov_b32 s91, 786560
    buffer_load_dwordx4 v13, s[40:43], s91 offen lds
    s_waitcnt vmcnt(6)
    s_barrier
    ds_read_b128 v[48:51], v8 offset:32768
    ds_read_b64_tr_b16 v[32:33], v12 offset:32768
    ds_read_b64_tr_b16 v[34:35], v12 offset:33280
    s_waitcnt lgkmcnt(6)
    v_mfma_f32_32x32x16_bf16 v[16:31], v[40:43], v[56:59], v[16:31]
    ds_read_b128 v[52:55], v9 offset:32768
    ds_read_b64_tr_b16 v[36:37], v12 offset:34816
    ds_read_b64_tr_b16 v[38:39], v12 offset:35328
    s_waitcnt lgkmcnt(6)
    v_mfma_f32_32x32x16_bf16 v[16:31], v[44:47], v[60:63], v[16:31]
    ds_read_b128 v[56:59], v10 offset:32768
    ds_read_b64_tr_b16 v[40:41], v12 offset:36864
    ds_read_b64_tr_b16 v[42:43], v12 offset:37376
    s_add_u32 m0, s89, 8192
    s_nop 0
    buffer_load_dwordx4 v105, s[32:35], 0 offen lds
    s_waitcnt lgkmcnt(6)
    v_mfma_f32_32x32x16_bf16 v[16:31], v[32:35], v[48:51], v[16:31]
    ds_read_b128 v[60:63], v11 offset:32768
    ds_read_b64_tr_b16 v[44:45], v12 offset:38912
    ds_read_b64_tr_b16 v[46:47], v12 offset:39424
    s_add_u32 m0, s89, 57344
    s_mov_b32 s91, 819200
    buffer_load_dwordx4 v13, s[40:43], s91 offen lds
    s_waitcnt lgkmcnt(6)
    v_mfma_f32_32x32x16_bf16 v[16:31], v[36:39], v[52:55], v[16:31]
    s_add_u32 m0, s89, 106496
    s_mov_b32 s91, 819328
    buffer_load_dwordx4 v13, s[40:43], s91 offen lds
    s_waitcnt vmcnt(6)
    s_barrier
    ds_read_b128 v[48:51], v8 offset:40960
    ds_read_b64_tr_b16 v[32:33], v12 offset:40960
    ds_read_b64_tr_b16 v[34:35], v12 offset:41472
    s_waitcnt lgkmcnt(6)
    v_mfma_f32_32x32x16_bf16 v[16:31], v[40:43], v[56:59], v[16:31]
    ds_read_b128 v[52:55], v9 offset:40960
    ds_read_b64_tr_b16 v[36:37], v12 offset:43008
    ds_read_b64_tr_b16 v[38:39], v12 offset:43520
    s_waitcnt lgkmcnt(6)
    v_mfma_f32_32x32x16_bf16 v[16:31], v[44:47], v[60:63], v[16:31]
    ds_read_b128 v[56:59], v10 offset:40960
    ds_read_b64_tr_b16 v[40:41], v12 offset:45056
    ds_read_b64_tr_b16 v[42:43], v12 offset:45568
    s_waitcnt lgkmcnt(6)
    v_mfma_f32_32x32x16_bf16 v[16:31], v[32:35], v[48:51], v[16:31]
    ds_read_b128 v[60:63], v11 offset:40960
    ds_read_b64_tr_b16 v[44:45], v12 offset:47104
    ds_read_b64_tr_b16 v[46:47], v12 offset:47616
    s_waitcnt lgkmcnt(6)
    v_mfma_f32_32x32x16_bf16 v[16:31], v[36:39], v[52:55], v[16:31]
    s_cmp_lg_u32 s86, 0
    s_cbranch_scc1 L_f4
    v_mov_b32 v0, 0
    s_lshl_b32 s91, s87, 2
    buffer_load_dword v6, v0, s[52:55], s91 offen sc0 sc1
L_f4:
    s_waitcnt vmcnt(3)
    s_barrier
    ds_read_b128 v[48:51], v8 offset:0
    ds_read_b64_tr_b16 v[32:33], v12 offset:0
    ds_read_b64_tr_b16 v[34:35], v12 offset:512
    s_waitcnt lgkmcnt(6)
    v_mfma_f32_32x32x16_bf16 v[16:31], v[40:43], v[56:59], v[16:31]
    ds_read_b128 v[52:55], v9 offset:0
    ds_read_b64_tr_b16 v[36:37], v12 offset:2048
    ds_read_b64_tr_b16 v[38:39], v12 offset:2560
    s_waitcnt lgkmcnt(6)
    v_mfma_f32_32x32x16_bf16 v[16:31], v[44:47], v[60:63], v[16:31]
    ds_read_b128 v[56:59], v10 offset:0
    ds_read_b64_tr_b16 v[40:41], v12 offset:4096
    ds_read_b64_tr_b16 v[42:43], v12 offset:4608
    s_waitcnt lgkmcnt(6)
    v_mfma_f32_32x32x16_bf16 v[16:31], v[32:35], v[48:51], v[16:31]
    ds_read_b128 v[60:63], v11 offset:0
    ds_read_b64_tr_b16 v[44:45], v12 offset:6144
    ds_read_b64_tr_b16 v[46:47], v12 offset:6656
    s_waitcnt lgkmcnt(6)
    v_mfma_f32_32x32x16_bf16 v[16:31], v[36:39], v[52:55], v[16:31]
    s_waitcnt vmcnt(0)
    s_barrier
    ds_read_b128 v[48:51], v8 offset:8192
    ds_read_b64_tr_b16 v[32:33], v12 offset:8192
    ds_read_b64_tr_b16 v[34:35], v12 offset:8704
    s_waitcnt lgkmcnt(6)
    v_mfma_f32_32x32x16_bf16 v[16:31], v[40:43], v[56:59], v[16:31]
    ds_read_b128 v[52:55], v9 offset:8192
    ds_read_b64_tr_b16 v[36:37], v12 offset:10240
    ds_read_b64_tr_b16 v[38:39], v12 offset:10752
    s_waitcnt lgkmcnt(6)
    v_mfma_f32_32x32x16_bf16 v[16:31], v[44:47], v[60:63], v[16:31]
    ds_read_b128 v[56:59], v10 offset:8192
    ds_read_b64_tr_b16 v[40:41], v12 offset:12288
    ds_read_b64_tr_b16 v[42:43], v12 offset:12800
    s_waitcnt lgkmcnt(6)
    v_mfma_f32_32x32x16_bf16 v[16:31], v[32:35], v[48:51], v[16:31]
    ds_read_b128 v[60:63], v11 offset:8192
    ds_read_b64_tr_b16 v[44:45], v12 offset:14336
    ds_read_b64_tr_b16 v[46:47], v12 offset:14848
    s_waitcnt lgkmcnt(6)
    v_mfma_f32_32x32x16_bf16 v[16:31], v[36:39], v[52:55], v[16:31]
    s_waitcnt lgkmcnt(3)
    v_mfma_f32_32x32x16_bf16 v[16:31], v[40:43], v[56:59], v[16:31]
    s_waitcnt lgkmcnt(0)
    v_mfma_f32_32x32x16_bf16 v[16:31], v[44:47], v[60:63], v[16:31]
    v_lshlrev_b32 v9, 3, v1
    v_lshlrev_b32 v8, 5, v1
    v_add_u32 v8, 161280, v8
    s_min_u32 s93, s88, 2
    s_and_b32 s91, s93, 1
    s_lshl_b32 s91, s91, 4
    s_cmp_lt_u32 s88, 2
    s_cselect_b32 s92, -1, 0
    s_cselect_b32 s93, 0, -1
    s_lshl_b32 s90, s87, 9
    s_mov_b32 s3, 0x40000
    s_nop 0
    v_pk_mul_f32 v[32:33], v[16:17], v[16:17]
    v_pk_mul_f32 v[34:35], v[18:19], v[18:19]
    v_pk_mul_f32 v[36:37], v[20:21], v[20:21]
    v_pk_mul_f32 v[38:39], v[22:23], v[22:23]
    v_pk_mul_f32 v[40:41], v[24:25], v[24:25]
    v_pk_mul_f32 v[42:43], v[26:27], v[26:27]
    v_pk_mul_f32 v[44:45], v[28:29], v[28:29]
    v_pk_mul_f32 v[46:47], v[30:31], v[30:31]
    v_pk_fma_f32 v[32:33], v[32:33], v[106:107], v[106:107] op_sel:[0,0,1] op_sel_hi:[1,0,1]
    v_pk_fma_f32 v[34:35], v[34:35], v[106:107], v[106:107] op_sel:[0,0,1] op_sel_hi:[1,0,1]
    v_pk_fma_f32 v[36:37], v[36:37], v[106:107], v[106:107] op_sel:[0,0,1] op_sel_hi:[1,0,1]
    v_pk_fma_f32 v[38:39], v[38:39], v[106:107], v[106:107] op_sel:[0,0,1] op_sel_hi:[1,0,1]
    v_pk_fma_f32 v[40:41], v[40:41], v[106:107], v[106:107] op_sel:[0,0,1] op_sel_hi:[1,0,1]
    v_pk_fma_f32 v[42:43], v[42:43], v[106:107], v[106:107] op_sel:[0,0,1] op_sel_hi:[1,0,1]
    v_pk_fma_f32 v[44:45], v[44:45], v[106:107], v[106:107] op_sel:[0,0,1] op_sel_hi:[1,0,1]
    v_pk_fma_f32 v[46:47], v[46:47], v[106:107], v[106:107] op_sel:[0,0,1] op_sel_hi:[1,0,1]
    v_pk_mul_f32 v[32:33], v[32:33], v[16:17]
    v_pk_mul_f32 v[34:35], v[34:35], v[18:19]
    v_pk_mul_f32 v[36:37], v[36:37], v[20:21]
    v_pk_mul_f32 v[38:39], v[38:39], v[22:23]
    v_pk_mul_f32 v[40:41], v[40:41], v[24:25]
    v_pk_mul_f32 v[42:43], v[42:43], v[26:27]
    v_pk_mul_f32 v[44:45], v[44:45], v[28:29]
    v_pk_mul_f32 v[46:47], v[46:47], v[30:31]
    v_exp_f32 v32, v32
    v_exp_f32 v33, v33
    v_exp_f32 v34, v34
    v_exp_f32 v35, v35
    v_exp_f32 v36, v36
    v_exp_f32 v37, v37
    v_exp_f32 v38, v38
    v_exp_f32 v39, v39
    v_exp_f32 v40, v40
    v_exp_f32 v41, v41
    v_exp_f32 v42, v42
    v_exp_f32 v43, v43
    v_exp_f32 v44, v44
    v_exp_f32 v45, v45
    v_exp_f32 v46, v46
    v_exp_f32 v47, v47
    v_pk_add_f32 v[32:33], v[32:33], 1.0 op_sel_hi:[1,0]
    v_pk_add_f32 v[34:35], v[34:35], 1.0 op_sel_hi:[1,0]
    v_pk_add_f32 v[36:37], v[36:37], 1.0 op_sel_hi:[1,0]
    v_pk_add_f32 v[38:39], v[38:39], 1.0 op_sel_hi:[1,0]
    v_pk_add_f32 v[40:41], v[40:41], 1.0 op_sel_hi:[1,0]
    v_pk_add_f32 v[42:43], v[42:43], 1.0 op_sel_hi:[1,0]
    v_pk_add_f32 v[44:45], v[44:45], 1.0 op_sel_hi:[1,0]
    v_pk_add_f32 v[46:47], v[46:47], 1.0 op_sel_hi:[1,0]
    v_rcp_f32 v32, v32
    v_rcp_f32 v33, v33
    v_rcp_f32 v34, v34
    v_rcp_f32 v35, v35
    v_rcp_f32 v36, v36
    v_rcp_f32 v37, v37
    v_rcp_f32 v38, v38
    v_rcp_f32 v39, v39
    v_rcp_f32 v40, v40
    v_rcp_f32 v41, v41
    v_rcp_f32 v42, v42
    v_rcp_f32 v43, v43
    v_rcp_f32 v44, v44
    v_rcp_f32 v45, v45
    v_rcp_f32 v46, v46
    v_rcp_f32 v47, v47
    v_pk_mul_f32 v[16:17], v[16:17], v[64:65]
    v_pk_mul_f32 v[18:19], v[18:19], v[66:67]
    v_pk_mul_f32 v[20:21], v[20:21], v[68:69]
    v_pk_mul_f32 v[22:23], v[22:23], v[70:71]
    v_pk_mul_f32 v[24:25], v[24:25], v[72:73]
    v_pk_mul_f32 v[26:27], v[26:27], v[74:75]
    v_pk_mul_f32 v[28:29], v[28:29], v[76:77]
    v_pk_mul_f32 v[30:31], v[30:31], v[78:79]
    v_pk_mul_f32 v[4:5], v[16:17], v[32:33]
    v_pk_mul_f32 v[108:109], v[18:19], v[34:35]
    v_pk_fma_f32 v[4:5], v[20:21], v[36:37], v[4:5]
    v_pk_fma_f32 v[108:109], v[22:23], v[38:39], v[108:109]
    v_pk_fma_f32 v[4:5], v[24:25], v[40:41], v[4:5]
    v_pk_fma_f32 v[108:109], v[26:27], v[42:43], v[108:109]
    v_pk_fma_f32 v[4:5], v[28:29], v[44:45], v[4:5]
    v_pk_fma_f32 v[108:109], v[30:31], v[46:47], v[108:109]
    v_pk_add_f32 v[4:5], v[4:5], v[108:109]
    v_add_f32 v4, v4, v5
    ds_write_b32 v2, v4
    s_branch L_final
L_cross:
    v_lshrrev_b32 v20, 3, v1
    v_mul_u32_u24 v14, 104, v20
    s_lshr_b32 s92, s86, 2
    s_lshl_b32 s92, s92, 2
    s_add_u32 s91, s89, s92
    s_add_u32 s91, s91, 147456
    v_add_u32 v14, s91, v14
    s_and_b32 s93, s86, 1
    s_lshl_b32 s93, s93, 4
    v_and_b32 v16, 31, v1
    v_xor_b32 v16, s93, v16
    v_lshrrev_b32 v17, 5, v1
    v_bfe_u32 v18, v1, 1, 3
    v_lshrrev_b32 v19, 4, v1
    v_and_b32 v20, 15, v1
    v_or_b32 v21, s93, v20
    v_xor_b32 v22, v19, v18
    v_lshlrev_b32 v22, 4, v22
    v_lshl_add_u32 v8, v21, 7, v22
    v_xor_b32 v9, 64, v8
    v_xor_b32 v10, 2048, v8
    v_xor_b32 v11, 2048, v9
    v_xor_b32 v21, s86, v18
    v_lshlrev_b32 v22, 12, v17
    v_lshl_add_u32 v22, v16, 7, v22
    v_lshl_add_u32 v12, v21, 4, v22
    v_lshlrev_b32 v13, 11, v17
    v_lshl_add_u32 v13, v16, 4, v13
    v_bfe_u32 v21, v1, 2, 2
    v_lshl_add_u32 v21, v19, 3, v21
    s_lshl_b32 s91, s86, 4
    v_lshl_add_u32 v21, v21, 7, s91
    v_and_b32 v22, 1, v1
    v_lshl_add_u32 v26, v22, 3, v21
    v_bfe_i32 v27, v1, 3, 1
    s_lshl_b32 s91, s86, 3
    s_lshl_b32 s92, s86, 1
    s_add_u32 s92, s92, 36
    s_cmp_ge_u32 s86, 6
    s_cselect_b32 s91, s92, s91
    s_cselect_b32 s60, 0xffff, -1
    s_cselect_b32 s61, 0, -1
    s_lshl_b32 s26, s91, 7
    v_lshrrev_b32 v20, 3, v1
    v_add_u32 v20, s91, v20
    v_subrev_u32 v21, 26, v20
    v_min_u32 v21, v20, v21
    v_lshrrev_b32 v24, 1, v21
    v_mov_b32 v22, 1966171168
    v_mov_b32 v23, 833960
    v_lshlrev_b32 v21, 2, v24
    v_lshrrev_b64 v[22:23], v21, v[22:23]
    v_and_b32 v21, 15, v22
    v_xor_b32 v21, v21, v1
    v_and_b32 v21, 7, v21
    v_lshlrev_b32 v20, 7, v20
    v_lshl_add_u32 v15, v21, 4, v20
    v_bfe_u32 v20, v1, 3, 2
    v_and_b32 v21, 3, v1
    v_lshl_add_u32 v20, v20, 2, v21
    v_min_u32 v20, 12, v20
    v_mov_b32 v22, 1935823168
    v_mov_b32 v23, 833960
    v_lshlrev_b32 v21, 2, v20
    v_lshrrev_b64 v[22:23], v21, v[22:23]
    v_and_b32 v21, 15, v22
    v_bfe_u32 v22, v1, 2, 1
    v_lshl_add_u32 v21, v21, 1, v22
    v_mad_u32_u24 v21, v17, 26, v21
    v_xor_b32 v20, s86, v20
    v_and_b32 v20, 7, v20
    v_lshlrev_b32 v20, 4, v20
    v_lshl_add_u32 v7, v21, 7, v20
    s_and_b32 s91, s88, 1
    s_lshl_b32 s91, s91, 10
    s_lshl_b32 s92, s86, 2
    s_add_u32 s91, s91, s92
    s_add_u32 s91, s91, 161280
    v_lshl_add_u32 v2, v16, 5, s91
    s_mov_b32 s94, 0x05040100
    s_mov_b32 s95, 0x07060302
    v_mov_b32 v103, 0
    v_mov_b32 v107, 0
    v_mov_b32 v111, 0
    v_mov_b32 v115, 0
    v_mov_b32 v119, 0
    v_mov_b32 v123, 0
    v_mov_b32 v127, 0
    v_mov_b32 v131, 0
    s_waitcnt vmcnt(3)
    ds_read_b32 v84, v14 offset:0
    ds_read_b32 v85, v14 offset:8
    ds_read_b32 v86, v14 offset:16
    ds_read_b32 v87, v14 offset:24
    ds_read_b32 v88, v14 offset:32
    ds_read_b32 v89, v14 offset:40
    ds_read_b32 v248, v14 offset:48
    ds_read_b32 v249, v14 offset:56
    s_add_u32 m0, s89, 8192
    s_waitcnt lgkmcnt(7)
    v_lshl_add_u32 v84, v84, 7, v3
    buffer_load_dwordx4 v84, s[32:35], 0 offen lds
    s_add_u32 m0, s89, 16384
    s_waitcnt lgkmcnt(6)
    v_lshl_add_u32 v85, v85, 7, v3
    buffer_load_dwordx4 v85, s[32:35], 0 offen lds
    s_waitcnt vmcnt(4)
    s_barrier
    s_add_u32 m0, s89, 24576
    s_waitcnt lgkmcnt(5)
    v_lshl_add_u32 v86, v86, 7, v3
    buffer_load_dwordx4 v86, s[32:35], 0 offen lds
    s_add_u32 m0, s89, 32768
    s_waitcnt lgkmcnt(4)
    v_lshl_add_u32 v87, v87, 7, v3
    buffer_load_dwordx4 v87, s[32:35], 0 offen lds
    s_barrier
    s_add_u32 m0, s89, 40960
    s_waitcnt lgkmcnt(3)
    v_lshl_add_u32 v88, v88, 7, v3
    buffer_load_dwordx4 v88, s[32:35], 0 offen lds
    s_add_u32 m0, s89, 49152
    s_waitcnt lgkmcnt(2)
    v_lshl_add_u32 v89, v89, 7, v3
    buffer_load_dwordx4 v89, s[32:35], 0 offen lds
    ds_read_b64_tr_b16 v[196:197], v26 offset:0
    ds_read_b64_tr_b16 v[198:199], v26 offset:512
    ds_read_b64_tr_b16 v[200:201], v26 offset:4096
    ds_read_b64_tr_b16 v[202:203], v26 offset:4608
    v_not_b32 v28, v27
    s_waitcnt lgkmcnt(0)
    v_and_b32 v204, v27, v196
    v_and_b32 v196, v28, v196
    v_and_b32 v205, v27, v197
    v_and_b32 v197, v28, v197
    v_and_b32 v206, v27, v198
    v_and_b32 v198, v28, v198
    v_and_b32 v207, v27, v199
    v_and_b32 v199, v28, v199
    v_and_b32 v208, v27, v200
    v_and_b32 v200, v28, v200
    v_and_b32 v209, v27, v201
    v_and_b32 v201, v28, v201
    v_and_b32 v210, v27, v202
    v_and_b32 v202, v28, v202
    v_and_b32 v211, v27, v203
    v_and_b32 v203, v28, v203
    s_cmp_lt_u32 s86, 4
    s_cbranch_scc1 L_r0
    v_and_b32 v30, 0x3c803c80, v27
    v_and_b32 v31, 0x3c803c80, v28
    v_or_b32 v196, v30, v196
    v_or_b32 v204, v31, v204
    v_or_b32 v197, v30, v197
    v_or_b32 v205, v31, v205
    v_or_b32 v198, v30, v198
    v_or_b32 v206, v31, v206
    v_or_b32 v199, v30, v199
    v_or_b32 v207, v31, v207
    v_or_b32 v200, v30, v200
    v_or_b32 v208, v31, v208
    v_or_b32 v201, v30, v201
    v_or_b32 v209, v31, v209
    v_or_b32 v202, v30, v202
    v_or_b32 v210, v31, v210
    v_or_b32 v203, v30, v203
    v_or_b32 v211, v31, v211
    v_and_b32 v20, 15, v1
    v_min_u32 v20, 12, v20
    v_xor_b32 v21, 1, v17
    v_mul_u32_u24 v21, 26, v21
    v_lshl_add_u32 v21, v20, 1, v21
    v_add_u32 v21, 114688, v21
    v_and_b32 v24, 1, v19
    v_mul_u32_u24 v24, 104, v24
    v_add_u32 v27, v21, v24
    v_add_u32 v28, v27, v24
    ds_read_u16 v68, v28 offset:0
    ds_read_u16 v69, v28 offset:52
    ds_read_u16 v70, v28 offset:104
    ds_read_u16 v71, v28 offset:156
    ds_read_u16 v72, v27 offset:416
    ds_read_u16 v73, v27 offset:468
    ds_read_u16 v247, v27 offset:624
    v_mov_b32 v22, 1935823168
    v_mov_b32 v23, 833960
    v_lshlrev_b32 v29, 2, v20
    v_lshrrev_b64 v[22:23], v29, v[22:23]
    v_and_b32 v29, 15, v22
    s_and_b32 s91, s86, 2
    s_add_u32 s91, s91, 115712
    v_lshl_add_u32 v22, v29, 2, s91
    v_mul_u32_u24 v23, 208, v19
    v_add_u32 v22, v22, v23
    ds_read_u16 v76, v22 offset:0
    ds_read_u16 v77, v22 offset:52
    ds_read_u16 v78, v22 offset:104
    ds_read_u16 v79, v22 offset:156
    v_mov_b32 v255, 0
    s_waitcnt lgkmcnt(4)
    v_lshl_or_b32 v244, v69, 16, v68
    v_lshl_or_b32 v245, v71, 16, v70
    v_lshl_or_b32 v246, v73, 16, v72
    s_waitcnt lgkmcnt(0)
    v_lshl_or_b32 v4, v77, 16, v76
    v_lshl_or_b32 v5, v79, 16, v78
    s_waitcnt vmcnt(4)
    s_barrier
    s_setprio 2
    ds_read_b128 v[132:135], v8 offset:8192
    ds_read_b128 v[136:139], v9 offset:8192
    ds_read_b128 v[148:151], v8 offset:12288
    ds_read_b128 v[152:155], v9 offset:12288
    ds_read_b128 v[140:143], v10 offset:8192
    ds_read_b128 v[144:147], v11 offset:8192
    s_add_u32 m0, s89, 57344
    v_lshl_add_u32 v248, v248, 7, v3
    buffer_load_dwordx4 v248, s[32:35], 0 offen lds
    ds_read_b32 v248, v14 offset:64
    ds_read_b128 v[156:159], v10 offset:12288
    ds_read_b128 v[160:163], v11 offset:12288
    ds_read_b128 v[16:19], v12 offset:8192
    s_waitcnt lgkmcnt(8)
    v_mfma_f32_16x16x32_bf16 v[212:215], v[196:199], v[132:135], 0
    ds_read_b128 v[164:167], v8 offset:16384
    v_mfma_f32_16x16x32_bf16 v[212:215], v[200:203], v[136:139], v[212:215]
    ds_read_b128 v[168:171], v9 offset:16384
    s_waitcnt lgkmcnt(8)
    ds_read_b128 v[180:183], v8 offset:20480
    v_mfma_f32_16x16x32_bf16 v[228:231], v[204:207], v[148:151], 0
    ds_read_b128 v[184:187], v9 offset:20480
    v_mfma_f32_16x16x32_bf16 v[228:231], v[208:211], v[152:155], v[228:231]
    ds_read_b128 v[172:175], v10 offset:16384
    s_waitcnt lgkmcnt(9)
    v_mfma_f32_16x16x32_bf16 v[216:219], v[196:199], v[140:143], 0
    ds_read_b128 v[176:179], v11 offset:16384
    v_mfma_f32_16x16x32_bf16 v[216:219], v[200:203], v[144:147], v[216:219]
    ds_read_b128 v[188:191], v10 offset:20480
    s_waitcnt lgkmcnt(8)
    ds_read_b128 v[192:195], v11 offset:20480
    v_mfma_f32_16x16x32_bf16 v[232:235], v[204:207], v[156:159], 0
    ds_read_b128 v[24:27], v12 offset:16384
    v_mfma_f32_16x16x32_bf16 v[232:235], v[208:211], v[160:163], v[232:235]
    s_add_u32 m0, s89, 65536
    v_lshl_add_u32 v249, v249, 7, v3
    buffer_load_dwordx4 v249, s[32:35], 0 offen lds
    ds_read_b32 v249, v14 offset:72
    s_waitcnt vmcnt(4)
    s_barrier
    s_waitcnt lgkmcnt(8)
    v_mfma_f32_16x16x32_bf16 v[220:223], v[196:199], v[164:167], 0
    ds_read_b128 v[132:135], v8 offset:24576
    v_mfma_f32_16x16x32_bf16 v[220:223], v[200:203], v[168:171], v[220:223]
    ds_read_b128 v[136:139], v9 offset:24576
    s_waitcnt lgkmcnt(8)
    ds_read_b128 v[148:151], v8 offset:28672
    v_mfma_f32_16x16x32_bf16 v[236:239], v[204:207], v[180:183], 0
    ds_read_b128 v[152:155], v9 offset:28672
    v_mfma_f32_16x16x32_bf16 v[236:239], v[208:211], v[184:187], v[236:239]
    ds_read_b128 v[140:143], v10 offset:24576
    s_waitcnt lgkmcnt(9)
    v_mfma_f32_16x16x32_bf16 v[224:227], v[196:199], v[172:175], 0
    ds_read_b128 v[144:147], v11 offset:24576
    v_mfma_f32_16x16x32_bf16 v[224:227], v[200:203], v[176:179], v[224:227]
    ds_read_b128 v[156:159], v10 offset:28672
    s_waitcnt lgkmcnt(9)
    ds_read_b128 v[160:163], v11 offset:28672
    v_mfma_f32_16x16x32_bf16 v[240:243], v[204:207], v[188:191], 0
    ds_read_b128 v[32:35], v12 offset:24576
    v_mfma_f32_16x16x32_bf16 v[240:243], v[208:211], v[192:195], v[240:243]
    v_cvt_pk_bf16_f32 v68, v228, v236
    v_cvt_pk_bf16_f32 v72, v229, v237
    v_cvt_pk_bf16_f32 v76, v230, v238
    v_cvt_pk_bf16_f32 v80, v231, v239
    s_mov_b32 exec_hi, 0
    v_cvt_pk_bf16_f32 v68, v212, v220
    v_cvt_pk_bf16_f32 v72, v213, v221
    v_cvt_pk_bf16_f32 v76, v214, v222
    v_cvt_pk_bf16_f32 v80, v215, v223
    s_mov_b32 exec_lo, 0xffff
    v_cvt_pk_bf16_f32 v252, v228, v236
    s_mov_b32 exec_lo, 0
    s_mov_b32 exec_hi, 0xffff
    v_cvt_pk_bf16_f32 v252, v212, v220
    s_mov_b64 exec, -1
    s_add_u32 m0, s89, 73728
    v_lshl_add_u32 v248, v248, 7, v3
    buffer_load_dwordx4 v248, s[32:35], 0 offen lds
    ds_read_b32 v248, v14 offset:80
    s_waitcnt lgkmcnt(8)
    v_mfma_f32_16x16x32_bf16 v[212:215], v[196:199], v[132:135], 0
    ds_read_b128 v[164:167], v8 offset:32768
    v_mfma_f32_16x16x32_bf16 v[212:215], v[200:203], v[136:139], v[212:215]
    ds_read_b128 v[168:171], v9 offset:32768
    s_waitcnt lgkmcnt(8)
    ds_read_b128 v[180:183], v8 offset:36864
    v_mfma_f32_16x16x32_bf16 v[228:231], v[204:207], v[148:151], 0
    ds_read_b128 v[184:187], v9 offset:36864
    v_mfma_f32_16x16x32_bf16 v[228:231], v[208:211], v[152:155], v[228:231]
    ds_read_b128 v[172:175], v10 offset:32768
    v_cvt_pk_bf16_f32 v84, v232, v240
    v_cvt_pk_bf16_f32 v88, v233, v241
    v_cvt_pk_bf16_f32 v92, v234, v242
    v_cvt_pk_bf16_f32 v96, v235, v243
    s_mov_b32 exec_hi, 0
    v_cvt_pk_bf16_f32 v84, v216, v224
    v_cvt_pk_bf16_f32 v88, v217, v225
    v_cvt_pk_bf16_f32 v92, v218, v226
    v_cvt_pk_bf16_f32 v96, v219, v227
    s_mov_b64 exec, -1
    s_waitcnt lgkmcnt(9)
    v_mfma_f32_16x16x32_bf16 v[216:219], v[196:199], v[140:143], 0
    ds_read_b128 v[176:179], v11 offset:32768
    v_mfma_f32_16x16x32_bf16 v[216:219], v[200:203], v[144:147], v[216:219]
    ds_read_b128 v[188:191], v10 offset:36864
    s_waitcnt lgkmcnt(9)
    ds_read_b128 v[192:195], v11 offset:36864
    v_mfma_f32_16x16x32_bf16 v[232:235], v[204:207], v[156:159], 0
    ds_read_b128 v[40:43], v12 offset:32768
    v_mfma_f32_16x16x32_bf16 v[232:235], v[208:211], v[160:163], v[232:235]
    v_permlane16_swap_b32 v68, v84
    v_permlane16_swap_b32 v72, v88
    v_permlane16_swap_b32 v76, v92
    v_permlane16_swap_b32 v80, v96
    s_add_u32 m0, s89, 81920
    v_lshl_add_u32 v249, v249, 7, v3
    buffer_load_dwordx4 v249, s[32:35], 0 offen lds
    ds_read_b32 v249, v14 offset:88
    s_waitcnt vmcnt(4)
    s_barrier
    s_waitcnt lgkmcnt(8)
    v_mfma_f32_16x16x32_bf16 v[220:223], v[196:199], v[164:167], 0
    ds_read_b128 v[132:135], v8 offset:40960
    v_mfma_f32_16x16x32_bf16 v[220:223], v[200:203], v[168:171], v[220:223]
    ds_read_b128 v[136:139], v9 offset:40960
    s_waitcnt lgkmcnt(8)
    ds_read_b128 v[148:151], v8 offset:45056
    v_mfma_f32_16x16x32_bf16 v[236:239], v[204:207], v[180:183], 0
    ds_read_b128 v[152:155], v9 offset:45056
    v_mfma_f32_16x16x32_bf16 v[236:239], v[208:211], v[184:187], v[236:239]
    ds_read_b128 v[140:143], v10 offset:40960
    s_waitcnt lgkmcnt(9)
    v_mfma_f32_16x16x32_bf16 v[224:227], v[196:199], v[172:175], 0
    ds_read_b128 v[144:147], v11 offset:40960
    v_mfma_f32_16x16x32_bf16 v[224:227], v[200:203], v[176:179], v[224:227]
    ds_read_b128 v[156:159], v10 offset:45056
    s_waitcnt lgkmcnt(9)
    ds_read_b128 v[160:163], v11 offset:45056
    v_mfma_f32_16x16x32_bf16 v[240:243], v[204:207], v[188:191], 0
    ds_read_b128 v[20:23], v12 offset:40960
    v_mfma_f32_16x16x32_bf16 v[240:243], v[208:211], v[192:195], v[240:243]
    v_cvt_pk_bf16_f32 v69, v228, v236
    v_cvt_pk_bf16_f32 v73, v229, v237
    v_cvt_pk_bf16_f32 v77, v230, v238
    v_cvt_pk_bf16_f32 v81, v231, v239
    s_mov_b32 exec_hi, 0
    v_cvt_pk_bf16_f32 v69, v212, v220
    v_cvt_pk_bf16_f32 v73, v213, v221
    v_cvt_pk_bf16_f32 v77, v214, v222
    v_cvt_pk_bf16_f32 v81, v215, v223
    s_mov_b32 exec_lo, 0xffff
    v_cvt_pk_bf16_f32 v253, v228, v236
    s_mov_b32 exec_lo, 0
    s_mov_b32 exec_hi, 0xffff
    v_cvt_pk_bf16_f32 v253, v212, v220
    s_mov_b64 exec, -1
    s_add_u32 m0, s89, 90112
    v_lshl_add_u32 v248, v248, 7, v3
    buffer_load_dwordx4 v248, s[32:35], 0 offen lds
    ds_read_b32 v248, v14 offset:96
    s_waitcnt lgkmcnt(8)
    v_mfma_f32_16x16x32_bf16 v[212:215], v[196:199], v[132:135], 0
    ds_read_b128 v[164:167], v8 offset:49152
    v_mfma_f32_16x16x32_bf16 v[212:215], v[200:203], v[136:139], v[212:215]
    ds_read_b128 v[168:171], v9 offset:49152
    s_waitcnt lgkmcnt(8)
    ds_read_b128 v[180:183], v8 offset:53248
    v_mfma_f32_16x16x32_bf16 v[228:231], v[204:207], v[148:151], 0
    ds_read_b128 v[184:187], v9 offset:53248
    v_mfma_f32_16x16x32_bf16 v[228:231], v[208:211], v[152:155], v[228:231]
    ds_read_b128 v[172:175], v10 offset:49152
    v_cvt_pk_bf16_f32 v85, v232, v240
    v_cvt_pk_bf16_f32 v89, v233, v241
    v_cvt_pk_bf16_f32 v93, v234, v242
    v_cvt_pk_bf16_f32 v97, v235, v243
    s_mov_b32 exec_hi, 0
    v_cvt_pk_bf16_f32 v85, v216, v224
    v_cvt_pk_bf16_f32 v89, v217, v225
    v_cvt_pk_bf16_f32 v93, v218, v226
    v_cvt_pk_bf16_f32 v97, v219, v227
    s_mov_b64 exec, -1
    s_waitcnt lgkmcnt(9)
    v_mfma_f32_16x16x32_bf16 v[216:219], v[196:199], v[140:143], 0
    ds_read_b128 v[176:179], v11 offset:49152
    v_mfma_f32_16x16x32_bf16 v[216:219], v[200:203], v[144:147], v[216:219]
    ds_read_b128 v[188:191], v10 offset:53248
    s_waitcnt lgkmcnt(9)
    ds_read_b128 v[192:195], v11 offset:53248
    v_mfma_f32_16x16x32_bf16 v[232:235], v[204:207], v[156:159], 0
    ds_read_b128 v[28:31], v12 offset:49152
    v_mfma_f32_16x16x32_bf16 v[232:235], v[208:211], v[160:163], v[232:235]
    v_permlane16_swap_b32 v69, v85
    v_permlane16_swap_b32 v73, v89
    v_permlane16_swap_b32 v77, v93
    v_permlane16_swap_b32 v81, v97
    s_add_u32 m0, s89, 98304
    v_lshl_add_u32 v249, v249, 7, v3
    buffer_load_dwordx4 v249, s[32:35], 0 offen lds
    v_add_u32 v8, 57344, v8
    v_add_u32 v9, 57344, v9
    v_add_u32 v10, 57344, v10
    v_add_u32 v11, 57344, v11
    v_add_u32 v12, 57344, v12
    s_waitcnt vmcnt(4)
    s_barrier
    s_waitcnt lgkmcnt(7)
    v_mfma_f32_16x16x32_bf16 v[220:223], v[196:199], v[164:167], 0
    ds_read_b128 v[132:135], v8 offset:0
    v_mfma_f32_16x16x32_bf16 v[220:223], v[200:203], v[168:171], v[220:223]
    ds_read_b128 v[136:139], v9 offset:0
    s_waitcnt lgkmcnt(7)
    ds_read_b128 v[148:151], v8 offset:4096
    v_mfma_f32_16x16x32_bf16 v[236:239], v[204:207], v[180:183], 0
    ds_read_b128 v[152:155], v9 offset:4096
    v_mfma_f32_16x16x32_bf16 v[236:239], v[208:211], v[184:187], v[236:239]
    ds_read_b128 v[140:143], v10 offset:0
    s_waitcnt lgkmcnt(8)
    v_mfma_f32_16x16x32_bf16 v[224:227], v[196:199], v[172:175], 0
    ds_read_b128 v[144:147], v11 offset:0
    v_mfma_f32_16x16x32_bf16 v[224:227], v[200:203], v[176:179], v[224:227]
    ds_read_b128 v[156:159], v10 offset:4096
    s_waitcnt lgkmcnt(8)
    ds_read_b128 v[160:163], v11 offset:4096
    v_mfma_f32_16x16x32_bf16 v[240:243], v[204:207], v[188:191], 0
    ds_read_b128 v[36:39], v12 offset:0
    v_mfma_f32_16x16x32_bf16 v[240:243], v[208:211], v[192:195], v[240:243]
    v_cvt_pk_bf16_f32 v100, v228, v236
    v_cvt_pk_bf16_f32 v104, v229, v237
    v_cvt_pk_bf16_f32 v108, v230, v238
    v_cvt_pk_bf16_f32 v112, v231, v239
    s_mov_b32 exec_hi, 0
    v_cvt_pk_bf16_f32 v100, v212, v220
    v_cvt_pk_bf16_f32 v104, v213, v221
    v_cvt_pk_bf16_f32 v108, v214, v222
    v_cvt_pk_bf16_f32 v112, v215, v223
    s_mov_b32 exec_lo, 0xffff0000
    v_cvt_pk_bf16_f32 v252, v228, v236
    s_mov_b32 exec_lo, 0
    s_mov_b32 exec_hi, 0xffff0000
    v_cvt_pk_bf16_f32 v252, v212, v220
    s_mov_b64 exec, -1
    s_add_u32 m0, s89, 106496
    v_lshl_add_u32 v248, v248, 7, v3
    buffer_load_dwordx4 v248, s[32:35], 0 offen lds
    s_waitcnt lgkmcnt(7)
    v_mfma_f32_16x16x32_bf16 v[212:215], v[196:199], v[132:135], 0
    ds_read_b128 v[164:167], v8 offset:8192
    v_mfma_f32_16x16x32_bf16 v[212:215], v[200:203], v[136:139], v[212:215]
    ds_read_b128 v[168:171], v9 offset:8192
    s_waitcnt lgkmcnt(7)
    ds_read_b128 v[180:183], v8 offset:12288
    v_mfma_f32_16x16x32_bf16 v[228:231], v[204:207], v[148:151], 0
    ds_read_b128 v[184:187], v9 offset:12288
    v_mfma_f32_16x16x32_bf16 v[228:231], v[208:211], v[152:155], v[228:231]
    ds_read_b128 v[172:175], v10 offset:8192
    v_cvt_pk_bf16_f32 v116, v232, v240
    v_cvt_pk_bf16_f32 v120, v233, v241
    v_cvt_pk_bf16_f32 v124, v234, v242
    v_cvt_pk_bf16_f32 v128, v235, v243
    s_mov_b32 exec_hi, 0
    v_cvt_pk_bf16_f32 v116, v216, v224
    v_cvt_pk_bf16_f32 v120, v217, v225
    v_cvt_pk_bf16_f32 v124, v218, v226
    v_cvt_pk_bf16_f32 v128, v219, v227
    s_mov_b64 exec, -1
    s_waitcnt lgkmcnt(8)
    v_mfma_f32_16x16x32_bf16 v[216:219], v[196:199], v[140:143], 0
    ds_read_b128 v[176:179], v11 offset:8192
    v_mfma_f32_16x16x32_bf16 v[216:219], v[200:203], v[144:147], v[216:219]
    ds_read_b128 v[188:191], v10 offset:12288
    s_waitcnt lgkmcnt(8)
    ds_read_b128 v[192:195], v11 offset:12288
    v_mfma_f32_16x16x32_bf16 v[232:235], v[204:207], v[156:159], 0
    ds_read_b128 v[44:47], v12 offset:8192
    v_mfma_f32_16x16x32_bf16 v[232:235], v[208:211], v[160:163], v[232:235]
    v_permlane16_swap_b32 v100, v116
    v_permlane16_swap_b32 v104, v120
    v_permlane16_swap_b32 v108, v124
    v_permlane16_swap_b32 v112, v128
    s_add_u32 m0, s26, 114688
    s_mov_b64 exec, s[60:61]
    s_mov_b32 s91, 0
    buffer_load_dwordx4 v15, s[36:39], s91 offen lds
    s_mov_b64 exec, -1
    s_add_u32 m0, s26, 121344
    s_mov_b64 exec, s[60:61]
    s_mov_b32 s91, 6656
    buffer_load_dwordx4 v15, s[36:39], s91 offen lds
    s_mov_b64 exec, -1
    s_waitcnt vmcnt(5)
    s_barrier
    s_waitcnt lgkmcnt(7)
    v_mfma_f32_16x16x32_bf16 v[220:223], v[196:199], v[164:167], 0
    ds_read_b128 v[132:135], v8 offset:16384
    v_mfma_f32_16x16x32_bf16 v[220:223], v[200:203], v[168:171], v[220:223]
    ds_read_b128 v[136:139], v9 offset:16384
    s_waitcnt lgkmcnt(7)
    ds_read_b128 v[148:151], v8 offset:20480
    v_mfma_f32_16x16x32_bf16 v[236:239], v[204:207], v[180:183], 0
    ds_read_b128 v[152:155], v9 offset:20480
    v_mfma_f32_16x16x32_bf16 v[236:239], v[208:211], v[184:187], v[236:239]
    ds_read_b128 v[140:143], v10 offset:16384
    s_waitcnt lgkmcnt(8)
    v_mfma_f32_16x16x32_bf16 v[224:227], v[196:199], v[172:175], 0
    ds_read_b128 v[144:147], v11 offset:16384
    v_mfma_f32_16x16x32_bf16 v[224:227], v[200:203], v[176:179], v[224:227]
    ds_read_b128 v[156:159], v10 offset:20480
    s_waitcnt lgkmcnt(8)
    ds_read_b128 v[160:163], v11 offset:20480
    v_mfma_f32_16x16x32_bf16 v[240:243], v[204:207], v[188:191], 0
    ds_read_b128 v[48:51], v12 offset:16384
    v_mfma_f32_16x16x32_bf16 v[240:243], v[208:211], v[192:195], v[240:243]
    v_cvt_pk_bf16_f32 v101, v228, v236
    v_cvt_pk_bf16_f32 v105, v229, v237
    v_cvt_pk_bf16_f32 v109, v230, v238
    v_cvt_pk_bf16_f32 v113, v231, v239
    s_mov_b32 exec_hi, 0
    v_cvt_pk_bf16_f32 v101, v212, v220
    v_cvt_pk_bf16_f32 v105, v213, v221
    v_cvt_pk_bf16_f32 v109, v214, v222
    v_cvt_pk_bf16_f32 v113, v215, v223
    s_mov_b32 exec_lo, 0xffff0000
    v_cvt_pk_bf16_f32 v253, v228, v236
    s_mov_b32 exec_lo, 0
    s_mov_b32 exec_hi, 0xffff0000
    v_cvt_pk_bf16_f32 v253, v212, v220
    s_mov_b64 exec, -1
    s_add_u32 m0, s26, 128000
    s_mov_b64 exec, s[60:61]
    s_mov_b32 s91, 13312
    buffer_load_dwordx4 v15, s[36:39], s91 offen lds
    s_mov_b64 exec, -1
    s_add_u32 m0, s26, 134656
    s_mov_b64 exec, s[60:61]
    s_mov_b32 s91, 19968
    buffer_load_dwordx4 v15, s[36:39], s91 offen lds
    s_mov_b64 exec, -1
    s_waitcnt lgkmcnt(7)
    v_mfma_f32_16x16x32_bf16 v[212:215], v[196:199], v[132:135], 0
    ds_read_b128 v[164:167], v8 offset:24576
    v_mfma_f32_16x16x32_bf16 v[212:215], v[200:203], v[136:139], v[212:215]
    ds_read_b128 v[168:171], v9 offset:24576
    s_waitcnt lgkmcnt(7)
    ds_read_b128 v[180:183], v8 offset:28672
    v_mfma_f32_16x16x32_bf16 v[228:231], v[204:207], v[148:151], 0
    ds_read_b128 v[184:187], v9 offset:28672
    v_mfma_f32_16x16x32_bf16 v[228:231], v[208:211], v[152:155], v[228:231]
    ds_read_b128 v[172:175], v10 offset:24576
    v_cvt_pk_bf16_f32 v117, v232, v240
    v_cvt_pk_bf16_f32 v121, v233, v241
    v_cvt_pk_bf16_f32 v125, v234, v242
    v_cvt_pk_bf16_f32 v129, v235, v243
    s_mov_b32 exec_hi, 0
    v_cvt_pk_bf16_f32 v117, v216, v224
    v_cvt_pk_bf16_f32 v121, v217, v225
    v_cvt_pk_bf16_f32 v125, v218, v226
    v_cvt_pk_bf16_f32 v129, v219, v227
    s_mov_b64 exec, -1
    s_waitcnt lgkmcnt(8)
    v_mfma_f32_16x16x32_bf16 v[216:219], v[196:199], v[140:143], 0
    ds_read_b128 v[176:179], v11 offset:24576
    v_mfma_f32_16x16x32_bf16 v[216:219], v[200:203], v[144:147], v[216:219]
    ds_read_b128 v[188:191], v10 offset:28672
    s_waitcnt lgkmcnt(8)
    ds_read_b128 v[192:195], v11 offset:28672
    v_mfma_f32_16x16x32_bf16 v[232:235], v[204:207], v[156:159], 0
    ds_read_b128 v[56:59], v12 offset:24576
    v_mfma_f32_16x16x32_bf16 v[232:235], v[208:211], v[160:163], v[232:235]
    v_permlane16_swap_b32 v101, v117
    v_permlane16_swap_b32 v105, v121
    v_permlane16_swap_b32 v109, v125
    v_permlane16_swap_b32 v113, v129
    s_add_u32 m0, s26, 141312
    s_mov_b64 exec, s[60:61]
    s_mov_b32 s91, 26624
    buffer_load_dwordx4 v15, s[36:39], s91 offen lds
    s_mov_b64 exec, -1
    s_add_u32 m0, s26, 147968
    s_mov_b64 exec, s[60:61]
    s_mov_b32 s91, 33280
    buffer_load_dwordx4 v15, s[36:39], s91 offen lds
    s_mov_b64 exec, -1
    s_waitcnt vmcnt(7)
    s_barrier
    s_waitcnt lgkmcnt(7)
    v_mfma_f32_16x16x32_bf16 v[220:223], v[196:199], v[164:167], 0
    ds_read_b128 v[132:135], v8 offset:32768
    v_mfma_f32_16x16x32_bf16 v[220:223], v[200:203], v[168:171], v[220:223]
    ds_read_b128 v[136:139], v9 offset:32768
    s_waitcnt lgkmcnt(7)
    ds_read_b128 v[148:151], v8 offset:36864
    v_mfma_f32_16x16x32_bf16 v[236:239], v[204:207], v[180:183], 0
    ds_read_b128 v[152:155], v9 offset:36864
    v_mfma_f32_16x16x32_bf16 v[236:239], v[208:211], v[184:187], v[236:239]
    ds_read_b128 v[140:143], v10 offset:32768
    s_waitcnt lgkmcnt(8)
    v_mfma_f32_16x16x32_bf16 v[224:227], v[196:199], v[172:175], 0
    ds_read_b128 v[144:147], v11 offset:32768
    v_mfma_f32_16x16x32_bf16 v[224:227], v[200:203], v[176:179], v[224:227]
    ds_read_b128 v[156:159], v10 offset:36864
    s_waitcnt lgkmcnt(8)
    ds_read_b128 v[160:163], v11 offset:36864
    v_mfma_f32_16x16x32_bf16 v[240:243], v[204:207], v[188:191], 0
    ds_read_b128 v[52:55], v12 offset:32768
    v_mfma_f32_16x16x32_bf16 v[240:243], v[208:211], v[192:195], v[240:243]
    v_cvt_pk_bf16_f32 v70, v228, v236
    v_cvt_pk_bf16_f32 v74, v229, v237
    v_cvt_pk_bf16_f32 v78, v230, v238
    v_cvt_pk_bf16_f32 v82, v231, v239
    s_mov_b32 exec_hi, 0
    v_cvt_pk_bf16_f32 v70, v212, v220
    v_cvt_pk_bf16_f32 v74, v213, v221
    v_cvt_pk_bf16_f32 v78, v214, v222
    v_cvt_pk_bf16_f32 v82, v215, v223
    s_mov_b32 exec_lo, 0xffff
    v_cvt_pk_bf16_f32 v254, v228, v236
    s_mov_b32 exec_lo, 0
    s_mov_b32 exec_hi, 0xffff
    v_cvt_pk_bf16_f32 v254, v212, v220
    s_mov_b64 exec, -1
    s_add_u32 m0, s26, 154624
    s_mov_b64 exec, s[60:61]
    s_mov_b32 s91, 39936
    buffer_load_dwordx4 v15, s[36:39], s91 offen lds
    s_mov_b64 exec, -1
    s_add_u32 m0, s26, 0
    s_mov_b64 exec, s[60:61]
    s_mov_b32 s91, 46592
    buffer_load_dwordx4 v15, s[36:39], s91 offen lds
    s_mov_b64 exec, -1
    s_waitcnt lgkmcnt(7)
    v_mfma_f32_16x16x32_bf16 v[212:215], v[196:199], v[132:135], 0
    ds_read_b128 v[164:167], v8 offset:40960
    v_mfma_f32_16x16x32_bf16 v[212:215], v[200:203], v[136:139], v[212:215]
    ds_read_b128 v[168:171], v9 offset:40960
    s_waitcnt lgkmcnt(7)
    ds_read_b128 v[180:183], v8 offset:45056
    v_mfma_f32_16x16x32_bf16 v[228:231], v[204:207], v[148:151], 0
    ds_read_b128 v[184:187], v9 offset:45056
    v_mfma_f32_16x16x32_bf16 v[228:231], v[208:211], v[152:155], v[228:231]
    ds_read_b128 v[172:175], v10 offset:40960
    v_cvt_pk_bf16_f32 v86, v232, v240
    v_cvt_pk_bf16_f32 v90, v233, v241
    v_cvt_pk_bf16_f32 v94, v234, v242
    v_cvt_pk_bf16_f32 v98, v235, v243
    s_mov_b32 exec_hi, 0
    v_cvt_pk_bf16_f32 v86, v216, v224
    v_cvt_pk_bf16_f32 v90, v217, v225
    v_cvt_pk_bf16_f32 v94, v218, v226
    v_cvt_pk_bf16_f32 v98, v219, v227
    s_mov_b64 exec, -1
    s_waitcnt lgkmcnt(8)
    v_mfma_f32_16x16x32_bf16 v[216:219], v[196:199], v[140:143], 0
    ds_read_b128 v[176:179], v11 offset:40960
    v_mfma_f32_16x16x32_bf16 v[216:219], v[200:203], v[144:147], v[216:219]
    ds_read_b128 v[188:191], v10 offset:45056
    s_waitcnt lgkmcnt(8)
    ds_read_b128 v[192:195], v11 offset:45056
    v_mfma_f32_16x16x32_bf16 v[232:235], v[204:207], v[156:159], 0
    ds_read_b128 v[60:63], v12 offset:40960
    v_mfma_f32_16x16x32_bf16 v[232:235], v[208:211], v[160:163], v[232:235]
    v_permlane16_swap_b32 v70, v86
    v_permlane16_swap_b32 v74, v90
    v_permlane16_swap_b32 v78, v94
    v_permlane16_swap_b32 v82, v98
    s_add_u32 m0, s26, 6656
    s_mov_b64 exec, s[60:61]
    s_mov_b32 s91, 53248
    buffer_load_dwordx4 v15, s[36:39], s91 offen lds
    s_mov_b64 exec, -1
    s_add_u32 m0, s26, 13312
    s_mov_b64 exec, s[60:61]
    s_mov_b32 s91, 59904
    buffer_load_dwordx4 v15, s[36:39], s91 offen lds
    s_mov_b64 exec, -1
    s_waitcnt vmcnt(3)
    s_barrier
    s_waitcnt lgkmcnt(7)
    v_mfma_f32_16x16x32_bf16 v[220:223], v[196:199], v[164:167], 0
    ds_read_b128 v[132:135], v8 offset:49152
    v_mfma_f32_16x16x32_bf16 v[220:223], v[200:203], v[168:171], v[220:223]
    ds_read_b128 v[136:139], v9 offset:49152
    s_waitcnt lgkmcnt(7)
    ds_read_b128 v[148:151], v8 offset:53248
    v_mfma_f32_16x16x32_bf16 v[236:239], v[204:207], v[180:183], 0
    ds_read_b128 v[152:155], v9 offset:53248
    v_mfma_f32_16x16x32_bf16 v[236:239], v[208:211], v[184:187], v[236:239]
    ds_read_b128 v[140:143], v10 offset:49152
    s_waitcnt lgkmcnt(8)
    v_mfma_f32_16x16x32_bf16 v[224:227], v[196:199], v[172:175], 0
    ds_read_b128 v[144:147], v11 offset:49152
    v_mfma_f32_16x16x32_bf16 v[224:227], v[200:203], v[176:179], v[224:227]
    ds_read_b128 v[156:159], v10 offset:53248
    s_waitcnt lgkmcnt(8)
    ds_read_b128 v[160:163], v11 offset:53248
    v_mfma_f32_16x16x32_bf16 v[240:243], v[204:207], v[188:191], 0
    ds_read_b128 v[64:67], v12 offset:49152
    v_mfma_f32_16x16x32_bf16 v[240:243], v[208:211], v[192:195], v[240:243]
    v_cvt_pk_bf16_f32 v102, v228, v236
    v_cvt_pk_bf16_f32 v106, v229, v237
    v_cvt_pk_bf16_f32 v110, v230, v238
    v_cvt_pk_bf16_f32 v114, v231, v239
    s_mov_b32 exec_hi, 0
    v_cvt_pk_bf16_f32 v102, v212, v220
    v_cvt_pk_bf16_f32 v106, v213, v221
    v_cvt_pk_bf16_f32 v110, v214, v222
    v_cvt_pk_bf16_f32 v114, v215, v223
    s_mov_b32 exec_lo, 0xffff0000
    v_cvt_pk_bf16_f32 v254, v228, v236
    s_mov_b32 exec_lo, 0
    s_mov_b32 exec_hi, 0xffff0000
    v_cvt_pk_bf16_f32 v254, v212, v220
    s_mov_b64 exec, -1
    s_add_u32 m0, s26, 19968
    s_mov_b64 exec, s[60:61]
    s_mov_b32 s91, 66560
    buffer_load_dwordx4 v15, s[36:39], s91 offen lds
    s_mov_b64 exec, -1
    s_add_u32 m0, s26, 26624
    s_mov_b64 exec, s[60:61]
    s_mov_b32 s91, 73216
    buffer_load_dwordx4 v15, s[36:39], s91 offen lds
    s_mov_b64 exec, -1
    s_add_u32 m0, s26, 33280
    s_mov_b64 exec, s[60:61]
    s_mov_b32 s91, 79872
    buffer_load_dwordx4 v15, s[36:39], s91 offen lds
    s_mov_b64 exec, -1
    s_waitcnt lgkmcnt(7)
    v_mfma_f32_16x16x32_bf16 v[212:215], v[196:199], v[132:135], 0
    v_add_u32 v250, 59904, v7
    v_mfma_f32_16x16x32_bf16 v[212:215], v[200:203], v[136:139], v[212:215]
    v_add_u32 v251, 119808, v7
    s_waitcnt lgkmcnt(5)
    ds_read_b128 v[164:167], v250 offset:54784
    v_mfma_f32_16x16x32_bf16 v[228:231], v[204:207], v[148:151], 0
    ds_read_b128 v[168:171], v251 offset:1536
    v_mfma_f32_16x16x32_bf16 v[228:231], v[208:211], v[152:155], v[228:231]
    ds_read_b128 v[172:175], v251 offset:8192
    v_cvt_pk_bf16_f32 v118, v232, v240
    v_cvt_pk_bf16_f32 v122, v233, v241
    v_cvt_pk_bf16_f32 v126, v234, v242
    v_cvt_pk_bf16_f32 v130, v235, v243
    s_mov_b32 exec_hi, 0
    v_cvt_pk_bf16_f32 v118, v216, v224
    v_cvt_pk_bf16_f32 v122, v217, v225
    v_cvt_pk_bf16_f32 v126, v218, v226
    v_cvt_pk_bf16_f32 v130, v219, v227
    s_mov_b64 exec, -1
    s_waitcnt lgkmcnt(6)
    v_mfma_f32_16x16x32_bf16 v[216:219], v[196:199], v[140:143], 0
    ds_read_b128 v[176:179], v251 offset:14848
    v_mfma_f32_16x16x32_bf16 v[216:219], v[200:203], v[144:147], v[216:219]
    ds_read_b128 v[180:183], v251 offset:21504
    s_waitcnt lgkmcnt(6)
    ds_read_b128 v[184:187], v251 offset:28160
    v_mfma_f32_16x16x32_bf16 v[232:235], v[204:207], v[156:159], 0
    ds_read_b128 v[188:191], v251 offset:34816
    v_mfma_f32_16x16x32_bf16 v[232:235], v[208:211], v[160:163], v[232:235]
    v_permlane16_swap_b32 v102, v118
    v_permlane16_swap_b32 v106, v122
    v_permlane16_swap_b32 v110, v126
    v_permlane16_swap_b32 v114, v130
    v_cvt_pk_bf16_f32 v71, v228, 0
    v_cvt_pk_bf16_f32 v75, v229, 0
    v_cvt_pk_bf16_f32 v79, v230, 0
    v_cvt_pk_bf16_f32 v83, v231, 0
    s_mov_b32 exec_hi, 0
    v_cvt_pk_bf16_f32 v71, v212, 0
    v_cvt_pk_bf16_f32 v75, v213, 0
    v_cvt_pk_bf16_f32 v79, v214, 0
    v_cvt_pk_bf16_f32 v83, v215, 0
    s_mov_b32 exec_lo, 0xffff
    v_cvt_pk_bf16_f32 v255, v228, 0
    s_mov_b32 exec_lo, 0
    s_mov_b32 exec_hi, 0xffff
    v_cvt_pk_bf16_f32 v255, v212, 0
    s_mov_b64 exec, -1
    v_cvt_pk_bf16_f32 v87, v232, 0
    v_cvt_pk_bf16_f32 v91, v233, 0
    v_cvt_pk_bf16_f32 v95, v234, 0
    v_cvt_pk_bf16_f32 v99, v235, 0
    s_mov_b32 exec_hi, 0
    v_cvt_pk_bf16_f32 v87, v216, 0
    v_cvt_pk_bf16_f32 v91, v217, 0
    v_cvt_pk_bf16_f32 v95, v218, 0
    v_cvt_pk_bf16_f32 v99, v219, 0
    s_mov_b64 exec, -1
    v_permlane16_swap_b32 v71, v87
    v_permlane16_swap_b32 v75, v91
    v_permlane16_swap_b32 v79, v95
    v_permlane16_swap_b32 v83, v99
    v_mov_b32 v8, v250
    v_mov_b32 v9, v251
    v_mfma_f32_16x16x32_bf16 v[236:239], v[244:247], v[252:255], 0
    v_mov_b32 v228, 0xbdd2d3e8
    s_and_b32 s91, s86, 2
    s_lshl_b32 s91, s91, 10
    s_and_b32 s92, s86, 1
    s_lshl_b32 s92, s92, 8
    s_add_u32 s91, s91, s92
    s_add_u32 s91, s91, 39936
    v_lshrrev_b32 v230, 4, v1
    v_lshl_add_u32 v230, v230, 9, s91
    v_and_b32 v231, 15, v1
    v_lshl_add_u32 v230, v231, 4, v230
    v_mul_f32 v240, v236, v236
    v_mul_f32 v241, v237, v237
    v_mul_f32 v242, v238, v238
    v_mul_f32 v243, v239, v239
    v_fmaak_f32 v240, v240, v228, 0xc0135761
    v_fmaak_f32 v241, v241, v228, 0xc0135761
    v_fmaak_f32 v242, v242, v228, 0xc0135761
    v_fmaak_f32 v243, v243, v228, 0xc0135761
    v_mul_f32 v240, v240, v236
    v_mul_f32 v241, v241, v237
    v_mul_f32 v242, v242, v238
    v_mul_f32 v243, v243, v239
    v_exp_f32 v240, v240
    v_exp_f32 v241, v241
    v_exp_f32 v242, v242
    v_exp_f32 v243, v243
    v_add_f32 v240, 1.0, v240
    v_add_f32 v241, 1.0, v241
    v_add_f32 v242, 1.0, v242
    v_add_f32 v243, 1.0, v243
    v_rcp_f32 v240, v240
    v_rcp_f32 v241, v241
    v_rcp_f32 v242, v242
    v_rcp_f32 v243, v243
    v_mul_f32 v240, v240, v236
    v_mul_f32 v241, v241, v237
    v_mul_f32 v242, v242, v238
    v_mul_f32 v243, v243, v239
    v_cvt_pk_bf16_f32 v232, v240, v241
    v_cvt_pk_bf16_f32 v233, v242, v243
    s_nop 1
    v_mfma_f32_16x16x16_bf16 v[236:239], v[4:5], v[232:233], 0
    s_nop 7
    v_mul_f32 v240, 0xbfb8aa3b, v236
    v_mul_f32 v241, 0xbfb8aa3b, v237
    v_mul_f32 v242, 0xbfb8aa3b, v238
    v_mul_f32 v243, 0xbfb8aa3b, v239
    v_exp_f32 v240, v240
    v_exp_f32 v241, v241
    v_exp_f32 v242, v242
    v_exp_f32 v243, v243
    v_add_f32 v240, 1.0, v240
    v_add_f32 v241, 1.0, v241
    v_add_f32 v242, 1.0, v242
    v_add_f32 v243, 1.0, v243
    v_rcp_f32 v240, v240
    v_rcp_f32 v241, v241
    v_rcp_f32 v242, v242
    v_rcp_f32 v243, v243
    v_cvt_pk_bf16_f32 v232, v240, v241
    v_cvt_pk_bf16_f32 v233, v242, v243
    v_and_b32 v234, 0xffff, v232
    v_lshrrev_b32 v235, 16, v232
    v_lshlrev_b32 v240, 16, v232
    v_and_b32 v241, 0xffff0000, v232
    v_lshlrev_b32 v242, 16, v233
    v_and_b32 v243, 0xffff0000, v233
    s_waitcnt vmcnt(0) lgkmcnt(7)
    ds_write_b64 v230, v[234:235] offset:4096
    ds_write_b128 v230, v[240:243]
    s_barrier
    ds_read_b128 v[192:195], v7 offset:0
    ds_read_b128 v[132:135], v7 offset:6656
    ds_read_b128 v[136:139], v7 offset:13312
    ds_read_b128 v[140:143], v7 offset:19968
    ds_read_b128 v[144:147], v7 offset:26624
    ds_read_b128 v[148:151], v7 offset:33280
    s_branch L_ct
L_r0:
    s_waitcnt vmcnt(4)
    s_barrier
    ds_read_b128 v[132:135], v8 offset:8192
    ds_read_b128 v[136:139], v9 offset:8192
    ds_read_b128 v[148:151], v8 offset:12288
    ds_read_b128 v[152:155], v9 offset:12288
    ds_read_b128 v[140:143], v10 offset:8192
    ds_read_b128 v[144:147], v11 offset:8192
    s_add_u32 m0, s89, 57344
    v_lshl_add_u32 v248, v248, 7, v3
    buffer_load_dwordx4 v248, s[32:35], 0 offen lds
    ds_read_b32 v248, v14 offset:64
    ds_read_b128 v[156:159], v10 offset:12288
    ds_read_b128 v[160:163], v11 offset:12288
    ds_read_b128 v[16:19], v12 offset:8192
    s_waitcnt lgkmcnt(8)
    v_mfma_f32_16x16x32_bf16 v[212:215], v[196:199], v[132:135], 0
    ds_read_b128 v[164:167], v8 offset:16384
    v_mfma_f32_16x16x32_bf16 v[212:215], v[200:203], v[136:139], v[212:215]
    ds_read_b128 v[168:171], v9 offset:16384
    s_waitcnt lgkmcnt(8)
    ds_read_b128 v[180:183], v8 offset:20480
    v_mfma_f32_16x16x32_bf16 v[212:215], v[204:207], v[148:151], v[212:215]
    ds_read_b128 v[184:187], v9 offset:20480
    v_mfma_f32_16x16x32_bf16 v[212:215], v[208:211], v[152:155], v[212:215]
    ds_read_b128 v[172:175], v10 offset:16384
    s_waitcnt lgkmcnt(9)
    v_mfma_f32_16x16x32_bf16 v[216:219], v[196:199], v[140:143], 0
    ds_read_b128 v[176:179], v11 offset:16384
    v_mfma_f32_16x16x32_bf16 v[216:219], v[200:203], v[144:147], v[216:219]
    ds_read_b128 v[188:191], v10 offset:20480
    s_waitcnt lgkmcnt(8)
    ds_read_b128 v[192:195], v11 offset:20480
    v_mfma_f32_16x16x32_bf16 v[216:219], v[204:207], v[156:159], v[216:219]
    ds_read_b128 v[24:27], v12 offset:16384
    v_mfma_f32_16x16x32_bf16 v[216:219], v[208:211], v[160:163], v[216:219]
    s_add_u32 m0, s89, 65536
    v_lshl_add_u32 v249, v249, 7, v3
    buffer_load_dwordx4 v249, s[32:35], 0 offen lds
    ds_read_b32 v249, v14 offset:72
    s_waitcnt vmcnt(4)
    s_barrier
    s_waitcnt lgkmcnt(8)
    v_mfma_f32_16x16x32_bf16 v[220:223], v[196:199], v[164:167], 0
    ds_read_b128 v[132:135], v8 offset:24576
    v_mfma_f32_16x16x32_bf16 v[220:223], v[200:203], v[168:171], v[220:223]
    ds_read_b128 v[136:139], v9 offset:24576
    s_waitcnt lgkmcnt(8)
    ds_read_b128 v[148:151], v8 offset:28672
    v_mfma_f32_16x16x32_bf16 v[220:223], v[204:207], v[180:183], v[220:223]
    ds_read_b128 v[152:155], v9 offset:28672
    v_mfma_f32_16x16x32_bf16 v[220:223], v[208:211], v[184:187], v[220:223]
    ds_read_b128 v[140:143], v10 offset:24576
    s_waitcnt lgkmcnt(9)
    v_mfma_f32_16x16x32_bf16 v[224:227], v[196:199], v[172:175], 0
    ds_read_b128 v[144:147], v11 offset:24576
    v_mfma_f32_16x16x32_bf16 v[224:227], v[200:203], v[176:179], v[224:227]
    ds_read_b128 v[156:159], v10 offset:28672
    s_waitcnt lgkmcnt(9)
    ds_read_b128 v[160:163], v11 offset:28672
    v_mfma_f32_16x16x32_bf16 v[224:227], v[204:207], v[188:191], v[224:227]
    ds_read_b128 v[32:35], v12 offset:24576
    v_mfma_f32_16x16x32_bf16 v[224:227], v[208:211], v[192:195], v[224:227]
    v_cvt_pk_bf16_f32 v68, v212, v220
    v_cvt_pk_bf16_f32 v72, v213, v221
    v_cvt_pk_bf16_f32 v76, v214, v222
    v_cvt_pk_bf16_f32 v80, v215, v223
    s_add_u32 m0, s89, 73728
    v_lshl_add_u32 v248, v248, 7, v3
    buffer_load_dwordx4 v248, s[32:35], 0 offen lds
    ds_read_b32 v248, v14 offset:80
    s_waitcnt lgkmcnt(8)
    v_mfma_f32_16x16x32_bf16 v[212:215], v[196:199], v[132:135], 0
    ds_read_b128 v[164:167], v8 offset:32768
    v_mfma_f32_16x16x32_bf16 v[212:215], v[200:203], v[136:139], v[212:215]
    ds_read_b128 v[168:171], v9 offset:32768
    s_waitcnt lgkmcnt(8)
    ds_read_b128 v[180:183], v8 offset:36864
    v_mfma_f32_16x16x32_bf16 v[212:215], v[204:207], v[148:151], v[212:215]
    ds_read_b128 v[184:187], v9 offset:36864
    v_mfma_f32_16x16x32_bf16 v[212:215], v[208:211], v[152:155], v[212:215]
    ds_read_b128 v[172:175], v10 offset:32768
    v_cvt_pk_bf16_f32 v84, v216, v224
    v_cvt_pk_bf16_f32 v88, v217, v225
    v_cvt_pk_bf16_f32 v92, v218, v226
    v_cvt_pk_bf16_f32 v96, v219, v227
    s_waitcnt lgkmcnt(9)
    v_mfma_f32_16x16x32_bf16 v[216:219], v[196:199], v[140:143], 0
    ds_read_b128 v[176:179], v11 offset:32768
    v_mfma_f32_16x16x32_bf16 v[216:219], v[200:203], v[144:147], v[216:219]
    ds_read_b128 v[188:191], v10 offset:36864
    s_waitcnt lgkmcnt(9)
    ds_read_b128 v[192:195], v11 offset:36864
    v_mfma_f32_16x16x32_bf16 v[216:219], v[204:207], v[156:159], v[216:219]
    ds_read_b128 v[40:43], v12 offset:32768
    v_mfma_f32_16x16x32_bf16 v[216:219], v[208:211], v[160:163], v[216:219]
    v_permlane16_swap_b32 v68, v84
    v_permlane16_swap_b32 v72, v88
    v_permlane16_swap_b32 v76, v92
    v_permlane16_swap_b32 v80, v96
    s_add_u32 m0, s89, 81920
    v_lshl_add_u32 v249, v249, 7, v3
    buffer_load_dwordx4 v249, s[32:35], 0 offen lds
    ds_read_b32 v249, v14 offset:88
    s_waitcnt vmcnt(4)
    s_barrier
    s_waitcnt lgkmcnt(8)
    v_mfma_f32_16x16x32_bf16 v[220:223], v[196:199], v[164:167], 0
    ds_read_b128 v[132:135], v8 offset:40960
    v_mfma_f32_16x16x32_bf16 v[220:223], v[200:203], v[168:171], v[220:223]
    ds_read_b128 v[136:139], v9 offset:40960
    s_waitcnt lgkmcnt(8)
    ds_read_b128 v[148:151], v8 offset:45056
    v_mfma_f32_16x16x32_bf16 v[220:223], v[204:207], v[180:183], v[220:223]
    ds_read_b128 v[152:155], v9 offset:45056
    v_mfma_f32_16x16x32_bf16 v[220:223], v[208:211], v[184:187], v[220:223]
    ds_read_b128 v[140:143], v10 offset:40960
    s_waitcnt lgkmcnt(9)
    v_mfma_f32_16x16x32_bf16 v[224:227], v[196:199], v[172:175], 0
    ds_read_b128 v[144:147], v11 offset:40960
    v_mfma_f32_16x16x32_bf16 v[224:227], v[200:203], v[176:179], v[224:227]
    ds_read_b128 v[156:159], v10 offset:45056
    s_waitcnt lgkmcnt(9)
    ds_read_b128 v[160:163], v11 offset:45056
    v_mfma_f32_16x16x32_bf16 v[224:227], v[204:207], v[188:191], v[224:227]
    ds_read_b128 v[20:23], v12 offset:40960
    v_mfma_f32_16x16x32_bf16 v[224:227], v[208:211], v[192:195], v[224:227]
    v_cvt_pk_bf16_f32 v69, v212, v220
    v_cvt_pk_bf16_f32 v73, v213, v221
    v_cvt_pk_bf16_f32 v77, v214, v222
    v_cvt_pk_bf16_f32 v81, v215, v223
    s_add_u32 m0, s89, 90112
    v_lshl_add_u32 v248, v248, 7, v3
    buffer_load_dwordx4 v248, s[32:35], 0 offen lds
    ds_read_b32 v248, v14 offset:96
    s_waitcnt lgkmcnt(8)
    v_mfma_f32_16x16x32_bf16 v[212:215], v[196:199], v[132:135], 0
    ds_read_b128 v[164:167], v8 offset:49152
    v_mfma_f32_16x16x32_bf16 v[212:215], v[200:203], v[136:139], v[212:215]
    ds_read_b128 v[168:171], v9 offset:49152
    s_waitcnt lgkmcnt(8)
    ds_read_b128 v[180:183], v8 offset:53248
    v_mfma_f32_16x16x32_bf16 v[212:215], v[204:207], v[148:151], v[212:215]
    ds_read_b128 v[184:187], v9 offset:53248
    v_mfma_f32_16x16x32_bf16 v[212:215], v[208:211], v[152:155], v[212:215]
    ds_read_b128 v[172:175], v10 offset:49152
    v_cvt_pk_bf16_f32 v85, v216, v224
    v_cvt_pk_bf16_f32 v89, v217, v225
    v_cvt_pk_bf16_f32 v93, v218, v226
    v_cvt_pk_bf16_f32 v97, v219, v227
    s_waitcnt lgkmcnt(9)
    v_mfma_f32_16x16x32_bf16 v[216:219], v[196:199], v[140:143], 0
    ds_read_b128 v[176:179], v11 offset:49152
    v_mfma_f32_16x16x32_bf16 v[216:219], v[200:203], v[144:147], v[216:219]
    ds_read_b128 v[188:191], v10 offset:53248
    s_waitcnt lgkmcnt(9)
    ds_read_b128 v[192:195], v11 offset:53248
    v_mfma_f32_16x16x32_bf16 v[216:219], v[204:207], v[156:159], v[216:219]
    ds_read_b128 v[28:31], v12 offset:49152
    v_mfma_f32_16x16x32_bf16 v[216:219], v[208:211], v[160:163], v[216:219]
    v_permlane16_swap_b32 v69, v85
    v_permlane16_swap_b32 v73, v89
    v_permlane16_swap_b32 v77, v93
    v_permlane16_swap_b32 v81, v97
    s_add_u32 m0, s89, 98304
    v_lshl_add_u32 v249, v249, 7, v3
    buffer_load_dwordx4 v249, s[32:35], 0 offen lds
    v_add_u32 v8, 57344, v8
    v_add_u32 v9, 57344, v9
    v_add_u32 v10, 57344, v10
    v_add_u32 v11, 57344, v11
    v_add_u32 v12, 57344, v12
    s_waitcnt vmcnt(4)
    s_barrier
    s_waitcnt lgkmcnt(7)
    v_mfma_f32_16x16x32_bf16 v[220:223], v[196:199], v[164:167], 0
    ds_read_b128 v[132:135], v8 offset:0
    v_mfma_f32_16x16x32_bf16 v[220:223], v[200:203], v[168:171], v[220:223]
    ds_read_b128 v[136:139], v9 offset:0
    s_waitcnt lgkmcnt(7)
    ds_read_b128 v[148:151], v8 offset:4096
    v_mfma_f32_16x16x32_bf16 v[220:223], v[204:207], v[180:183], v[220:223]
    ds_read_b128 v[152:155], v9 offset:4096
    v_mfma_f32_16x16x32_bf16 v[220:223], v[208:211], v[184:187], v[220:223]
    ds_read_b128 v[140:143], v10 offset:0
    s_waitcnt lgkmcnt(8)
    v_mfma_f32_16x16x32_bf16 v[224:227], v[196:199], v[172:175], 0
    ds_read_b128 v[144:147], v11 offset:0
    v_mfma_f32_16x16x32_bf16 v[224:227], v[200:203], v[176:179], v[224:227]
    ds_read_b128 v[156:159], v10 offset:4096
    s_waitcnt lgkmcnt(8)
    ds_read_b128 v[160:163], v11 offset:4096
    v_mfma_f32_16x16x32_bf16 v[224:227], v[204:207], v[188:191], v[224:227]
    ds_read_b128 v[36:39], v12 offset:0
    v_mfma_f32_16x16x32_bf16 v[224:227], v[208:211], v[192:195], v[224:227]
    v_cvt_pk_bf16_f32 v100, v212, v220
    v_cvt_pk_bf16_f32 v104, v213, v221
    v_cvt_pk_bf16_f32 v108, v214, v222
    v_cvt_pk_bf16_f32 v112, v215, v223
    s_add_u32 m0, s89, 106496
    v_lshl_add_u32 v248, v248, 7, v3
    buffer_load_dwordx4 v248, s[32:35], 0 offen lds
    s_waitcnt lgkmcnt(7)
    v_mfma_f32_16x16x32_bf16 v[212:215], v[196:199], v[132:135], 0
    ds_read_b128 v[164:167], v8 offset:8192
    v_mfma_f32_16x16x32_bf16 v[212:215], v[200:203], v[136:139], v[212:215]
    ds_read_b128 v[168:171], v9 offset:8192
    s_waitcnt lgkmcnt(7)
    ds_read_b128 v[180:183], v8 offset:12288
    v_mfma_f32_16x16x32_bf16 v[212:215], v[204:207], v[148:151], v[212:215]
    ds_read_b128 v[184:187], v9 offset:12288
    v_mfma_f32_16x16x32_bf16 v[212:215], v[208:211], v[152:155], v[212:215]
    ds_read_b128 v[172:175], v10 offset:8192
    v_cvt_pk_bf16_f32 v116, v216, v224
    v_cvt_pk_bf16_f32 v120, v217, v225
    v_cvt_pk_bf16_f32 v124, v218, v226
    v_cvt_pk_bf16_f32 v128, v219, v227
    s_waitcnt lgkmcnt(8)
    v_mfma_f32_16x16x32_bf16 v[216:219], v[196:199], v[140:143], 0
    ds_read_b128 v[176:179], v11 offset:8192
    v_mfma_f32_16x16x32_bf16 v[216:219], v[200:203], v[144:147], v[216:219]
    ds_read_b128 v[188:191], v10 offset:12288
    s_waitcnt lgkmcnt(8)
    ds_read_b128 v[192:195], v11 offset:12288
    v_mfma_f32_16x16x32_bf16 v[216:219], v[204:207], v[156:159], v[216:219]
    ds_read_b128 v[44:47], v12 offset:8192
    v_mfma_f32_16x16x32_bf16 v[216:219], v[208:211], v[160:163], v[216:219]
    v_permlane16_swap_b32 v100, v116
    v_permlane16_swap_b32 v104, v120
    v_permlane16_swap_b32 v108, v124
    v_permlane16_swap_b32 v112, v128
    s_add_u32 m0, s26, 114688
    s_mov_b64 exec, s[60:61]
    s_mov_b32 s91, 0
    buffer_load_dwordx4 v15, s[36:39], s91 offen lds
    s_mov_b64 exec, -1
    s_add_u32 m0, s26, 121344
    s_mov_b64 exec, s[60:61]
    s_mov_b32 s91, 6656
    buffer_load_dwordx4 v15, s[36:39], s91 offen lds
    s_mov_b64 exec, -1
    s_waitcnt vmcnt(5)
    s_barrier
    s_waitcnt lgkmcnt(7)
    v_mfma_f32_16x16x32_bf16 v[220:223], v[196:199], v[164:167], 0
    ds_read_b128 v[132:135], v8 offset:16384
    v_mfma_f32_16x16x32_bf16 v[220:223], v[200:203], v[168:171], v[220:223]
    ds_read_b128 v[136:139], v9 offset:16384
    s_waitcnt lgkmcnt(7)
    ds_read_b128 v[148:151], v8 offset:20480
    v_mfma_f32_16x16x32_bf16 v[220:223], v[204:207], v[180:183], v[220:223]
    ds_read_b128 v[152:155], v9 offset:20480
    v_mfma_f32_16x16x32_bf16 v[220:223], v[208:211], v[184:187], v[220:223]
    ds_read_b128 v[140:143], v10 offset:16384
    s_waitcnt lgkmcnt(8)
    v_mfma_f32_16x16x32_bf16 v[224:227], v[196:199], v[172:175], 0
    ds_read_b128 v[144:147], v11 offset:16384
    v_mfma_f32_16x16x32_bf16 v[224:227], v[200:203], v[176:179], v[224:227]
    ds_read_b128 v[156:159], v10 offset:20480
    s_waitcnt lgkmcnt(8)
    ds_read_b128 v[160:163], v11 offset:20480
    v_mfma_f32_16x16x32_bf16 v[224:227], v[204:207], v[188:191], v[224:227]
    ds_read_b128 v[48:51], v12 offset:16384
    v_mfma_f32_16x16x32_bf16 v[224:227], v[208:211], v[192:195], v[224:227]
    v_cvt_pk_bf16_f32 v101, v212, v220
    v_cvt_pk_bf16_f32 v105, v213, v221
    v_cvt_pk_bf16_f32 v109, v214, v222
    v_cvt_pk_bf16_f32 v113, v215, v223
    s_add_u32 m0, s26, 128000
    s_mov_b64 exec, s[60:61]
    s_mov_b32 s91, 13312
    buffer_load_dwordx4 v15, s[36:39], s91 offen lds
    s_mov_b64 exec, -1
    s_add_u32 m0, s26, 134656
    s_mov_b64 exec, s[60:61]
    s_mov_b32 s91, 19968
    buffer_load_dwordx4 v15, s[36:39], s91 offen lds
    s_mov_b64 exec, -1
    s_waitcnt lgkmcnt(7)
    v_mfma_f32_16x16x32_bf16 v[212:215], v[196:199], v[132:135], 0
    ds_read_b128 v[164:167], v8 offset:24576
    v_mfma_f32_16x16x32_bf16 v[212:215], v[200:203], v[136:139], v[212:215]
    ds_read_b128 v[168:171], v9 offset:24576
    s_waitcnt lgkmcnt(7)
    ds_read_b128 v[180:183], v8 offset:28672
    v_mfma_f32_16x16x32_bf16 v[212:215], v[204:207], v[148:151], v[212:215]
    ds_read_b128 v[184:187], v9 offset:28672
    v_mfma_f32_16x16x32_bf16 v[212:215], v[208:211], v[152:155], v[212:215]
    ds_read_b128 v[172:175], v10 offset:24576
    v_cvt_pk_bf16_f32 v117, v216, v224
    v_cvt_pk_bf16_f32 v121, v217, v225
    v_cvt_pk_bf16_f32 v125, v218, v226
    v_cvt_pk_bf16_f32 v129, v219, v227
    s_waitcnt lgkmcnt(8)
    v_mfma_f32_16x16x32_bf16 v[216:219], v[196:199], v[140:143], 0
    ds_read_b128 v[176:179], v11 offset:24576
    v_mfma_f32_16x16x32_bf16 v[216:219], v[200:203], v[144:147], v[216:219]
    ds_read_b128 v[188:191], v10 offset:28672
    s_waitcnt lgkmcnt(8)
    ds_read_b128 v[192:195], v11 offset:28672
    v_mfma_f32_16x16x32_bf16 v[216:219], v[204:207], v[156:159], v[216:219]
    ds_read_b128 v[56:59], v12 offset:24576
    v_mfma_f32_16x16x32_bf16 v[216:219], v[208:211], v[160:163], v[216:219]
    v_permlane16_swap_b32 v101, v117
    v_permlane16_swap_b32 v105, v121
    v_permlane16_swap_b32 v109, v125
    v_permlane16_swap_b32 v113, v129
    s_add_u32 m0, s26, 141312
    s_mov_b64 exec, s[60:61]
    s_mov_b32 s91, 26624
    buffer_load_dwordx4 v15, s[36:39], s91 offen lds
    s_mov_b64 exec, -1
    s_add_u32 m0, s26, 147968
    s_mov_b64 exec, s[60:61]
    s_mov_b32 s91, 33280
    buffer_load_dwordx4 v15, s[36:39], s91 offen lds
    s_mov_b64 exec, -1
    s_waitcnt vmcnt(7)
    s_barrier
    s_waitcnt lgkmcnt(7)
    v_mfma_f32_16x16x32_bf16 v[220:223], v[196:199], v[164:167], 0
    ds_read_b128 v[132:135], v8 offset:32768
    v_mfma_f32_16x16x32_bf16 v[220:223], v[200:203], v[168:171], v[220:223]
    ds_read_b128 v[136:139], v9 offset:32768
    s_waitcnt lgkmcnt(7)
    ds_read_b128 v[148:151], v8 offset:36864
    v_mfma_f32_16x16x32_bf16 v[220:223], v[204:207], v[180:183], v[220:223]
    ds_read_b128 v[152:155], v9 offset:36864
    v_mfma_f32_16x16x32_bf16 v[220:223], v[208:211], v[184:187], v[220:223]
    ds_read_b128 v[140:143], v10 offset:32768
    s_waitcnt lgkmcnt(8)
    v_mfma_f32_16x16x32_bf16 v[224:227], v[196:199], v[172:175], 0
    ds_read_b128 v[144:147], v11 offset:32768
    v_mfma_f32_16x16x32_bf16 v[224:227], v[200:203], v[176:179], v[224:227]
    ds_read_b128 v[156:159], v10 offset:36864
    s_waitcnt lgkmcnt(8)
    ds_read_b128 v[160:163], v11 offset:36864
    v_mfma_f32_16x16x32_bf16 v[224:227], v[204:207], v[188:191], v[224:227]
    ds_read_b128 v[52:55], v12 offset:32768
    v_mfma_f32_16x16x32_bf16 v[224:227], v[208:211], v[192:195], v[224:227]
    v_cvt_pk_bf16_f32 v70, v212, v220
    v_cvt_pk_bf16_f32 v74, v213, v221
    v_cvt_pk_bf16_f32 v78, v214, v222
    v_cvt_pk_bf16_f32 v82, v215, v223
    s_add_u32 m0, s26, 154624
    s_mov_b64 exec, s[60:61]
    s_mov_b32 s91, 39936
    buffer_load_dwordx4 v15, s[36:39], s91 offen lds
    s_mov_b64 exec, -1
    s_add_u32 m0, s26, 0
    s_mov_b64 exec, s[60:61]
    s_mov_b32 s91, 46592
    buffer_load_dwordx4 v15, s[36:39], s91 offen lds
    s_mov_b64 exec, -1
    s_waitcnt lgkmcnt(7)
    v_mfma_f32_16x16x32_bf16 v[212:215], v[196:199], v[132:135], 0
    ds_read_b128 v[164:167], v8 offset:40960
    v_mfma_f32_16x16x32_bf16 v[212:215], v[200:203], v[136:139], v[212:215]
    ds_read_b128 v[168:171], v9 offset:40960
    s_waitcnt lgkmcnt(7)
    ds_read_b128 v[180:183], v8 offset:45056
    v_mfma_f32_16x16x32_bf16 v[212:215], v[204:207], v[148:151], v[212:215]
    ds_read_b128 v[184:187], v9 offset:45056
    v_mfma_f32_16x16x32_bf16 v[212:215], v[208:211], v[152:155], v[212:215]
    ds_read_b128 v[172:175], v10 offset:40960
    v_cvt_pk_bf16_f32 v86, v216, v224
    v_cvt_pk_bf16_f32 v90, v217, v225
    v_cvt_pk_bf16_f32 v94, v218, v226
    v_cvt_pk_bf16_f32 v98, v219, v227
    s_waitcnt lgkmcnt(8)
    v_mfma_f32_16x16x32_bf16 v[216:219], v[196:199], v[140:143], 0
    ds_read_b128 v[176:179], v11 offset:40960
    v_mfma_f32_16x16x32_bf16 v[216:219], v[200:203], v[144:147], v[216:219]
    ds_read_b128 v[188:191], v10 offset:45056
    s_waitcnt lgkmcnt(8)
    ds_read_b128 v[192:195], v11 offset:45056
    v_mfma_f32_16x16x32_bf16 v[216:219], v[204:207], v[156:159], v[216:219]
    ds_read_b128 v[60:63], v12 offset:40960
    v_mfma_f32_16x16x32_bf16 v[216:219], v[208:211], v[160:163], v[216:219]
    v_permlane16_swap_b32 v70, v86
    v_permlane16_swap_b32 v74, v90
    v_permlane16_swap_b32 v78, v94
    v_permlane16_swap_b32 v82, v98
    s_add_u32 m0, s26, 6656
    s_mov_b64 exec, s[60:61]
    s_mov_b32 s91, 53248
    buffer_load_dwordx4 v15, s[36:39], s91 offen lds
    s_mov_b64 exec, -1
    s_add_u32 m0, s26, 13312
    s_mov_b64 exec, s[60:61]
    s_mov_b32 s91, 59904
    buffer_load_dwordx4 v15, s[36:39], s91 offen lds
    s_mov_b64 exec, -1
    s_waitcnt vmcnt(3)
    s_barrier
    s_waitcnt lgkmcnt(7)
    v_mfma_f32_16x16x32_bf16 v[220:223], v[196:199], v[164:167], 0
    ds_read_b128 v[132:135], v8 offset:49152
    v_mfma_f32_16x16x32_bf16 v[220:223], v[200:203], v[168:171], v[220:223]
    ds_read_b128 v[136:139], v9 offset:49152
    s_waitcnt lgkmcnt(7)
    ds_read_b128 v[148:151], v8 offset:53248
    v_mfma_f32_16x16x32_bf16 v[220:223], v[204:207], v[180:183], v[220:223]
    ds_read_b128 v[152:155], v9 offset:53248
    v_mfma_f32_16x16x32_bf16 v[220:223], v[208:211], v[184:187], v[220:223]
    ds_read_b128 v[140:143], v10 offset:49152
    s_waitcnt lgkmcnt(8)
    v_mfma_f32_16x16x32_bf16 v[224:227], v[196:199], v[172:175], 0
    ds_read_b128 v[144:147], v11 offset:49152
    v_mfma_f32_16x16x32_bf16 v[224:227], v[200:203], v[176:179], v[224:227]
    ds_read_b128 v[156:159], v10 offset:53248
    s_waitcnt lgkmcnt(8)
    ds_read_b128 v[160:163], v11 offset:53248
    v_mfma_f32_16x16x32_bf16 v[224:227], v[204:207], v[188:191], v[224:227]
    ds_read_b128 v[64:67], v12 offset:49152
    v_mfma_f32_16x16x32_bf16 v[224:227], v[208:211], v[192:195], v[224:227]
    v_cvt_pk_bf16_f32 v102, v212, v220
    v_cvt_pk_bf16_f32 v106, v213, v221
    v_cvt_pk_bf16_f32 v110, v214, v222
    v_cvt_pk_bf16_f32 v114, v215, v223
    s_add_u32 m0, s26, 19968
    s_mov_b64 exec, s[60:61]
    s_mov_b32 s91, 66560
    buffer_load_dwordx4 v15, s[36:39], s91 offen lds
    s_mov_b64 exec, -1
    s_add_u32 m0, s26, 26624
    s_mov_b64 exec, s[60:61]
    s_mov_b32 s91, 73216
    buffer_load_dwordx4 v15, s[36:39], s91 offen lds
    s_mov_b64 exec, -1
    s_add_u32 m0, s26, 33280
    s_mov_b64 exec, s[60:61]
    s_mov_b32 s91, 79872
    buffer_load_dwordx4 v15, s[36:39], s91 offen lds
    s_mov_b64 exec, -1
    s_waitcnt lgkmcnt(7)
    v_mfma_f32_16x16x32_bf16 v[212:215], v[196:199], v[132:135], 0
    v_add_u32 v250, 59904, v7
    v_mfma_f32_16x16x32_bf16 v[212:215], v[200:203], v[136:139], v[212:215]
    v_add_u32 v251, 119808, v7
    s_waitcnt lgkmcnt(5)
    ds_read_b128 v[164:167], v250 offset:54784
    v_mfma_f32_16x16x32_bf16 v[212:215], v[204:207], v[148:151], v[212:215]
    ds_read_b128 v[168:171], v251 offset:1536
    v_mfma_f32_16x16x32_bf16 v[212:215], v[208:211], v[152:155], v[212:215]
    ds_read_b128 v[172:175], v251 offset:8192
    v_cvt_pk_bf16_f32 v118, v216, v224
    v_cvt_pk_bf16_f32 v122, v217, v225
    v_cvt_pk_bf16_f32 v126, v218, v226
    v_cvt_pk_bf16_f32 v130, v219, v227
    s_waitcnt lgkmcnt(6)
    v_mfma_f32_16x16x32_bf16 v[216:219], v[196:199], v[140:143], 0
    ds_read_b128 v[176:179], v251 offset:14848
    v_mfma_f32_16x16x32_bf16 v[216:219], v[200:203], v[144:147], v[216:219]
    ds_read_b128 v[180:183], v251 offset:21504
    s_waitcnt lgkmcnt(6)
    ds_read_b128 v[184:187], v251 offset:28160
    v_mfma_f32_16x16x32_bf16 v[216:219], v[204:207], v[156:159], v[216:219]
    ds_read_b128 v[188:191], v251 offset:34816
    v_mfma_f32_16x16x32_bf16 v[216:219], v[208:211], v[160:163], v[216:219]
    v_permlane16_swap_b32 v102, v118
    v_permlane16_swap_b32 v106, v122
    v_permlane16_swap_b32 v110, v126
    v_permlane16_swap_b32 v114, v130
    v_cvt_pk_bf16_f32 v71, v212, 0
    v_cvt_pk_bf16_f32 v75, v213, 0
    v_cvt_pk_bf16_f32 v79, v214, 0
    v_cvt_pk_bf16_f32 v83, v215, 0
    v_cvt_pk_bf16_f32 v87, v216, 0
    v_cvt_pk_bf16_f32 v91, v217, 0
    v_cvt_pk_bf16_f32 v95, v218, 0
    v_cvt_pk_bf16_f32 v99, v219, 0
    v_permlane16_swap_b32 v71, v87
    v_permlane16_swap_b32 v75, v91
    v_permlane16_swap_b32 v79, v95
    v_permlane16_swap_b32 v83, v99
    v_mov_b32 v8, v250
    v_mov_b32 v9, v251
    s_waitcnt vmcnt(0) lgkmcnt(7)
    s_barrier
    ds_read_b128 v[192:195], v7 offset:0
    ds_read_b128 v[132:135], v7 offset:6656
    ds_read_b128 v[136:139], v7 offset:13312
    ds_read_b128 v[140:143], v7 offset:19968
    ds_read_b128 v[144:147], v7 offset:26624
    ds_read_b128 v[148:151], v7 offset:33280
L_ct:
    s_setprio 3
    v_mov_b32 v159, 0
    v_mov_b32 v199, 0
    v_mov_b32 v207, 0
    v_mov_b32 v4, 0
    v_mov_b32 v5, 0
    s_waitcnt lgkmcnt(11)
    v_perm_b32 v152, v168, v164, s94
    s_waitcnt lgkmcnt(9)
    v_perm_b32 v153, v176, v172, s94
    s_waitcnt lgkmcnt(7)
    v_perm_b32 v156, v184, v180, s94
    s_waitcnt lgkmcnt(5)
    v_perm_b32 v157, v192, v188, s94
    s_waitcnt lgkmcnt(3)
    v_perm_b32 v154, v136, v132, s94
    s_waitcnt lgkmcnt(1)
    v_perm_b32 v158, v144, v140, s94
    s_waitcnt lgkmcnt(0)
    v_and_b32 v155, 0xffff, v148
    s_nop 1
    v_mfma_f32_32x32x16_bf16 v[208:223], v[152:155], v[68:71], 0
    v_perm_b32 v160, v168, v164, s95
    v_perm_b32 v161, v176, v172, s95
    v_perm_b32 v196, v184, v180, s95
    v_perm_b32 v197, v192, v188, s95
    v_perm_b32 v162, v136, v132, s95
    v_perm_b32 v198, v144, v140, s95
    v_lshrrev_b32 v163, 16, v148
    v_mfma_f32_32x32x16_bf16 v[208:223], v[156:159], v[100:103], v[208:223]
    v_perm_b32 v200, v169, v165, s94
    v_perm_b32 v201, v177, v173, s94
    v_perm_b32 v204, v185, v181, s94
    v_perm_b32 v205, v193, v189, s94
    v_perm_b32 v202, v137, v133, s94
    v_perm_b32 v206, v145, v141, s94
    v_and_b32 v203, 0xffff, v149
    v_mfma_f32_32x32x16_bf16 v[240:255], v[160:163], v[72:75], 0
    v_perm_b32 v152, v169, v165, s95
    v_perm_b32 v153, v177, v173, s95
    v_perm_b32 v156, v185, v181, s95
    v_mfma_f32_32x32x16_bf16 v[240:255], v[196:199], v[104:107], v[240:255]
    v_perm_b32 v157, v193, v189, s95
    v_perm_b32 v154, v137, v133, s95
    s_setprio 2
    v_perm_b32 v158, v145, v141, s95
    v_lshrrev_b32 v155, 16, v149
    v_mfma_f32_32x32x16_bf16 v[224:239], v[200:203], v[76:79], 0
    v_perm_b32 v160, v170, v166, s94
    v_perm_b32 v161, v178, v174, s94
    v_perm_b32 v196, v186, v182, s94
    v_perm_b32 v197, v194, v190, s94
    v_perm_b32 v162, v138, v134, s94
    v_perm_b32 v198, v146, v142, s94
    v_and_b32 v163, 0xffff, v150
    v_mfma_f32_32x32x16_bf16 v[224:239], v[204:207], v[108:111], v[224:239]
    v_cvt_pk_bf16_f32 v208, v208, v240
    v_cvt_pk_bf16_f32 v209, v209, v241
    v_cvt_pk_bf16_f32 v210, v210, v242
    v_cvt_pk_bf16_f32 v211, v211, v243
    v_cvt_pk_bf16_f32 v212, v212, v244
    v_cvt_pk_bf16_f32 v213, v213, v245
    v_cvt_pk_bf16_f32 v214, v214, v246
    v_cvt_pk_bf16_f32 v215, v215, v247
    v_cvt_pk_bf16_f32 v216, v216, v248
    v_cvt_pk_bf16_f32 v217, v217, v249
    v_cvt_pk_bf16_f32 v218, v218, v250
    v_cvt_pk_bf16_f32 v219, v219, v251
    v_cvt_pk_bf16_f32 v220, v220, v252
    v_mfma_f32_32x32x16_bf16 v[240:255], v[152:155], v[80:83], 0
    v_perm_b32 v200, v170, v166, s95
    v_perm_b32 v201, v178, v174, s95
    v_perm_b32 v204, v186, v182, s95
    v_mfma_f32_32x32x16_bf16 v[240:255], v[156:159], v[112:115], v[240:255]
    v_perm_b32 v205, v194, v190, s95
    v_perm_b32 v202, v138, v134, s95
    v_perm_b32 v206, v146, v142, s95
    v_lshrrev_b32 v203, 16, v150
    v_dot2c_f32_bf16 v4, v208, v16
    v_dot2c_f32_bf16 v5, v209, v20
    s_add_u32 m0, s26, 48128
    s_mov_b64 exec, s[60:61]
    s_mov_b32 s91, 86528
    buffer_load_dwordx4 v15, s[36:39], s91 offen lds
    s_mov_b64 exec, -1
    s_add_u32 m0, s26, 54784
    s_mov_b64 exec, s[60:61]
    s_mov_b32 s91, 93184
    buffer_load_dwordx4 v15, s[36:39], s91 offen lds
    s_mov_b64 exec, -1
    v_dot2c_f32_bf16 v4, v210, v24
    v_dot2c_f32_bf16 v5, v211, v28
    s_setprio 1
    v_dot2c_f32_bf16 v4, v212, v32
    v_dot2c_f32_bf16 v5, v213, v36
    v_dot2c_f32_bf16 v4, v214, v40
    v_dot2c_f32_bf16 v5, v215, v44
    s_add_u32 m0, s26, 61440
    s_mov_b64 exec, s[60:61]
    s_mov_b32 s91, 99840
    buffer_load_dwordx4 v15, s[36:39], s91 offen lds
    s_mov_b64 exec, -1
    s_add_u32 m0, s26, 68096
    s_mov_b64 exec, s[60:61]
    s_mov_b32 s91, 106496
    buffer_load_dwordx4 v15, s[36:39], s91 offen lds
    s_mov_b64 exec, -1
    v_dot2c_f32_bf16 v4, v216, v48
    v_dot2c_f32_bf16 v5, v217, v52
    v_dot2c_f32_bf16 v4, v218, v56
    v_dot2c_f32_bf16 v5, v219, v60
    v_dot2c_f32_bf16 v4, v220, v64
    v_mfma_f32_32x32x16_bf16 v[208:223], v[160:163], v[84:87], 0
    v_cvt_pk_bf16_f32 v224, v224, v240
    v_cvt_pk_bf16_f32 v225, v225, v241
    v_cvt_pk_bf16_f32 v226, v226, v242
    v_cvt_pk_bf16_f32 v227, v227, v243
    v_cvt_pk_bf16_f32 v228, v228, v244
    v_cvt_pk_bf16_f32 v229, v229, v245
    v_cvt_pk_bf16_f32 v230, v230, v246
    v_mfma_f32_32x32x16_bf16 v[208:223], v[196:199], v[116:119], v[208:223]
    v_cvt_pk_bf16_f32 v231, v231, v247
    v_cvt_pk_bf16_f32 v232, v232, v248
    v_cvt_pk_bf16_f32 v233, v233, v249
    v_cvt_pk_bf16_f32 v234, v234, v250
    v_cvt_pk_bf16_f32 v235, v235, v251
    v_cvt_pk_bf16_f32 v236, v236, v252
    v_mfma_f32_32x32x16_bf16 v[240:255], v[200:203], v[88:91], 0
    v_perm_b32 v152, v171, v167, s94
    v_perm_b32 v153, v179, v175, s94
    v_perm_b32 v156, v187, v183, s94
    v_perm_b32 v157, v195, v191, s94
    v_perm_b32 v154, v139, v135, s94
    v_perm_b32 v158, v147, v143, s94
    v_and_b32 v155, 0xffff, v151
    v_mfma_f32_32x32x16_bf16 v[240:255], v[204:207], v[120:123], v[240:255]
    v_perm_b32 v160, v171, v167, s95
    v_perm_b32 v161, v179, v175, s95
    v_perm_b32 v196, v187, v183, s95
    v_perm_b32 v197, v195, v191, s95
    v_perm_b32 v162, v139, v135, s95
    v_perm_b32 v198, v147, v143, s95
    s_setprio 0
    v_lshrrev_b32 v163, 16, v151
    v_dot2c_f32_bf16 v4, v224, v17
    v_dot2c_f32_bf16 v5, v225, v21
    s_add_u32 m0, s26, 74752
    s_mov_b64 exec, s[60:61]
    s_mov_b32 s91, 113152
    buffer_load_dwordx4 v15, s[36:39], s91 offen lds
    s_mov_b64 exec, -1
    s_add_u32 m0, s26, 81408
    s_mov_b64 exec, s[60:61]
    s_mov_b32 s91, 119808
    buffer_load_dwordx4 v15, s[36:39], s91 offen lds
    s_mov_b64 exec, -1
    v_dot2c_f32_bf16 v4, v226, v25
    v_dot2c_f32_bf16 v5, v227, v29
    v_dot2c_f32_bf16 v4, v228, v33
    v_dot2c_f32_bf16 v5, v229, v37
    v_dot2c_f32_bf16 v4, v230, v41
    v_dot2c_f32_bf16 v5, v231, v45
    s_add_u32 m0, s26, 88064
    s_mov_b64 exec, s[60:61]
    s_mov_b32 s91, 126464
    buffer_load_dwordx4 v15, s[36:39], s91 offen lds
    s_mov_b64 exec, -1
    v_dot2c_f32_bf16 v4, v232, v49
    v_dot2c_f32_bf16 v5, v233, v53
    v_dot2c_f32_bf16 v4, v234, v57
    v_dot2c_f32_bf16 v5, v235, v61
    v_dot2c_f32_bf16 v4, v236, v65
    v_mfma_f32_32x32x16_bf16 v[224:239], v[152:155], v[92:95], 0
    v_cvt_pk_bf16_f32 v208, v208, v240
    v_cvt_pk_bf16_f32 v209, v209, v241
    v_cvt_pk_bf16_f32 v210, v210, v242
    v_cvt_pk_bf16_f32 v211, v211, v243
    v_cvt_pk_bf16_f32 v212, v212, v244
    v_cvt_pk_bf16_f32 v213, v213, v245
    v_cvt_pk_bf16_f32 v214, v214, v246
    v_mfma_f32_32x32x16_bf16 v[224:239], v[156:159], v[124:127], v[224:239]
    v_cvt_pk_bf16_f32 v215, v215, v247
    v_cvt_pk_bf16_f32 v216, v216, v248
    v_cvt_pk_bf16_f32 v217, v217, v249
    v_cvt_pk_bf16_f32 v218, v218, v250
    v_cvt_pk_bf16_f32 v219, v219, v251
    v_cvt_pk_bf16_f32 v220, v220, v252
    v_mfma_f32_32x32x16_bf16 v[240:255], v[160:163], v[96:99], 0
    v_mfma_f32_32x32x16_bf16 v[240:255], v[196:199], v[128:131], v[240:255]
    v_dot2c_f32_bf16 v4, v208, v18
    v_dot2c_f32_bf16 v5, v209, v22
    s_add_u32 m0, s26, 94720
    s_mov_b64 exec, s[60:61]
    s_mov_b32 s91, 133120
    buffer_load_dwordx4 v15, s[36:39], s91 offen lds
    s_mov_b64 exec, -1
    v_dot2c_f32_bf16 v4, v210, v26
    v_dot2c_f32_bf16 v5, v211, v30
    v_dot2c_f32_bf16 v4, v212, v34
    v_dot2c_f32_bf16 v5, v213, v38
    v_dot2c_f32_bf16 v4, v214, v42
    v_dot2c_f32_bf16 v5, v215, v46
    s_barrier
    s_setprio 3
    v_dot2c_f32_bf16 v4, v216, v50
    v_dot2c_f32_bf16 v5, v217, v54
    v_dot2c_f32_bf16 v4, v218, v58
    v_dot2c_f32_bf16 v5, v219, v62
    v_dot2c_f32_bf16 v4, v220, v66
    ds_read_b64 v[152:153], v13 offset:44032
    v_cvt_pk_bf16_f32 v224, v224, v240
    v_cvt_pk_bf16_f32 v225, v225, v241
    ds_read_b128 v[208:211], v13 offset:39936
    v_cvt_pk_bf16_f32 v226, v226, v242
    v_cvt_pk_bf16_f32 v227, v227, v243
    ds_read_b64 v[154:155], v13 offset:44544
    v_cvt_pk_bf16_f32 v228, v228, v244
    v_cvt_pk_bf16_f32 v229, v229, v245
    ds_read_b128 v[212:215], v13 offset:40448
    v_cvt_pk_bf16_f32 v230, v230, v246
    v_cvt_pk_bf16_f32 v231, v231, v247
    ds_read_b64 v[200:201], v13 offset:45056
    v_cvt_pk_bf16_f32 v232, v232, v248
    v_cvt_pk_bf16_f32 v233, v233, v249
    ds_read_b128 v[216:219], v13 offset:40960
    v_cvt_pk_bf16_f32 v234, v234, v250
    v_cvt_pk_bf16_f32 v235, v235, v251
    ds_read_b64 v[202:203], v13 offset:45568
    v_cvt_pk_bf16_f32 v236, v236, v252
    ds_read_b128 v[220:223], v13 offset:41472
    v_dot2c_f32_bf16 v4, v224, v19
    v_dot2c_f32_bf16 v5, v225, v23
    v_dot2c_f32_bf16 v4, v226, v27
    v_dot2c_f32_bf16 v5, v227, v31
    v_dot2c_f32_bf16 v4, v228, v35
    v_dot2c_f32_bf16 v5, v229, v39
    v_dot2c_f32_bf16 v4, v230, v43
    v_dot2c_f32_bf16 v5, v231, v47
    v_dot2c_f32_bf16 v4, v232, v51
    v_dot2c_f32_bf16 v5, v233, v55
    v_dot2c_f32_bf16 v4, v234, v59
    v_dot2c_f32_bf16 v5, v235, v63
    v_dot2c_f32_bf16 v4, v236, v67
    s_cmp_lg_u32 s86, 0
    s_cbranch_scc1 L_f5
    v_mov_b32 v0, 0
    s_lshl_b32 s91, s87, 2
    buffer_load_dword v6, v0, s[52:55], s91 offen sc0 sc1
L_f5:
    s_waitcnt lgkmcnt(6)
    v_dot2_f32_bf16 v224, v68, v152, 0
    v_dot2_f32_bf16 v225, v68, v210, 0
    s_setprio 2
    v_dot2_f32_bf16 v226, v100, v153, 0
    s_add_u32 m0, s26, 101376
    s_mov_b64 exec, s[60:61]
    s_mov_b32 s91, 139776
    buffer_load_dwordx4 v15, s[36:39], s91 offen lds
    s_mov_b64 exec, -1
    v_dot2_f32_bf16 v227, v100, v211, 0
    s_waitcnt lgkmcnt(4)
    v_dot2_f32_bf16 v228, v69, v154, 0
    v_dot2_f32_bf16 v229, v69, v214, 0
    v_dot2_f32_bf16 v230, v101, v155, 0
    v_dot2_f32_bf16 v231, v101, v215, 0
    s_waitcnt lgkmcnt(2)
    v_dot2_f32_bf16 v232, v70, v200, 0
    v_dot2_f32_bf16 v233, v70, v218, 0
    v_dot2_f32_bf16 v234, v102, v201, 0
    s_add_u32 m0, s26, 108032
    s_mov_b64 exec, s[60:61]
    s_mov_b32 s91, 146432
    buffer_load_dwordx4 v15, s[36:39], s91 offen lds
    s_mov_b64 exec, -1
    v_dot2_f32_bf16 v235, v102, v219, 0
    s_waitcnt lgkmcnt(0)
    v_dot2_f32_bf16 v236, v71, v202, 0
    v_cvt_pk_bf16_f32 v68, v224, v225
    v_cvt_pk_bf16_f32 v100, v226, v227
    v_cvt_pk_bf16_f32 v69, v228, v229
    v_cvt_pk_bf16_f32 v101, v230, v231
    v_cvt_pk_bf16_f32 v70, v232, v233
    v_cvt_pk_bf16_f32 v102, v234, v235
    v_cvt_pk_bf16_f32 v71, v236, 0
    s_add_u32 m0, s26, 114688
    s_mov_b64 exec, s[60:61]
    s_mov_b32 s91, 153088
    buffer_load_dwordx4 v15, s[36:39], s91 offen lds
    s_mov_b64 exec, -1
    v_dot2_f32_bf16 v237, v72, v152, 0
    v_dot2_f32_bf16 v238, v72, v210, 0
    v_dot2_f32_bf16 v239, v104, v153, 0
    v_dot2_f32_bf16 v240, v104, v211, 0
    v_dot2_f32_bf16 v241, v73, v154, 0
    v_dot2_f32_bf16 v242, v73, v214, 0
    v_dot2_f32_bf16 v243, v105, v155, 0
    v_dot2_f32_bf16 v244, v105, v215, 0
    s_add_u32 m0, s26, 121344
    s_mov_b64 exec, s[60:61]
    s_setprio 1
    s_mov_b32 s91, 159744
    buffer_load_dwordx4 v15, s[36:39], s91 offen lds
    s_mov_b64 exec, -1
    v_dot2_f32_bf16 v245, v74, v200, 0
    v_dot2_f32_bf16 v246, v74, v218, 0
    v_dot2_f32_bf16 v247, v106, v201, 0
    v_dot2_f32_bf16 v248, v106, v219, 0
    v_dot2_f32_bf16 v249, v75, v202, 0
    v_cvt_pk_bf16_f32 v72, v237, v238
    v_cvt_pk_bf16_f32 v104, v239, v240
    v_cvt_pk_bf16_f32 v73, v241, v242
    s_add_u32 m0, s26, 128000
    s_mov_b64 exec, s[60:61]
    s_mov_b32 s91, 166400
    buffer_load_dwordx4 v15, s[36:39], s91 offen lds
    s_mov_b64 exec, -1
    v_cvt_pk_bf16_f32 v105, v243, v244
    v_cvt_pk_bf16_f32 v74, v245, v246
    v_cvt_pk_bf16_f32 v106, v247, v248
    v_cvt_pk_bf16_f32 v75, v249, 0
    v_dot2_f32_bf16 v224, v76, v152, 0
    v_dot2_f32_bf16 v225, v76, v210, 0
    v_dot2_f32_bf16 v226, v108, v153, 0
    v_dot2_f32_bf16 v227, v108, v211, 0
    v_dot2_f32_bf16 v228, v77, v154, 0
    v_dot2_f32_bf16 v229, v77, v214, 0
    v_dot2_f32_bf16 v230, v109, v155, 0
    v_dot2_f32_bf16 v231, v109, v215, 0
    v_dot2_f32_bf16 v232, v78, v200, 0
    v_dot2_f32_bf16 v233, v78, v218, 0
    v_dot2_f32_bf16 v234, v110, v201, 0
    v_dot2_f32_bf16 v235, v110, v219, 0
    v_dot2_f32_bf16 v236, v79, v202, 0
    v_cvt_pk_bf16_f32 v76, v224, v225
    v_cvt_pk_bf16_f32 v108, v226, v227
    v_cvt_pk_bf16_f32 v77, v228, v229
    v_cvt_pk_bf16_f32 v109, v230, v231
    v_cvt_pk_bf16_f32 v78, v232, v233
    v_cvt_pk_bf16_f32 v110, v234, v235
    v_cvt_pk_bf16_f32 v79, v236, 0
    v_dot2_f32_bf16 v237, v80, v152, 0
    s_setprio 0
    v_dot2_f32_bf16 v238, v80, v210, 0
    v_dot2_f32_bf16 v239, v112, v153, 0
    v_dot2_f32_bf16 v240, v112, v211, 0
    v_dot2_f32_bf16 v241, v81, v154, 0
    v_dot2_f32_bf16 v242, v81, v214, 0
    v_dot2_f32_bf16 v243, v113, v155, 0
    v_dot2_f32_bf16 v244, v113, v215, 0
    v_dot2_f32_bf16 v245, v82, v200, 0
    v_dot2_f32_bf16 v246, v82, v218, 0
    v_dot2_f32_bf16 v247, v114, v201, 0
    v_dot2_f32_bf16 v248, v114, v219, 0
    v_dot2_f32_bf16 v249, v83, v202, 0
    v_cvt_pk_bf16_f32 v80, v237, v238
    v_cvt_pk_bf16_f32 v112, v239, v240
    v_cvt_pk_bf16_f32 v81, v241, v242
    v_cvt_pk_bf16_f32 v113, v243, v244
    v_cvt_pk_bf16_f32 v82, v245, v246
    v_cvt_pk_bf16_f32 v114, v247, v248
    v_cvt_pk_bf16_f32 v83, v249, 0
    v_dot2_f32_bf16 v224, v84, v152, 0
    v_dot2_f32_bf16 v225, v84, v210, 0
    v_dot2_f32_bf16 v226, v116, v153, 0
    v_dot2_f32_bf16 v227, v116, v211, 0
    v_dot2_f32_bf16 v228, v85, v154, 0
    v_dot2_f32_bf16 v229, v85, v214, 0
    v_dot2_f32_bf16 v230, v117, v155, 0
    v_dot2_f32_bf16 v231, v117, v215, 0
    v_dot2_f32_bf16 v232, v86, v200, 0
    v_dot2_f32_bf16 v233, v86, v218, 0
    v_dot2_f32_bf16 v234, v118, v201, 0
    v_dot2_f32_bf16 v235, v118, v219, 0
    v_dot2_f32_bf16 v236, v87, v202, 0
    v_cvt_pk_bf16_f32 v84, v224, v225
    v_cvt_pk_bf16_f32 v116, v226, v227
    v_cvt_pk_bf16_f32 v85, v228, v229
    v_cvt_pk_bf16_f32 v117, v230, v231
    v_cvt_pk_bf16_f32 v86, v232, v233
    v_cvt_pk_bf16_f32 v118, v234, v235
    v_cvt_pk_bf16_f32 v87, v236, 0
    s_waitcnt vmcnt(0)
    s_barrier
    s_setprio 3
    ds_read_b128 v[164:167], v7 offset:48128
    v_dot2_f32_bf16 v237, v88, v152, 0
    v_dot2_f32_bf16 v238, v88, v210, 0
    v_dot2_f32_bf16 v239, v120, v153, 0
    ds_read_b128 v[168:171], v7 offset:54784
    v_dot2_f32_bf16 v240, v120, v211, 0
    v_dot2_f32_bf16 v241, v89, v154, 0
    v_dot2_f32_bf16 v242, v89, v214, 0
    ds_read_b128 v[172:175], v8 offset:1536
    v_dot2_f32_bf16 v243, v121, v155, 0
    v_dot2_f32_bf16 v244, v121, v215, 0
    v_dot2_f32_bf16 v245, v90, v200, 0
    ds_read_b128 v[176:179], v8 offset:8192
    v_dot2_f32_bf16 v246, v90, v218, 0
    v_dot2_f32_bf16 v247, v122, v201, 0
    v_dot2_f32_bf16 v248, v122, v219, 0
    ds_read_b128 v[180:183], v8 offset:14848
    v_dot2_f32_bf16 v249, v91, v202, 0
    v_cvt_pk_bf16_f32 v88, v237, v238
    v_cvt_pk_bf16_f32 v120, v239, v240
    v_cvt_pk_bf16_f32 v89, v241, v242
    ds_read_b128 v[184:187], v8 offset:21504
    v_cvt_pk_bf16_f32 v121, v243, v244
    v_cvt_pk_bf16_f32 v90, v245, v246
    v_cvt_pk_bf16_f32 v122, v247, v248
    v_cvt_pk_bf16_f32 v91, v249, 0
    ds_read_b128 v[188:191], v8 offset:28160
    v_dot2_f32_bf16 v224, v92, v152, 0
    v_dot2_f32_bf16 v225, v92, v210, 0
    v_dot2_f32_bf16 v226, v124, v153, 0
    ds_read_b128 v[192:195], v8 offset:34816
    v_dot2_f32_bf16 v227, v124, v211, 0
    v_dot2_f32_bf16 v228, v93, v154, 0
    v_dot2_f32_bf16 v229, v93, v214, 0
    ds_read_b128 v[132:135], v8 offset:41472
    v_dot2_f32_bf16 v230, v125, v155, 0
    v_dot2_f32_bf16 v231, v125, v215, 0
    v_dot2_f32_bf16 v232, v94, v200, 0
    ds_read_b128 v[136:139], v8 offset:48128
    v_dot2_f32_bf16 v233, v94, v218, 0
    v_dot2_f32_bf16 v234, v126, v201, 0
    v_dot2_f32_bf16 v235, v126, v219, 0
    ds_read_b128 v[140:143], v8 offset:54784
    v_dot2_f32_bf16 v236, v95, v202, 0
    v_cvt_pk_bf16_f32 v92, v224, v225
    v_cvt_pk_bf16_f32 v124, v226, v227
    v_cvt_pk_bf16_f32 v93, v228, v229
    ds_read_b128 v[144:147], v9 offset:1536
    v_cvt_pk_bf16_f32 v125, v230, v231
    v_cvt_pk_bf16_f32 v94, v232, v233
    v_cvt_pk_bf16_f32 v126, v234, v235
    v_cvt_pk_bf16_f32 v95, v236, 0
    ds_read_b128 v[148:151], v9 offset:8192
    v_dot2_f32_bf16 v237, v96, v152, 0
    v_dot2_f32_bf16 v238, v96, v210, 0
    v_dot2_f32_bf16 v239, v128, v153, 0
    v_dot2_f32_bf16 v240, v128, v211, 0
    v_dot2_f32_bf16 v241, v97, v154, 0
    v_dot2_f32_bf16 v242, v97, v214, 0
    v_dot2_f32_bf16 v243, v129, v155, 0
    v_dot2_f32_bf16 v244, v129, v215, 0
    v_dot2_f32_bf16 v245, v98, v200, 0
    v_dot2_f32_bf16 v246, v98, v218, 0
    v_dot2_f32_bf16 v247, v130, v201, 0
    v_dot2_f32_bf16 v248, v130, v219, 0
    v_dot2_f32_bf16 v249, v99, v202, 0
    v_cvt_pk_bf16_f32 v96, v237, v238
    v_cvt_pk_bf16_f32 v128, v239, v240
    v_cvt_pk_bf16_f32 v97, v241, v242
    v_cvt_pk_bf16_f32 v129, v243, v244
    v_cvt_pk_bf16_f32 v98, v245, v246
    v_cvt_pk_bf16_f32 v130, v247, v248
    v_cvt_pk_bf16_f32 v99, v249, 0
    s_min_u32 s93, s88, 2
    s_and_b32 s91, s93, 1
    s_setprio 2
    s_lshl_b32 s91, s91, 4
    s_cmp_lt_u32 s88, 2
    s_cselect_b32 s92, -1, 0
    s_cselect_b32 s93, 0, -1
    s_lshl_b32 s90, s87, 9
    s_mov_b32 s3, 0x40000
    v_lshlrev_b32 v9, 3, v1
    v_lshlrev_b32 v8, 5, v1
    v_add_u32 v8, 161280, v8
    s_waitcnt lgkmcnt(11)
    v_perm_b32 v152, v168, v164, s94
    s_waitcnt lgkmcnt(9)
    v_perm_b32 v153, v176, v172, s94
    s_waitcnt lgkmcnt(7)
    v_perm_b32 v156, v184, v180, s94
    s_waitcnt lgkmcnt(5)
    v_perm_b32 v157, v192, v188, s94
    s_waitcnt lgkmcnt(3)
    v_perm_b32 v154, v136, v132, s94
    s_waitcnt lgkmcnt(1)
    v_perm_b32 v158, v144, v140, s94
    s_waitcnt lgkmcnt(0)
    v_and_b32 v155, 0xffff, v148
    s_nop 1
    v_mfma_f32_32x32x16_bf16 v[208:223], v[152:155], v[68:71], 0
    v_perm_b32 v160, v168, v164, s95
    v_perm_b32 v161, v176, v172, s95
    v_perm_b32 v196, v184, v180, s95
    v_perm_b32 v197, v192, v188, s95
    v_perm_b32 v162, v136, v132, s95
    v_perm_b32 v198, v144, v140, s95
    v_lshrrev_b32 v163, 16, v148
    v_mfma_f32_32x32x16_bf16 v[208:223], v[156:159], v[100:103], v[208:223]
    v_perm_b32 v200, v169, v165, s94
    v_perm_b32 v201, v177, v173, s94
    v_perm_b32 v204, v185, v181, s94
    v_perm_b32 v205, v193, v189, s94
    v_perm_b32 v202, v137, v133, s94
    v_perm_b32 v206, v145, v141, s94
    v_and_b32 v203, 0xffff, v149
    v_mfma_f32_32x32x16_bf16 v[240:255], v[160:163], v[72:75], 0
    v_perm_b32 v152, v169, v165, s95
    v_perm_b32 v153, v177, v173, s95
    v_perm_b32 v156, v185, v181, s95
    v_mfma_f32_32x32x16_bf16 v[240:255], v[196:199], v[104:107], v[240:255]
    v_perm_b32 v157, v193, v189, s95
    v_perm_b32 v154, v137, v133, s95
    v_perm_b32 v158, v145, v141, s95
    v_lshrrev_b32 v155, 16, v149
    v_mfma_f32_32x32x16_bf16 v[224:239], v[200:203], v[76:79], 0
    v_perm_b32 v160, v170, v166, s94
    v_perm_b32 v161, v178, v174, s94
    v_perm_b32 v196, v186, v182, s94
    v_perm_b32 v197, v194, v190, s94
    v_perm_b32 v162, v138, v134, s94
    v_perm_b32 v198, v146, v142, s94
    v_and_b32 v163, 0xffff, v150
    v_mfma_f32_32x32x16_bf16 v[224:239], v[204:207], v[108:111], v[224:239]
    v_cvt_pk_bf16_f32 v208, v208, v240
    v_cvt_pk_bf16_f32 v209, v209, v241
    s_setprio 1
    v_cvt_pk_bf16_f32 v210, v210, v242
    v_cvt_pk_bf16_f32 v211, v211, v243
    v_cvt_pk_bf16_f32 v212, v212, v244
    v_cvt_pk_bf16_f32 v213, v213, v245
    v_cvt_pk_bf16_f32 v214, v214, v246
    v_cvt_pk_bf16_f32 v215, v215, v247
    v_cvt_pk_bf16_f32 v216, v216, v248
    v_cvt_pk_bf16_f32 v217, v217, v249
    v_cvt_pk_bf16_f32 v218, v218, v250
    v_cvt_pk_bf16_f32 v219, v219, v251
    v_cvt_pk_bf16_f32 v220, v220, v252
    v_mfma_f32_32x32x16_bf16 v[240:255], v[152:155], v[80:83], 0
    v_perm_b32 v200, v170, v166, s95
    v_perm_b32 v201, v178, v174, s95
    v_perm_b32 v204, v186, v182, s95
    v_mfma_f32_32x32x16_bf16 v[240:255], v[156:159], v[112:115], v[240:255]
    v_perm_b32 v205, v194, v190, s95
    v_perm_b32 v202, v138, v134, s95
    v_perm_b32 v206, v146, v142, s95
    v_lshrrev_b32 v203, 16, v150
    v_dot2_f32_bf16 v68, v208, v16, 0
    v_dot2_f32_bf16 v69, v209, v20, 0
    v_dot2_f32_bf16 v70, v210, v24, 0
    v_dot2_f32_bf16 v71, v211, v28, 0
    v_dot2_f32_bf16 v72, v212, v32, 0
    v_dot2_f32_bf16 v73, v213, v36, 0
    v_dot2_f32_bf16 v74, v214, v40, 0
    v_dot2_f32_bf16 v75, v215, v44, 0
    v_dot2_f32_bf16 v100, v216, v48, 0
    v_dot2_f32_bf16 v101, v217, v52, 0
    v_dot2_f32_bf16 v102, v218, v56, 0
    v_dot2_f32_bf16 v103, v219, v60, 0
    v_dot2_f32_bf16 v104, v220, v64, 0
    v_mfma_f32_32x32x16_bf16 v[208:223], v[160:163], v[84:87], 0
    v_cvt_pk_bf16_f32 v224, v224, v240
    v_cvt_pk_bf16_f32 v225, v225, v241
    v_cvt_pk_bf16_f32 v226, v226, v242
    v_cvt_pk_bf16_f32 v227, v227, v243
    v_cvt_pk_bf16_f32 v228, v228, v244
    v_cvt_pk_bf16_f32 v229, v229, v245
    v_cvt_pk_bf16_f32 v230, v230, v246
    v_mfma_f32_32x32x16_bf16 v[208:223], v[196:199], v[116:119], v[208:223]
    v_cvt_pk_bf16_f32 v231, v231, v247
    v_cvt_pk_bf16_f32 v232, v232, v248
    v_cvt_pk_bf16_f32 v233, v233, v249
    v_cvt_pk_bf16_f32 v234, v234, v250
    v_cvt_pk_bf16_f32 v235, v235, v251
    v_cvt_pk_bf16_f32 v236, v236, v252
    v_mfma_f32_32x32x16_bf16 v[240:255], v[200:203], v[88:91], 0
    v_perm_b32 v152, v171, v167, s94
    v_perm_b32 v153, v179, v175, s94
    v_perm_b32 v156, v187, v183, s94
    v_perm_b32 v157, v195, v191, s94
    v_perm_b32 v154, v139, v135, s94
    v_perm_b32 v158, v147, v143, s94
    v_and_b32 v155, 0xffff, v151
    v_mfma_f32_32x32x16_bf16 v[240:255], v[204:207], v[120:123], v[240:255]
    v_perm_b32 v160, v171, v167, s95
    v_perm_b32 v161, v179, v175, s95
    v_perm_b32 v196, v187, v183, s95
    v_perm_b32 v197, v195, v191, s95
    v_perm_b32 v162, v139, v135, s95
    v_perm_b32 v198, v147, v143, s95
    v_lshrrev_b32 v163, 16, v151
    v_dot2c_f32_bf16 v68, v224, v17
    v_dot2c_f32_bf16 v69, v225, v21
    s_setprio 0
    ds_read_b128 v[76:79], v13 offset:39936
    v_dot2c_f32_bf16 v70, v226, v25
    v_dot2c_f32_bf16 v71, v227, v29
    v_dot2c_f32_bf16 v72, v228, v33
    v_dot2c_f32_bf16 v73, v229, v37
    v_dot2c_f32_bf16 v74, v230, v41
    v_dot2c_f32_bf16 v75, v231, v45
    ds_read_b128 v[80:83], v13 offset:40448
    v_dot2c_f32_bf16 v100, v232, v49
    v_dot2c_f32_bf16 v101, v233, v53
    v_dot2c_f32_bf16 v102, v234, v57
    v_dot2c_f32_bf16 v103, v235, v61
    v_dot2c_f32_bf16 v104, v236, v65
    v_mfma_f32_32x32x16_bf16 v[224:239], v[152:155], v[92:95], 0
    v_cvt_pk_bf16_f32 v208, v208, v240
    v_cvt_pk_bf16_f32 v209, v209, v241
    v_cvt_pk_bf16_f32 v210, v210, v242
    v_cvt_pk_bf16_f32 v211, v211, v243
    v_cvt_pk_bf16_f32 v212, v212, v244
    v_cvt_pk_bf16_f32 v213, v213, v245
    v_cvt_pk_bf16_f32 v214, v214, v246
    v_mfma_f32_32x32x16_bf16 v[224:239], v[156:159], v[124:127], v[224:239]
    v_cvt_pk_bf16_f32 v215, v215, v247
    v_cvt_pk_bf16_f32 v216, v216, v248
    v_cvt_pk_bf16_f32 v217, v217, v249
    v_cvt_pk_bf16_f32 v218, v218, v250
    v_cvt_pk_bf16_f32 v219, v219, v251
    v_cvt_pk_bf16_f32 v220, v220, v252
    v_mfma_f32_32x32x16_bf16 v[240:255], v[160:163], v[96:99], 0
    v_mfma_f32_32x32x16_bf16 v[240:255], v[196:199], v[128:131], v[240:255]
    v_dot2c_f32_bf16 v68, v208, v18
    v_dot2c_f32_bf16 v69, v209, v22
    ds_read_b128 v[108:111], v13 offset:40960
    v_dot2c_f32_bf16 v70, v210, v26
    v_dot2c_f32_bf16 v71, v211, v30
    v_dot2c_f32_bf16 v72, v212, v34
    v_dot2c_f32_bf16 v73, v213, v38
    v_dot2c_f32_bf16 v74, v214, v42
    v_dot2c_f32_bf16 v75, v215, v46
    ds_read_b128 v[112:115], v13 offset:41472
    v_dot2c_f32_bf16 v100, v216, v50
    v_dot2c_f32_bf16 v101, v217, v54
    v_dot2c_f32_bf16 v102, v218, v58
    v_dot2c_f32_bf16 v103, v219, v62
    v_dot2c_f32_bf16 v104, v220, v66
    v_cvt_pk_bf16_f32 v224, v224, v240
    v_cvt_pk_bf16_f32 v225, v225, v241
    v_cvt_pk_bf16_f32 v226, v226, v242
    v_cvt_pk_bf16_f32 v227, v227, v243
    v_cvt_pk_bf16_f32 v228, v228, v244
    v_cvt_pk_bf16_f32 v229, v229, v245
    v_cvt_pk_bf16_f32 v230, v230, v246
    v_cvt_pk_bf16_f32 v231, v231, v247
    v_cvt_pk_bf16_f32 v232, v232, v248
    v_cvt_pk_bf16_f32 v233, v233, v249
    v_cvt_pk_bf16_f32 v234, v234, v250
    v_cvt_pk_bf16_f32 v235, v235, v251
    v_cvt_pk_bf16_f32 v236, v236, v252
    v_dot2c_f32_bf16 v68, v224, v19
    v_dot2c_f32_bf16 v69, v225, v23
    v_dot2c_f32_bf16 v70, v226, v27
    v_dot2c_f32_bf16 v71, v227, v31
    v_dot2c_f32_bf16 v72, v228, v35
    v_dot2c_f32_bf16 v73, v229, v39
    v_dot2c_f32_bf16 v74, v230, v43
    v_dot2c_f32_bf16 v75, v231, v47
    v_dot2c_f32_bf16 v100, v232, v51
    v_dot2c_f32_bf16 v101, v233, v55
    v_dot2c_f32_bf16 v102, v234, v59
    v_dot2c_f32_bf16 v103, v235, v63
    v_dot2c_f32_bf16 v104, v236, v67
    s_waitcnt lgkmcnt(0)
    s_nop 1
    v_fmac_f32 v4, v112, v104
    v_pk_mul_f32 v[208:209], v[76:77], v[68:69]
    v_pk_mul_f32 v[210:211], v[78:79], v[70:71]
    v_pk_fma_f32 v[4:5], v[80:81], v[72:73], v[4:5]
    v_pk_fma_f32 v[208:209], v[82:83], v[74:75], v[208:209]
    v_pk_fma_f32 v[210:211], v[108:109], v[100:101], v[210:211]
    v_pk_fma_f32 v[4:5], v[110:111], v[102:103], v[4:5]
    v_pk_add_f32 v[208:209], v[208:209], v[210:211]
    v_pk_add_f32 v[4:5], v[4:5], v[208:209]
    v_add_f32 v208, v4, v5
    v_add_f32 v5, v4, v5
    v_mov_b32 v4, v208
    s_nop 1
    v_permlane32_swap_b32 v4, v5
    v_add_f32 v4, v4, v5
    ds_write_b32 v2, v4
L_final:
    s_waitcnt lgkmcnt(0)
    s_barrier
    s_cmp_lg_u32 s86, 0
    s_cbranch_scc1 L_end
    ds_read_b128 v[240:243], v8 offset:0
    ds_read_b128 v[244:247], v8 offset:16
    s_waitcnt vmcnt(0)
L_spin:
    v_readfirstlane_b32 s89, v6
    s_nop 0
    s_cmp_eq_u32 s89, 1
    s_cbranch_scc1 L_go
    s_sleep 2
    s_lshl_b32 s89, s87, 2
    buffer_load_dword v6, v0, s[52:55], s89 offen sc0 sc1
    s_waitcnt vmcnt(0)
    s_sub_u32 s3, s3, 1
    s_cbranch_scc0 L_spin
L_go:
    s_cmp_eq_u32 s88, 2
    s_cselect_b32 exec_hi, 0, -1
    s_cmp_eq_u32 s88, 3
    s_cselect_b32 exec_lo, 0, -1
    s_waitcnt lgkmcnt(0)
    v_pk_add_f32 v[240:241], v[240:241], v[244:245]
    v_pk_add_f32 v[242:243], v[242:243], v[246:247]
    v_pk_add_f32 v[240:241], v[240:241], v[242:243]
    v_add_f32 v240, v240, v241
    v_cvt_pk_bf16_f32 v241, v240, 0
    v_cmp_eq_u32 s[44:45], 0, v241
    v_mov_b32 v242, 0x8000
    v_lshlrev_b32 v10, 1, v1
    v_cndmask_b32 v241, v241, v242, s[44:45]
    v_lshlrev_b32 v241, s91, v241
    v_and_b32 v248, s92, v241
    v_and_b32 v249, s93, v241
    buffer_atomic_or_x2 v[248:249], v9, s[56:59], s90 offen sc0 sc1
    v_and_b32 v244, s92, v241
    v_and_b32 v245, s93, v241
    s_lshl_b32 s92, s87, 7
    s_waitcnt vmcnt(0)
    v_or_b32 v248, v248, v244
    v_or_b32 v249, v249, v245
    v_lshlrev_b32 v240, 16, v248
    v_and_b32 v241, 0xffff0000, v248
    v_lshlrev_b32 v242, 16, v249
    v_min3_u32 v244, v240, v241, v242
    v_cmp_ne_u32 vcc, 0, v244
    v_add_f32 v240, v240, v241
    s_and_b64 exec, exec, vcc
    s_cbranch_execz L_end
    v_add_f32 v240, v240, v242
    v_cvt_pk_bf16_f32 v240, v240, v240
    buffer_store_short v240, v10, s[48:51], s92 offen
L_end:
    s_endpgm
.section .rodata,"a"
.p2align 6
.amdhsa_kernel standalone__deep_cross_fibinet__recsys_kernel
  .amdhsa_next_free_vgpr 256
  .amdhsa_next_free_sgpr 102
  .amdhsa_accum_offset 256
  .amdhsa_group_segment_fixed_size 0
  .amdhsa_kernarg_size 88
  .amdhsa_user_sgpr_count 2
  .amdhsa_user_sgpr_kernarg_segment_ptr 1
  .amdhsa_system_sgpr_workgroup_id_x 1
.end_amdhsa_kernel
```

```asm
; @launch grid=(256,1,1) block=(512,1,1) lds=163840
.amdgcn_target "amdgcn-amd-amdhsa--gfx950"
.text
.globl standalone__deep_cross_fibinet__recsys_kernel
.p2align 8
.type standalone__deep_cross_fibinet__recsys_kernel,@function
standalone__deep_cross_fibinet__recsys_kernel:
    s_cmp_ge_u32 s2, 256
    s_cbranch_scc1 L_end
    v_lshrrev_b32 v242, 6, v0
    s_load_dwordx16 s[4:19], s[0:1], 0
    v_readfirstlane_b32 s86, v242
    s_load_dwordx4 s[20:23], s[0:1], 64
    s_load_dwordx2 s[24:25], s[0:1], 80
    s_getpc_b64 s[92:93]
    s_bfe_u32 s88, s2, 0x20003
    s_lshr_b32 s91, s2, 4
    s_and_b32 s91, s91, 2
    s_xor_b32 s88, s88, s91
    s_mul_i32 s91, s88, 5888
    v_lshl_add_u32 v240, v0, 7, s91
    v_min_u32 v240, 23196, v240
    v_mov_b32 v241, s93
    v_add_co_u32 v240, vcc, s92, v240
    v_and_b32 v1, 63, v0
    s_lshl_b32 s89, s86, 10
    v_addc_co_u32 v241, vcc, 0, v241, vcc
    v_cmp_gt_u32 vcc, 46, v0
    v_lshlrev_b32 v246, 4, v1
    s_and_saveexec_b64 s[92:93], vcc
    s_cbranch_execz L_cpf
    global_load_dword v6, v[240:241], off
L_cpf:
    s_mov_b64 exec, -1
    s_lshr_b32 s91, s2, 5
    s_lshl_b32 s91, s91, 3
    s_and_b32 s92, s2, 7
    s_add_u32 s87, s91, s92
    s_lshl_b32 s27, s92, 3
    s_lshr_b32 s91, s2, 5
    s_add_u32 s27, s27, s91
    s_and_b32 s91, s88, 1
    s_lshl_b32 s91, s91, 2
    s_and_b32 s92, s86, 3
    s_add_u32 s91, s91, s92
    s_cmp_ge_u32 s88, 2
    s_cselect_b32 s91, s91, s86
    s_lshl_b32 s92, s87, 3
    s_add_u32 s91, s91, s92
    s_mul_i32 s90, s91, 832
    s_mov_b32 s30, 425984
    s_mov_b32 s31, 0x00020000
    s_mov_b32 s42, 851968
    s_mov_b32 s43, 0x00020000
    s_mov_b32 s38, 173056
    s_mov_b32 s39, 0x00020000
    s_lshr_b32 s91, s2, 5
    s_lshl_b32 s91, s91, 1
    s_and_b32 s92, s88, 1
    s_add_u32 s91, s91, s92
    s_lshl_b32 s91, s91, 3
    s_add_u32 s91, s91, s86
    s_mul_i32 s91, s91, 16
    s_cmp_ge_u32 s88, 2
    s_cselect_b32 s92, 12, 0
    s_cselect_b32 s93, 3, 11
    s_add_u32 s91, s91, s92
    s_lshl_b32 s91, s91, 7
    v_min_u32 v247, s93, v1
    s_mul_i32 s92, s2, 18
    s_mul_i32 s93, s86, 3
    s_add_u32 s92, s92, s93
    s_add_u32 s92, s92, 2048
    s_lshr_b32 s93, s91, 7
    s_sub_u32 s92, s92, s93
    s_sub_u32 s92, s92, 61
    v_add_u32 v248, s92, v1
    v_cmp_le_u32 s[44:45], 61, v1
    s_nop 1
    v_cndmask_b32 v247, v247, v248, s[44:45]
    v_lshlrev_b32 v247, 7, v247
    s_mul_i32 s92, s2, 768
    s_lshl_b32 s93, s86, 7
    s_add_u32 s92, s92, s93
    s_add_u32 m0, s89, 147456
    s_waitcnt lgkmcnt(0)
    s_mov_b32 s28, s4
    s_and_b32 s29, s5, 0xffff
    buffer_load_dwordx4 v246, s[28:31], s90 offen lds
    s_barrier
    s_cmp_lt_u32 s88, 2
    s_cbranch_scc1 L_sm1
    s_mov_b32 s44, s12
    s_and_b32 s45, s13, 0xffff
    s_mov_b32 s46, 8192
    s_mov_b32 s47, 0x00020000
    s_mov_b32 m0, s89
    s_nop 0
    buffer_load_dwordx4 v246, s[44:47], s89 offen lds
    s_cmp_eq_u32 s86, 0
    s_cselect_b32 s44, s8, s10
    s_cselect_b32 s45, s9, s11
    s_and_b32 s45, s45, 0xffff
    s_movk_i32 s46, 676
    s_add_u32 m0, s89, 114688
    s_nop 0
    buffer_load_dwordx4 v246, s[44:47], 0 offen lds
L_sm1:
    s_mov_b32 s40, s16
    s_and_b32 s41, s17, 0xffff
    buffer_load_dword v6, v247, s[40:43], s91 offen
    s_mov_b32 s36, s14
    s_and_b32 s37, s15, 0xffff
    buffer_load_dword v6, off, s[36:39], s92
    s_mov_b32 s32, s6
    s_and_b32 s33, s7, 0xffff
    s_mov_b32 s34, 12800000
    s_mov_b32 s35, 0x00020000
    v_and_b32 v245, 7, v1
    v_bfe_u32 v247, v0, 4, 3
    v_xor_b32 v247, v247, v245
    v_lshlrev_b32 v3, 4, v247
    s_mov_b32 s48, s20
    s_and_b32 s49, s21, 0xffff
    s_mov_b32 s50, 8192
    s_mov_b32 s51, 0x00020000
    s_mov_b32 s52, s22
    s_and_b32 s53, s23, 0xffff
    s_mov_b32 s54, 256
    s_mov_b32 s55, 0x00020000
    s_mov_b32 s56, s24
    s_and_b32 s57, s25, 0xffff
    s_mov_b32 s58, 268435456
    s_mov_b32 s59, 0x00020000
    s_cmp_ge_u32 s88, 2
    s_cbranch_scc1 L_cross
    s_mov_b32 s44, s18
    s_and_b32 s45, s19, 0xffff
    s_mov_b32 s46, 512
    s_mov_b32 s47, 0x00020000
    v_lshrrev_b32 v241, 4, v1
    s_lshl_b32 s91, s88, 8
    s_lshr_b32 s92, s86, 1
    s_lshl_b32 s92, s92, 6
    s_add_u32 s91, s91, s92
    v_lshlrev_b32 v248, 3, v241
    buffer_load_dwordx2 v[112:113], v248, s[44:47], s91 offen offset:0
    buffer_load_dwordx2 v[114:115], v248, s[44:47], s91 offen offset:32
    v_lshrrev_b32 v247, 3, v1
    v_and_b32 v247, 2, v247
    s_and_b32 s91, s86, 1
    s_lshl_b32 s91, s91, 2
    v_or_b32 v247, s91, v247
    v_xor_b32 v247, v247, v245
    v_lshrrev_b32 v248, 3, v0
    v_lshlrev_b32 v248, 9, v248
    v_lshl_add_u32 v247, v247, 4, v248
    s_lshl_b32 s91, s88, 8
    v_add_u32 v13, s91, v247
    v_lshrrev_b32 v244, 3, v1
    v_mul_u32_u24 v14, 104, v244
    s_add_u32 s91, s89, 147456
    v_add_u32 v14, s91, v14
    v_and_b32 v240, 15, v1
    v_bfe_u32 v242, v1, 1, 3
    s_and_b32 s91, s86, 1
    s_lshl_b32 s91, s91, 12
    v_lshl_add_u32 v244, v240, 7, s91
    v_xor_b32 v245, v241, v242
    v_lshl_add_u32 v8, v245, 4, v244
    v_xor_b32 v9, 64, v8
    v_bfe_u32 v244, v1, 2, 2
    v_lshl_add_u32 v245, v241, 3, v244
    s_lshr_b32 s92, s86, 2
    s_mul_i32 s92, s92, 49152
    s_add_u32 s92, s92, 49152
    v_lshl_add_u32 v245, v245, 7, s92
    v_bfe_u32 v246, v1, 1, 1
    s_and_b32 s91, s86, 2
    s_lshl_b32 s91, s91, 1
    v_or_b32 v246, s91, v246
    v_lshrrev_b32 v247, 2, v1
    v_and_b32 v247, 6, v247
    v_xor_b32 v246, v246, v247
    v_lshl_add_u32 v245, v246, 4, v245
    v_and_b32 v247, 1, v1
    v_lshl_add_u32 v10, v247, 3, v245
    v_xor_b32 v11, 32, v10
    s_lshr_b32 s92, s86, 1
    s_lshl_b32 s92, s92, 3
    s_add_u32 s92, s92, 161280
    s_and_b32 s91, s86, 1
    s_lshl_b32 s91, s91, 10
    s_add_u32 s92, s92, s91
    v_and_b32 v244, 1, v241
    v_lshl_add_u32 v244, v244, 2, s92
    v_lshl_add_u32 v244, v240, 5, v244
    v_and_b32 v245, 32, v1
    v_lshl_add_u32 v2, v245, 4, v244
    v_mov_b32 v106, 0xbdd2d3e8
    v_mov_b32 v107, 0xc0135761
    s_waitcnt vmcnt(4)
    ds_read_b64 v[80:81], v14 offset:0
    ds_read_b64 v[82:83], v14 offset:8
    ds_read_b64 v[84:85], v14 offset:16
    ds_read_b64 v[86:87], v14 offset:24
    ds_read_b64 v[88:89], v14 offset:32
    ds_read_b64 v[90:91], v14 offset:40
    ds_read_b64 v[92:93], v14 offset:48
    ds_read_b64 v[94:95], v14 offset:56
    ds_read_b64 v[96:97], v14 offset:64
    ds_read_b64 v[98:99], v14 offset:72
    ds_read_b64 v[100:101], v14 offset:80
    ds_read_b64 v[102:103], v14 offset:88
    ds_read_b64 v[104:105], v14 offset:96
    s_barrier
    s_add_u32 m0, s89, 49152
    s_mov_b32 s91, 0
    buffer_load_dwordx4 v13, s[40:43], s91 offen lds
    s_add_u32 m0, s89, 98304
    s_mov_b32 s91, 128
    buffer_load_dwordx4 v13, s[40:43], s91 offen lds
    s_add_u32 m0, s89, 57344
    s_mov_b32 s91, 32768
    buffer_load_dwordx4 v13, s[40:43], s91 offen lds
    s_add_u32 m0, s89, 106496
    s_mov_b32 s91, 32896
    buffer_load_dwordx4 v13, s[40:43], s91 offen lds
    s_waitcnt lgkmcnt(0)
    v_lshl_add_u32 v80, v80, 7, v3
    v_lshl_add_u32 v81, v81, 7, v3
    v_lshl_add_u32 v82, v82, 7, v3
    v_lshl_add_u32 v83, v83, 7, v3
    v_lshl_add_u32 v84, v84, 7, v3
    v_lshl_add_u32 v85, v85, 7, v3
    v_lshl_add_u32 v86, v86, 7, v3
    v_lshl_add_u32 v87, v87, 7, v3
    v_lshl_add_u32 v88, v88, 7, v3
    v_lshl_add_u32 v89, v89, 7, v3
    v_lshl_add_u32 v90, v90, 7, v3
    v_lshl_add_u32 v91, v91, 7, v3
    v_lshl_add_u32 v92, v92, 7, v3
    v_lshl_add_u32 v93, v93, 7, v3
    v_lshl_add_u32 v94, v94, 7, v3
    v_lshl_add_u32 v95, v95, 7, v3
    v_lshl_add_u32 v96, v96, 7, v3
    v_lshl_add_u32 v97, v97, 7, v3
    v_lshl_add_u32 v98, v98, 7, v3
    v_lshl_add_u32 v99, v99, 7, v3
    v_lshl_add_u32 v100, v100, 7, v3
    v_lshl_add_u32 v101, v101, 7, v3
    v_lshl_add_u32 v102, v102, 7, v3
    v_lshl_add_u32 v103, v103, 7, v3
    v_lshl_add_u32 v104, v104, 7, v3
    v_lshl_add_u32 v105, v105, 7, v3
    s_waitcnt vmcnt(4)
    v_lshlrev_b32 v64, 16, v112
    v_and_b32 v65, 0xffff0000, v112
    v_lshlrev_b32 v66, 16, v113
    v_and_b32 v67, 0xffff0000, v113
    v_lshlrev_b32 v68, 16, v114
    v_and_b32 v69, 0xffff0000, v114
    v_lshlrev_b32 v70, 16, v115
    v_and_b32 v71, 0xffff0000, v115
    s_add_u32 m0, s89, 65536
    s_mov_b32 s91, 65536
    buffer_load_dwordx4 v13, s[40:43], s91 offen lds
    s_add_u32 m0, s89, 114688
    s_mov_b32 s91, 65664
    buffer_load_dwordx4 v13, s[40:43], s91 offen lds
    s_barrier
    s_add_u32 m0, s89, 0
    s_nop 0
    buffer_load_dwordx4 v80, s[32:35], 0 offen lds
    s_add_u32 m0, s89, 8192
    s_nop 0
    buffer_load_dwordx4 v81, s[32:35], 0 offen lds
    s_add_u32 m0, s89, 16384
    s_nop 0
    buffer_load_dwordx4 v82, s[32:35], 0 offen lds
    s_waitcnt vmcnt(2)
    s_barrier
    ds_read_b128 v[136:139], v8 offset:0
    ds_read_b64_tr_b16 v[128:129], v10 offset:0
    ds_read_b64_tr_b16 v[130:131], v10 offset:512
    ds_read_b128 v[140:143], v8 offset:2048
    s_add_u32 m0, s89, 24576
    s_nop 0
    buffer_load_dwordx4 v83, s[32:35], 0 offen lds
    ds_read_b64_tr_b16 v[132:133], v11 offset:0
    ds_read_b64_tr_b16 v[134:135], v11 offset:512
    s_waitcnt lgkmcnt(3)
    v_mfma_f32_16x16x32_bf16 v[16:19], v[128:131], v[136:139], 0
    ds_read_b128 v[152:155], v9 offset:0
    s_add_u32 m0, s89, 73728
    s_mov_b32 s91, 98304
    buffer_load_dwordx4 v13, s[40:43], s91 offen lds
    s_waitcnt lgkmcnt(3)
    v_mfma_f32_16x16x32_bf16 v[24:27], v[128:131], v[140:143], 0
    ds_read_b64_tr_b16 v[144:145], v10 offset:4096
    ds_read_b64_tr_b16 v[146:147], v10 offset:4608
    s_waitcnt lgkmcnt(3)
    v_mfma_f32_16x16x32_bf16 v[28:31], v[132:135], v[140:143], 0
    ds_read_b128 v[156:159], v9 offset:2048
    s_add_u32 m0, s89, 122880
    s_mov_b32 s91, 98432
    buffer_load_dwordx4 v13, s[40:43], s91 offen lds
    v_mfma_f32_16x16x32_bf16 v[20:23], v[132:135], v[136:139], 0
    ds_read_b64_tr_b16 v[148:149], v11 offset:4096
    ds_read_b64_tr_b16 v[150:151], v11 offset:4608
    s_waitcnt vmcnt(4)
    s_barrier
    s_waitcnt lgkmcnt(3)
    v_mfma_f32_16x16x32_bf16 v[16:19], v[144:147], v[152:155], v[16:19]
    ds_read_b128 v[168:171], v8 offset:8192
    s_waitcnt lgkmcnt(3)
    v_mfma_f32_16x16x32_bf16 v[24:27], v[144:147], v[156:159], v[24:27]
    ds_read_b64_tr_b16 v[160:161], v10 offset:8192
    ds_read_b64_tr_b16 v[162:163], v10 offset:8704
    s_waitcnt lgkmcnt(3)
    v_mfma_f32_16x16x32_bf16 v[28:31], v[148:151], v[156:159], v[28:31]
    ds_read_b128 v[172:175], v8 offset:10240
    s_add_u32 m0, s89, 32768
    s_nop 0
    buffer_load_dwordx4 v84, s[32:35], 0 offen lds
    v_mfma_f32_16x16x32_bf16 v[20:23], v[148:151], v[152:155], v[20:23]
    ds_read_b64_tr_b16 v[164:165], v11 offset:8192
    ds_read_b64_tr_b16 v[166:167], v11 offset:8704
    s_waitcnt lgkmcnt(3)
    v_mfma_f32_16x16x32_bf16 v[16:19], v[160:163], v[168:171], v[16:19]
    ds_read_b128 v[184:187], v9 offset:8192
    s_add_u32 m0, s89, 81920
    s_mov_b32 s91, 131072
    buffer_load_dwordx4 v13, s[40:43], s91 offen lds
    s_waitcnt lgkmcnt(3)
    v_mfma_f32_16x16x32_bf16 v[24:27], v[160:163], v[172:175], v[24:27]
    ds_read_b64_tr_b16 v[176:177], v10 offset:12288
    ds_read_b64_tr_b16 v[178:179], v10 offset:12800
    s_waitcnt lgkmcnt(3)
    v_mfma_f32_16x16x32_bf16 v[28:31], v[164:167], v[172:175], v[28:31]
    ds_read_b128 v[188:191], v9 offset:10240
    s_add_u32 m0, s89, 131072
    s_mov_b32 s91, 131200
    buffer_load_dwordx4 v13, s[40:43], s91 offen lds
    v_mfma_f32_16x16x32_bf16 v[20:23], v[164:167], v[168:171], v[20:23]
    ds_read_b64_tr_b16 v[180:181], v11 offset:12288
    ds_read_b64_tr_b16 v[182:183], v11 offset:12800
    s_waitcnt vmcnt(6)
    s_barrier
    s_waitcnt lgkmcnt(3)
    v_mfma_f32_16x16x32_bf16 v[16:19], v[176:179], v[184:187], v[16:19]
    ds_read_b128 v[136:139], v8 offset:16384
    s_waitcnt lgkmcnt(3)
    v_mfma_f32_16x16x32_bf16 v[24:27], v[176:179], v[188:191], v[24:27]
    ds_read_b64_tr_b16 v[128:129], v10 offset:16384
    ds_read_b64_tr_b16 v[130:131], v10 offset:16896
    s_waitcnt lgkmcnt(3)
    v_mfma_f32_16x16x32_bf16 v[28:31], v[180:183], v[188:191], v[28:31]
    ds_read_b128 v[140:143], v8 offset:18432
    s_add_u32 m0, s89, 40960
    s_nop 0
    buffer_load_dwordx4 v85, s[32:35], 0 offen lds
    v_mfma_f32_16x16x32_bf16 v[20:23], v[180:183], v[184:187], v[20:23]
    ds_read_b64_tr_b16 v[132:133], v11 offset:16384
    ds_read_b64_tr_b16 v[134:135], v11 offset:16896
    s_waitcnt lgkmcnt(3)
    v_mfma_f32_16x16x32_bf16 v[16:19], v[128:131], v[136:139], v[16:19]
    ds_read_b128 v[152:155], v9 offset:16384
    s_add_u32 m0, s89, 90112
    s_mov_b32 s91, 163840
    buffer_load_dwordx4 v13, s[40:43], s91 offen lds
    s_waitcnt lgkmcnt(3)
    v_mfma_f32_16x16x32_bf16 v[24:27], v[128:131], v[140:143], v[24:27]
    ds_read_b64_tr_b16 v[144:145], v10 offset:20480
    ds_read_b64_tr_b16 v[146:147], v10 offset:20992
    s_waitcnt lgkmcnt(3)
    v_mfma_f32_16x16x32_bf16 v[28:31], v[132:135], v[140:143], v[28:31]
    ds_read_b128 v[156:159], v9 offset:18432
    s_add_u32 m0, s89, 139264
    s_mov_b32 s91, 163968
    buffer_load_dwordx4 v13, s[40:43], s91 offen lds
    v_mfma_f32_16x16x32_bf16 v[20:23], v[132:135], v[136:139], v[20:23]
    ds_read_b64_tr_b16 v[148:149], v11 offset:20480
    ds_read_b64_tr_b16 v[150:151], v11 offset:20992
    s_waitcnt vmcnt(6)
    s_barrier
    s_waitcnt lgkmcnt(3)
    v_mfma_f32_16x16x32_bf16 v[16:19], v[144:147], v[152:155], v[16:19]
    ds_read_b128 v[168:171], v8 offset:24576
    s_waitcnt lgkmcnt(3)
    v_mfma_f32_16x16x32_bf16 v[24:27], v[144:147], v[156:159], v[24:27]
    ds_read_b64_tr_b16 v[160:161], v10 offset:24576
    ds_read_b64_tr_b16 v[162:163], v10 offset:25088
    s_waitcnt lgkmcnt(3)
    v_mfma_f32_16x16x32_bf16 v[28:31], v[148:151], v[156:159], v[28:31]
    ds_read_b128 v[172:175], v8 offset:26624
    s_add_u32 m0, s89, 0
    s_nop 0
    buffer_load_dwordx4 v86, s[32:35], 0 offen lds
    v_mfma_f32_16x16x32_bf16 v[20:23], v[148:151], v[152:155], v[20:23]
    ds_read_b64_tr_b16 v[164:165], v11 offset:24576
    ds_read_b64_tr_b16 v[166:167], v11 offset:25088
    s_waitcnt lgkmcnt(3)
    v_mfma_f32_16x16x32_bf16 v[16:19], v[160:163], v[168:171], v[16:19]
    ds_read_b128 v[184:187], v9 offset:24576
    s_add_u32 m0, s89, 49152
    s_mov_b32 s91, 196608
    buffer_load_dwordx4 v13, s[40:43], s91 offen lds
    s_waitcnt lgkmcnt(3)
    v_mfma_f32_16x16x32_bf16 v[24:27], v[160:163], v[172:175], v[24:27]
    ds_read_b64_tr_b16 v[176:177], v10 offset:28672
    ds_read_b64_tr_b16 v[178:179], v10 offset:29184
    s_waitcnt lgkmcnt(3)
    v_mfma_f32_16x16x32_bf16 v[28:31], v[164:167], v[172:175], v[28:31]
    ds_read_b128 v[188:191], v9 offset:26624
    s_add_u32 m0, s89, 98304
    s_mov_b32 s91, 196736
    buffer_load_dwordx4 v13, s[40:43], s91 offen lds
    v_mfma_f32_16x16x32_bf16 v[20:23], v[164:167], v[168:171], v[20:23]
    ds_read_b64_tr_b16 v[180:181], v11 offset:28672
    ds_read_b64_tr_b16 v[182:183], v11 offset:29184
    s_waitcnt vmcnt(6)
    s_barrier
    s_waitcnt lgkmcnt(3)
    v_mfma_f32_16x16x32_bf16 v[16:19], v[176:179], v[184:187], v[16:19]
    ds_read_b128 v[136:139], v8 offset:32768
    s_waitcnt lgkmcnt(3)
    v_mfma_f32_16x16x32_bf16 v[24:27], v[176:179], v[188:191], v[24:27]
    ds_read_b64_tr_b16 v[128:129], v10 offset:32768
    ds_read_b64_tr_b16 v[130:131], v10 offset:33280
    s_waitcnt lgkmcnt(3)
    v_mfma_f32_16x16x32_bf16 v[28:31], v[180:183], v[188:191], v[28:31]
    ds_read_b128 v[140:143], v8 offset:34816
    s_add_u32 m0, s89, 8192
    s_nop 0
    buffer_load_dwordx4 v87, s[32:35], 0 offen lds
    v_mfma_f32_16x16x32_bf16 v[20:23], v[180:183], v[184:187], v[20:23]
    ds_read_b64_tr_b16 v[132:133], v11 offset:32768
    ds_read_b64_tr_b16 v[134:135], v11 offset:33280
    s_waitcnt lgkmcnt(3)
    v_mfma_f32_16x16x32_bf16 v[16:19], v[128:131], v[136:139], v[16:19]
    ds_read_b128 v[152:155], v9 offset:32768
    s_add_u32 m0, s89, 57344
    s_mov_b32 s91, 229376
    buffer_load_dwordx4 v13, s[40:43], s91 offen lds
    s_waitcnt lgkmcnt(3)
    v_mfma_f32_16x16x32_bf16 v[24:27], v[128:131], v[140:143], v[24:27]
    ds_read_b64_tr_b16 v[144:145], v10 offset:36864
    ds_read_b64_tr_b16 v[146:147], v10 offset:37376
    s_waitcnt lgkmcnt(3)
    v_mfma_f32_16x16x32_bf16 v[28:31], v[132:135], v[140:143], v[28:31]
    ds_read_b128 v[156:159], v9 offset:34816
    s_add_u32 m0, s89, 106496
    s_mov_b32 s91, 229504
    buffer_load_dwordx4 v13, s[40:43], s91 offen lds
    v_mfma_f32_16x16x32_bf16 v[20:23], v[132:135], v[136:139], v[20:23]
    ds_read_b64_tr_b16 v[148:149], v11 offset:36864
    ds_read_b64_tr_b16 v[150:151], v11 offset:37376
    s_waitcnt vmcnt(6)
    s_barrier
    s_waitcnt lgkmcnt(3)
    v_mfma_f32_16x16x32_bf16 v[16:19], v[144:147], v[152:155], v[16:19]
    ds_read_b128 v[168:171], v8 offset:40960
    s_waitcnt lgkmcnt(3)
    v_mfma_f32_16x16x32_bf16 v[24:27], v[144:147], v[156:159], v[24:27]
    ds_read_b64_tr_b16 v[160:161], v10 offset:40960
    ds_read_b64_tr_b16 v[162:163], v10 offset:41472
    s_waitcnt lgkmcnt(3)
    v_mfma_f32_16x16x32_bf16 v[28:31], v[148:151], v[156:159], v[28:31]
    ds_read_b128 v[172:175], v8 offset:43008
    s_add_u32 m0, s89, 16384
    s_nop 0
    buffer_load_dwordx4 v88, s[32:35], 0 offen lds
    v_mfma_f32_16x16x32_bf16 v[20:23], v[148:151], v[152:155], v[20:23]
    ds_read_b64_tr_b16 v[164:165], v11 offset:40960
    ds_read_b64_tr_b16 v[166:167], v11 offset:41472
    s_waitcnt lgkmcnt(3)
    v_mfma_f32_16x16x32_bf16 v[16:19], v[160:163], v[168:171], v[16:19]
    ds_read_b128 v[184:187], v9 offset:40960
    s_add_u32 m0, s89, 65536
    s_mov_b32 s91, 262144
    buffer_load_dwordx4 v13, s[40:43], s91 offen lds
    s_waitcnt lgkmcnt(3)
    v_mfma_f32_16x16x32_bf16 v[24:27], v[160:163], v[172:175], v[24:27]
    ds_read_b64_tr_b16 v[176:177], v10 offset:45056
    ds_read_b64_tr_b16 v[178:179], v10 offset:45568
    s_waitcnt lgkmcnt(3)
    v_mfma_f32_16x16x32_bf16 v[28:31], v[164:167], v[172:175], v[28:31]
    ds_read_b128 v[188:191], v9 offset:43008
    s_add_u32 m0, s89, 114688
    s_mov_b32 s91, 262272
    buffer_load_dwordx4 v13, s[40:43], s91 offen lds
    v_mfma_f32_16x16x32_bf16 v[20:23], v[164:167], v[168:171], v[20:23]
    ds_read_b64_tr_b16 v[180:181], v11 offset:45056
    ds_read_b64_tr_b16 v[182:183], v11 offset:45568
    s_waitcnt vmcnt(6)
    s_barrier
    s_waitcnt lgkmcnt(3)
    v_mfma_f32_16x16x32_bf16 v[16:19], v[176:179], v[184:187], v[16:19]
    ds_read_b128 v[136:139], v8 offset:0
    s_waitcnt lgkmcnt(3)
    v_mfma_f32_16x16x32_bf16 v[24:27], v[176:179], v[188:191], v[24:27]
    ds_read_b64_tr_b16 v[128:129], v10 offset:0
    ds_read_b64_tr_b16 v[130:131], v10 offset:512
    s_waitcnt lgkmcnt(3)
    v_mfma_f32_16x16x32_bf16 v[28:31], v[180:183], v[188:191], v[28:31]
    ds_read_b128 v[140:143], v8 offset:2048
    s_add_u32 m0, s89, 24576
    s_nop 0
    buffer_load_dwordx4 v89, s[32:35], 0 offen lds
    v_mfma_f32_16x16x32_bf16 v[20:23], v[180:183], v[184:187], v[20:23]
    ds_read_b64_tr_b16 v[132:133], v11 offset:0
    ds_read_b64_tr_b16 v[134:135], v11 offset:512
    s_waitcnt lgkmcnt(3)
    v_mfma_f32_16x16x32_bf16 v[16:19], v[128:131], v[136:139], v[16:19]
    ds_read_b128 v[152:155], v9 offset:0
    s_add_u32 m0, s89, 73728
    s_mov_b32 s91, 294912
    buffer_load_dwordx4 v13, s[40:43], s91 offen lds
    s_waitcnt lgkmcnt(3)
    v_mfma_f32_16x16x32_bf16 v[24:27], v[128:131], v[140:143], v[24:27]
    ds_read_b64_tr_b16 v[144:145], v10 offset:4096
    ds_read_b64_tr_b16 v[146:147], v10 offset:4608
    s_waitcnt lgkmcnt(3)
    v_mfma_f32_16x16x32_bf16 v[28:31], v[132:135], v[140:143], v[28:31]
    ds_read_b128 v[156:159], v9 offset:2048
    s_add_u32 m0, s89, 122880
    s_mov_b32 s91, 295040
    buffer_load_dwordx4 v13, s[40:43], s91 offen lds
    v_mfma_f32_16x16x32_bf16 v[20:23], v[132:135], v[136:139], v[20:23]
    ds_read_b64_tr_b16 v[148:149], v11 offset:4096
    ds_read_b64_tr_b16 v[150:151], v11 offset:4608
    s_waitcnt vmcnt(6)
    s_barrier
    s_waitcnt lgkmcnt(3)
    v_mfma_f32_16x16x32_bf16 v[16:19], v[144:147], v[152:155], v[16:19]
    ds_read_b128 v[168:171], v8 offset:8192
    s_waitcnt lgkmcnt(3)
    v_mfma_f32_16x16x32_bf16 v[24:27], v[144:147], v[156:159], v[24:27]
    ds_read_b64_tr_b16 v[160:161], v10 offset:8192
    ds_read_b64_tr_b16 v[162:163], v10 offset:8704
    s_waitcnt lgkmcnt(3)
    v_mfma_f32_16x16x32_bf16 v[28:31], v[148:151], v[156:159], v[28:31]
    ds_read_b128 v[172:175], v8 offset:10240
    s_add_u32 m0, s89, 32768
    s_nop 0
    buffer_load_dwordx4 v90, s[32:35], 0 offen lds
    v_mfma_f32_16x16x32_bf16 v[20:23], v[148:151], v[152:155], v[20:23]
    ds_read_b64_tr_b16 v[164:165], v11 offset:8192
    ds_read_b64_tr_b16 v[166:167], v11 offset:8704
    s_waitcnt lgkmcnt(3)
    v_mfma_f32_16x16x32_bf16 v[16:19], v[160:163], v[168:171], v[16:19]
    ds_read_b128 v[184:187], v9 offset:8192
    s_add_u32 m0, s89, 81920
    s_mov_b32 s91, 327680
    buffer_load_dwordx4 v13, s[40:43], s91 offen lds
    s_waitcnt lgkmcnt(3)
    v_mfma_f32_16x16x32_bf16 v[24:27], v[160:163], v[172:175], v[24:27]
    ds_read_b64_tr_b16 v[176:177], v10 offset:12288
    ds_read_b64_tr_b16 v[178:179], v10 offset:12800
    s_waitcnt lgkmcnt(3)
    v_mfma_f32_16x16x32_bf16 v[28:31], v[164:167], v[172:175], v[28:31]
    ds_read_b128 v[188:191], v9 offset:10240
    s_add_u32 m0, s89, 131072
    s_mov_b32 s91, 327808
    buffer_load_dwordx4 v13, s[40:43], s91 offen lds
    v_mfma_f32_16x16x32_bf16 v[20:23], v[164:167], v[168:171], v[20:23]
    ds_read_b64_tr_b16 v[180:181], v11 offset:12288
    ds_read_b64_tr_b16 v[182:183], v11 offset:12800
    s_waitcnt vmcnt(6)
    s_barrier
    s_waitcnt lgkmcnt(3)
    v_mfma_f32_16x16x32_bf16 v[16:19], v[176:179], v[184:187], v[16:19]
    ds_read_b128 v[136:139], v8 offset:16384
    s_waitcnt lgkmcnt(3)
    v_mfma_f32_16x16x32_bf16 v[24:27], v[176:179], v[188:191], v[24:27]
    ds_read_b64_tr_b16 v[128:129], v10 offset:16384
    ds_read_b64_tr_b16 v[130:131], v10 offset:16896
    s_waitcnt lgkmcnt(3)
    v_mfma_f32_16x16x32_bf16 v[28:31], v[180:183], v[188:191], v[28:31]
    ds_read_b128 v[140:143], v8 offset:18432
    s_add_u32 m0, s89, 40960
    s_nop 0
    buffer_load_dwordx4 v91, s[32:35], 0 offen lds
    v_mfma_f32_16x16x32_bf16 v[20:23], v[180:183], v[184:187], v[20:23]
    ds_read_b64_tr_b16 v[132:133], v11 offset:16384
    ds_read_b64_tr_b16 v[134:135], v11 offset:16896
    s_waitcnt lgkmcnt(3)
    v_mfma_f32_16x16x32_bf16 v[16:19], v[128:131], v[136:139], v[16:19]
    ds_read_b128 v[152:155], v9 offset:16384
    s_add_u32 m0, s89, 90112
    s_mov_b32 s91, 360448
    buffer_load_dwordx4 v13, s[40:43], s91 offen lds
    s_waitcnt lgkmcnt(3)
    v_mfma_f32_16x16x32_bf16 v[24:27], v[128:131], v[140:143], v[24:27]
    ds_read_b64_tr_b16 v[144:145], v10 offset:20480
    ds_read_b64_tr_b16 v[146:147], v10 offset:20992
    s_waitcnt lgkmcnt(3)
    v_mfma_f32_16x16x32_bf16 v[28:31], v[132:135], v[140:143], v[28:31]
    ds_read_b128 v[156:159], v9 offset:18432
    s_add_u32 m0, s89, 139264
    s_mov_b32 s91, 360576
    buffer_load_dwordx4 v13, s[40:43], s91 offen lds
    v_mfma_f32_16x16x32_bf16 v[20:23], v[132:135], v[136:139], v[20:23]
    ds_read_b64_tr_b16 v[148:149], v11 offset:20480
    ds_read_b64_tr_b16 v[150:151], v11 offset:20992
    s_waitcnt vmcnt(6)
    s_barrier
    s_waitcnt lgkmcnt(3)
    v_mfma_f32_16x16x32_bf16 v[16:19], v[144:147], v[152:155], v[16:19]
    ds_read_b128 v[168:171], v8 offset:24576
    s_waitcnt lgkmcnt(3)
    v_mfma_f32_16x16x32_bf16 v[24:27], v[144:147], v[156:159], v[24:27]
    ds_read_b64_tr_b16 v[160:161], v10 offset:24576
    ds_read_b64_tr_b16 v[162:163], v10 offset:25088
    s_waitcnt lgkmcnt(3)
    v_mfma_f32_16x16x32_bf16 v[28:31], v[148:151], v[156:159], v[28:31]
    ds_read_b128 v[172:175], v8 offset:26624
    s_add_u32 m0, s89, 0
    s_nop 0
    buffer_load_dwordx4 v92, s[32:35], 0 offen lds
    v_mfma_f32_16x16x32_bf16 v[20:23], v[148:151], v[152:155], v[20:23]
    ds_read_b64_tr_b16 v[164:165], v11 offset:24576
    ds_read_b64_tr_b16 v[166:167], v11 offset:25088
    s_waitcnt lgkmcnt(3)
    v_mfma_f32_16x16x32_bf16 v[16:19], v[160:163], v[168:171], v[16:19]
    ds_read_b128 v[184:187], v9 offset:24576
    s_add_u32 m0, s89, 49152
    s_mov_b32 s91, 393216
    buffer_load_dwordx4 v13, s[40:43], s91 offen lds
    s_waitcnt lgkmcnt(3)
    v_mfma_f32_16x16x32_bf16 v[24:27], v[160:163], v[172:175], v[24:27]
    ds_read_b64_tr_b16 v[176:177], v10 offset:28672
    ds_read_b64_tr_b16 v[178:179], v10 offset:29184
    s_waitcnt lgkmcnt(3)
    v_mfma_f32_16x16x32_bf16 v[28:31], v[164:167], v[172:175], v[28:31]
    ds_read_b128 v[188:191], v9 offset:26624
    s_add_u32 m0, s89, 98304
    s_mov_b32 s91, 393344
    buffer_load_dwordx4 v13, s[40:43], s91 offen lds
    v_mfma_f32_16x16x32_bf16 v[20:23], v[164:167], v[168:171], v[20:23]
    ds_read_b64_tr_b16 v[180:181], v11 offset:28672
    ds_read_b64_tr_b16 v[182:183], v11 offset:29184
    s_waitcnt vmcnt(6)
    s_barrier
    s_waitcnt lgkmcnt(3)
    v_mfma_f32_16x16x32_bf16 v[16:19], v[176:179], v[184:187], v[16:19]
    ds_read_b128 v[136:139], v8 offset:32768
    s_waitcnt lgkmcnt(3)
    v_mfma_f32_16x16x32_bf16 v[24:27], v[176:179], v[188:191], v[24:27]
    ds_read_b64_tr_b16 v[128:129], v10 offset:32768
    ds_read_b64_tr_b16 v[130:131], v10 offset:33280
    s_waitcnt lgkmcnt(3)
    v_mfma_f32_16x16x32_bf16 v[28:31], v[180:183], v[188:191], v[28:31]
    ds_read_b128 v[140:143], v8 offset:34816
    s_add_u32 m0, s89, 8192
    s_nop 0
    buffer_load_dwordx4 v93, s[32:35], 0 offen lds
    v_mfma_f32_16x16x32_bf16 v[20:23], v[180:183], v[184:187], v[20:23]
    ds_read_b64_tr_b16 v[132:133], v11 offset:32768
    ds_read_b64_tr_b16 v[134:135], v11 offset:33280
    s_waitcnt lgkmcnt(3)
    v_mfma_f32_16x16x32_bf16 v[16:19], v[128:131], v[136:139], v[16:19]
    ds_read_b128 v[152:155], v9 offset:32768
    s_add_u32 m0, s89, 57344
    s_mov_b32 s91, 425984
    buffer_load_dwordx4 v13, s[40:43], s91 offen lds
    s_waitcnt lgkmcnt(3)
    v_mfma_f32_16x16x32_bf16 v[24:27], v[128:131], v[140:143], v[24:27]
    ds_read_b64_tr_b16 v[144:145], v10 offset:36864
    ds_read_b64_tr_b16 v[146:147], v10 offset:37376
    s_waitcnt lgkmcnt(3)
    v_mfma_f32_16x16x32_bf16 v[28:31], v[132:135], v[140:143], v[28:31]
    ds_read_b128 v[156:159], v9 offset:34816
    s_add_u32 m0, s89, 106496
    s_mov_b32 s91, 426112
    buffer_load_dwordx4 v13, s[40:43], s91 offen lds
    v_mfma_f32_16x16x32_bf16 v[20:23], v[132:135], v[136:139], v[20:23]
    ds_read_b64_tr_b16 v[148:149], v11 offset:36864
    ds_read_b64_tr_b16 v[150:151], v11 offset:37376
    s_waitcnt vmcnt(6)
    s_barrier
    s_waitcnt lgkmcnt(3)
    v_mfma_f32_16x16x32_bf16 v[16:19], v[144:147], v[152:155], v[16:19]
    ds_read_b128 v[168:171], v8 offset:40960
    s_waitcnt lgkmcnt(3)
    v_mfma_f32_16x16x32_bf16 v[24:27], v[144:147], v[156:159], v[24:27]
    ds_read_b64_tr_b16 v[160:161], v10 offset:40960
    ds_read_b64_tr_b16 v[162:163], v10 offset:41472
    s_waitcnt lgkmcnt(3)
    v_mfma_f32_16x16x32_bf16 v[28:31], v[148:151], v[156:159], v[28:31]
    ds_read_b128 v[172:175], v8 offset:43008
    s_add_u32 m0, s89, 16384
    s_nop 0
    buffer_load_dwordx4 v94, s[32:35], 0 offen lds
    v_mfma_f32_16x16x32_bf16 v[20:23], v[148:151], v[152:155], v[20:23]
    ds_read_b64_tr_b16 v[164:165], v11 offset:40960
    ds_read_b64_tr_b16 v[166:167], v11 offset:41472
    s_waitcnt lgkmcnt(3)
    v_mfma_f32_16x16x32_bf16 v[16:19], v[160:163], v[168:171], v[16:19]
    ds_read_b128 v[184:187], v9 offset:40960
    s_add_u32 m0, s89, 65536
    s_mov_b32 s91, 458752
    buffer_load_dwordx4 v13, s[40:43], s91 offen lds
    s_waitcnt lgkmcnt(3)
    v_mfma_f32_16x16x32_bf16 v[24:27], v[160:163], v[172:175], v[24:27]
    ds_read_b64_tr_b16 v[176:177], v10 offset:45056
    ds_read_b64_tr_b16 v[178:179], v10 offset:45568
    s_waitcnt lgkmcnt(3)
    v_mfma_f32_16x16x32_bf16 v[28:31], v[164:167], v[172:175], v[28:31]
    ds_read_b128 v[188:191], v9 offset:43008
    s_add_u32 m0, s89, 114688
    s_mov_b32 s91, 458880
    buffer_load_dwordx4 v13, s[40:43], s91 offen lds
    v_mfma_f32_16x16x32_bf16 v[20:23], v[164:167], v[168:171], v[20:23]
    ds_read_b64_tr_b16 v[180:181], v11 offset:45056
    ds_read_b64_tr_b16 v[182:183], v11 offset:45568
    s_waitcnt vmcnt(6)
    s_barrier
    s_waitcnt lgkmcnt(3)
    v_mfma_f32_16x16x32_bf16 v[16:19], v[176:179], v[184:187], v[16:19]
    ds_read_b128 v[136:139], v8 offset:0
    s_waitcnt lgkmcnt(3)
    v_mfma_f32_16x16x32_bf16 v[24:27], v[176:179], v[188:191], v[24:27]
    ds_read_b64_tr_b16 v[128:129], v10 offset:0
    ds_read_b64_tr_b16 v[130:131], v10 offset:512
    s_waitcnt lgkmcnt(3)
    v_mfma_f32_16x16x32_bf16 v[28:31], v[180:183], v[188:191], v[28:31]
    ds_read_b128 v[140:143], v8 offset:2048
    s_add_u32 m0, s89, 24576
    s_nop 0
    buffer_load_dwordx4 v95, s[32:35], 0 offen lds
    v_mfma_f32_16x16x32_bf16 v[20:23], v[180:183], v[184:187], v[20:23]
    ds_read_b64_tr_b16 v[132:133], v11 offset:0
    ds_read_b64_tr_b16 v[134:135], v11 offset:512
    s_waitcnt lgkmcnt(3)
    v_mfma_f32_16x16x32_bf16 v[16:19], v[128:131], v[136:139], v[16:19]
    ds_read_b128 v[152:155], v9 offset:0
    s_add_u32 m0, s89, 73728
    s_mov_b32 s91, 491520
    buffer_load_dwordx4 v13, s[40:43], s91 offen lds
    s_waitcnt lgkmcnt(3)
    v_mfma_f32_16x16x32_bf16 v[24:27], v[128:131], v[140:143], v[24:27]
    ds_read_b64_tr_b16 v[144:145], v10 offset:4096
    ds_read_b64_tr_b16 v[146:147], v10 offset:4608
    s_waitcnt lgkmcnt(3)
    v_mfma_f32_16x16x32_bf16 v[28:31], v[132:135], v[140:143], v[28:31]
    ds_read_b128 v[156:159], v9 offset:2048
    s_add_u32 m0, s89, 122880
    s_mov_b32 s91, 491648
    buffer_load_dwordx4 v13, s[40:43], s91 offen lds
    v_mfma_f32_16x16x32_bf16 v[20:23], v[132:135], v[136:139], v[20:23]
    ds_read_b64_tr_b16 v[148:149], v11 offset:4096
    ds_read_b64_tr_b16 v[150:151], v11 offset:4608
    s_waitcnt vmcnt(6)
    s_barrier
    s_waitcnt lgkmcnt(3)
    v_mfma_f32_16x16x32_bf16 v[16:19], v[144:147], v[152:155], v[16:19]
    ds_read_b128 v[168:171], v8 offset:8192
    s_waitcnt lgkmcnt(3)
    v_mfma_f32_16x16x32_bf16 v[24:27], v[144:147], v[156:159], v[24:27]
    ds_read_b64_tr_b16 v[160:161], v10 offset:8192
    ds_read_b64_tr_b16 v[162:163], v10 offset:8704
    s_waitcnt lgkmcnt(3)
    v_mfma_f32_16x16x32_bf16 v[28:31], v[148:151], v[156:159], v[28:31]
    ds_read_b128 v[172:175], v8 offset:10240
    s_add_u32 m0, s89, 32768
    s_nop 0
    buffer_load_dwordx4 v96, s[32:35], 0 offen lds
    v_mfma_f32_16x16x32_bf16 v[20:23], v[148:151], v[152:155], v[20:23]
    ds_read_b64_tr_b16 v[164:165], v11 offset:8192
    ds_read_b64_tr_b16 v[166:167], v11 offset:8704
    s_waitcnt lgkmcnt(3)
    v_mfma_f32_16x16x32_bf16 v[16:19], v[160:163], v[168:171], v[16:19]
    ds_read_b128 v[184:187], v9 offset:8192
    s_add_u32 m0, s89, 81920
    s_mov_b32 s91, 524288
    buffer_load_dwordx4 v13, s[40:43], s91 offen lds
    s_waitcnt lgkmcnt(3)
    v_mfma_f32_16x16x32_bf16 v[24:27], v[160:163], v[172:175], v[24:27]
    ds_read_b64_tr_b16 v[176:177], v10 offset:12288
    ds_read_b64_tr_b16 v[178:179], v10 offset:12800
    s_waitcnt lgkmcnt(3)
    v_mfma_f32_16x16x32_bf16 v[28:31], v[164:167], v[172:175], v[28:31]
    ds_read_b128 v[188:191], v9 offset:10240
    s_add_u32 m0, s89, 131072
    s_mov_b32 s91, 524416
    buffer_load_dwordx4 v13, s[40:43], s91 offen lds
    v_mfma_f32_16x16x32_bf16 v[20:23], v[164:167], v[168:171], v[20:23]
    ds_read_b64_tr_b16 v[180:181], v11 offset:12288
    ds_read_b64_tr_b16 v[182:183], v11 offset:12800
    s_waitcnt vmcnt(6)
    s_barrier
    s_waitcnt lgkmcnt(3)
    v_mfma_f32_16x16x32_bf16 v[16:19], v[176:179], v[184:187], v[16:19]
    ds_read_b128 v[136:139], v8 offset:16384
    s_waitcnt lgkmcnt(3)
    v_mfma_f32_16x16x32_bf16 v[24:27], v[176:179], v[188:191], v[24:27]
    ds_read_b64_tr_b16 v[128:129], v10 offset:16384
    ds_read_b64_tr_b16 v[130:131], v10 offset:16896
    s_waitcnt lgkmcnt(3)
    v_mfma_f32_16x16x32_bf16 v[28:31], v[180:183], v[188:191], v[28:31]
    ds_read_b128 v[140:143], v8 offset:18432
    s_add_u32 m0, s89, 40960
    s_nop 0
    buffer_load_dwordx4 v97, s[32:35], 0 offen lds
    v_mfma_f32_16x16x32_bf16 v[20:23], v[180:183], v[184:187], v[20:23]
    ds_read_b64_tr_b16 v[132:133], v11 offset:16384
    ds_read_b64_tr_b16 v[134:135], v11 offset:16896
    s_waitcnt lgkmcnt(3)
    v_mfma_f32_16x16x32_bf16 v[16:19], v[128:131], v[136:139], v[16:19]
    ds_read_b128 v[152:155], v9 offset:16384
    s_add_u32 m0, s89, 90112
    s_mov_b32 s91, 557056
    buffer_load_dwordx4 v13, s[40:43], s91 offen lds
    s_waitcnt lgkmcnt(3)
    v_mfma_f32_16x16x32_bf16 v[24:27], v[128:131], v[140:143], v[24:27]
    ds_read_b64_tr_b16 v[144:145], v10 offset:20480
    ds_read_b64_tr_b16 v[146:147], v10 offset:20992
    s_waitcnt lgkmcnt(3)
    v_mfma_f32_16x16x32_bf16 v[28:31], v[132:135], v[140:143], v[28:31]
    ds_read_b128 v[156:159], v9 offset:18432
    s_add_u32 m0, s89, 139264
    s_mov_b32 s91, 557184
    buffer_load_dwordx4 v13, s[40:43], s91 offen lds
    v_mfma_f32_16x16x32_bf16 v[20:23], v[132:135], v[136:139], v[20:23]
    ds_read_b64_tr_b16 v[148:149], v11 offset:20480
    ds_read_b64_tr_b16 v[150:151], v11 offset:20992
    s_waitcnt vmcnt(6)
    s_barrier
    s_waitcnt lgkmcnt(3)
    v_mfma_f32_16x16x32_bf16 v[16:19], v[144:147], v[152:155], v[16:19]
    ds_read_b128 v[168:171], v8 offset:24576
    s_waitcnt lgkmcnt(3)
    v_mfma_f32_16x16x32_bf16 v[24:27], v[144:147], v[156:159], v[24:27]
    ds_read_b64_tr_b16 v[160:161], v10 offset:24576
    ds_read_b64_tr_b16 v[162:163], v10 offset:25088
    s_waitcnt lgkmcnt(3)
    v_mfma_f32_16x16x32_bf16 v[28:31], v[148:151], v[156:159], v[28:31]
    ds_read_b128 v[172:175], v8 offset:26624
    s_add_u32 m0, s89, 0
    s_nop 0
    buffer_load_dwordx4 v98, s[32:35], 0 offen lds
    v_mfma_f32_16x16x32_bf16 v[20:23], v[148:151], v[152:155], v[20:23]
    ds_read_b64_tr_b16 v[164:165], v11 offset:24576
    ds_read_b64_tr_b16 v[166:167], v11 offset:25088
    s_waitcnt lgkmcnt(3)
    v_mfma_f32_16x16x32_bf16 v[16:19], v[160:163], v[168:171], v[16:19]
    ds_read_b128 v[184:187], v9 offset:24576
    s_add_u32 m0, s89, 49152
    s_mov_b32 s91, 589824
    buffer_load_dwordx4 v13, s[40:43], s91 offen lds
    s_waitcnt lgkmcnt(3)
    v_mfma_f32_16x16x32_bf16 v[24:27], v[160:163], v[172:175], v[24:27]
    ds_read_b64_tr_b16 v[176:177], v10 offset:28672
    ds_read_b64_tr_b16 v[178:179], v10 offset:29184
    s_waitcnt lgkmcnt(3)
    v_mfma_f32_16x16x32_bf16 v[28:31], v[164:167], v[172:175], v[28:31]
    ds_read_b128 v[188:191], v9 offset:26624
    s_add_u32 m0, s89, 98304
    s_mov_b32 s91, 589952
    buffer_load_dwordx4 v13, s[40:43], s91 offen lds
    v_mfma_f32_16x16x32_bf16 v[20:23], v[164:167], v[168:171], v[20:23]
    ds_read_b64_tr_b16 v[180:181], v11 offset:28672
    ds_read_b64_tr_b16 v[182:183], v11 offset:29184
    s_waitcnt vmcnt(6)
    s_barrier
    s_waitcnt lgkmcnt(3)
    v_mfma_f32_16x16x32_bf16 v[16:19], v[176:179], v[184:187], v[16:19]
    ds_read_b128 v[136:139], v8 offset:32768
    s_waitcnt lgkmcnt(3)
    v_mfma_f32_16x16x32_bf16 v[24:27], v[176:179], v[188:191], v[24:27]
    ds_read_b64_tr_b16 v[128:129], v10 offset:32768
    ds_read_b64_tr_b16 v[130:131], v10 offset:33280
    s_waitcnt lgkmcnt(3)
    v_mfma_f32_16x16x32_bf16 v[28:31], v[180:183], v[188:191], v[28:31]
    ds_read_b128 v[140:143], v8 offset:34816
    s_add_u32 m0, s89, 8192
    s_nop 0
    buffer_load_dwordx4 v99, s[32:35], 0 offen lds
    v_mfma_f32_16x16x32_bf16 v[20:23], v[180:183], v[184:187], v[20:23]
    ds_read_b64_tr_b16 v[132:133], v11 offset:32768
    ds_read_b64_tr_b16 v[134:135], v11 offset:33280
    s_waitcnt lgkmcnt(3)
    v_mfma_f32_16x16x32_bf16 v[16:19], v[128:131], v[136:139], v[16:19]
    ds_read_b128 v[152:155], v9 offset:32768
    s_add_u32 m0, s89, 57344
    s_mov_b32 s91, 622592
    buffer_load_dwordx4 v13, s[40:43], s91 offen lds
    s_waitcnt lgkmcnt(3)
    v_mfma_f32_16x16x32_bf16 v[24:27], v[128:131], v[140:143], v[24:27]
    ds_read_b64_tr_b16 v[144:145], v10 offset:36864
    ds_read_b64_tr_b16 v[146:147], v10 offset:37376
    s_waitcnt lgkmcnt(3)
    v_mfma_f32_16x16x32_bf16 v[28:31], v[132:135], v[140:143], v[28:31]
    ds_read_b128 v[156:159], v9 offset:34816
    s_add_u32 m0, s89, 106496
    s_mov_b32 s91, 622720
    buffer_load_dwordx4 v13, s[40:43], s91 offen lds
    v_mfma_f32_16x16x32_bf16 v[20:23], v[132:135], v[136:139], v[20:23]
    ds_read_b64_tr_b16 v[148:149], v11 offset:36864
    ds_read_b64_tr_b16 v[150:151], v11 offset:37376
    s_waitcnt vmcnt(6)
    s_barrier
    s_waitcnt lgkmcnt(3)
    v_mfma_f32_16x16x32_bf16 v[16:19], v[144:147], v[152:155], v[16:19]
    ds_read_b128 v[168:171], v8 offset:40960
    s_waitcnt lgkmcnt(3)
    v_mfma_f32_16x16x32_bf16 v[24:27], v[144:147], v[156:159], v[24:27]
    ds_read_b64_tr_b16 v[160:161], v10 offset:40960
    ds_read_b64_tr_b16 v[162:163], v10 offset:41472
    s_waitcnt lgkmcnt(3)
    v_mfma_f32_16x16x32_bf16 v[28:31], v[148:151], v[156:159], v[28:31]
    ds_read_b128 v[172:175], v8 offset:43008
    s_add_u32 m0, s89, 16384
    s_nop 0
    buffer_load_dwordx4 v100, s[32:35], 0 offen lds
    v_mfma_f32_16x16x32_bf16 v[20:23], v[148:151], v[152:155], v[20:23]
    ds_read_b64_tr_b16 v[164:165], v11 offset:40960
    ds_read_b64_tr_b16 v[166:167], v11 offset:41472
    s_waitcnt lgkmcnt(3)
    v_mfma_f32_16x16x32_bf16 v[16:19], v[160:163], v[168:171], v[16:19]
    ds_read_b128 v[184:187], v9 offset:40960
    s_add_u32 m0, s89, 65536
    s_mov_b32 s91, 655360
    buffer_load_dwordx4 v13, s[40:43], s91 offen lds
    s_waitcnt lgkmcnt(3)
    v_mfma_f32_16x16x32_bf16 v[24:27], v[160:163], v[172:175], v[24:27]
    ds_read_b64_tr_b16 v[176:177], v10 offset:45056
    ds_read_b64_tr_b16 v[178:179], v10 offset:45568
    s_waitcnt lgkmcnt(3)
    v_mfma_f32_16x16x32_bf16 v[28:31], v[164:167], v[172:175], v[28:31]
    ds_read_b128 v[188:191], v9 offset:43008
    s_add_u32 m0, s89, 114688
    s_mov_b32 s91, 655488
    buffer_load_dwordx4 v13, s[40:43], s91 offen lds
    v_mfma_f32_16x16x32_bf16 v[20:23], v[164:167], v[168:171], v[20:23]
    ds_read_b64_tr_b16 v[180:181], v11 offset:45056
    ds_read_b64_tr_b16 v[182:183], v11 offset:45568
    s_waitcnt vmcnt(6)
    s_barrier
    s_waitcnt lgkmcnt(3)
    v_mfma_f32_16x16x32_bf16 v[16:19], v[176:179], v[184:187], v[16:19]
    ds_read_b128 v[136:139], v8 offset:0
    s_waitcnt lgkmcnt(3)
    v_mfma_f32_16x16x32_bf16 v[24:27], v[176:179], v[188:191], v[24:27]
    ds_read_b64_tr_b16 v[128:129], v10 offset:0
    ds_read_b64_tr_b16 v[130:131], v10 offset:512
    s_waitcnt lgkmcnt(3)
    v_mfma_f32_16x16x32_bf16 v[28:31], v[180:183], v[188:191], v[28:31]
    ds_read_b128 v[140:143], v8 offset:2048
    s_add_u32 m0, s89, 24576
    s_nop 0
    buffer_load_dwordx4 v101, s[32:35], 0 offen lds
    v_mfma_f32_16x16x32_bf16 v[20:23], v[180:183], v[184:187], v[20:23]
    ds_read_b64_tr_b16 v[132:133], v11 offset:0
    ds_read_b64_tr_b16 v[134:135], v11 offset:512
    s_waitcnt lgkmcnt(3)
    v_mfma_f32_16x16x32_bf16 v[16:19], v[128:131], v[136:139], v[16:19]
    ds_read_b128 v[152:155], v9 offset:0
    s_add_u32 m0, s89, 73728
    s_mov_b32 s91, 688128
    buffer_load_dwordx4 v13, s[40:43], s91 offen lds
    s_waitcnt lgkmcnt(3)
    v_mfma_f32_16x16x32_bf16 v[24:27], v[128:131], v[140:143], v[24:27]
    ds_read_b64_tr_b16 v[144:145], v10 offset:4096
    ds_read_b64_tr_b16 v[146:147], v10 offset:4608
    s_waitcnt lgkmcnt(3)
    v_mfma_f32_16x16x32_bf16 v[28:31], v[132:135], v[140:143], v[28:31]
    ds_read_b128 v[156:159], v9 offset:2048
    s_add_u32 m0, s89, 122880
    s_mov_b32 s91, 688256
    buffer_load_dwordx4 v13, s[40:43], s91 offen lds
    v_mfma_f32_16x16x32_bf16 v[20:23], v[132:135], v[136:139], v[20:23]
    ds_read_b64_tr_b16 v[148:149], v11 offset:4096
    ds_read_b64_tr_b16 v[150:151], v11 offset:4608
    s_waitcnt vmcnt(6)
    s_barrier
    s_waitcnt lgkmcnt(3)
    v_mfma_f32_16x16x32_bf16 v[16:19], v[144:147], v[152:155], v[16:19]
    ds_read_b128 v[168:171], v8 offset:8192
    s_waitcnt lgkmcnt(3)
    v_mfma_f32_16x16x32_bf16 v[24:27], v[144:147], v[156:159], v[24:27]
    ds_read_b64_tr_b16 v[160:161], v10 offset:8192
    ds_read_b64_tr_b16 v[162:163], v10 offset:8704
    s_waitcnt lgkmcnt(3)
    v_mfma_f32_16x16x32_bf16 v[28:31], v[148:151], v[156:159], v[28:31]
    ds_read_b128 v[172:175], v8 offset:10240
    s_add_u32 m0, s89, 32768
    s_nop 0
    buffer_load_dwordx4 v102, s[32:35], 0 offen lds
    v_mfma_f32_16x16x32_bf16 v[20:23], v[148:151], v[152:155], v[20:23]
    ds_read_b64_tr_b16 v[164:165], v11 offset:8192
    ds_read_b64_tr_b16 v[166:167], v11 offset:8704
    s_waitcnt lgkmcnt(3)
    v_mfma_f32_16x16x32_bf16 v[16:19], v[160:163], v[168:171], v[16:19]
    ds_read_b128 v[184:187], v9 offset:8192
    s_add_u32 m0, s89, 81920
    s_mov_b32 s91, 720896
    buffer_load_dwordx4 v13, s[40:43], s91 offen lds
    s_waitcnt lgkmcnt(3)
    v_mfma_f32_16x16x32_bf16 v[24:27], v[160:163], v[172:175], v[24:27]
    ds_read_b64_tr_b16 v[176:177], v10 offset:12288
    ds_read_b64_tr_b16 v[178:179], v10 offset:12800
    s_waitcnt lgkmcnt(3)
    v_mfma_f32_16x16x32_bf16 v[28:31], v[164:167], v[172:175], v[28:31]
    ds_read_b128 v[188:191], v9 offset:10240
    s_add_u32 m0, s89, 131072
    s_mov_b32 s91, 721024
    buffer_load_dwordx4 v13, s[40:43], s91 offen lds
    v_mfma_f32_16x16x32_bf16 v[20:23], v[164:167], v[168:171], v[20:23]
    ds_read_b64_tr_b16 v[180:181], v11 offset:12288
    ds_read_b64_tr_b16 v[182:183], v11 offset:12800
    s_waitcnt vmcnt(6)
    s_barrier
    s_waitcnt lgkmcnt(3)
    v_mfma_f32_16x16x32_bf16 v[16:19], v[176:179], v[184:187], v[16:19]
    ds_read_b128 v[136:139], v8 offset:16384
    s_waitcnt lgkmcnt(3)
    v_mfma_f32_16x16x32_bf16 v[24:27], v[176:179], v[188:191], v[24:27]
    ds_read_b64_tr_b16 v[128:129], v10 offset:16384
    ds_read_b64_tr_b16 v[130:131], v10 offset:16896
    s_waitcnt lgkmcnt(3)
    v_mfma_f32_16x16x32_bf16 v[28:31], v[180:183], v[188:191], v[28:31]
    ds_read_b128 v[140:143], v8 offset:18432
    s_add_u32 m0, s89, 40960
    s_nop 0
    buffer_load_dwordx4 v103, s[32:35], 0 offen lds
    v_mfma_f32_16x16x32_bf16 v[20:23], v[180:183], v[184:187], v[20:23]
    ds_read_b64_tr_b16 v[132:133], v11 offset:16384
    ds_read_b64_tr_b16 v[134:135], v11 offset:16896
    s_waitcnt lgkmcnt(3)
    v_mfma_f32_16x16x32_bf16 v[16:19], v[128:131], v[136:139], v[16:19]
    ds_read_b128 v[152:155], v9 offset:16384
    s_add_u32 m0, s89, 90112
    s_mov_b32 s91, 753664
    buffer_load_dwordx4 v13, s[40:43], s91 offen lds
    s_waitcnt lgkmcnt(3)
    v_mfma_f32_16x16x32_bf16 v[24:27], v[128:131], v[140:143], v[24:27]
    ds_read_b64_tr_b16 v[144:145], v10 offset:20480
    ds_read_b64_tr_b16 v[146:147], v10 offset:20992
    s_waitcnt lgkmcnt(3)
    v_mfma_f32_16x16x32_bf16 v[28:31], v[132:135], v[140:143], v[28:31]
    ds_read_b128 v[156:159], v9 offset:18432
    s_add_u32 m0, s89, 139264
    s_mov_b32 s91, 753792
    buffer_load_dwordx4 v13, s[40:43], s91 offen lds
    v_mfma_f32_16x16x32_bf16 v[20:23], v[132:135], v[136:139], v[20:23]
    ds_read_b64_tr_b16 v[148:149], v11 offset:20480
    ds_read_b64_tr_b16 v[150:151], v11 offset:20992
    s_waitcnt vmcnt(6)
    s_barrier
    s_waitcnt lgkmcnt(3)
    v_mfma_f32_16x16x32_bf16 v[16:19], v[144:147], v[152:155], v[16:19]
    ds_read_b128 v[168:171], v8 offset:24576
    s_waitcnt lgkmcnt(3)
    v_mfma_f32_16x16x32_bf16 v[24:27], v[144:147], v[156:159], v[24:27]
    ds_read_b64_tr_b16 v[160:161], v10 offset:24576
    ds_read_b64_tr_b16 v[162:163], v10 offset:25088
    s_waitcnt lgkmcnt(3)
    v_mfma_f32_16x16x32_bf16 v[28:31], v[148:151], v[156:159], v[28:31]
    ds_read_b128 v[172:175], v8 offset:26624
    s_add_u32 m0, s89, 0
    s_nop 0
    buffer_load_dwordx4 v104, s[32:35], 0 offen lds
    v_mfma_f32_16x16x32_bf16 v[20:23], v[148:151], v[152:155], v[20:23]
    ds_read_b64_tr_b16 v[164:165], v11 offset:24576
    ds_read_b64_tr_b16 v[166:167], v11 offset:25088
    s_waitcnt lgkmcnt(3)
    v_mfma_f32_16x16x32_bf16 v[16:19], v[160:163], v[168:171], v[16:19]
    ds_read_b128 v[184:187], v9 offset:24576
    s_add_u32 m0, s89, 49152
    s_mov_b32 s91, 786432
    buffer_load_dwordx4 v13, s[40:43], s91 offen lds
    s_waitcnt lgkmcnt(3)
    v_mfma_f32_16x16x32_bf16 v[24:27], v[160:163], v[172:175], v[24:27]
    ds_read_b64_tr_b16 v[176:177], v10 offset:28672
    ds_read_b64_tr_b16 v[178:179], v10 offset:29184
    s_waitcnt lgkmcnt(3)
    v_mfma_f32_16x16x32_bf16 v[28:31], v[164:167], v[172:175], v[28:31]
    ds_read_b128 v[188:191], v9 offset:26624
    s_add_u32 m0, s89, 98304
    s_mov_b32 s91, 786560
    buffer_load_dwordx4 v13, s[40:43], s91 offen lds
    v_mfma_f32_16x16x32_bf16 v[20:23], v[164:167], v[168:171], v[20:23]
    ds_read_b64_tr_b16 v[180:181], v11 offset:28672
    ds_read_b64_tr_b16 v[182:183], v11 offset:29184
    s_waitcnt vmcnt(6)
    s_barrier
    s_waitcnt lgkmcnt(3)
    v_mfma_f32_16x16x32_bf16 v[16:19], v[176:179], v[184:187], v[16:19]
    ds_read_b128 v[136:139], v8 offset:32768
    s_waitcnt lgkmcnt(3)
    v_mfma_f32_16x16x32_bf16 v[24:27], v[176:179], v[188:191], v[24:27]
    ds_read_b64_tr_b16 v[128:129], v10 offset:32768
    ds_read_b64_tr_b16 v[130:131], v10 offset:33280
    s_waitcnt lgkmcnt(3)
    v_mfma_f32_16x16x32_bf16 v[28:31], v[180:183], v[188:191], v[28:31]
    ds_read_b128 v[140:143], v8 offset:34816
    s_add_u32 m0, s89, 8192
    s_nop 0
    buffer_load_dwordx4 v105, s[32:35], 0 offen lds
    v_mfma_f32_16x16x32_bf16 v[20:23], v[180:183], v[184:187], v[20:23]
    ds_read_b64_tr_b16 v[132:133], v11 offset:32768
    ds_read_b64_tr_b16 v[134:135], v11 offset:33280
    s_waitcnt lgkmcnt(3)
    v_mfma_f32_16x16x32_bf16 v[16:19], v[128:131], v[136:139], v[16:19]
    ds_read_b128 v[152:155], v9 offset:32768
    s_add_u32 m0, s89, 57344
    s_mov_b32 s91, 819200
    buffer_load_dwordx4 v13, s[40:43], s91 offen lds
    s_waitcnt lgkmcnt(3)
    v_mfma_f32_16x16x32_bf16 v[24:27], v[128:131], v[140:143], v[24:27]
    ds_read_b64_tr_b16 v[144:145], v10 offset:36864
    ds_read_b64_tr_b16 v[146:147], v10 offset:37376
    s_waitcnt lgkmcnt(3)
    v_mfma_f32_16x16x32_bf16 v[28:31], v[132:135], v[140:143], v[28:31]
    ds_read_b128 v[156:159], v9 offset:34816
    s_add_u32 m0, s89, 106496
    s_mov_b32 s91, 819328
    buffer_load_dwordx4 v13, s[40:43], s91 offen lds
    v_mfma_f32_16x16x32_bf16 v[20:23], v[132:135], v[136:139], v[20:23]
    ds_read_b64_tr_b16 v[148:149], v11 offset:36864
    ds_read_b64_tr_b16 v[150:151], v11 offset:37376
    s_waitcnt vmcnt(6)
    s_barrier
    s_waitcnt lgkmcnt(3)
    v_mfma_f32_16x16x32_bf16 v[16:19], v[144:147], v[152:155], v[16:19]
    ds_read_b128 v[168:171], v8 offset:40960
    s_waitcnt lgkmcnt(3)
    v_mfma_f32_16x16x32_bf16 v[24:27], v[144:147], v[156:159], v[24:27]
    ds_read_b64_tr_b16 v[160:161], v10 offset:40960
    ds_read_b64_tr_b16 v[162:163], v10 offset:41472
    s_waitcnt lgkmcnt(3)
    v_mfma_f32_16x16x32_bf16 v[28:31], v[148:151], v[156:159], v[28:31]
    ds_read_b128 v[172:175], v8 offset:43008
    v_mfma_f32_16x16x32_bf16 v[20:23], v[148:151], v[152:155], v[20:23]
    ds_read_b64_tr_b16 v[164:165], v11 offset:40960
    ds_read_b64_tr_b16 v[166:167], v11 offset:41472
    s_waitcnt lgkmcnt(3)
    v_mfma_f32_16x16x32_bf16 v[16:19], v[160:163], v[168:171], v[16:19]
    ds_read_b128 v[184:187], v9 offset:40960
    s_waitcnt lgkmcnt(3)
    v_mfma_f32_16x16x32_bf16 v[24:27], v[160:163], v[172:175], v[24:27]
    ds_read_b64_tr_b16 v[176:177], v10 offset:45056
    ds_read_b64_tr_b16 v[178:179], v10 offset:45568
    s_waitcnt lgkmcnt(3)
    v_mfma_f32_16x16x32_bf16 v[28:31], v[164:167], v[172:175], v[28:31]
    ds_read_b128 v[188:191], v9 offset:43008
    v_mfma_f32_16x16x32_bf16 v[20:23], v[164:167], v[168:171], v[20:23]
    ds_read_b64_tr_b16 v[180:181], v11 offset:45056
    ds_read_b64_tr_b16 v[182:183], v11 offset:45568
    s_waitcnt vmcnt(3)
    s_barrier
    s_waitcnt lgkmcnt(3)
    v_mfma_f32_16x16x32_bf16 v[16:19], v[176:179], v[184:187], v[16:19]
    ds_read_b128 v[136:139], v8 offset:0
    s_waitcnt lgkmcnt(3)
    v_mfma_f32_16x16x32_bf16 v[24:27], v[176:179], v[188:191], v[24:27]
    ds_read_b64_tr_b16 v[128:129], v10 offset:0
    ds_read_b64_tr_b16 v[130:131], v10 offset:512
    s_waitcnt lgkmcnt(3)
    v_mfma_f32_16x16x32_bf16 v[28:31], v[180:183], v[188:191], v[28:31]
    ds_read_b128 v[140:143], v8 offset:2048
    v_mfma_f32_16x16x32_bf16 v[20:23], v[180:183], v[184:187], v[20:23]
    ds_read_b64_tr_b16 v[132:133], v11 offset:0
    ds_read_b64_tr_b16 v[134:135], v11 offset:512
    s_waitcnt lgkmcnt(3)
    v_mfma_f32_16x16x32_bf16 v[16:19], v[128:131], v[136:139], v[16:19]
    ds_read_b128 v[152:155], v9 offset:0
    s_waitcnt lgkmcnt(3)
    v_mfma_f32_16x16x32_bf16 v[24:27], v[128:131], v[140:143], v[24:27]
    ds_read_b64_tr_b16 v[144:145], v10 offset:4096
    ds_read_b64_tr_b16 v[146:147], v10 offset:4608
    s_waitcnt lgkmcnt(3)
    v_mfma_f32_16x16x32_bf16 v[28:31], v[132:135], v[140:143], v[28:31]
    ds_read_b128 v[156:159], v9 offset:2048
    v_mfma_f32_16x16x32_bf16 v[20:23], v[132:135], v[136:139], v[20:23]
    ds_read_b64_tr_b16 v[148:149], v11 offset:4096
    ds_read_b64_tr_b16 v[150:151], v11 offset:4608
    s_waitcnt vmcnt(0)
    s_barrier
    s_waitcnt lgkmcnt(3)
    v_mfma_f32_16x16x32_bf16 v[16:19], v[144:147], v[152:155], v[16:19]
    ds_read_b128 v[168:171], v8 offset:8192
    s_waitcnt lgkmcnt(3)
    v_mfma_f32_16x16x32_bf16 v[24:27], v[144:147], v[156:159], v[24:27]
    ds_read_b64_tr_b16 v[160:161], v10 offset:8192
    ds_read_b64_tr_b16 v[162:163], v10 offset:8704
    s_waitcnt lgkmcnt(3)
    v_mfma_f32_16x16x32_bf16 v[28:31], v[148:151], v[156:159], v[28:31]
    ds_read_b128 v[172:175], v8 offset:10240
    v_mfma_f32_16x16x32_bf16 v[20:23], v[148:151], v[152:155], v[20:23]
    ds_read_b64_tr_b16 v[164:165], v11 offset:8192
    ds_read_b64_tr_b16 v[166:167], v11 offset:8704
    s_waitcnt lgkmcnt(3)
    v_mfma_f32_16x16x32_bf16 v[16:19], v[160:163], v[168:171], v[16:19]
    ds_read_b128 v[184:187], v9 offset:8192
    s_waitcnt lgkmcnt(3)
    v_mfma_f32_16x16x32_bf16 v[24:27], v[160:163], v[172:175], v[24:27]
    ds_read_b64_tr_b16 v[176:177], v10 offset:12288
    ds_read_b64_tr_b16 v[178:179], v10 offset:12800
    s_waitcnt lgkmcnt(3)
    v_mfma_f32_16x16x32_bf16 v[28:31], v[164:167], v[172:175], v[28:31]
    ds_read_b128 v[188:191], v9 offset:10240
    v_mfma_f32_16x16x32_bf16 v[20:23], v[164:167], v[168:171], v[20:23]
    ds_read_b64_tr_b16 v[180:181], v11 offset:12288
    ds_read_b64_tr_b16 v[182:183], v11 offset:12800
    s_cmp_lg_u32 s86, 0
    s_cbranch_scc1 L_f2
    s_lshr_b32 s91, s27, 2
    s_lshl_b32 s91, s91, 4
    buffer_load_dword v6, off, s[52:55], s91 sc0 sc1
L_f2:
    s_waitcnt lgkmcnt(3)
    v_mfma_f32_16x16x32_bf16 v[16:19], v[176:179], v[184:187], v[16:19]
    s_waitcnt lgkmcnt(2)
    v_mfma_f32_16x16x32_bf16 v[24:27], v[176:179], v[188:191], v[24:27]
    s_waitcnt lgkmcnt(0)
    v_mfma_f32_16x16x32_bf16 v[28:31], v[180:183], v[188:191], v[28:31]
    v_mfma_f32_16x16x32_bf16 v[20:23], v[180:183], v[184:187], v[20:23]
    v_lshlrev_b32 v9, 3, v1
    v_lshlrev_b32 v8, 5, v1
    v_add_u32 v8, 161280, v8
    s_min_u32 s93, s88, 2
    s_and_b32 s91, s93, 1
    s_lshl_b32 s91, s91, 4
    s_cmp_lt_u32 s88, 2
    s_cselect_b32 s92, -1, 0
    s_cselect_b32 s93, 0, -1
    s_lshl_b32 s90, s27, 9
    s_mov_b32 s3, 0x40000
    v_pk_mul_f32 v[32:33], v[16:17], v[16:17]
    v_pk_mul_f32 v[34:35], v[18:19], v[18:19]
    v_pk_mul_f32 v[36:37], v[20:21], v[20:21]
    v_pk_mul_f32 v[38:39], v[22:23], v[22:23]
    v_pk_mul_f32 v[40:41], v[24:25], v[24:25]
    v_pk_mul_f32 v[42:43], v[26:27], v[26:27]
    v_pk_mul_f32 v[44:45], v[28:29], v[28:29]
    v_pk_mul_f32 v[46:47], v[30:31], v[30:31]
    v_pk_fma_f32 v[32:33], v[32:33], v[106:107], v[106:107] op_sel:[0,0,1] op_sel_hi:[1,0,1]
    v_pk_fma_f32 v[34:35], v[34:35], v[106:107], v[106:107] op_sel:[0,0,1] op_sel_hi:[1,0,1]
    v_pk_fma_f32 v[36:37], v[36:37], v[106:107], v[106:107] op_sel:[0,0,1] op_sel_hi:[1,0,1]
    v_pk_fma_f32 v[38:39], v[38:39], v[106:107], v[106:107] op_sel:[0,0,1] op_sel_hi:[1,0,1]
    v_pk_fma_f32 v[40:41], v[40:41], v[106:107], v[106:107] op_sel:[0,0,1] op_sel_hi:[1,0,1]
    v_pk_fma_f32 v[42:43], v[42:43], v[106:107], v[106:107] op_sel:[0,0,1] op_sel_hi:[1,0,1]
    v_pk_fma_f32 v[44:45], v[44:45], v[106:107], v[106:107] op_sel:[0,0,1] op_sel_hi:[1,0,1]
    v_pk_fma_f32 v[46:47], v[46:47], v[106:107], v[106:107] op_sel:[0,0,1] op_sel_hi:[1,0,1]
    v_pk_mul_f32 v[32:33], v[32:33], v[16:17]
    v_pk_mul_f32 v[34:35], v[34:35], v[18:19]
    v_pk_mul_f32 v[36:37], v[36:37], v[20:21]
    v_pk_mul_f32 v[38:39], v[38:39], v[22:23]
    v_pk_mul_f32 v[40:41], v[40:41], v[24:25]
    v_pk_mul_f32 v[42:43], v[42:43], v[26:27]
    v_pk_mul_f32 v[44:45], v[44:45], v[28:29]
    v_pk_mul_f32 v[46:47], v[46:47], v[30:31]
    v_exp_f32 v32, v32
    v_exp_f32 v33, v33
    v_exp_f32 v34, v34
    v_exp_f32 v35, v35
    v_exp_f32 v36, v36
    v_exp_f32 v37, v37
    v_exp_f32 v38, v38
    v_exp_f32 v39, v39
    v_exp_f32 v40, v40
    v_exp_f32 v41, v41
    v_exp_f32 v42, v42
    v_exp_f32 v43, v43
    v_exp_f32 v44, v44
    v_exp_f32 v45, v45
    v_exp_f32 v46, v46
    v_exp_f32 v47, v47
    v_pk_add_f32 v[32:33], v[32:33], 1.0 op_sel_hi:[1,0]
    v_pk_add_f32 v[34:35], v[34:35], 1.0 op_sel_hi:[1,0]
    v_pk_add_f32 v[36:37], v[36:37], 1.0 op_sel_hi:[1,0]
    v_pk_add_f32 v[38:39], v[38:39], 1.0 op_sel_hi:[1,0]
    v_pk_add_f32 v[40:41], v[40:41], 1.0 op_sel_hi:[1,0]
    v_pk_add_f32 v[42:43], v[42:43], 1.0 op_sel_hi:[1,0]
    v_pk_add_f32 v[44:45], v[44:45], 1.0 op_sel_hi:[1,0]
    v_pk_add_f32 v[46:47], v[46:47], 1.0 op_sel_hi:[1,0]
    v_rcp_f32 v32, v32
    v_rcp_f32 v33, v33
    v_rcp_f32 v34, v34
    v_rcp_f32 v35, v35
    v_rcp_f32 v36, v36
    v_rcp_f32 v37, v37
    v_rcp_f32 v38, v38
    v_rcp_f32 v39, v39
    v_rcp_f32 v40, v40
    v_rcp_f32 v41, v41
    v_rcp_f32 v42, v42
    v_rcp_f32 v43, v43
    v_rcp_f32 v44, v44
    v_rcp_f32 v45, v45
    v_rcp_f32 v46, v46
    v_rcp_f32 v47, v47
    v_pk_mul_f32 v[16:17], v[16:17], v[64:65]
    v_pk_mul_f32 v[18:19], v[18:19], v[66:67]
    v_pk_mul_f32 v[20:21], v[20:21], v[68:69]
    v_pk_mul_f32 v[22:23], v[22:23], v[70:71]
    v_pk_mul_f32 v[24:25], v[24:25], v[64:65]
    v_pk_mul_f32 v[26:27], v[26:27], v[66:67]
    v_pk_mul_f32 v[28:29], v[28:29], v[68:69]
    v_pk_mul_f32 v[30:31], v[30:31], v[70:71]
    v_pk_mul_f32 v[108:109], v[16:17], v[32:33]
    v_pk_mul_f32 v[110:111], v[24:25], v[40:41]
    v_pk_fma_f32 v[108:109], v[18:19], v[34:35], v[108:109]
    v_pk_fma_f32 v[110:111], v[26:27], v[42:43], v[110:111]
    v_pk_fma_f32 v[108:109], v[20:21], v[36:37], v[108:109]
    v_pk_fma_f32 v[110:111], v[28:29], v[44:45], v[110:111]
    v_pk_fma_f32 v[108:109], v[22:23], v[38:39], v[108:109]
    v_pk_fma_f32 v[110:111], v[30:31], v[46:47], v[110:111]
    v_add_f32 v4, v108, v109
    v_add_f32 v5, v110, v111
    s_nop 1
    v_permlane32_swap_b32 v4, v5
    v_add_f32 v4, v4, v5
    ds_write_b32 v2, v4
    s_branch L_final
L_cross:
    v_lshrrev_b32 v20, 3, v1
    v_mul_u32_u24 v14, 104, v20
    s_lshr_b32 s92, s86, 2
    s_lshl_b32 s92, s92, 2
    s_add_u32 s91, s89, s92
    s_add_u32 s91, s91, 147456
    v_add_u32 v14, s91, v14
    s_and_b32 s93, s86, 1
    s_lshl_b32 s93, s93, 4
    v_and_b32 v16, 31, v1
    v_xor_b32 v16, s93, v16
    v_lshrrev_b32 v17, 5, v1
    v_bfe_u32 v18, v1, 1, 3
    v_lshrrev_b32 v19, 4, v1
    v_and_b32 v20, 15, v1
    v_or_b32 v21, s93, v20
    v_xor_b32 v22, v19, v18
    v_lshlrev_b32 v22, 4, v22
    v_lshl_add_u32 v8, v21, 7, v22
    v_xor_b32 v9, 64, v8
    v_xor_b32 v10, 2048, v8
    v_xor_b32 v11, 2048, v9
    v_xor_b32 v21, s86, v18
    v_lshlrev_b32 v22, 12, v17
    v_lshl_add_u32 v22, v16, 7, v22
    v_lshl_add_u32 v12, v21, 4, v22
    v_lshlrev_b32 v13, 11, v17
    v_lshl_add_u32 v13, v16, 4, v13
    v_bfe_u32 v21, v1, 2, 2
    v_lshl_add_u32 v21, v19, 3, v21
    s_lshl_b32 s91, s86, 4
    v_lshl_add_u32 v21, v21, 7, s91
    v_and_b32 v22, 1, v1
    v_lshl_add_u32 v26, v22, 3, v21
    v_bfe_i32 v27, v1, 3, 1
    s_lshl_b32 s91, s86, 3
    s_lshl_b32 s92, s86, 1
    s_add_u32 s92, s92, 36
    s_cmp_ge_u32 s86, 6
    s_cselect_b32 s91, s92, s91
    s_cselect_b32 s60, 0xffff, -1
    s_cselect_b32 s61, 0, -1
    s_lshl_b32 s26, s91, 7
    v_lshrrev_b32 v20, 3, v1
    v_add_u32 v20, s91, v20
    v_subrev_u32 v21, 26, v20
    v_min_u32 v21, v20, v21
    v_lshrrev_b32 v24, 1, v21
    v_mov_b32 v22, 1966171168
    v_mov_b32 v23, 833960
    v_lshlrev_b32 v21, 2, v24
    v_lshrrev_b64 v[22:23], v21, v[22:23]
    v_and_b32 v21, 15, v22
    v_xor_b32 v21, v21, v1
    v_and_b32 v21, 7, v21
    v_lshlrev_b32 v20, 7, v20
    v_lshl_add_u32 v15, v21, 4, v20
    v_bfe_u32 v20, v1, 3, 2
    v_and_b32 v21, 3, v1
    v_lshl_add_u32 v20, v20, 2, v21
    v_min_u32 v20, 12, v20
    v_mov_b32 v22, 1935823168
    v_mov_b32 v23, 833960
    v_lshlrev_b32 v21, 2, v20
    v_lshrrev_b64 v[22:23], v21, v[22:23]
    v_and_b32 v21, 15, v22
    v_bfe_u32 v22, v1, 2, 1
    v_lshl_add_u32 v21, v21, 1, v22
    v_mad_u32_u24 v21, v17, 26, v21
    v_xor_b32 v20, s86, v20
    v_and_b32 v20, 7, v20
    v_lshlrev_b32 v20, 4, v20
    v_lshl_add_u32 v7, v21, 7, v20
    s_and_b32 s91, s88, 1
    s_lshl_b32 s91, s91, 10
    s_lshl_b32 s92, s86, 2
    s_add_u32 s91, s91, s92
    s_add_u32 s91, s91, 161280
    v_lshl_add_u32 v2, v16, 5, s91
    s_mov_b32 s94, 0x05040100
    s_mov_b32 s95, 0x07060302
    v_mov_b32 v103, 0
    v_mov_b32 v107, 0
    v_mov_b32 v111, 0
    v_mov_b32 v115, 0
    v_mov_b32 v119, 0
    v_mov_b32 v123, 0
    v_mov_b32 v127, 0
    v_mov_b32 v131, 0
    s_waitcnt vmcnt(4)
    ds_read_b32 v84, v14 offset:0
    ds_read_b32 v85, v14 offset:8
    ds_read_b32 v86, v14 offset:16
    ds_read_b32 v87, v14 offset:24
    ds_read_b32 v88, v14 offset:32
    ds_read_b32 v89, v14 offset:40
    ds_read_b32 v248, v14 offset:48
    ds_read_b32 v249, v14 offset:56
    s_add_u32 m0, s89, 8192
    s_waitcnt lgkmcnt(7)
    v_lshl_add_u32 v84, v84, 7, v3
    buffer_load_dwordx4 v84, s[32:35], 0 offen lds
    s_add_u32 m0, s89, 16384
    s_waitcnt lgkmcnt(6)
    v_lshl_add_u32 v85, v85, 7, v3
    buffer_load_dwordx4 v85, s[32:35], 0 offen lds
    s_waitcnt vmcnt(4)
    s_barrier
    s_add_u32 m0, s89, 24576
    s_waitcnt lgkmcnt(5)
    v_lshl_add_u32 v86, v86, 7, v3
    buffer_load_dwordx4 v86, s[32:35], 0 offen lds
    s_add_u32 m0, s89, 32768
    s_waitcnt lgkmcnt(4)
    v_lshl_add_u32 v87, v87, 7, v3
    buffer_load_dwordx4 v87, s[32:35], 0 offen lds
    s_barrier
    s_add_u32 m0, s89, 40960
    s_waitcnt lgkmcnt(3)
    v_lshl_add_u32 v88, v88, 7, v3
    buffer_load_dwordx4 v88, s[32:35], 0 offen lds
    s_add_u32 m0, s89, 49152
    s_waitcnt lgkmcnt(2)
    v_lshl_add_u32 v89, v89, 7, v3
    buffer_load_dwordx4 v89, s[32:35], 0 offen lds
    ds_read_b64_tr_b16 v[196:197], v26 offset:0
    ds_read_b64_tr_b16 v[198:199], v26 offset:512
    ds_read_b64_tr_b16 v[200:201], v26 offset:4096
    ds_read_b64_tr_b16 v[202:203], v26 offset:4608
    v_not_b32 v28, v27
    s_waitcnt lgkmcnt(0)
    v_and_b32 v204, v27, v196
    v_and_b32 v196, v28, v196
    v_and_b32 v205, v27, v197
    v_and_b32 v197, v28, v197
    v_and_b32 v206, v27, v198
    v_and_b32 v198, v28, v198
    v_and_b32 v207, v27, v199
    v_and_b32 v199, v28, v199
    v_and_b32 v208, v27, v200
    v_and_b32 v200, v28, v200
    v_and_b32 v209, v27, v201
    v_and_b32 v201, v28, v201
    v_and_b32 v210, v27, v202
    v_and_b32 v202, v28, v202
    v_and_b32 v211, v27, v203
    v_and_b32 v203, v28, v203
    s_cmp_lt_u32 s86, 4
    s_cbranch_scc1 L_r0
    v_and_b32 v30, 0x3c803c80, v27
    v_and_b32 v31, 0x3c803c80, v28
    v_or_b32 v196, v30, v196
    v_or_b32 v204, v31, v204
    v_or_b32 v197, v30, v197
    v_or_b32 v205, v31, v205
    v_or_b32 v198, v30, v198
    v_or_b32 v206, v31, v206
    v_or_b32 v199, v30, v199
    v_or_b32 v207, v31, v207
    v_or_b32 v200, v30, v200
    v_or_b32 v208, v31, v208
    v_or_b32 v201, v30, v201
    v_or_b32 v209, v31, v209
    v_or_b32 v202, v30, v202
    v_or_b32 v210, v31, v210
    v_or_b32 v203, v30, v203
    v_or_b32 v211, v31, v211
    v_and_b32 v20, 15, v1
    v_min_u32 v20, 12, v20
    v_xor_b32 v21, 1, v17
    v_mul_u32_u24 v21, 26, v21
    v_lshl_add_u32 v21, v20, 1, v21
    v_add_u32 v21, 114688, v21
    v_and_b32 v24, 1, v19
    v_mul_u32_u24 v24, 104, v24
    v_add_u32 v27, v21, v24
    v_add_u32 v28, v27, v24
    ds_read_u16 v68, v28 offset:0
    ds_read_u16 v69, v28 offset:52
    ds_read_u16 v70, v28 offset:104
    ds_read_u16 v71, v28 offset:156
    ds_read_u16 v72, v27 offset:416
    ds_read_u16 v73, v27 offset:468
    ds_read_u16 v247, v27 offset:624
    v_mov_b32 v22, 1935823168
    v_mov_b32 v23, 833960
    v_lshlrev_b32 v29, 2, v20
    v_lshrrev_b64 v[22:23], v29, v[22:23]
    v_and_b32 v29, 15, v22
    s_and_b32 s91, s86, 2
    s_add_u32 s91, s91, 115712
    v_lshl_add_u32 v22, v29, 2, s91
    v_mul_u32_u24 v23, 208, v19
    v_add_u32 v22, v22, v23
    ds_read_u16 v76, v22 offset:0
    ds_read_u16 v77, v22 offset:52
    ds_read_u16 v78, v22 offset:104
    ds_read_u16 v79, v22 offset:156
    v_mov_b32 v255, 0
    s_waitcnt lgkmcnt(4)
    v_lshl_or_b32 v244, v69, 16, v68
    v_lshl_or_b32 v245, v71, 16, v70
    v_lshl_or_b32 v246, v73, 16, v72
    s_waitcnt lgkmcnt(0)
    v_lshl_or_b32 v4, v77, 16, v76
    v_lshl_or_b32 v5, v79, 16, v78
    s_waitcnt vmcnt(4)
    s_barrier
    s_setprio 2
    ds_read_b128 v[132:135], v8 offset:8192
    ds_read_b128 v[136:139], v9 offset:8192
    ds_read_b128 v[148:151], v8 offset:12288
    ds_read_b128 v[152:155], v9 offset:12288
    ds_read_b128 v[140:143], v10 offset:8192
    ds_read_b128 v[144:147], v11 offset:8192
    s_add_u32 m0, s89, 57344
    v_lshl_add_u32 v248, v248, 7, v3
    buffer_load_dwordx4 v248, s[32:35], 0 offen lds
    ds_read_b32 v248, v14 offset:64
    ds_read_b128 v[156:159], v10 offset:12288
    ds_read_b128 v[160:163], v11 offset:12288
    ds_read_b128 v[16:19], v12 offset:8192
    s_waitcnt lgkmcnt(8)
    v_mfma_f32_16x16x32_bf16 v[212:215], v[196:199], v[132:135], 0
    ds_read_b128 v[164:167], v8 offset:16384
    v_mfma_f32_16x16x32_bf16 v[212:215], v[200:203], v[136:139], v[212:215]
    ds_read_b128 v[168:171], v9 offset:16384
    s_waitcnt lgkmcnt(8)
    ds_read_b128 v[180:183], v8 offset:20480
    v_mfma_f32_16x16x32_bf16 v[228:231], v[204:207], v[148:151], 0
    ds_read_b128 v[184:187], v9 offset:20480
    v_mfma_f32_16x16x32_bf16 v[228:231], v[208:211], v[152:155], v[228:231]
    ds_read_b128 v[172:175], v10 offset:16384
    s_waitcnt lgkmcnt(9)
    v_mfma_f32_16x16x32_bf16 v[216:219], v[196:199], v[140:143], 0
    ds_read_b128 v[176:179], v11 offset:16384
    v_mfma_f32_16x16x32_bf16 v[216:219], v[200:203], v[144:147], v[216:219]
    ds_read_b128 v[188:191], v10 offset:20480
    s_waitcnt lgkmcnt(8)
    ds_read_b128 v[192:195], v11 offset:20480
    v_mfma_f32_16x16x32_bf16 v[232:235], v[204:207], v[156:159], 0
    ds_read_b128 v[24:27], v12 offset:16384
    v_mfma_f32_16x16x32_bf16 v[232:235], v[208:211], v[160:163], v[232:235]
    s_add_u32 m0, s89, 65536
    v_lshl_add_u32 v249, v249, 7, v3
    buffer_load_dwordx4 v249, s[32:35], 0 offen lds
    ds_read_b32 v249, v14 offset:72
    s_waitcnt vmcnt(4)
    s_barrier
    s_waitcnt lgkmcnt(8)
    v_mfma_f32_16x16x32_bf16 v[220:223], v[196:199], v[164:167], 0
    ds_read_b128 v[132:135], v8 offset:24576
    v_mfma_f32_16x16x32_bf16 v[220:223], v[200:203], v[168:171], v[220:223]
    ds_read_b128 v[136:139], v9 offset:24576
    s_waitcnt lgkmcnt(8)
    ds_read_b128 v[148:151], v8 offset:28672
    v_mfma_f32_16x16x32_bf16 v[236:239], v[204:207], v[180:183], 0
    ds_read_b128 v[152:155], v9 offset:28672
    v_mfma_f32_16x16x32_bf16 v[236:239], v[208:211], v[184:187], v[236:239]
    ds_read_b128 v[140:143], v10 offset:24576
    s_waitcnt lgkmcnt(9)
    v_mfma_f32_16x16x32_bf16 v[224:227], v[196:199], v[172:175], 0
    ds_read_b128 v[144:147], v11 offset:24576
    v_mfma_f32_16x16x32_bf16 v[224:227], v[200:203], v[176:179], v[224:227]
    ds_read_b128 v[156:159], v10 offset:28672
    s_waitcnt lgkmcnt(9)
    ds_read_b128 v[160:163], v11 offset:28672
    v_mfma_f32_16x16x32_bf16 v[240:243], v[204:207], v[188:191], 0
    ds_read_b128 v[32:35], v12 offset:24576
    v_mfma_f32_16x16x32_bf16 v[240:243], v[208:211], v[192:195], v[240:243]
    v_cvt_pk_bf16_f32 v68, v228, v236
    v_cvt_pk_bf16_f32 v72, v229, v237
    v_cvt_pk_bf16_f32 v76, v230, v238
    v_cvt_pk_bf16_f32 v80, v231, v239
    s_mov_b32 exec_hi, 0
    v_cvt_pk_bf16_f32 v68, v212, v220
    v_cvt_pk_bf16_f32 v72, v213, v221
    v_cvt_pk_bf16_f32 v76, v214, v222
    v_cvt_pk_bf16_f32 v80, v215, v223
    s_mov_b32 exec_lo, 0xffff
    v_cvt_pk_bf16_f32 v252, v228, v236
    s_mov_b32 exec_lo, 0
    s_mov_b32 exec_hi, 0xffff
    v_cvt_pk_bf16_f32 v252, v212, v220
    s_mov_b64 exec, -1
    s_add_u32 m0, s89, 73728
    v_lshl_add_u32 v248, v248, 7, v3
    buffer_load_dwordx4 v248, s[32:35], 0 offen lds
    ds_read_b32 v248, v14 offset:80
    s_waitcnt lgkmcnt(8)
    v_mfma_f32_16x16x32_bf16 v[212:215], v[196:199], v[132:135], 0
    ds_read_b128 v[164:167], v8 offset:32768
    v_mfma_f32_16x16x32_bf16 v[212:215], v[200:203], v[136:139], v[212:215]
    ds_read_b128 v[168:171], v9 offset:32768
    s_waitcnt lgkmcnt(8)
    ds_read_b128 v[180:183], v8 offset:36864
    v_mfma_f32_16x16x32_bf16 v[228:231], v[204:207], v[148:151], 0
    ds_read_b128 v[184:187], v9 offset:36864
    v_mfma_f32_16x16x32_bf16 v[228:231], v[208:211], v[152:155], v[228:231]
    ds_read_b128 v[172:175], v10 offset:32768
    v_cvt_pk_bf16_f32 v84, v232, v240
    v_cvt_pk_bf16_f32 v88, v233, v241
    v_cvt_pk_bf16_f32 v92, v234, v242
    v_cvt_pk_bf16_f32 v96, v235, v243
    s_mov_b32 exec_hi, 0
    v_cvt_pk_bf16_f32 v84, v216, v224
    v_cvt_pk_bf16_f32 v88, v217, v225
    v_cvt_pk_bf16_f32 v92, v218, v226
    v_cvt_pk_bf16_f32 v96, v219, v227
    s_mov_b64 exec, -1
    s_waitcnt lgkmcnt(9)
    v_mfma_f32_16x16x32_bf16 v[216:219], v[196:199], v[140:143], 0
    ds_read_b128 v[176:179], v11 offset:32768
    v_mfma_f32_16x16x32_bf16 v[216:219], v[200:203], v[144:147], v[216:219]
    ds_read_b128 v[188:191], v10 offset:36864
    s_waitcnt lgkmcnt(9)
    ds_read_b128 v[192:195], v11 offset:36864
    v_mfma_f32_16x16x32_bf16 v[232:235], v[204:207], v[156:159], 0
    ds_read_b128 v[40:43], v12 offset:32768
    v_mfma_f32_16x16x32_bf16 v[232:235], v[208:211], v[160:163], v[232:235]
    v_permlane16_swap_b32 v68, v84
    v_permlane16_swap_b32 v72, v88
    v_permlane16_swap_b32 v76, v92
    v_permlane16_swap_b32 v80, v96
    s_add_u32 m0, s89, 81920
    v_lshl_add_u32 v249, v249, 7, v3
    buffer_load_dwordx4 v249, s[32:35], 0 offen lds
    ds_read_b32 v249, v14 offset:88
    s_lshr_b32 s91, s2, 5
    s_lshl_b32 s91, s91, 1
    s_and_b32 s92, s88, 1
    s_add_u32 s91, s91, s92
    v_min_u32 v6, 15, v1
    s_lshl_b32 s91, s91, 3
    s_add_u32 s91, s91, s86
    s_mul_i32 s91, s91, 2048
    s_add_u32 s91, s91, 262144
    v_lshlrev_b32 v6, 7, v6
    buffer_load_dword v0, v6, s[40:43], s91 offen
    s_waitcnt vmcnt(5)
    s_barrier
    s_waitcnt lgkmcnt(8)
    v_mfma_f32_16x16x32_bf16 v[220:223], v[196:199], v[164:167], 0
    ds_read_b128 v[132:135], v8 offset:40960
    v_mfma_f32_16x16x32_bf16 v[220:223], v[200:203], v[168:171], v[220:223]
    ds_read_b128 v[136:139], v9 offset:40960
    s_waitcnt lgkmcnt(8)
    ds_read_b128 v[148:151], v8 offset:45056
    v_mfma_f32_16x16x32_bf16 v[236:239], v[204:207], v[180:183], 0
    ds_read_b128 v[152:155], v9 offset:45056
    v_mfma_f32_16x16x32_bf16 v[236:239], v[208:211], v[184:187], v[236:239]
    ds_read_b128 v[140:143], v10 offset:40960
    s_waitcnt lgkmcnt(9)
    v_mfma_f32_16x16x32_bf16 v[224:227], v[196:199], v[172:175], 0
    ds_read_b128 v[144:147], v11 offset:40960
    v_mfma_f32_16x16x32_bf16 v[224:227], v[200:203], v[176:179], v[224:227]
    ds_read_b128 v[156:159], v10 offset:45056
    s_waitcnt lgkmcnt(9)
    ds_read_b128 v[160:163], v11 offset:45056
    v_mfma_f32_16x16x32_bf16 v[240:243], v[204:207], v[188:191], 0
    ds_read_b128 v[20:23], v12 offset:40960
    v_mfma_f32_16x16x32_bf16 v[240:243], v[208:211], v[192:195], v[240:243]
    v_cvt_pk_bf16_f32 v69, v228, v236
    v_cvt_pk_bf16_f32 v73, v229, v237
    v_cvt_pk_bf16_f32 v77, v230, v238
    v_cvt_pk_bf16_f32 v81, v231, v239
    s_mov_b32 exec_hi, 0
    v_cvt_pk_bf16_f32 v69, v212, v220
    v_cvt_pk_bf16_f32 v73, v213, v221
    v_cvt_pk_bf16_f32 v77, v214, v222
    v_cvt_pk_bf16_f32 v81, v215, v223
    s_mov_b32 exec_lo, 0xffff
    v_cvt_pk_bf16_f32 v253, v228, v236
    s_mov_b32 exec_lo, 0
    s_mov_b32 exec_hi, 0xffff
    v_cvt_pk_bf16_f32 v253, v212, v220
    s_mov_b64 exec, -1
    s_add_u32 m0, s89, 90112
    v_lshl_add_u32 v248, v248, 7, v3
    buffer_load_dwordx4 v248, s[32:35], 0 offen lds
    ds_read_b32 v248, v14 offset:96
    s_waitcnt lgkmcnt(8)
    v_mfma_f32_16x16x32_bf16 v[212:215], v[196:199], v[132:135], 0
    ds_read_b128 v[164:167], v8 offset:49152
    v_mfma_f32_16x16x32_bf16 v[212:215], v[200:203], v[136:139], v[212:215]
    ds_read_b128 v[168:171], v9 offset:49152
    s_waitcnt lgkmcnt(8)
    ds_read_b128 v[180:183], v8 offset:53248
    v_mfma_f32_16x16x32_bf16 v[228:231], v[204:207], v[148:151], 0
    ds_read_b128 v[184:187], v9 offset:53248
    v_mfma_f32_16x16x32_bf16 v[228:231], v[208:211], v[152:155], v[228:231]
    ds_read_b128 v[172:175], v10 offset:49152
    v_cvt_pk_bf16_f32 v85, v232, v240
    v_cvt_pk_bf16_f32 v89, v233, v241
    v_cvt_pk_bf16_f32 v93, v234, v242
    v_cvt_pk_bf16_f32 v97, v235, v243
    s_mov_b32 exec_hi, 0
    v_cvt_pk_bf16_f32 v85, v216, v224
    v_cvt_pk_bf16_f32 v89, v217, v225
    v_cvt_pk_bf16_f32 v93, v218, v226
    v_cvt_pk_bf16_f32 v97, v219, v227
    s_mov_b64 exec, -1
    s_waitcnt lgkmcnt(9)
    v_mfma_f32_16x16x32_bf16 v[216:219], v[196:199], v[140:143], 0
    ds_read_b128 v[176:179], v11 offset:49152
    v_mfma_f32_16x16x32_bf16 v[216:219], v[200:203], v[144:147], v[216:219]
    ds_read_b128 v[188:191], v10 offset:53248
    s_waitcnt lgkmcnt(9)
    ds_read_b128 v[192:195], v11 offset:53248
    v_mfma_f32_16x16x32_bf16 v[232:235], v[204:207], v[156:159], 0
    ds_read_b128 v[28:31], v12 offset:49152
    v_mfma_f32_16x16x32_bf16 v[232:235], v[208:211], v[160:163], v[232:235]
    v_permlane16_swap_b32 v69, v85
    v_permlane16_swap_b32 v73, v89
    v_permlane16_swap_b32 v77, v93
    v_permlane16_swap_b32 v81, v97
    s_add_u32 m0, s89, 98304
    v_lshl_add_u32 v249, v249, 7, v3
    buffer_load_dwordx4 v249, s[32:35], 0 offen lds
    v_add_u32 v8, 57344, v8
    v_add_u32 v9, 57344, v9
    v_add_u32 v10, 57344, v10
    v_add_u32 v11, 57344, v11
    v_add_u32 v12, 57344, v12
    s_waitcnt vmcnt(5)
    s_barrier
    s_waitcnt lgkmcnt(7)
    v_mfma_f32_16x16x32_bf16 v[220:223], v[196:199], v[164:167], 0
    ds_read_b128 v[132:135], v8 offset:0
    v_mfma_f32_16x16x32_bf16 v[220:223], v[200:203], v[168:171], v[220:223]
    ds_read_b128 v[136:139], v9 offset:0
    s_waitcnt lgkmcnt(7)
    ds_read_b128 v[148:151], v8 offset:4096
    v_mfma_f32_16x16x32_bf16 v[236:239], v[204:207], v[180:183], 0
    ds_read_b128 v[152:155], v9 offset:4096
    v_mfma_f32_16x16x32_bf16 v[236:239], v[208:211], v[184:187], v[236:239]
    ds_read_b128 v[140:143], v10 offset:0
    s_waitcnt lgkmcnt(8)
    v_mfma_f32_16x16x32_bf16 v[224:227], v[196:199], v[172:175], 0
    ds_read_b128 v[144:147], v11 offset:0
    v_mfma_f32_16x16x32_bf16 v[224:227], v[200:203], v[176:179], v[224:227]
    ds_read_b128 v[156:159], v10 offset:4096
    s_waitcnt lgkmcnt(8)
    ds_read_b128 v[160:163], v11 offset:4096
    v_mfma_f32_16x16x32_bf16 v[240:243], v[204:207], v[188:191], 0
    ds_read_b128 v[36:39], v12 offset:0
    v_mfma_f32_16x16x32_bf16 v[240:243], v[208:211], v[192:195], v[240:243]
    v_cvt_pk_bf16_f32 v100, v228, v236
    v_cvt_pk_bf16_f32 v104, v229, v237
    v_cvt_pk_bf16_f32 v108, v230, v238
    v_cvt_pk_bf16_f32 v112, v231, v239
    s_mov_b32 exec_hi, 0
    v_cvt_pk_bf16_f32 v100, v212, v220
    v_cvt_pk_bf16_f32 v104, v213, v221
    v_cvt_pk_bf16_f32 v108, v214, v222
    v_cvt_pk_bf16_f32 v112, v215, v223
    s_mov_b32 exec_lo, 0xffff0000
    v_cvt_pk_bf16_f32 v252, v228, v236
    s_mov_b32 exec_lo, 0
    s_mov_b32 exec_hi, 0xffff0000
    v_cvt_pk_bf16_f32 v252, v212, v220
    s_mov_b64 exec, -1
    s_add_u32 m0, s89, 106496
    v_lshl_add_u32 v248, v248, 7, v3
    buffer_load_dwordx4 v248, s[32:35], 0 offen lds
    v_mov_b32 v248, 0
    v_mov_b32 v249, 0
    v_lshlrev_b32 v6, 3, v1
    v_and_b32 v6, 255, v6
    s_lshl_b32 s91, s27, 9
    s_mul_i32 s92, s86, 256
    s_add_u32 s91, s91, s92
    s_and_b32 s92, s27, 3
    s_lshl_b32 s92, s92, 2
    s_add_u32 s92, s92, s88
    s_cmp_eq_u32 s92, 2
    s_cselect_b32 s91, s91, 0x40000000
    buffer_store_dwordx2 v[248:249], v6, s[56:59], s91 offen sc0 sc1
    s_waitcnt lgkmcnt(7)
    v_mfma_f32_16x16x32_bf16 v[212:215], v[196:199], v[132:135], 0
    ds_read_b128 v[164:167], v8 offset:8192
    v_mfma_f32_16x16x32_bf16 v[212:215], v[200:203], v[136:139], v[212:215]
    ds_read_b128 v[168:171], v9 offset:8192
    s_waitcnt lgkmcnt(7)
    ds_read_b128 v[180:183], v8 offset:12288
    v_mfma_f32_16x16x32_bf16 v[228:231], v[204:207], v[148:151], 0
    ds_read_b128 v[184:187], v9 offset:12288
    v_mfma_f32_16x16x32_bf16 v[228:231], v[208:211], v[152:155], v[228:231]
    ds_read_b128 v[172:175], v10 offset:8192
    v_cvt_pk_bf16_f32 v116, v232, v240
    v_cvt_pk_bf16_f32 v120, v233, v241
    v_cvt_pk_bf16_f32 v124, v234, v242
    v_cvt_pk_bf16_f32 v128, v235, v243
    s_mov_b32 exec_hi, 0
    v_cvt_pk_bf16_f32 v116, v216, v224
    v_cvt_pk_bf16_f32 v120, v217, v225
    v_cvt_pk_bf16_f32 v124, v218, v226
    v_cvt_pk_bf16_f32 v128, v219, v227
    s_mov_b64 exec, -1
    s_waitcnt lgkmcnt(8)
    v_mfma_f32_16x16x32_bf16 v[216:219], v[196:199], v[140:143], 0
    ds_read_b128 v[176:179], v11 offset:8192
    v_mfma_f32_16x16x32_bf16 v[216:219], v[200:203], v[144:147], v[216:219]
    ds_read_b128 v[188:191], v10 offset:12288
    s_waitcnt lgkmcnt(8)
    ds_read_b128 v[192:195], v11 offset:12288
    v_mfma_f32_16x16x32_bf16 v[232:235], v[204:207], v[156:159], 0
    ds_read_b128 v[44:47], v12 offset:8192
    v_mfma_f32_16x16x32_bf16 v[232:235], v[208:211], v[160:163], v[232:235]
    v_permlane16_swap_b32 v100, v116
    v_permlane16_swap_b32 v104, v120
    v_permlane16_swap_b32 v108, v124
    v_permlane16_swap_b32 v112, v128
    s_add_u32 m0, s26, 114688
    s_mov_b64 exec, s[60:61]
    s_mov_b32 s91, 0
    buffer_load_dwordx4 v15, s[36:39], s91 offen lds
    s_mov_b64 exec, -1
    s_add_u32 m0, s26, 121344
    s_mov_b64 exec, s[60:61]
    s_mov_b32 s91, 6656
    buffer_load_dwordx4 v15, s[36:39], s91 offen lds
    s_mov_b64 exec, -1
    s_add_u32 m0, s26, 128000
    s_mov_b64 exec, s[60:61]
    s_mov_b32 s91, 13312
    buffer_load_dwordx4 v15, s[36:39], s91 offen lds
    s_mov_b64 exec, -1
    s_waitcnt vmcnt(8)
    s_barrier
    s_waitcnt lgkmcnt(7)
    v_mfma_f32_16x16x32_bf16 v[220:223], v[196:199], v[164:167], 0
    ds_read_b128 v[132:135], v8 offset:16384
    v_mfma_f32_16x16x32_bf16 v[220:223], v[200:203], v[168:171], v[220:223]
    ds_read_b128 v[136:139], v9 offset:16384
    s_waitcnt lgkmcnt(7)
    ds_read_b128 v[148:151], v8 offset:20480
    v_mfma_f32_16x16x32_bf16 v[236:239], v[204:207], v[180:183], 0
    ds_read_b128 v[152:155], v9 offset:20480
    v_mfma_f32_16x16x32_bf16 v[236:239], v[208:211], v[184:187], v[236:239]
    ds_read_b128 v[140:143], v10 offset:16384
    s_waitcnt lgkmcnt(8)
    v_mfma_f32_16x16x32_bf16 v[224:227], v[196:199], v[172:175], 0
    ds_read_b128 v[144:147], v11 offset:16384
    v_mfma_f32_16x16x32_bf16 v[224:227], v[200:203], v[176:179], v[224:227]
    ds_read_b128 v[156:159], v10 offset:20480
    s_waitcnt lgkmcnt(8)
    ds_read_b128 v[160:163], v11 offset:20480
    v_mfma_f32_16x16x32_bf16 v[240:243], v[204:207], v[188:191], 0
    ds_read_b128 v[48:51], v12 offset:16384
    v_mfma_f32_16x16x32_bf16 v[240:243], v[208:211], v[192:195], v[240:243]
    v_cvt_pk_bf16_f32 v101, v228, v236
    v_cvt_pk_bf16_f32 v105, v229, v237
    v_cvt_pk_bf16_f32 v109, v230, v238
    v_cvt_pk_bf16_f32 v113, v231, v239
    s_mov_b32 exec_hi, 0
    v_cvt_pk_bf16_f32 v101, v212, v220
    v_cvt_pk_bf16_f32 v105, v213, v221
    v_cvt_pk_bf16_f32 v109, v214, v222
    v_cvt_pk_bf16_f32 v113, v215, v223
    s_mov_b32 exec_lo, 0xffff0000
    v_cvt_pk_bf16_f32 v253, v228, v236
    s_mov_b32 exec_lo, 0
    s_mov_b32 exec_hi, 0xffff0000
    v_cvt_pk_bf16_f32 v253, v212, v220
    s_mov_b64 exec, -1
    s_add_u32 m0, s26, 134656
    s_mov_b64 exec, s[60:61]
    s_mov_b32 s91, 19968
    buffer_load_dwordx4 v15, s[36:39], s91 offen lds
    s_mov_b64 exec, -1
    s_add_u32 m0, s26, 141312
    s_mov_b64 exec, s[60:61]
    s_mov_b32 s91, 26624
    buffer_load_dwordx4 v15, s[36:39], s91 offen lds
    s_mov_b64 exec, -1
    s_add_u32 m0, s26, 147968
    s_mov_b64 exec, s[60:61]
    s_mov_b32 s91, 33280
    buffer_load_dwordx4 v15, s[36:39], s91 offen lds
    s_mov_b64 exec, -1
    s_waitcnt lgkmcnt(7)
    v_mfma_f32_16x16x32_bf16 v[212:215], v[196:199], v[132:135], 0
    ds_read_b128 v[164:167], v8 offset:24576
    v_mfma_f32_16x16x32_bf16 v[212:215], v[200:203], v[136:139], v[212:215]
    ds_read_b128 v[168:171], v9 offset:24576
    s_waitcnt lgkmcnt(7)
    ds_read_b128 v[180:183], v8 offset:28672
    v_mfma_f32_16x16x32_bf16 v[228:231], v[204:207], v[148:151], 0
    ds_read_b128 v[184:187], v9 offset:28672
    v_mfma_f32_16x16x32_bf16 v[228:231], v[208:211], v[152:155], v[228:231]
    ds_read_b128 v[172:175], v10 offset:24576
    v_cvt_pk_bf16_f32 v117, v232, v240
    v_cvt_pk_bf16_f32 v121, v233, v241
    v_cvt_pk_bf16_f32 v125, v234, v242
    v_cvt_pk_bf16_f32 v129, v235, v243
    s_mov_b32 exec_hi, 0
    v_cvt_pk_bf16_f32 v117, v216, v224
    v_cvt_pk_bf16_f32 v121, v217, v225
    v_cvt_pk_bf16_f32 v125, v218, v226
    v_cvt_pk_bf16_f32 v129, v219, v227
    s_mov_b64 exec, -1
    s_waitcnt lgkmcnt(8)
    v_mfma_f32_16x16x32_bf16 v[216:219], v[196:199], v[140:143], 0
    ds_read_b128 v[176:179], v11 offset:24576
    v_mfma_f32_16x16x32_bf16 v[216:219], v[200:203], v[144:147], v[216:219]
    ds_read_b128 v[188:191], v10 offset:28672
    s_waitcnt lgkmcnt(8)
    ds_read_b128 v[192:195], v11 offset:28672
    v_mfma_f32_16x16x32_bf16 v[232:235], v[204:207], v[156:159], 0
    ds_read_b128 v[56:59], v12 offset:24576
    v_mfma_f32_16x16x32_bf16 v[232:235], v[208:211], v[160:163], v[232:235]
    v_permlane16_swap_b32 v101, v117
    v_permlane16_swap_b32 v105, v121
    v_permlane16_swap_b32 v109, v125
    v_permlane16_swap_b32 v113, v129
    s_add_u32 m0, s26, 154624
    s_mov_b64 exec, s[60:61]
    s_mov_b32 s91, 39936
    buffer_load_dwordx4 v15, s[36:39], s91 offen lds
    s_mov_b64 exec, -1
    s_add_u32 m0, s26, 0
    s_mov_b64 exec, s[60:61]
    s_mov_b32 s91, 46592
    buffer_load_dwordx4 v15, s[36:39], s91 offen lds
    s_mov_b64 exec, -1
    s_waitcnt vmcnt(10)
    s_barrier
    s_waitcnt lgkmcnt(7)
    v_mfma_f32_16x16x32_bf16 v[220:223], v[196:199], v[164:167], 0
    ds_read_b128 v[132:135], v8 offset:32768
    v_mfma_f32_16x16x32_bf16 v[220:223], v[200:203], v[168:171], v[220:223]
    ds_read_b128 v[136:139], v9 offset:32768
    s_waitcnt lgkmcnt(7)
    ds_read_b128 v[148:151], v8 offset:36864
    v_mfma_f32_16x16x32_bf16 v[236:239], v[204:207], v[180:183], 0
    ds_read_b128 v[152:155], v9 offset:36864
    v_mfma_f32_16x16x32_bf16 v[236:239], v[208:211], v[184:187], v[236:239]
    ds_read_b128 v[140:143], v10 offset:32768
    s_waitcnt lgkmcnt(8)
    v_mfma_f32_16x16x32_bf16 v[224:227], v[196:199], v[172:175], 0
    ds_read_b128 v[144:147], v11 offset:32768
    v_mfma_f32_16x16x32_bf16 v[224:227], v[200:203], v[176:179], v[224:227]
    ds_read_b128 v[156:159], v10 offset:36864
    s_waitcnt lgkmcnt(8)
    ds_read_b128 v[160:163], v11 offset:36864
    v_mfma_f32_16x16x32_bf16 v[240:243], v[204:207], v[188:191], 0
    ds_read_b128 v[52:55], v12 offset:32768
    v_mfma_f32_16x16x32_bf16 v[240:243], v[208:211], v[192:195], v[240:243]
    v_cvt_pk_bf16_f32 v70, v228, v236
    v_cvt_pk_bf16_f32 v74, v229, v237
    v_cvt_pk_bf16_f32 v78, v230, v238
    v_cvt_pk_bf16_f32 v82, v231, v239
    s_mov_b32 exec_hi, 0
    v_cvt_pk_bf16_f32 v70, v212, v220
    v_cvt_pk_bf16_f32 v74, v213, v221
    v_cvt_pk_bf16_f32 v78, v214, v222
    v_cvt_pk_bf16_f32 v82, v215, v223
    s_mov_b32 exec_lo, 0xffff
    v_cvt_pk_bf16_f32 v254, v228, v236
    s_mov_b32 exec_lo, 0
    s_mov_b32 exec_hi, 0xffff
    v_cvt_pk_bf16_f32 v254, v212, v220
    s_mov_b64 exec, -1
    s_add_u32 m0, s26, 6656
    s_mov_b64 exec, s[60:61]
    s_mov_b32 s91, 53248
    buffer_load_dwordx4 v15, s[36:39], s91 offen lds
    s_mov_b64 exec, -1
    s_add_u32 m0, s26, 13312
    s_mov_b64 exec, s[60:61]
    s_mov_b32 s91, 59904
    buffer_load_dwordx4 v15, s[36:39], s91 offen lds
    s_mov_b64 exec, -1
    s_waitcnt lgkmcnt(7)
    v_mfma_f32_16x16x32_bf16 v[212:215], v[196:199], v[132:135], 0
    ds_read_b128 v[164:167], v8 offset:40960
    v_mfma_f32_16x16x32_bf16 v[212:215], v[200:203], v[136:139], v[212:215]
    ds_read_b128 v[168:171], v9 offset:40960
    s_waitcnt lgkmcnt(7)
    ds_read_b128 v[180:183], v8 offset:45056
    v_mfma_f32_16x16x32_bf16 v[228:231], v[204:207], v[148:151], 0
    ds_read_b128 v[184:187], v9 offset:45056
    v_mfma_f32_16x16x32_bf16 v[228:231], v[208:211], v[152:155], v[228:231]
    ds_read_b128 v[172:175], v10 offset:40960
    v_cvt_pk_bf16_f32 v86, v232, v240
    v_cvt_pk_bf16_f32 v90, v233, v241
    v_cvt_pk_bf16_f32 v94, v234, v242
    v_cvt_pk_bf16_f32 v98, v235, v243
    s_mov_b32 exec_hi, 0
    v_cvt_pk_bf16_f32 v86, v216, v224
    v_cvt_pk_bf16_f32 v90, v217, v225
    v_cvt_pk_bf16_f32 v94, v218, v226
    v_cvt_pk_bf16_f32 v98, v219, v227
    s_mov_b64 exec, -1
    s_waitcnt lgkmcnt(8)
    v_mfma_f32_16x16x32_bf16 v[216:219], v[196:199], v[140:143], 0
    ds_read_b128 v[176:179], v11 offset:40960
    v_mfma_f32_16x16x32_bf16 v[216:219], v[200:203], v[144:147], v[216:219]
    ds_read_b128 v[188:191], v10 offset:45056
    s_waitcnt lgkmcnt(8)
    ds_read_b128 v[192:195], v11 offset:45056
    v_mfma_f32_16x16x32_bf16 v[232:235], v[204:207], v[156:159], 0
    ds_read_b128 v[60:63], v12 offset:40960
    v_mfma_f32_16x16x32_bf16 v[232:235], v[208:211], v[160:163], v[232:235]
    v_permlane16_swap_b32 v70, v86
    v_permlane16_swap_b32 v74, v90
    v_permlane16_swap_b32 v78, v94
    v_permlane16_swap_b32 v82, v98
    s_add_u32 m0, s26, 19968
    s_mov_b64 exec, s[60:61]
    s_mov_b32 s91, 66560
    buffer_load_dwordx4 v15, s[36:39], s91 offen lds
    s_mov_b64 exec, -1
    s_add_u32 m0, s26, 26624
    s_mov_b64 exec, s[60:61]
    s_mov_b32 s91, 73216
    buffer_load_dwordx4 v15, s[36:39], s91 offen lds
    s_mov_b64 exec, -1
    s_waitcnt vmcnt(5)
    s_barrier
    s_waitcnt lgkmcnt(7)
    v_mfma_f32_16x16x32_bf16 v[220:223], v[196:199], v[164:167], 0
    ds_read_b128 v[132:135], v8 offset:49152
    v_mfma_f32_16x16x32_bf16 v[220:223], v[200:203], v[168:171], v[220:223]
    ds_read_b128 v[136:139], v9 offset:49152
    s_waitcnt lgkmcnt(7)
    ds_read_b128 v[148:151], v8 offset:53248
    v_mfma_f32_16x16x32_bf16 v[236:239], v[204:207], v[180:183], 0
    ds_read_b128 v[152:155], v9 offset:53248
    v_mfma_f32_16x16x32_bf16 v[236:239], v[208:211], v[184:187], v[236:239]
    ds_read_b128 v[140:143], v10 offset:49152
    s_waitcnt lgkmcnt(8)
    v_mfma_f32_16x16x32_bf16 v[224:227], v[196:199], v[172:175], 0
    ds_read_b128 v[144:147], v11 offset:49152
    v_mfma_f32_16x16x32_bf16 v[224:227], v[200:203], v[176:179], v[224:227]
    ds_read_b128 v[156:159], v10 offset:53248
    s_waitcnt lgkmcnt(8)
    ds_read_b128 v[160:163], v11 offset:53248
    v_mfma_f32_16x16x32_bf16 v[240:243], v[204:207], v[188:191], 0
    ds_read_b128 v[64:67], v12 offset:49152
    v_mfma_f32_16x16x32_bf16 v[240:243], v[208:211], v[192:195], v[240:243]
    v_cvt_pk_bf16_f32 v102, v228, v236
    v_cvt_pk_bf16_f32 v106, v229, v237
    v_cvt_pk_bf16_f32 v110, v230, v238
    v_cvt_pk_bf16_f32 v114, v231, v239
    s_mov_b32 exec_hi, 0
    v_cvt_pk_bf16_f32 v102, v212, v220
    v_cvt_pk_bf16_f32 v106, v213, v221
    v_cvt_pk_bf16_f32 v110, v214, v222
    v_cvt_pk_bf16_f32 v114, v215, v223
    s_mov_b32 exec_lo, 0xffff0000
    v_cvt_pk_bf16_f32 v254, v228, v236
    s_mov_b32 exec_lo, 0
    s_mov_b32 exec_hi, 0xffff0000
    v_cvt_pk_bf16_f32 v254, v212, v220
    s_mov_b64 exec, -1
    s_add_u32 m0, s26, 33280
    s_mov_b64 exec, s[60:61]
    s_mov_b32 s91, 79872
    buffer_load_dwordx4 v15, s[36:39], s91 offen lds
    s_mov_b64 exec, -1
    s_lshr_b32 s91, s2, 5
    s_lshl_b32 s91, s91, 1
    s_and_b32 s92, s88, 1
    s_add_u32 s91, s91, s92
    v_min_u32 v6, 19, v1
    s_lshl_b32 s91, s91, 3
    s_add_u32 s91, s91, s86
    s_mul_i32 s91, s91, 2560
    s_add_u32 s91, s91, 524288
    v_lshlrev_b32 v6, 7, v6
    buffer_load_dword v0, v6, s[40:43], s91 offen
    s_waitcnt lgkmcnt(7)
    v_mfma_f32_16x16x32_bf16 v[212:215], v[196:199], v[132:135], 0
    v_add_u32 v250, 59904, v7
    v_mfma_f32_16x16x32_bf16 v[212:215], v[200:203], v[136:139], v[212:215]
    v_add_u32 v251, 119808, v7
    s_waitcnt lgkmcnt(5)
    ds_read_b128 v[164:167], v250 offset:54784
    v_mfma_f32_16x16x32_bf16 v[228:231], v[204:207], v[148:151], 0
    ds_read_b128 v[168:171], v251 offset:1536
    v_mfma_f32_16x16x32_bf16 v[228:231], v[208:211], v[152:155], v[228:231]
    ds_read_b128 v[172:175], v251 offset:8192
    v_cvt_pk_bf16_f32 v118, v232, v240
    v_cvt_pk_bf16_f32 v122, v233, v241
    v_cvt_pk_bf16_f32 v126, v234, v242
    v_cvt_pk_bf16_f32 v130, v235, v243
    s_mov_b32 exec_hi, 0
    v_cvt_pk_bf16_f32 v118, v216, v224
    v_cvt_pk_bf16_f32 v122, v217, v225
    v_cvt_pk_bf16_f32 v126, v218, v226
    v_cvt_pk_bf16_f32 v130, v219, v227
    s_mov_b64 exec, -1
    s_waitcnt lgkmcnt(6)
    v_mfma_f32_16x16x32_bf16 v[216:219], v[196:199], v[140:143], 0
    ds_read_b128 v[176:179], v251 offset:14848
    v_mfma_f32_16x16x32_bf16 v[216:219], v[200:203], v[144:147], v[216:219]
    ds_read_b128 v[180:183], v251 offset:21504
    s_waitcnt lgkmcnt(6)
    ds_read_b128 v[184:187], v251 offset:28160
    v_mfma_f32_16x16x32_bf16 v[232:235], v[204:207], v[156:159], 0
    ds_read_b128 v[188:191], v251 offset:34816
    v_mfma_f32_16x16x32_bf16 v[232:235], v[208:211], v[160:163], v[232:235]
    v_permlane16_swap_b32 v102, v118
    v_permlane16_swap_b32 v106, v122
    v_permlane16_swap_b32 v110, v126
    v_permlane16_swap_b32 v114, v130
    v_cvt_pk_bf16_f32 v71, v228, 0
    v_cvt_pk_bf16_f32 v75, v229, 0
    v_cvt_pk_bf16_f32 v79, v230, 0
    v_cvt_pk_bf16_f32 v83, v231, 0
    s_mov_b32 exec_hi, 0
    v_cvt_pk_bf16_f32 v71, v212, 0
    v_cvt_pk_bf16_f32 v75, v213, 0
    v_cvt_pk_bf16_f32 v79, v214, 0
    v_cvt_pk_bf16_f32 v83, v215, 0
    s_mov_b32 exec_lo, 0xffff
    v_cvt_pk_bf16_f32 v255, v228, 0
    s_mov_b32 exec_lo, 0
    s_mov_b32 exec_hi, 0xffff
    v_cvt_pk_bf16_f32 v255, v212, 0
    s_mov_b64 exec, -1
    v_cvt_pk_bf16_f32 v87, v232, 0
    v_cvt_pk_bf16_f32 v91, v233, 0
    v_cvt_pk_bf16_f32 v95, v234, 0
    v_cvt_pk_bf16_f32 v99, v235, 0
    s_mov_b32 exec_hi, 0
    v_cvt_pk_bf16_f32 v87, v216, 0
    v_cvt_pk_bf16_f32 v91, v217, 0
    v_cvt_pk_bf16_f32 v95, v218, 0
    v_cvt_pk_bf16_f32 v99, v219, 0
    s_mov_b64 exec, -1
    v_permlane16_swap_b32 v71, v87
    v_permlane16_swap_b32 v75, v91
    v_permlane16_swap_b32 v79, v95
    v_permlane16_swap_b32 v83, v99
    v_mov_b32 v8, v250
    v_mov_b32 v9, v251
    v_mfma_f32_16x16x32_bf16 v[136:139], v[244:247], v[252:255], 0
    v_mov_b32 v152, 0xbdd2d3e8
    s_and_b32 s91, s86, 2
    s_lshl_b32 s91, s91, 10
    s_and_b32 s92, s86, 1
    s_lshl_b32 s92, s92, 8
    s_add_u32 s91, s91, s92
    s_add_u32 s91, s91, 39936
    v_lshrrev_b32 v154, 4, v1
    v_lshl_add_u32 v154, v154, 9, s91
    v_and_b32 v155, 15, v1
    v_lshl_add_u32 v154, v155, 4, v154
    v_mul_f32 v148, v136, v136
    v_mul_f32 v149, v137, v137
    v_mul_f32 v150, v138, v138
    v_mul_f32 v151, v139, v139
    v_fmaak_f32 v148, v148, v152, 0xc0135761
    v_fmaak_f32 v149, v149, v152, 0xc0135761
    v_fmaak_f32 v150, v150, v152, 0xc0135761
    v_fmaak_f32 v151, v151, v152, 0xc0135761
    v_mul_f32 v148, v148, v136
    v_mul_f32 v149, v149, v137
    v_mul_f32 v150, v150, v138
    v_mul_f32 v151, v151, v139
    v_exp_f32 v148, v148
    v_exp_f32 v149, v149
    v_exp_f32 v150, v150
    v_exp_f32 v151, v151
    v_add_f32 v148, 1.0, v148
    v_add_f32 v149, 1.0, v149
    v_add_f32 v150, 1.0, v150
    v_add_f32 v151, 1.0, v151
    v_rcp_f32 v148, v148
    v_rcp_f32 v149, v149
    v_rcp_f32 v150, v150
    v_rcp_f32 v151, v151
    v_mul_f32 v148, v148, v136
    v_mul_f32 v149, v149, v137
    v_mul_f32 v150, v150, v138
    v_mul_f32 v151, v151, v139
    v_cvt_pk_bf16_f32 v132, v148, v149
    v_cvt_pk_bf16_f32 v133, v150, v151
    s_nop 1
    v_mfma_f32_16x16x16_bf16 v[136:139], v[4:5], v[132:133], 0
    s_nop 7
    v_mul_f32 v148, 0xbfb8aa3b, v136
    v_mul_f32 v149, 0xbfb8aa3b, v137
    v_mul_f32 v150, 0xbfb8aa3b, v138
    v_mul_f32 v151, 0xbfb8aa3b, v139
    v_exp_f32 v148, v148
    v_exp_f32 v149, v149
    v_exp_f32 v150, v150
    v_exp_f32 v151, v151
    v_add_f32 v148, 1.0, v148
    v_add_f32 v149, 1.0, v149
    v_add_f32 v150, 1.0, v150
    v_add_f32 v151, 1.0, v151
    v_rcp_f32 v148, v148
    v_rcp_f32 v149, v149
    v_rcp_f32 v150, v150
    v_rcp_f32 v151, v151
    v_cvt_pk_bf16_f32 v132, v148, v149
    v_cvt_pk_bf16_f32 v133, v150, v151
    v_and_b32 v134, 0xffff, v132
    v_lshrrev_b32 v135, 16, v132
    v_lshlrev_b32 v148, 16, v132
    v_and_b32 v149, 0xffff0000, v132
    v_lshlrev_b32 v150, 16, v133
    v_and_b32 v151, 0xffff0000, v133
    s_waitcnt vmcnt(1) lgkmcnt(7)
    ds_write_b64 v154, v[134:135] offset:4096
    ds_write_b128 v154, v[148:151]
    s_waitcnt lgkmcnt(0)
    s_barrier
    ds_read_b128 v[192:195], v7 offset:0
    ds_read_b128 v[132:135], v7 offset:6656
    ds_read_b128 v[136:139], v7 offset:13312
    ds_read_b128 v[140:143], v7 offset:19968
    ds_read_b128 v[144:147], v7 offset:26624
    ds_read_b128 v[148:151], v7 offset:33280
    s_branch L_ct
L_r0:
    s_waitcnt vmcnt(4)
    s_barrier
    ds_read_b128 v[132:135], v8 offset:8192
    ds_read_b128 v[136:139], v9 offset:8192
    ds_read_b128 v[148:151], v8 offset:12288
    ds_read_b128 v[152:155], v9 offset:12288
    ds_read_b128 v[140:143], v10 offset:8192
    ds_read_b128 v[144:147], v11 offset:8192
    s_add_u32 m0, s89, 57344
    v_lshl_add_u32 v248, v248, 7, v3
    buffer_load_dwordx4 v248, s[32:35], 0 offen lds
    ds_read_b32 v248, v14 offset:64
    ds_read_b128 v[156:159], v10 offset:12288
    ds_read_b128 v[160:163], v11 offset:12288
    ds_read_b128 v[16:19], v12 offset:8192
    s_waitcnt lgkmcnt(8)
    v_mfma_f32_16x16x32_bf16 v[212:215], v[196:199], v[132:135], 0
    ds_read_b128 v[164:167], v8 offset:16384
    v_mfma_f32_16x16x32_bf16 v[212:215], v[200:203], v[136:139], v[212:215]
    ds_read_b128 v[168:171], v9 offset:16384
    s_waitcnt lgkmcnt(8)
    ds_read_b128 v[180:183], v8 offset:20480
    v_mfma_f32_16x16x32_bf16 v[212:215], v[204:207], v[148:151], v[212:215]
    ds_read_b128 v[184:187], v9 offset:20480
    v_mfma_f32_16x16x32_bf16 v[212:215], v[208:211], v[152:155], v[212:215]
    ds_read_b128 v[172:175], v10 offset:16384
    s_waitcnt lgkmcnt(9)
    v_mfma_f32_16x16x32_bf16 v[216:219], v[196:199], v[140:143], 0
    ds_read_b128 v[176:179], v11 offset:16384
    v_mfma_f32_16x16x32_bf16 v[216:219], v[200:203], v[144:147], v[216:219]
    ds_read_b128 v[188:191], v10 offset:20480
    s_waitcnt lgkmcnt(8)
    ds_read_b128 v[192:195], v11 offset:20480
    v_mfma_f32_16x16x32_bf16 v[216:219], v[204:207], v[156:159], v[216:219]
    ds_read_b128 v[24:27], v12 offset:16384
    v_mfma_f32_16x16x32_bf16 v[216:219], v[208:211], v[160:163], v[216:219]
    s_add_u32 m0, s89, 65536
    v_lshl_add_u32 v249, v249, 7, v3
    buffer_load_dwordx4 v249, s[32:35], 0 offen lds
    ds_read_b32 v249, v14 offset:72
    s_waitcnt vmcnt(4)
    s_barrier
    s_waitcnt lgkmcnt(8)
    v_mfma_f32_16x16x32_bf16 v[220:223], v[196:199], v[164:167], 0
    ds_read_b128 v[132:135], v8 offset:24576
    v_mfma_f32_16x16x32_bf16 v[220:223], v[200:203], v[168:171], v[220:223]
    ds_read_b128 v[136:139], v9 offset:24576
    s_waitcnt lgkmcnt(8)
    ds_read_b128 v[148:151], v8 offset:28672
    v_mfma_f32_16x16x32_bf16 v[220:223], v[204:207], v[180:183], v[220:223]
    ds_read_b128 v[152:155], v9 offset:28672
    v_mfma_f32_16x16x32_bf16 v[220:223], v[208:211], v[184:187], v[220:223]
    ds_read_b128 v[140:143], v10 offset:24576
    s_waitcnt lgkmcnt(9)
    v_mfma_f32_16x16x32_bf16 v[224:227], v[196:199], v[172:175], 0
    ds_read_b128 v[144:147], v11 offset:24576
    v_mfma_f32_16x16x32_bf16 v[224:227], v[200:203], v[176:179], v[224:227]
    ds_read_b128 v[156:159], v10 offset:28672
    s_waitcnt lgkmcnt(9)
    ds_read_b128 v[160:163], v11 offset:28672
    v_mfma_f32_16x16x32_bf16 v[224:227], v[204:207], v[188:191], v[224:227]
    ds_read_b128 v[32:35], v12 offset:24576
    v_mfma_f32_16x16x32_bf16 v[224:227], v[208:211], v[192:195], v[224:227]
    v_cvt_pk_bf16_f32 v68, v212, v220
    v_cvt_pk_bf16_f32 v72, v213, v221
    v_cvt_pk_bf16_f32 v76, v214, v222
    v_cvt_pk_bf16_f32 v80, v215, v223
    s_add_u32 m0, s89, 73728
    v_lshl_add_u32 v248, v248, 7, v3
    buffer_load_dwordx4 v248, s[32:35], 0 offen lds
    ds_read_b32 v248, v14 offset:80
    s_waitcnt lgkmcnt(8)
    v_mfma_f32_16x16x32_bf16 v[212:215], v[196:199], v[132:135], 0
    ds_read_b128 v[164:167], v8 offset:32768
    v_mfma_f32_16x16x32_bf16 v[212:215], v[200:203], v[136:139], v[212:215]
    ds_read_b128 v[168:171], v9 offset:32768
    s_waitcnt lgkmcnt(8)
    ds_read_b128 v[180:183], v8 offset:36864
    v_mfma_f32_16x16x32_bf16 v[212:215], v[204:207], v[148:151], v[212:215]
    ds_read_b128 v[184:187], v9 offset:36864
    v_mfma_f32_16x16x32_bf16 v[212:215], v[208:211], v[152:155], v[212:215]
    ds_read_b128 v[172:175], v10 offset:32768
    v_cvt_pk_bf16_f32 v84, v216, v224
    v_cvt_pk_bf16_f32 v88, v217, v225
    v_cvt_pk_bf16_f32 v92, v218, v226
    v_cvt_pk_bf16_f32 v96, v219, v227
    s_waitcnt lgkmcnt(9)
    v_mfma_f32_16x16x32_bf16 v[216:219], v[196:199], v[140:143], 0
    ds_read_b128 v[176:179], v11 offset:32768
    v_mfma_f32_16x16x32_bf16 v[216:219], v[200:203], v[144:147], v[216:219]
    ds_read_b128 v[188:191], v10 offset:36864
    s_waitcnt lgkmcnt(9)
    ds_read_b128 v[192:195], v11 offset:36864
    v_mfma_f32_16x16x32_bf16 v[216:219], v[204:207], v[156:159], v[216:219]
    ds_read_b128 v[40:43], v12 offset:32768
    v_mfma_f32_16x16x32_bf16 v[216:219], v[208:211], v[160:163], v[216:219]
    v_permlane16_swap_b32 v68, v84
    v_permlane16_swap_b32 v72, v88
    v_permlane16_swap_b32 v76, v92
    v_permlane16_swap_b32 v80, v96
    s_add_u32 m0, s89, 81920
    v_lshl_add_u32 v249, v249, 7, v3
    buffer_load_dwordx4 v249, s[32:35], 0 offen lds
    ds_read_b32 v249, v14 offset:88
    s_lshr_b32 s91, s2, 5
    s_lshl_b32 s91, s91, 1
    s_and_b32 s92, s88, 1
    s_add_u32 s91, s91, s92
    v_min_u32 v6, 15, v1
    s_lshl_b32 s91, s91, 3
    s_add_u32 s91, s91, s86
    s_mul_i32 s91, s91, 2048
    s_add_u32 s91, s91, 262144
    v_lshlrev_b32 v6, 7, v6
    buffer_load_dword v0, v6, s[40:43], s91 offen
    s_waitcnt vmcnt(5)
    s_barrier
    s_waitcnt lgkmcnt(8)
    v_mfma_f32_16x16x32_bf16 v[220:223], v[196:199], v[164:167], 0
    ds_read_b128 v[132:135], v8 offset:40960
    v_mfma_f32_16x16x32_bf16 v[220:223], v[200:203], v[168:171], v[220:223]
    ds_read_b128 v[136:139], v9 offset:40960
    s_waitcnt lgkmcnt(8)
    ds_read_b128 v[148:151], v8 offset:45056
    v_mfma_f32_16x16x32_bf16 v[220:223], v[204:207], v[180:183], v[220:223]
    ds_read_b128 v[152:155], v9 offset:45056
    v_mfma_f32_16x16x32_bf16 v[220:223], v[208:211], v[184:187], v[220:223]
    ds_read_b128 v[140:143], v10 offset:40960
    s_waitcnt lgkmcnt(9)
    v_mfma_f32_16x16x32_bf16 v[224:227], v[196:199], v[172:175], 0
    ds_read_b128 v[144:147], v11 offset:40960
    v_mfma_f32_16x16x32_bf16 v[224:227], v[200:203], v[176:179], v[224:227]
    ds_read_b128 v[156:159], v10 offset:45056
    s_waitcnt lgkmcnt(9)
    ds_read_b128 v[160:163], v11 offset:45056
    v_mfma_f32_16x16x32_bf16 v[224:227], v[204:207], v[188:191], v[224:227]
    ds_read_b128 v[20:23], v12 offset:40960
    v_mfma_f32_16x16x32_bf16 v[224:227], v[208:211], v[192:195], v[224:227]
    v_cvt_pk_bf16_f32 v69, v212, v220
    v_cvt_pk_bf16_f32 v73, v213, v221
    v_cvt_pk_bf16_f32 v77, v214, v222
    v_cvt_pk_bf16_f32 v81, v215, v223
    s_add_u32 m0, s89, 90112
    v_lshl_add_u32 v248, v248, 7, v3
    buffer_load_dwordx4 v248, s[32:35], 0 offen lds
    ds_read_b32 v248, v14 offset:96
    s_waitcnt lgkmcnt(8)
    v_mfma_f32_16x16x32_bf16 v[212:215], v[196:199], v[132:135], 0
    ds_read_b128 v[164:167], v8 offset:49152
    v_mfma_f32_16x16x32_bf16 v[212:215], v[200:203], v[136:139], v[212:215]
    ds_read_b128 v[168:171], v9 offset:49152
    s_waitcnt lgkmcnt(8)
    ds_read_b128 v[180:183], v8 offset:53248
    v_mfma_f32_16x16x32_bf16 v[212:215], v[204:207], v[148:151], v[212:215]
    ds_read_b128 v[184:187], v9 offset:53248
    v_mfma_f32_16x16x32_bf16 v[212:215], v[208:211], v[152:155], v[212:215]
    ds_read_b128 v[172:175], v10 offset:49152
    v_cvt_pk_bf16_f32 v85, v216, v224
    v_cvt_pk_bf16_f32 v89, v217, v225
    v_cvt_pk_bf16_f32 v93, v218, v226
    v_cvt_pk_bf16_f32 v97, v219, v227
    s_waitcnt lgkmcnt(9)
    v_mfma_f32_16x16x32_bf16 v[216:219], v[196:199], v[140:143], 0
    ds_read_b128 v[176:179], v11 offset:49152
    v_mfma_f32_16x16x32_bf16 v[216:219], v[200:203], v[144:147], v[216:219]
    ds_read_b128 v[188:191], v10 offset:53248
    s_waitcnt lgkmcnt(9)
    ds_read_b128 v[192:195], v11 offset:53248
    v_mfma_f32_16x16x32_bf16 v[216:219], v[204:207], v[156:159], v[216:219]
    ds_read_b128 v[28:31], v12 offset:49152
    v_mfma_f32_16x16x32_bf16 v[216:219], v[208:211], v[160:163], v[216:219]
    v_permlane16_swap_b32 v69, v85
    v_permlane16_swap_b32 v73, v89
    v_permlane16_swap_b32 v77, v93
    v_permlane16_swap_b32 v81, v97
    s_add_u32 m0, s89, 98304
    v_lshl_add_u32 v249, v249, 7, v3
    buffer_load_dwordx4 v249, s[32:35], 0 offen lds
    v_add_u32 v8, 57344, v8
    v_add_u32 v9, 57344, v9
    v_add_u32 v10, 57344, v10
    v_add_u32 v11, 57344, v11
    v_add_u32 v12, 57344, v12
    s_waitcnt vmcnt(5)
    s_barrier
    s_waitcnt lgkmcnt(7)
    v_mfma_f32_16x16x32_bf16 v[220:223], v[196:199], v[164:167], 0
    ds_read_b128 v[132:135], v8 offset:0
    v_mfma_f32_16x16x32_bf16 v[220:223], v[200:203], v[168:171], v[220:223]
    ds_read_b128 v[136:139], v9 offset:0
    s_waitcnt lgkmcnt(7)
    ds_read_b128 v[148:151], v8 offset:4096
    v_mfma_f32_16x16x32_bf16 v[220:223], v[204:207], v[180:183], v[220:223]
    ds_read_b128 v[152:155], v9 offset:4096
    v_mfma_f32_16x16x32_bf16 v[220:223], v[208:211], v[184:187], v[220:223]
    ds_read_b128 v[140:143], v10 offset:0
    s_waitcnt lgkmcnt(8)
    v_mfma_f32_16x16x32_bf16 v[224:227], v[196:199], v[172:175], 0
    ds_read_b128 v[144:147], v11 offset:0
    v_mfma_f32_16x16x32_bf16 v[224:227], v[200:203], v[176:179], v[224:227]
    ds_read_b128 v[156:159], v10 offset:4096
    s_waitcnt lgkmcnt(8)
    ds_read_b128 v[160:163], v11 offset:4096
    v_mfma_f32_16x16x32_bf16 v[224:227], v[204:207], v[188:191], v[224:227]
    ds_read_b128 v[36:39], v12 offset:0
    v_mfma_f32_16x16x32_bf16 v[224:227], v[208:211], v[192:195], v[224:227]
    v_cvt_pk_bf16_f32 v100, v212, v220
    v_cvt_pk_bf16_f32 v104, v213, v221
    v_cvt_pk_bf16_f32 v108, v214, v222
    v_cvt_pk_bf16_f32 v112, v215, v223
    s_add_u32 m0, s89, 106496
    v_lshl_add_u32 v248, v248, 7, v3
    buffer_load_dwordx4 v248, s[32:35], 0 offen lds
    v_mov_b32 v248, 0
    v_mov_b32 v249, 0
    v_lshlrev_b32 v6, 3, v1
    v_and_b32 v6, 255, v6
    s_lshl_b32 s91, s27, 9
    s_mul_i32 s92, s86, 256
    s_add_u32 s91, s91, s92
    s_and_b32 s92, s27, 3
    s_lshl_b32 s92, s92, 2
    s_add_u32 s92, s92, s88
    s_cmp_eq_u32 s92, 2
    s_cselect_b32 s91, s91, 0x40000000
    buffer_store_dwordx2 v[248:249], v6, s[56:59], s91 offen sc0 sc1
    s_waitcnt lgkmcnt(7)
    v_mfma_f32_16x16x32_bf16 v[212:215], v[196:199], v[132:135], 0
    ds_read_b128 v[164:167], v8 offset:8192
    v_mfma_f32_16x16x32_bf16 v[212:215], v[200:203], v[136:139], v[212:215]
    ds_read_b128 v[168:171], v9 offset:8192
    s_waitcnt lgkmcnt(7)
    ds_read_b128 v[180:183], v8 offset:12288
    v_mfma_f32_16x16x32_bf16 v[212:215], v[204:207], v[148:151], v[212:215]
    ds_read_b128 v[184:187], v9 offset:12288
    v_mfma_f32_16x16x32_bf16 v[212:215], v[208:211], v[152:155], v[212:215]
    ds_read_b128 v[172:175], v10 offset:8192
    v_cvt_pk_bf16_f32 v116, v216, v224
    v_cvt_pk_bf16_f32 v120, v217, v225
    v_cvt_pk_bf16_f32 v124, v218, v226
    v_cvt_pk_bf16_f32 v128, v219, v227
    s_waitcnt lgkmcnt(8)
    v_mfma_f32_16x16x32_bf16 v[216:219], v[196:199], v[140:143], 0
    ds_read_b128 v[176:179], v11 offset:8192
    v_mfma_f32_16x16x32_bf16 v[216:219], v[200:203], v[144:147], v[216:219]
    ds_read_b128 v[188:191], v10 offset:12288
    s_waitcnt lgkmcnt(8)
    ds_read_b128 v[192:195], v11 offset:12288
    v_mfma_f32_16x16x32_bf16 v[216:219], v[204:207], v[156:159], v[216:219]
    ds_read_b128 v[44:47], v12 offset:8192
    v_mfma_f32_16x16x32_bf16 v[216:219], v[208:211], v[160:163], v[216:219]
    v_permlane16_swap_b32 v100, v116
    v_permlane16_swap_b32 v104, v120
    v_permlane16_swap_b32 v108, v124
    v_permlane16_swap_b32 v112, v128
    s_add_u32 m0, s26, 114688
    s_mov_b64 exec, s[60:61]
    s_mov_b32 s91, 0
    buffer_load_dwordx4 v15, s[36:39], s91 offen lds
    s_mov_b64 exec, -1
    s_add_u32 m0, s26, 121344
    s_mov_b64 exec, s[60:61]
    s_mov_b32 s91, 6656
    buffer_load_dwordx4 v15, s[36:39], s91 offen lds
    s_mov_b64 exec, -1
    s_add_u32 m0, s26, 128000
    s_mov_b64 exec, s[60:61]
    s_mov_b32 s91, 13312
    buffer_load_dwordx4 v15, s[36:39], s91 offen lds
    s_mov_b64 exec, -1
    s_waitcnt vmcnt(8)
    s_barrier
    s_waitcnt lgkmcnt(7)
    v_mfma_f32_16x16x32_bf16 v[220:223], v[196:199], v[164:167], 0
    ds_read_b128 v[132:135], v8 offset:16384
    v_mfma_f32_16x16x32_bf16 v[220:223], v[200:203], v[168:171], v[220:223]
    ds_read_b128 v[136:139], v9 offset:16384
    s_waitcnt lgkmcnt(7)
    ds_read_b128 v[148:151], v8 offset:20480
    v_mfma_f32_16x16x32_bf16 v[220:223], v[204:207], v[180:183], v[220:223]
    ds_read_b128 v[152:155], v9 offset:20480
    v_mfma_f32_16x16x32_bf16 v[220:223], v[208:211], v[184:187], v[220:223]
    ds_read_b128 v[140:143], v10 offset:16384
    s_waitcnt lgkmcnt(8)
    v_mfma_f32_16x16x32_bf16 v[224:227], v[196:199], v[172:175], 0
    ds_read_b128 v[144:147], v11 offset:16384
    v_mfma_f32_16x16x32_bf16 v[224:227], v[200:203], v[176:179], v[224:227]
    ds_read_b128 v[156:159], v10 offset:20480
    s_waitcnt lgkmcnt(8)
    ds_read_b128 v[160:163], v11 offset:20480
    v_mfma_f32_16x16x32_bf16 v[224:227], v[204:207], v[188:191], v[224:227]
    ds_read_b128 v[48:51], v12 offset:16384
    v_mfma_f32_16x16x32_bf16 v[224:227], v[208:211], v[192:195], v[224:227]
    v_cvt_pk_bf16_f32 v101, v212, v220
    v_cvt_pk_bf16_f32 v105, v213, v221
    v_cvt_pk_bf16_f32 v109, v214, v222
    v_cvt_pk_bf16_f32 v113, v215, v223
    s_add_u32 m0, s26, 134656
    s_mov_b64 exec, s[60:61]
    s_mov_b32 s91, 19968
    buffer_load_dwordx4 v15, s[36:39], s91 offen lds
    s_mov_b64 exec, -1
    s_add_u32 m0, s26, 141312
    s_mov_b64 exec, s[60:61]
    s_mov_b32 s91, 26624
    buffer_load_dwordx4 v15, s[36:39], s91 offen lds
    s_mov_b64 exec, -1
    s_add_u32 m0, s26, 147968
    s_mov_b64 exec, s[60:61]
    s_mov_b32 s91, 33280
    buffer_load_dwordx4 v15, s[36:39], s91 offen lds
    s_mov_b64 exec, -1
    s_waitcnt lgkmcnt(7)
    v_mfma_f32_16x16x32_bf16 v[212:215], v[196:199], v[132:135], 0
    ds_read_b128 v[164:167], v8 offset:24576
    v_mfma_f32_16x16x32_bf16 v[212:215], v[200:203], v[136:139], v[212:215]
    ds_read_b128 v[168:171], v9 offset:24576
    s_waitcnt lgkmcnt(7)
    ds_read_b128 v[180:183], v8 offset:28672
    v_mfma_f32_16x16x32_bf16 v[212:215], v[204:207], v[148:151], v[212:215]
    ds_read_b128 v[184:187], v9 offset:28672
    v_mfma_f32_16x16x32_bf16 v[212:215], v[208:211], v[152:155], v[212:215]
    ds_read_b128 v[172:175], v10 offset:24576
    v_cvt_pk_bf16_f32 v117, v216, v224
    v_cvt_pk_bf16_f32 v121, v217, v225
    v_cvt_pk_bf16_f32 v125, v218, v226
    v_cvt_pk_bf16_f32 v129, v219, v227
    s_waitcnt lgkmcnt(8)
    v_mfma_f32_16x16x32_bf16 v[216:219], v[196:199], v[140:143], 0
    ds_read_b128 v[176:179], v11 offset:24576
    v_mfma_f32_16x16x32_bf16 v[216:219], v[200:203], v[144:147], v[216:219]
    ds_read_b128 v[188:191], v10 offset:28672
    s_waitcnt lgkmcnt(8)
    ds_read_b128 v[192:195], v11 offset:28672
    v_mfma_f32_16x16x32_bf16 v[216:219], v[204:207], v[156:159], v[216:219]
    ds_read_b128 v[56:59], v12 offset:24576
    v_mfma_f32_16x16x32_bf16 v[216:219], v[208:211], v[160:163], v[216:219]
    v_permlane16_swap_b32 v101, v117
    v_permlane16_swap_b32 v105, v121
    v_permlane16_swap_b32 v109, v125
    v_permlane16_swap_b32 v113, v129
    s_add_u32 m0, s26, 154624
    s_mov_b64 exec, s[60:61]
    s_mov_b32 s91, 39936
    buffer_load_dwordx4 v15, s[36:39], s91 offen lds
    s_mov_b64 exec, -1
    s_add_u32 m0, s26, 0
    s_mov_b64 exec, s[60:61]
    s_mov_b32 s91, 46592
    buffer_load_dwordx4 v15, s[36:39], s91 offen lds
    s_mov_b64 exec, -1
    s_waitcnt vmcnt(10)
    s_barrier
    s_waitcnt lgkmcnt(7)
    v_mfma_f32_16x16x32_bf16 v[220:223], v[196:199], v[164:167], 0
    ds_read_b128 v[132:135], v8 offset:32768
    v_mfma_f32_16x16x32_bf16 v[220:223], v[200:203], v[168:171], v[220:223]
    ds_read_b128 v[136:139], v9 offset:32768
    s_waitcnt lgkmcnt(7)
    ds_read_b128 v[148:151], v8 offset:36864
    v_mfma_f32_16x16x32_bf16 v[220:223], v[204:207], v[180:183], v[220:223]
    ds_read_b128 v[152:155], v9 offset:36864
    v_mfma_f32_16x16x32_bf16 v[220:223], v[208:211], v[184:187], v[220:223]
    ds_read_b128 v[140:143], v10 offset:32768
    s_waitcnt lgkmcnt(8)
    v_mfma_f32_16x16x32_bf16 v[224:227], v[196:199], v[172:175], 0
    ds_read_b128 v[144:147], v11 offset:32768
    v_mfma_f32_16x16x32_bf16 v[224:227], v[200:203], v[176:179], v[224:227]
    ds_read_b128 v[156:159], v10 offset:36864
    s_waitcnt lgkmcnt(8)
    ds_read_b128 v[160:163], v11 offset:36864
    v_mfma_f32_16x16x32_bf16 v[224:227], v[204:207], v[188:191], v[224:227]
    ds_read_b128 v[52:55], v12 offset:32768
    v_mfma_f32_16x16x32_bf16 v[224:227], v[208:211], v[192:195], v[224:227]
    v_cvt_pk_bf16_f32 v70, v212, v220
    v_cvt_pk_bf16_f32 v74, v213, v221
    v_cvt_pk_bf16_f32 v78, v214, v222
    v_cvt_pk_bf16_f32 v82, v215, v223
    s_add_u32 m0, s26, 6656
    s_mov_b64 exec, s[60:61]
    s_mov_b32 s91, 53248
    buffer_load_dwordx4 v15, s[36:39], s91 offen lds
    s_mov_b64 exec, -1
    s_add_u32 m0, s26, 13312
    s_mov_b64 exec, s[60:61]
    s_mov_b32 s91, 59904
    buffer_load_dwordx4 v15, s[36:39], s91 offen lds
    s_mov_b64 exec, -1
    s_waitcnt lgkmcnt(7)
    v_mfma_f32_16x16x32_bf16 v[212:215], v[196:199], v[132:135], 0
    ds_read_b128 v[164:167], v8 offset:40960
    v_mfma_f32_16x16x32_bf16 v[212:215], v[200:203], v[136:139], v[212:215]
    ds_read_b128 v[168:171], v9 offset:40960
    s_waitcnt lgkmcnt(7)
    ds_read_b128 v[180:183], v8 offset:45056
    v_mfma_f32_16x16x32_bf16 v[212:215], v[204:207], v[148:151], v[212:215]
    ds_read_b128 v[184:187], v9 offset:45056
    v_mfma_f32_16x16x32_bf16 v[212:215], v[208:211], v[152:155], v[212:215]
    ds_read_b128 v[172:175], v10 offset:40960
    v_cvt_pk_bf16_f32 v86, v216, v224
    v_cvt_pk_bf16_f32 v90, v217, v225
    v_cvt_pk_bf16_f32 v94, v218, v226
    v_cvt_pk_bf16_f32 v98, v219, v227
    s_waitcnt lgkmcnt(8)
    v_mfma_f32_16x16x32_bf16 v[216:219], v[196:199], v[140:143], 0
    ds_read_b128 v[176:179], v11 offset:40960
    v_mfma_f32_16x16x32_bf16 v[216:219], v[200:203], v[144:147], v[216:219]
    ds_read_b128 v[188:191], v10 offset:45056
    s_waitcnt lgkmcnt(8)
    ds_read_b128 v[192:195], v11 offset:45056
    v_mfma_f32_16x16x32_bf16 v[216:219], v[204:207], v[156:159], v[216:219]
    ds_read_b128 v[60:63], v12 offset:40960
    v_mfma_f32_16x16x32_bf16 v[216:219], v[208:211], v[160:163], v[216:219]
    v_permlane16_swap_b32 v70, v86
    v_permlane16_swap_b32 v74, v90
    v_permlane16_swap_b32 v78, v94
    v_permlane16_swap_b32 v82, v98
    s_add_u32 m0, s26, 19968
    s_mov_b64 exec, s[60:61]
    s_mov_b32 s91, 66560
    buffer_load_dwordx4 v15, s[36:39], s91 offen lds
    s_mov_b64 exec, -1
    s_add_u32 m0, s26, 26624
    s_mov_b64 exec, s[60:61]
    s_mov_b32 s91, 73216
    buffer_load_dwordx4 v15, s[36:39], s91 offen lds
    s_mov_b64 exec, -1
    s_waitcnt vmcnt(5)
    s_barrier
    s_waitcnt lgkmcnt(7)
    v_mfma_f32_16x16x32_bf16 v[220:223], v[196:199], v[164:167], 0
    ds_read_b128 v[132:135], v8 offset:49152
    v_mfma_f32_16x16x32_bf16 v[220:223], v[200:203], v[168:171], v[220:223]
    ds_read_b128 v[136:139], v9 offset:49152
    s_waitcnt lgkmcnt(7)
    ds_read_b128 v[148:151], v8 offset:53248
    v_mfma_f32_16x16x32_bf16 v[220:223], v[204:207], v[180:183], v[220:223]
    ds_read_b128 v[152:155], v9 offset:53248
    v_mfma_f32_16x16x32_bf16 v[220:223], v[208:211], v[184:187], v[220:223]
    ds_read_b128 v[140:143], v10 offset:49152
    s_waitcnt lgkmcnt(8)
    v_mfma_f32_16x16x32_bf16 v[224:227], v[196:199], v[172:175], 0
    ds_read_b128 v[144:147], v11 offset:49152
    v_mfma_f32_16x16x32_bf16 v[224:227], v[200:203], v[176:179], v[224:227]
    ds_read_b128 v[156:159], v10 offset:53248
    s_waitcnt lgkmcnt(8)
    ds_read_b128 v[160:163], v11 offset:53248
    v_mfma_f32_16x16x32_bf16 v[224:227], v[204:207], v[188:191], v[224:227]
    ds_read_b128 v[64:67], v12 offset:49152
    v_mfma_f32_16x16x32_bf16 v[224:227], v[208:211], v[192:195], v[224:227]
    v_cvt_pk_bf16_f32 v102, v212, v220
    v_cvt_pk_bf16_f32 v106, v213, v221
    v_cvt_pk_bf16_f32 v110, v214, v222
    v_cvt_pk_bf16_f32 v114, v215, v223
    s_add_u32 m0, s26, 33280
    s_mov_b64 exec, s[60:61]
    s_mov_b32 s91, 79872
    buffer_load_dwordx4 v15, s[36:39], s91 offen lds
    s_mov_b64 exec, -1
    s_lshr_b32 s91, s2, 5
    s_lshl_b32 s91, s91, 1
    s_and_b32 s92, s88, 1
    s_add_u32 s91, s91, s92
    v_min_u32 v6, 19, v1
    s_lshl_b32 s91, s91, 3
    s_add_u32 s91, s91, s86
    s_mul_i32 s91, s91, 2560
    s_add_u32 s91, s91, 524288
    v_lshlrev_b32 v6, 7, v6
    buffer_load_dword v0, v6, s[40:43], s91 offen
    s_waitcnt lgkmcnt(7)
    v_mfma_f32_16x16x32_bf16 v[212:215], v[196:199], v[132:135], 0
    v_add_u32 v250, 59904, v7
    v_mfma_f32_16x16x32_bf16 v[212:215], v[200:203], v[136:139], v[212:215]
    v_add_u32 v251, 119808, v7
    s_waitcnt lgkmcnt(5)
    ds_read_b128 v[164:167], v250 offset:54784
    v_mfma_f32_16x16x32_bf16 v[212:215], v[204:207], v[148:151], v[212:215]
    ds_read_b128 v[168:171], v251 offset:1536
    v_mfma_f32_16x16x32_bf16 v[212:215], v[208:211], v[152:155], v[212:215]
    ds_read_b128 v[172:175], v251 offset:8192
    v_cvt_pk_bf16_f32 v118, v216, v224
    v_cvt_pk_bf16_f32 v122, v217, v225
    v_cvt_pk_bf16_f32 v126, v218, v226
    v_cvt_pk_bf16_f32 v130, v219, v227
    s_waitcnt lgkmcnt(6)
    v_mfma_f32_16x16x32_bf16 v[216:219], v[196:199], v[140:143], 0
    ds_read_b128 v[176:179], v251 offset:14848
    v_mfma_f32_16x16x32_bf16 v[216:219], v[200:203], v[144:147], v[216:219]
    ds_read_b128 v[180:183], v251 offset:21504
    s_waitcnt lgkmcnt(6)
    ds_read_b128 v[184:187], v251 offset:28160
    v_mfma_f32_16x16x32_bf16 v[216:219], v[204:207], v[156:159], v[216:219]
    ds_read_b128 v[188:191], v251 offset:34816
    v_mfma_f32_16x16x32_bf16 v[216:219], v[208:211], v[160:163], v[216:219]
    v_permlane16_swap_b32 v102, v118
    v_permlane16_swap_b32 v106, v122
    v_permlane16_swap_b32 v110, v126
    v_permlane16_swap_b32 v114, v130
    v_cvt_pk_bf16_f32 v71, v212, 0
    v_cvt_pk_bf16_f32 v75, v213, 0
    v_cvt_pk_bf16_f32 v79, v214, 0
    v_cvt_pk_bf16_f32 v83, v215, 0
    v_cvt_pk_bf16_f32 v87, v216, 0
    v_cvt_pk_bf16_f32 v91, v217, 0
    v_cvt_pk_bf16_f32 v95, v218, 0
    v_cvt_pk_bf16_f32 v99, v219, 0
    v_permlane16_swap_b32 v71, v87
    v_permlane16_swap_b32 v75, v91
    v_permlane16_swap_b32 v79, v95
    v_permlane16_swap_b32 v83, v99
    v_mov_b32 v8, v250
    v_mov_b32 v9, v251
    s_waitcnt vmcnt(1) lgkmcnt(7)
    s_waitcnt lgkmcnt(0)
    s_barrier
    s_cmp_lg_u32 s86, 3
    s_cbranch_scc1 L_fl3
    s_and_b32 s92, s27, 3
    s_lshl_b32 s92, s92, 2
    s_add_u32 s92, s92, s88
    s_cmp_eq_u32 s92, 2
    s_cbranch_scc0 L_fl3
    v_mov_b32 v6, 1
    s_lshl_b32 s91, s27, 2
    s_mov_b64 exec, 1
    buffer_store_dword v6, off, s[52:55], s91 sc0 sc1
    s_mov_b64 exec, -1
L_fl3:
    ds_read_b128 v[192:195], v7 offset:0
    ds_read_b128 v[132:135], v7 offset:6656
    ds_read_b128 v[136:139], v7 offset:13312
    ds_read_b128 v[140:143], v7 offset:19968
    ds_read_b128 v[144:147], v7 offset:26624
    ds_read_b128 v[148:151], v7 offset:33280
L_ct:
    s_setprio 3
    v_mov_b32 v159, 0
    v_mov_b32 v199, 0
    v_mov_b32 v207, 0
    v_mov_b32 v4, 0
    v_mov_b32 v5, 0
    v_perm_b32 v152, v168, v164, s94
    v_perm_b32 v153, v176, v172, s94
    v_perm_b32 v156, v184, v180, s94
    s_waitcnt lgkmcnt(5)
    v_perm_b32 v157, v192, v188, s94
    s_waitcnt lgkmcnt(3)
    v_perm_b32 v154, v136, v132, s94
    s_waitcnt lgkmcnt(1)
    v_perm_b32 v158, v144, v140, s94
    s_waitcnt lgkmcnt(0)
    v_and_b32 v155, 0xffff, v148
    s_nop 1
    v_mfma_f32_32x32x16_bf16 v[208:223], v[152:155], v[68:71], 0
    v_perm_b32 v160, v168, v164, s95
    v_perm_b32 v161, v176, v172, s95
    v_perm_b32 v196, v184, v180, s95
    v_perm_b32 v197, v192, v188, s95
    v_perm_b32 v162, v136, v132, s95
    v_perm_b32 v198, v144, v140, s95
    v_lshrrev_b32 v163, 16, v148
    v_mfma_f32_32x32x16_bf16 v[208:223], v[156:159], v[100:103], v[208:223]
    v_perm_b32 v200, v169, v165, s94
    v_perm_b32 v201, v177, v173, s94
    v_perm_b32 v204, v185, v181, s94
    v_perm_b32 v205, v193, v189, s94
    v_perm_b32 v202, v137, v133, s94
    v_perm_b32 v206, v145, v141, s94
    v_and_b32 v203, 0xffff, v149
    s_add_u32 m0, s26, 48128
    s_mov_b64 exec, s[60:61]
    s_mov_b32 s91, 86528
    buffer_load_dwordx4 v15, s[36:39], s91 offen lds
    s_mov_b64 exec, -1
    v_mfma_f32_32x32x16_bf16 v[224:239], v[160:163], v[72:75], 0
    v_perm_b32 v152, v169, v165, s95
    v_perm_b32 v153, v177, v173, s95
    v_perm_b32 v156, v185, v181, s95
    v_perm_b32 v157, v193, v189, s95
    v_mfma_f32_32x32x16_bf16 v[224:239], v[196:199], v[104:107], v[224:239]
    v_perm_b32 v154, v137, v133, s95
    v_perm_b32 v158, v145, v141, s95
    v_lshrrev_b32 v155, 16, v149
    s_add_u32 m0, s26, 54784
    s_mov_b64 exec, s[60:61]
    s_mov_b32 s91, 93184
    buffer_load_dwordx4 v15, s[36:39], s91 offen lds
    s_mov_b64 exec, -1
    s_add_u32 m0, s26, 61440
    s_mov_b64 exec, s[60:61]
    s_mov_b32 s91, 99840
    buffer_load_dwordx4 v15, s[36:39], s91 offen lds
    s_mov_b64 exec, -1
    v_mfma_f32_32x32x16_bf16 v[240:255], v[200:203], v[76:79], 0
    v_perm_b32 v160, v170, v166, s94
    v_perm_b32 v161, v178, v174, s94
    v_perm_b32 v196, v186, v182, s94
    v_perm_b32 v197, v194, v190, s94
    v_perm_b32 v162, v138, v134, s94
    v_perm_b32 v198, v146, v142, s94
    v_and_b32 v163, 0xffff, v150
    v_mfma_f32_32x32x16_bf16 v[240:255], v[204:207], v[108:111], v[240:255]
    v_cvt_pk_bf16_f32 v164, v208, v224
    v_cvt_pk_bf16_f32 v168, v209, v225
    v_cvt_pk_bf16_f32 v172, v210, v226
    v_cvt_pk_bf16_f32 v176, v211, v227
    v_cvt_pk_bf16_f32 v180, v212, v228
    v_cvt_pk_bf16_f32 v184, v213, v229
    v_cvt_pk_bf16_f32 v188, v214, v230
    v_cvt_pk_bf16_f32 v192, v215, v231
    v_cvt_pk_bf16_f32 v132, v216, v232
    v_cvt_pk_bf16_f32 v136, v217, v233
    v_cvt_pk_bf16_f32 v140, v218, v234
    v_cvt_pk_bf16_f32 v144, v219, v235
    s_setprio 2
    v_cvt_pk_bf16_f32 v148, v220, v236
    v_mfma_f32_32x32x16_bf16 v[208:223], v[152:155], v[80:83], 0
    v_perm_b32 v200, v170, v166, s95
    v_perm_b32 v201, v178, v174, s95
    v_perm_b32 v204, v186, v182, s95
    v_perm_b32 v205, v194, v190, s95
    v_mfma_f32_32x32x16_bf16 v[208:223], v[156:159], v[112:115], v[208:223]
    v_perm_b32 v202, v138, v134, s95
    v_perm_b32 v206, v146, v142, s95
    v_lshrrev_b32 v203, 16, v150
    s_add_u32 m0, s26, 68096
    s_mov_b64 exec, s[60:61]
    s_mov_b32 s91, 106496
    buffer_load_dwordx4 v15, s[36:39], s91 offen lds
    s_mov_b64 exec, -1
    s_add_u32 m0, s26, 74752
    s_mov_b64 exec, s[60:61]
    s_mov_b32 s91, 113152
    buffer_load_dwordx4 v15, s[36:39], s91 offen lds
    s_mov_b64 exec, -1
    v_mfma_f32_32x32x16_bf16 v[224:239], v[160:163], v[84:87], 0
    v_perm_b32 v152, v171, v167, s94
    v_perm_b32 v153, v179, v175, s94
    v_perm_b32 v156, v187, v183, s94
    v_perm_b32 v157, v195, v191, s94
    v_perm_b32 v154, v139, v135, s94
    v_perm_b32 v158, v147, v143, s94
    v_and_b32 v155, 0xffff, v151
    v_mfma_f32_32x32x16_bf16 v[224:239], v[196:199], v[116:119], v[224:239]
    v_cvt_pk_bf16_f32 v165, v240, v208
    v_cvt_pk_bf16_f32 v169, v241, v209
    v_cvt_pk_bf16_f32 v173, v242, v210
    v_cvt_pk_bf16_f32 v177, v243, v211
    v_cvt_pk_bf16_f32 v181, v244, v212
    v_cvt_pk_bf16_f32 v185, v245, v213
    v_cvt_pk_bf16_f32 v189, v246, v214
    v_cvt_pk_bf16_f32 v193, v247, v215
    v_cvt_pk_bf16_f32 v133, v248, v216
    v_cvt_pk_bf16_f32 v137, v249, v217
    v_cvt_pk_bf16_f32 v141, v250, v218
    v_cvt_pk_bf16_f32 v145, v251, v219
    v_cvt_pk_bf16_f32 v149, v252, v220
    v_mfma_f32_32x32x16_bf16 v[240:255], v[200:203], v[88:91], 0
    v_perm_b32 v160, v171, v167, s95
    v_perm_b32 v161, v179, v175, s95
    v_perm_b32 v196, v187, v183, s95
    v_perm_b32 v197, v195, v191, s95
    v_mfma_f32_32x32x16_bf16 v[240:255], v[204:207], v[120:123], v[240:255]
    v_perm_b32 v162, v139, v135, s95
    v_perm_b32 v198, v147, v143, s95
    v_lshrrev_b32 v163, 16, v151
    s_add_u32 m0, s26, 81408
    s_mov_b64 exec, s[60:61]
    s_mov_b32 s91, 119808
    buffer_load_dwordx4 v15, s[36:39], s91 offen lds
    s_mov_b64 exec, -1
    s_add_u32 m0, s26, 88064
    s_mov_b64 exec, s[60:61]
    s_mov_b32 s91, 126464
    buffer_load_dwordx4 v15, s[36:39], s91 offen lds
    s_mov_b64 exec, -1
    v_mfma_f32_32x32x16_bf16 v[208:223], v[152:155], v[92:95], 0
    s_add_u32 m0, s26, 94720
    s_mov_b64 exec, s[60:61]
    s_mov_b32 s91, 133120
    buffer_load_dwordx4 v15, s[36:39], s91 offen lds
    s_mov_b64 exec, -1
    v_mfma_f32_32x32x16_bf16 v[208:223], v[156:159], v[124:127], v[208:223]
    v_cvt_pk_bf16_f32 v166, v224, v240
    v_cvt_pk_bf16_f32 v170, v225, v241
    v_cvt_pk_bf16_f32 v174, v226, v242
    v_cvt_pk_bf16_f32 v178, v227, v243
    v_cvt_pk_bf16_f32 v182, v228, v244
    v_cvt_pk_bf16_f32 v186, v229, v245
    v_cvt_pk_bf16_f32 v190, v230, v246
    v_cvt_pk_bf16_f32 v194, v231, v247
    v_cvt_pk_bf16_f32 v134, v232, v248
    v_cvt_pk_bf16_f32 v138, v233, v249
    v_cvt_pk_bf16_f32 v142, v234, v250
    v_cvt_pk_bf16_f32 v146, v235, v251
    v_cvt_pk_bf16_f32 v150, v236, v252
    v_mfma_f32_32x32x16_bf16 v[224:239], v[160:163], v[96:99], 0
    v_mfma_f32_32x32x16_bf16 v[224:239], v[196:199], v[128:131], v[224:239]
    s_add_u32 m0, s26, 101376
    s_mov_b64 exec, s[60:61]
    s_mov_b32 s91, 139776
    buffer_load_dwordx4 v15, s[36:39], s91 offen lds
    s_setprio 1
    s_mov_b64 exec, -1
    s_add_u32 m0, s26, 108032
    s_mov_b64 exec, s[60:61]
    s_mov_b32 s91, 146432
    buffer_load_dwordx4 v15, s[36:39], s91 offen lds
    s_mov_b64 exec, -1
    ds_read_b64 v[152:153], v13 offset:44032
    v_cvt_pk_bf16_f32 v167, v208, v224
    v_cvt_pk_bf16_f32 v171, v209, v225
    ds_read_b128 v[240:243], v13 offset:39936
    v_cvt_pk_bf16_f32 v175, v210, v226
    v_cvt_pk_bf16_f32 v179, v211, v227
    ds_read_b64 v[154:155], v13 offset:44544
    v_cvt_pk_bf16_f32 v183, v212, v228
    v_cvt_pk_bf16_f32 v187, v213, v229
    ds_read_b128 v[244:247], v13 offset:40448
    v_cvt_pk_bf16_f32 v191, v214, v230
    v_cvt_pk_bf16_f32 v195, v215, v231
    ds_read_b64 v[200:201], v13 offset:45056
    v_cvt_pk_bf16_f32 v135, v216, v232
    v_cvt_pk_bf16_f32 v139, v217, v233
    ds_read_b128 v[248:251], v13 offset:40960
    v_cvt_pk_bf16_f32 v143, v218, v234
    v_cvt_pk_bf16_f32 v147, v219, v235
    ds_read_b64 v[202:203], v13 offset:45568
    v_cvt_pk_bf16_f32 v151, v220, v236
    ds_read_b128 v[252:255], v13 offset:41472
    v_dot2c_f32_bf16 v4, v164, v16
    v_dot2c_f32_bf16 v5, v168, v20
    v_dot2c_f32_bf16 v4, v172, v24
    v_dot2c_f32_bf16 v5, v176, v28
    v_dot2c_f32_bf16 v4, v180, v32
    v_dot2c_f32_bf16 v5, v184, v36
    v_dot2c_f32_bf16 v4, v188, v40
    v_dot2c_f32_bf16 v5, v192, v44
    v_dot2c_f32_bf16 v4, v132, v48
    v_dot2c_f32_bf16 v5, v136, v52
    v_dot2c_f32_bf16 v4, v140, v56
    v_dot2c_f32_bf16 v5, v144, v60
    v_dot2c_f32_bf16 v4, v148, v64
    v_dot2c_f32_bf16 v4, v165, v17
    v_dot2c_f32_bf16 v5, v169, v21
    v_dot2c_f32_bf16 v4, v173, v25
    v_dot2c_f32_bf16 v5, v177, v29
    v_dot2c_f32_bf16 v4, v181, v33
    v_dot2c_f32_bf16 v5, v185, v37
    v_dot2c_f32_bf16 v4, v189, v41
    v_dot2c_f32_bf16 v5, v193, v45
    v_dot2c_f32_bf16 v4, v133, v49
    v_dot2c_f32_bf16 v5, v137, v53
    v_dot2c_f32_bf16 v4, v141, v57
    v_dot2c_f32_bf16 v5, v145, v61
    v_dot2c_f32_bf16 v4, v149, v65
    v_dot2c_f32_bf16 v4, v166, v18
    v_dot2c_f32_bf16 v5, v170, v22
    v_dot2c_f32_bf16 v4, v174, v26
    v_dot2c_f32_bf16 v5, v178, v30
    v_dot2c_f32_bf16 v4, v182, v34
    v_dot2c_f32_bf16 v5, v186, v38
    v_dot2c_f32_bf16 v4, v190, v42
    v_dot2c_f32_bf16 v5, v194, v46
    v_dot2c_f32_bf16 v4, v134, v50
    v_dot2c_f32_bf16 v5, v138, v54
    v_dot2c_f32_bf16 v4, v142, v58
    v_dot2c_f32_bf16 v5, v146, v62
    v_dot2c_f32_bf16 v4, v150, v66
    v_dot2c_f32_bf16 v4, v167, v19
    v_dot2c_f32_bf16 v5, v171, v23
    v_dot2c_f32_bf16 v4, v175, v27
    v_dot2c_f32_bf16 v5, v179, v31
    v_dot2c_f32_bf16 v4, v183, v35
    v_dot2c_f32_bf16 v5, v187, v39
    v_dot2c_f32_bf16 v4, v191, v43
    v_dot2c_f32_bf16 v5, v195, v47
    v_dot2c_f32_bf16 v4, v135, v51
    v_dot2c_f32_bf16 v5, v139, v55
    v_dot2c_f32_bf16 v4, v143, v59
    v_dot2c_f32_bf16 v5, v147, v63
    v_dot2c_f32_bf16 v4, v151, v67
    s_waitcnt lgkmcnt(6)
    v_dot2_f32_bf16 v208, v68, v152, 0
    v_dot2_f32_bf16 v209, v68, v242, 0
    v_dot2_f32_bf16 v210, v100, v153, 0
    s_add_u32 m0, s26, 114688
    s_mov_b64 exec, s[60:61]
    s_mov_b32 s91, 153088
    buffer_load_dwordx4 v15, s[36:39], s91 offen lds
    s_mov_b64 exec, -1
    v_dot2_f32_bf16 v211, v100, v243, 0
    s_waitcnt lgkmcnt(4)
    v_dot2_f32_bf16 v212, v69, v154, 0
    v_dot2_f32_bf16 v213, v69, v246, 0
    v_dot2_f32_bf16 v214, v101, v155, 0
    v_dot2_f32_bf16 v215, v101, v247, 0
    s_waitcnt lgkmcnt(2)
    v_dot2_f32_bf16 v216, v70, v200, 0
    v_dot2_f32_bf16 v217, v70, v250, 0
    v_dot2_f32_bf16 v218, v102, v201, 0
    s_add_u32 m0, s26, 121344
    s_mov_b64 exec, s[60:61]
    s_mov_b32 s91, 159744
    buffer_load_dwordx4 v15, s[36:39], s91 offen lds
    s_mov_b64 exec, -1
    v_dot2_f32_bf16 v219, v102, v251, 0
    s_waitcnt lgkmcnt(0)
    v_dot2_f32_bf16 v220, v71, v202, 0
    v_cvt_pk_bf16_f32 v68, v208, v209
    v_cvt_pk_bf16_f32 v100, v210, v211
    s_setprio 0
    v_cvt_pk_bf16_f32 v69, v212, v213
    v_cvt_pk_bf16_f32 v101, v214, v215
    v_cvt_pk_bf16_f32 v70, v216, v217
    v_cvt_pk_bf16_f32 v102, v218, v219
    v_cvt_pk_bf16_f32 v71, v220, 0
    s_add_u32 m0, s26, 128000
    s_mov_b64 exec, s[60:61]
    s_mov_b32 s91, 166400
    buffer_load_dwordx4 v15, s[36:39], s91 offen lds
    s_mov_b64 exec, -1
    v_dot2_f32_bf16 v221, v72, v152, 0
    v_dot2_f32_bf16 v222, v72, v242, 0
    v_dot2_f32_bf16 v223, v104, v153, 0
    v_dot2_f32_bf16 v224, v104, v243, 0
    v_dot2_f32_bf16 v225, v73, v154, 0
    v_dot2_f32_bf16 v226, v73, v246, 0
    v_dot2_f32_bf16 v227, v105, v155, 0
    v_dot2_f32_bf16 v228, v105, v247, 0
    v_dot2_f32_bf16 v229, v74, v200, 0
    v_dot2_f32_bf16 v230, v74, v250, 0
    v_dot2_f32_bf16 v231, v106, v201, 0
    v_dot2_f32_bf16 v232, v106, v251, 0
    v_dot2_f32_bf16 v233, v75, v202, 0
    v_cvt_pk_bf16_f32 v72, v221, v222
    v_cvt_pk_bf16_f32 v104, v223, v224
    v_cvt_pk_bf16_f32 v73, v225, v226
    v_cvt_pk_bf16_f32 v105, v227, v228
    v_cvt_pk_bf16_f32 v74, v229, v230
    v_cvt_pk_bf16_f32 v106, v231, v232
    v_cvt_pk_bf16_f32 v75, v233, 0
    v_dot2_f32_bf16 v208, v76, v152, 0
    v_dot2_f32_bf16 v209, v76, v242, 0
    v_dot2_f32_bf16 v210, v108, v153, 0
    v_dot2_f32_bf16 v211, v108, v243, 0
    v_dot2_f32_bf16 v212, v77, v154, 0
    v_dot2_f32_bf16 v213, v77, v246, 0
    v_dot2_f32_bf16 v214, v109, v155, 0
    v_dot2_f32_bf16 v215, v109, v247, 0
    v_dot2_f32_bf16 v216, v78, v200, 0
    v_dot2_f32_bf16 v217, v78, v250, 0
    v_dot2_f32_bf16 v218, v110, v201, 0
    v_dot2_f32_bf16 v219, v110, v251, 0
    v_dot2_f32_bf16 v220, v79, v202, 0
    v_cvt_pk_bf16_f32 v76, v208, v209
    v_cvt_pk_bf16_f32 v108, v210, v211
    v_cvt_pk_bf16_f32 v77, v212, v213
    v_cvt_pk_bf16_f32 v109, v214, v215
    v_cvt_pk_bf16_f32 v78, v216, v217
    v_cvt_pk_bf16_f32 v110, v218, v219
    v_cvt_pk_bf16_f32 v79, v220, 0
    v_dot2_f32_bf16 v221, v80, v152, 0
    v_dot2_f32_bf16 v222, v80, v242, 0
    v_dot2_f32_bf16 v223, v112, v153, 0
    v_dot2_f32_bf16 v224, v112, v243, 0
    v_dot2_f32_bf16 v225, v81, v154, 0
    v_dot2_f32_bf16 v226, v81, v246, 0
    v_dot2_f32_bf16 v227, v113, v155, 0
    v_dot2_f32_bf16 v228, v113, v247, 0
    v_dot2_f32_bf16 v229, v82, v200, 0
    v_dot2_f32_bf16 v230, v82, v250, 0
    v_dot2_f32_bf16 v231, v114, v201, 0
    v_dot2_f32_bf16 v232, v114, v251, 0
    v_dot2_f32_bf16 v233, v83, v202, 0
    v_cvt_pk_bf16_f32 v80, v221, v222
    v_cvt_pk_bf16_f32 v112, v223, v224
    v_cvt_pk_bf16_f32 v81, v225, v226
    v_cvt_pk_bf16_f32 v113, v227, v228
    v_cvt_pk_bf16_f32 v82, v229, v230
    v_cvt_pk_bf16_f32 v114, v231, v232
    v_cvt_pk_bf16_f32 v83, v233, 0
    v_dot2_f32_bf16 v208, v84, v152, 0
    v_dot2_f32_bf16 v209, v84, v242, 0
    v_dot2_f32_bf16 v210, v116, v153, 0
    v_dot2_f32_bf16 v211, v116, v243, 0
    v_dot2_f32_bf16 v212, v85, v154, 0
    v_dot2_f32_bf16 v213, v85, v246, 0
    v_dot2_f32_bf16 v214, v117, v155, 0
    v_dot2_f32_bf16 v215, v117, v247, 0
    v_dot2_f32_bf16 v216, v86, v200, 0
    v_dot2_f32_bf16 v217, v86, v250, 0
    v_dot2_f32_bf16 v218, v118, v201, 0
    v_dot2_f32_bf16 v219, v118, v251, 0
    v_dot2_f32_bf16 v220, v87, v202, 0
    v_cvt_pk_bf16_f32 v84, v208, v209
    v_cvt_pk_bf16_f32 v116, v210, v211
    v_cvt_pk_bf16_f32 v85, v212, v213
    v_cvt_pk_bf16_f32 v117, v214, v215
    v_cvt_pk_bf16_f32 v86, v216, v217
    v_cvt_pk_bf16_f32 v118, v218, v219
    v_cvt_pk_bf16_f32 v87, v220, 0
    s_waitcnt vmcnt(0)
    s_barrier
    s_setprio 3
    s_cmp_lg_u32 s86, 0
    s_cbranch_scc1 L_f4
    s_lshr_b32 s91, s27, 2
    s_lshl_b32 s91, s91, 4
    buffer_load_dword v6, off, s[52:55], s91 sc0 sc1
L_f4:
    ds_read_b128 v[164:167], v7 offset:48128
    v_dot2_f32_bf16 v221, v88, v152, 0
    v_dot2_f32_bf16 v222, v88, v242, 0
    v_dot2_f32_bf16 v223, v120, v153, 0
    ds_read_b128 v[168:171], v7 offset:54784
    v_dot2_f32_bf16 v224, v120, v243, 0
    v_dot2_f32_bf16 v225, v89, v154, 0
    v_dot2_f32_bf16 v226, v89, v246, 0
    ds_read_b128 v[172:175], v8 offset:1536
    v_dot2_f32_bf16 v227, v121, v155, 0
    v_dot2_f32_bf16 v228, v121, v247, 0
    v_dot2_f32_bf16 v229, v90, v200, 0
    ds_read_b128 v[176:179], v8 offset:8192
    v_dot2_f32_bf16 v230, v90, v250, 0
    v_dot2_f32_bf16 v231, v122, v201, 0
    v_dot2_f32_bf16 v232, v122, v251, 0
    ds_read_b128 v[180:183], v8 offset:14848
    v_dot2_f32_bf16 v233, v91, v202, 0
    v_cvt_pk_bf16_f32 v88, v221, v222
    v_cvt_pk_bf16_f32 v120, v223, v224
    v_cvt_pk_bf16_f32 v89, v225, v226
    ds_read_b128 v[184:187], v8 offset:21504
    v_cvt_pk_bf16_f32 v121, v227, v228
    v_cvt_pk_bf16_f32 v90, v229, v230
    v_cvt_pk_bf16_f32 v122, v231, v232
    v_cvt_pk_bf16_f32 v91, v233, 0
    ds_read_b128 v[188:191], v8 offset:28160
    v_dot2_f32_bf16 v208, v92, v152, 0
    v_dot2_f32_bf16 v209, v92, v242, 0
    v_dot2_f32_bf16 v210, v124, v153, 0
    ds_read_b128 v[192:195], v8 offset:34816
    v_dot2_f32_bf16 v211, v124, v243, 0
    v_dot2_f32_bf16 v212, v93, v154, 0
    v_dot2_f32_bf16 v213, v93, v246, 0
    ds_read_b128 v[132:135], v8 offset:41472
    v_dot2_f32_bf16 v214, v125, v155, 0
    v_dot2_f32_bf16 v215, v125, v247, 0
    v_dot2_f32_bf16 v216, v94, v200, 0
    ds_read_b128 v[136:139], v8 offset:48128
    v_dot2_f32_bf16 v217, v94, v250, 0
    v_dot2_f32_bf16 v218, v126, v201, 0
    v_dot2_f32_bf16 v219, v126, v251, 0
    ds_read_b128 v[140:143], v8 offset:54784
    v_dot2_f32_bf16 v220, v95, v202, 0
    v_cvt_pk_bf16_f32 v92, v208, v209
    v_cvt_pk_bf16_f32 v124, v210, v211
    v_cvt_pk_bf16_f32 v93, v212, v213
    ds_read_b128 v[144:147], v9 offset:1536
    v_cvt_pk_bf16_f32 v125, v214, v215
    v_cvt_pk_bf16_f32 v94, v216, v217
    v_cvt_pk_bf16_f32 v126, v218, v219
    v_cvt_pk_bf16_f32 v95, v220, 0
    ds_read_b128 v[148:151], v9 offset:8192
    v_dot2_f32_bf16 v221, v96, v152, 0
    v_dot2_f32_bf16 v222, v96, v242, 0
    v_dot2_f32_bf16 v223, v128, v153, 0
    v_dot2_f32_bf16 v224, v128, v243, 0
    v_dot2_f32_bf16 v225, v97, v154, 0
    v_dot2_f32_bf16 v226, v97, v246, 0
    v_dot2_f32_bf16 v227, v129, v155, 0
    v_dot2_f32_bf16 v228, v129, v247, 0
    v_dot2_f32_bf16 v229, v98, v200, 0
    v_dot2_f32_bf16 v230, v98, v250, 0
    v_dot2_f32_bf16 v231, v130, v201, 0
    v_dot2_f32_bf16 v232, v130, v251, 0
    v_dot2_f32_bf16 v233, v99, v202, 0
    v_cvt_pk_bf16_f32 v96, v221, v222
    v_cvt_pk_bf16_f32 v128, v223, v224
    v_cvt_pk_bf16_f32 v97, v225, v226
    v_cvt_pk_bf16_f32 v129, v227, v228
    s_setprio 2
    v_cvt_pk_bf16_f32 v98, v229, v230
    v_cvt_pk_bf16_f32 v130, v231, v232
    v_cvt_pk_bf16_f32 v99, v233, 0
    s_waitcnt lgkmcnt(11)
    v_perm_b32 v152, v168, v164, s94
    s_waitcnt lgkmcnt(9)
    v_perm_b32 v153, v176, v172, s94
    s_waitcnt lgkmcnt(7)
    v_perm_b32 v156, v184, v180, s94
    s_waitcnt lgkmcnt(5)
    v_perm_b32 v157, v192, v188, s94
    s_waitcnt lgkmcnt(3)
    v_perm_b32 v154, v136, v132, s94
    s_waitcnt lgkmcnt(1)
    v_perm_b32 v158, v144, v140, s94
    s_waitcnt lgkmcnt(0)
    v_and_b32 v155, 0xffff, v148
    s_nop 1
    v_mfma_f32_32x32x16_bf16 v[208:223], v[152:155], v[68:71], 0
    v_perm_b32 v160, v168, v164, s95
    v_perm_b32 v161, v176, v172, s95
    v_perm_b32 v196, v184, v180, s95
    v_perm_b32 v197, v192, v188, s95
    v_perm_b32 v162, v136, v132, s95
    v_perm_b32 v198, v144, v140, s95
    v_lshrrev_b32 v163, 16, v148
    v_mfma_f32_32x32x16_bf16 v[208:223], v[156:159], v[100:103], v[208:223]
    v_perm_b32 v200, v169, v165, s94
    v_perm_b32 v201, v177, v173, s94
    v_perm_b32 v204, v185, v181, s94
    v_perm_b32 v205, v193, v189, s94
    v_perm_b32 v202, v137, v133, s94
    v_perm_b32 v206, v145, v141, s94
    v_and_b32 v203, 0xffff, v149
    v_mfma_f32_32x32x16_bf16 v[224:239], v[160:163], v[72:75], 0
    v_perm_b32 v152, v169, v165, s95
    v_perm_b32 v153, v177, v173, s95
    v_perm_b32 v156, v185, v181, s95
    v_perm_b32 v157, v193, v189, s95
    v_mfma_f32_32x32x16_bf16 v[224:239], v[196:199], v[104:107], v[224:239]
    v_perm_b32 v154, v137, v133, s95
    v_perm_b32 v158, v145, v141, s95
    v_lshrrev_b32 v155, 16, v149
    v_mfma_f32_32x32x16_bf16 v[240:255], v[200:203], v[76:79], 0
    v_perm_b32 v160, v170, v166, s94
    v_perm_b32 v161, v178, v174, s94
    v_perm_b32 v196, v186, v182, s94
    v_perm_b32 v197, v194, v190, s94
    v_perm_b32 v162, v138, v134, s94
    v_perm_b32 v198, v146, v142, s94
    v_and_b32 v163, 0xffff, v150
    v_mfma_f32_32x32x16_bf16 v[240:255], v[204:207], v[108:111], v[240:255]
    v_cvt_pk_bf16_f32 v164, v208, v224
    v_cvt_pk_bf16_f32 v168, v209, v225
    v_cvt_pk_bf16_f32 v172, v210, v226
    v_cvt_pk_bf16_f32 v176, v211, v227
    v_cvt_pk_bf16_f32 v180, v212, v228
    v_cvt_pk_bf16_f32 v184, v213, v229
    v_cvt_pk_bf16_f32 v188, v214, v230
    v_cvt_pk_bf16_f32 v192, v215, v231
    v_cvt_pk_bf16_f32 v132, v216, v232
    v_cvt_pk_bf16_f32 v136, v217, v233
    s_setprio 1
    v_cvt_pk_bf16_f32 v140, v218, v234
    v_cvt_pk_bf16_f32 v144, v219, v235
    v_cvt_pk_bf16_f32 v148, v220, v236
    v_mfma_f32_32x32x16_bf16 v[208:223], v[152:155], v[80:83], 0
    v_perm_b32 v200, v170, v166, s95
    v_perm_b32 v201, v178, v174, s95
    v_perm_b32 v204, v186, v182, s95
    v_perm_b32 v205, v194, v190, s95
    v_mfma_f32_32x32x16_bf16 v[208:223], v[156:159], v[112:115], v[208:223]
    v_perm_b32 v202, v138, v134, s95
    v_perm_b32 v206, v146, v142, s95
    v_lshrrev_b32 v203, 16, v150
    v_mfma_f32_32x32x16_bf16 v[224:239], v[160:163], v[84:87], 0
    v_perm_b32 v152, v171, v167, s94
    v_perm_b32 v153, v179, v175, s94
    v_perm_b32 v156, v187, v183, s94
    v_perm_b32 v157, v195, v191, s94
    v_perm_b32 v154, v139, v135, s94
    v_perm_b32 v158, v147, v143, s94
    v_and_b32 v155, 0xffff, v151
    v_mfma_f32_32x32x16_bf16 v[224:239], v[196:199], v[116:119], v[224:239]
    v_cvt_pk_bf16_f32 v165, v240, v208
    v_cvt_pk_bf16_f32 v169, v241, v209
    v_cvt_pk_bf16_f32 v173, v242, v210
    v_cvt_pk_bf16_f32 v177, v243, v211
    v_cvt_pk_bf16_f32 v181, v244, v212
    v_cvt_pk_bf16_f32 v185, v245, v213
    v_cvt_pk_bf16_f32 v189, v246, v214
    v_cvt_pk_bf16_f32 v193, v247, v215
    v_cvt_pk_bf16_f32 v133, v248, v216
    v_cvt_pk_bf16_f32 v137, v249, v217
    v_cvt_pk_bf16_f32 v141, v250, v218
    v_cvt_pk_bf16_f32 v145, v251, v219
    v_cvt_pk_bf16_f32 v149, v252, v220
    ds_read_b128 v[76:79], v13 offset:39936
    v_mfma_f32_32x32x16_bf16 v[240:255], v[200:203], v[88:91], 0
    v_perm_b32 v160, v171, v167, s95
    v_perm_b32 v161, v179, v175, s95
    v_perm_b32 v196, v187, v183, s95
    v_perm_b32 v197, v195, v191, s95
    v_mfma_f32_32x32x16_bf16 v[240:255], v[204:207], v[120:123], v[240:255]
    v_perm_b32 v162, v139, v135, s95
    v_perm_b32 v198, v147, v143, s95
    v_lshrrev_b32 v163, 16, v151
    ds_read_b128 v[80:83], v13 offset:40448
    v_mfma_f32_32x32x16_bf16 v[208:223], v[152:155], v[92:95], 0
    ds_read_b128 v[108:111], v13 offset:40960
    v_mfma_f32_32x32x16_bf16 v[208:223], v[156:159], v[124:127], v[208:223]
    s_nop 4
    v_cvt_pk_bf16_f32 v166, v224, v240
    v_cvt_pk_bf16_f32 v170, v225, v241
    v_cvt_pk_bf16_f32 v174, v226, v242
    v_cvt_pk_bf16_f32 v178, v227, v243
    v_cvt_pk_bf16_f32 v182, v228, v244
    v_cvt_pk_bf16_f32 v186, v229, v245
    v_cvt_pk_bf16_f32 v190, v230, v246
    v_cvt_pk_bf16_f32 v194, v231, v247
    v_cvt_pk_bf16_f32 v134, v232, v248
    v_cvt_pk_bf16_f32 v138, v233, v249
    v_cvt_pk_bf16_f32 v142, v234, v250
    v_cvt_pk_bf16_f32 v146, v235, v251
    v_cvt_pk_bf16_f32 v150, v236, v252
    v_mfma_f32_32x32x16_bf16 v[224:239], v[160:163], v[96:99], 0
    s_min_u32 s93, s88, 2
    s_and_b32 s91, s93, 1
    s_lshl_b32 s91, s91, 4
    s_cmp_lt_u32 s88, 2
    s_cselect_b32 s92, -1, 0
    s_setprio 0
    s_cselect_b32 s93, 0, -1
    v_mfma_f32_32x32x16_bf16 v[224:239], v[196:199], v[128:131], v[224:239]
    s_lshl_b32 s90, s27, 9
    s_mov_b32 s3, 0x40000
    v_lshlrev_b32 v9, 3, v1
    v_lshlrev_b32 v8, 5, v1
    v_add_u32 v8, 161280, v8
    ds_read_b128 v[112:115], v13 offset:41472
    s_nop 5
    v_cvt_pk_bf16_f32 v167, v208, v224
    v_cvt_pk_bf16_f32 v171, v209, v225
    v_cvt_pk_bf16_f32 v175, v210, v226
    v_cvt_pk_bf16_f32 v179, v211, v227
    v_cvt_pk_bf16_f32 v183, v212, v228
    v_cvt_pk_bf16_f32 v187, v213, v229
    v_cvt_pk_bf16_f32 v191, v214, v230
    v_cvt_pk_bf16_f32 v195, v215, v231
    v_cvt_pk_bf16_f32 v135, v216, v232
    v_cvt_pk_bf16_f32 v139, v217, v233
    v_cvt_pk_bf16_f32 v143, v218, v234
    v_cvt_pk_bf16_f32 v147, v219, v235
    v_cvt_pk_bf16_f32 v151, v220, v236
    v_dot2_f32_bf16 v68, v164, v16, 0
    v_dot2_f32_bf16 v69, v168, v20, 0
    v_dot2_f32_bf16 v70, v172, v24, 0
    v_dot2_f32_bf16 v71, v176, v28, 0
    v_dot2_f32_bf16 v72, v180, v32, 0
    v_dot2_f32_bf16 v73, v184, v36, 0
    v_dot2_f32_bf16 v74, v188, v40, 0
    v_dot2_f32_bf16 v75, v192, v44, 0
    v_dot2_f32_bf16 v100, v132, v48, 0
    v_dot2_f32_bf16 v101, v136, v52, 0
    v_dot2_f32_bf16 v102, v140, v56, 0
    v_dot2_f32_bf16 v103, v144, v60, 0
    v_dot2_f32_bf16 v104, v148, v64, 0
    v_dot2c_f32_bf16 v68, v165, v17
    v_dot2c_f32_bf16 v69, v169, v21
    v_dot2c_f32_bf16 v70, v173, v25
    v_dot2c_f32_bf16 v71, v177, v29
    v_dot2c_f32_bf16 v72, v181, v33
    v_dot2c_f32_bf16 v73, v185, v37
    v_dot2c_f32_bf16 v74, v189, v41
    v_dot2c_f32_bf16 v75, v193, v45
    v_dot2c_f32_bf16 v100, v133, v49
    v_dot2c_f32_bf16 v101, v137, v53
    v_dot2c_f32_bf16 v102, v141, v57
    v_dot2c_f32_bf16 v103, v145, v61
    v_dot2c_f32_bf16 v104, v149, v65
    v_dot2c_f32_bf16 v68, v166, v18
    v_dot2c_f32_bf16 v69, v170, v22
    v_dot2c_f32_bf16 v70, v174, v26
    v_dot2c_f32_bf16 v71, v178, v30
    v_dot2c_f32_bf16 v72, v182, v34
    v_dot2c_f32_bf16 v73, v186, v38
    v_dot2c_f32_bf16 v74, v190, v42
    v_dot2c_f32_bf16 v75, v194, v46
    v_dot2c_f32_bf16 v100, v134, v50
    v_dot2c_f32_bf16 v101, v138, v54
    v_dot2c_f32_bf16 v102, v142, v58
    v_dot2c_f32_bf16 v103, v146, v62
    v_dot2c_f32_bf16 v104, v150, v66
    v_dot2c_f32_bf16 v68, v167, v19
    v_dot2c_f32_bf16 v69, v171, v23
    v_dot2c_f32_bf16 v70, v175, v27
    v_dot2c_f32_bf16 v71, v179, v31
    v_dot2c_f32_bf16 v72, v183, v35
    v_dot2c_f32_bf16 v73, v187, v39
    v_dot2c_f32_bf16 v74, v191, v43
    v_dot2c_f32_bf16 v75, v195, v47
    v_dot2c_f32_bf16 v100, v135, v51
    v_dot2c_f32_bf16 v101, v139, v55
    v_dot2c_f32_bf16 v102, v143, v59
    v_dot2c_f32_bf16 v103, v147, v63
    v_dot2c_f32_bf16 v104, v151, v67
    s_waitcnt lgkmcnt(0)
    s_nop 1
    v_fmac_f32 v4, v112, v104
    v_pk_mul_f32 v[208:209], v[76:77], v[68:69]
    v_pk_mul_f32 v[210:211], v[78:79], v[70:71]
    v_pk_fma_f32 v[4:5], v[80:81], v[72:73], v[4:5]
    v_pk_fma_f32 v[208:209], v[82:83], v[74:75], v[208:209]
    v_pk_fma_f32 v[210:211], v[108:109], v[100:101], v[210:211]
    v_pk_fma_f32 v[4:5], v[110:111], v[102:103], v[4:5]
    v_pk_add_f32 v[208:209], v[208:209], v[210:211]
    v_pk_add_f32 v[4:5], v[4:5], v[208:209]
    v_add_f32 v208, v4, v5
    v_add_f32 v5, v4, v5
    v_mov_b32 v4, v208
    s_nop 1
    v_permlane32_swap_b32 v4, v5
    v_add_f32 v4, v4, v5
    ds_write_b32 v2, v4
L_final:
    s_waitcnt lgkmcnt(0)
    s_barrier
    s_cmp_lg_u32 s86, 0
    s_cbranch_scc1 L_end
    ds_read_b128 v[240:243], v8 offset:0
    ds_read_b128 v[244:247], v8 offset:16
    s_waitcnt vmcnt(0)
L_spin:
    v_readfirstlane_b32 s89, v6
    s_nop 0
    s_cmp_eq_u32 s89, 1
    s_cbranch_scc1 L_go
    s_sleep 2
    s_lshr_b32 s89, s27, 2
    s_lshl_b32 s89, s89, 4
    buffer_load_dword v6, off, s[52:55], s89 sc0 sc1
    s_waitcnt vmcnt(0)
    s_sub_u32 s3, s3, 1
    s_cbranch_scc0 L_spin
L_go:
    s_cmp_eq_u32 s88, 2
    s_cselect_b32 exec_hi, 0, -1
    s_cmp_eq_u32 s88, 3
    s_cselect_b32 exec_lo, 0, -1
    s_waitcnt lgkmcnt(0)
    v_pk_add_f32 v[240:241], v[240:241], v[244:245]
    v_pk_add_f32 v[242:243], v[242:243], v[246:247]
    v_pk_add_f32 v[240:241], v[240:241], v[242:243]
    v_add_f32 v240, v240, v241
    v_cvt_pk_bf16_f32 v241, v240, 0
    v_cmp_eq_u32 s[44:45], 0, v241
    v_mov_b32 v242, 0x8000
    v_lshlrev_b32 v10, 1, v1
    v_cndmask_b32 v241, v241, v242, s[44:45]
    v_lshlrev_b32 v241, s91, v241
    v_and_b32 v248, s92, v241
    v_and_b32 v249, s93, v241
    buffer_atomic_or_x2 v[248:249], v9, s[56:59], s90 offen sc0 sc1
    v_and_b32 v244, s92, v241
    v_and_b32 v245, s93, v241
    s_lshl_b32 s92, s87, 7
    s_waitcnt vmcnt(0)
    v_or_b32 v248, v248, v244
    v_or_b32 v249, v249, v245
    v_lshlrev_b32 v240, 16, v248
    v_and_b32 v241, 0xffff0000, v248
    v_lshlrev_b32 v242, 16, v249
    v_min3_u32 v244, v240, v241, v242
    v_cmp_ne_u32 vcc, 0, v244
    v_add_f32 v240, v240, v241
    s_and_b64 exec, exec, vcc
    s_cbranch_execz L_end
    v_add_f32 v240, v240, v242
    v_cvt_pk_bf16_f32 v240, v240, v240
    buffer_store_short v240, v10, s[48:51], s92 offen
L_end:
    s_endpgm
.section .rodata,"a"
.p2align 6
.amdhsa_kernel standalone__deep_cross_fibinet__recsys_kernel
  .amdhsa_next_free_vgpr 256
  .amdhsa_next_free_sgpr 102
  .amdhsa_accum_offset 256
  .amdhsa_group_segment_fixed_size 0
  .amdhsa_kernarg_size 88
  .amdhsa_user_sgpr_count 2
  .amdhsa_user_sgpr_kernarg_segment_ptr 1
  .amdhsa_system_sgpr_workgroup_id_x 1
.end_amdhsa_kernel
```
